```python
import torch

def _softmax(x, axis=-1):
    return torch.softmax(x, dim=axis)
def _gelu(x):
    return torch.nn.functional.gelu(x, approximate="tanh")
def _silu(x):
    return torch.nn.functional.silu(x)
def _sigmoid(x):
    return torch.sigmoid(x)
def _layernorm(x, axis=-1, eps=1e-5):
    m = x.mean(dim=axis, keepdim=True)
    v = x.var(dim=axis, keepdim=True, unbiased=False)
    return (x - m) / torch.sqrt(v + eps)
def _scatter_add(tgt, idx, src, axis=0):
    return tgt.clone().index_add_(axis, idx, src)
def _segment_sum(src, seg, n):
    out = torch.zeros((n,) + src.shape[1:], dtype=src.dtype)
    return out.index_add_(0, seg, src)
def _pad(x, pw):
    flat = tuple(v for pair in reversed(pw) for v in pair)
    return torch.nn.functional.pad(x, flat)

kernel_name = 'recurrent_scan__sliding_block__glu_gated_bilinear__prompt'

def setup_inputs():

    _w = (lambda a: (lambda t: t.to(torch.bfloat16) if t.is_floating_point() else t)(torch.as_tensor(a)))
    def _A_setup():
        B, S, D = 1, 2048, 576
        return {
            "x": _w((lambda *s: torch.randn(*s, dtype=torch.bfloat16) * 0.05)(B, S, D)),
            "wqkv": _w((lambda *s: torch.randn(*s, dtype=torch.bfloat16) * 0.2)(D, 3 * D)),
            "wo": _w((lambda *s: torch.randn(*s, dtype=torch.bfloat16) * 0.2)(D, D)),
        }
    _A_in = _A_setup()

    def _B_setup():
        B, S, D, F = 1, 2048, 576, 4608
        return {
            "x": _w((lambda *s: torch.randn(*s, dtype=torch.bfloat16) * 0.05)(B, S, D)),
            "w_gate": _w((lambda *s: torch.randn(*s, dtype=torch.bfloat16) * 0.1)(D, F) * (D ** -0.5)),
            "w_up": _w((lambda *s: torch.randn(*s, dtype=torch.bfloat16) * 0.1)(D, F) * (D ** -0.5)),
            "w_down": _w((lambda *s: torch.randn(*s, dtype=torch.bfloat16) * 0.1)(F, D) * (F ** -0.5)),
        }
    _B_in = _B_setup()

    return {
        "A_x": _A_in["x"],
        "A_wqkv": _A_in["wqkv"],
        "A_wo": _A_in["wo"],
        "B_x": _B_in["x"],
        "B_w_gate": _B_in["w_gate"],
        "B_w_up": _B_in["w_up"],
        "B_w_down": _B_in["w_down"],
    }

def reference(A_x, A_wqkv, A_wo, B_x, B_w_gate, B_w_up, B_w_down):
    def _A_ref(x, wqkv, wo):
        B, S, D = x.shape
        H = 32; Dh = D // H; W = 256
        qkv = (lambda x, *d: x.permute(*d))((x @ wqkv).reshape(B, S, 3, H, Dh), 2, 0, 3, 1, 4)
        q, k, v = qkv[0], qkv[1], qkv[2]
        scores = torch.einsum("bhqd,bhkd->bhqk", q, k) * (Dh ** -0.5)
        idx = torch.arange(S)
        mask = (idx[:, None] - idx[None, :] >= 0) & (idx[:, None] - idx[None, :] < W)
        scores = torch.where(mask[None, None], scores, -1e9)
        p = _softmax(scores, axis=-1)
        o = torch.einsum("bhqk,bhkd->bhqd", p, v)
        return (lambda x, *d: x.permute(*d))(o, 0, 2, 1, 3).reshape(B, S, D) @ wo

    def _B_ref(x, w_gate, w_up, w_down):
        g = torch.einsum("bsd,df->bsf", x, w_gate)
        u = torch.einsum("bsd,df->bsf", x, w_up)
        h = g * u
        return torch.einsum("bsf,fd->bsd", h, w_down)

    x = A_x
    xn = _layernorm(x, axis=-1)
    s = _A_ref(xn, A_wqkv, A_wo)
    g = _silu(_B_ref(xn, B_w_gate, B_w_up, B_w_down))
    return x + s * g
```

```asm
; @launch grid=(256,1,1) block=(256,1,1) lds=163840
.amdgcn_target "amdgcn-amd-amdhsa--gfx950"
.text
.globl recurrent_scan__sliding_block__glu_gated_bilinear__prompt_kernel
.p2align 8
.type recurrent_scan__sliding_block__glu_gated_bilinear__prompt_kernel,@function
recurrent_scan__sliding_block__glu_gated_bilinear__prompt_kernel:
    s_cmp_ge_u32 s2, 256
    s_cbranch_scc1 L_mk_end
    s_load_dwordx16 s[64:79], s[0:1], 0
    s_load_dwordx4 s[80:83], s[0:1], 64
    v_and_b32 v64, 63, v0
    v_lshrrev_b32 v65, 6, v0
    s_nop 0
    v_readfirstlane_b32 s3, v65
    v_and_b32 v65, 7, v64
    v_lshrrev_b32 v66, 3, v64
    v_mul_u32_u24 v92, 1152, v65
    v_lshl_add_u32 v92, v66, 4, v92
    v_mov_b32 v67, 0
    s_mul_i32 s56, s2, 9216
    s_mul_i32 s47, s3, 384
    s_add_u32 s56, s56, s47
    s_cmp_eq_u32 s3, 3
    s_cselect_b32 s56, 1073741824, s56
    s_mov_b32 s55, 60817408
    s_getpc_b64 s[28:29]
L_mk_pc:
    s_mov_b32 s30, L_mk_end-L_mk_pc
    s_mov_b32 s31, 0x00020000
    s_bfe_u32 s47, s2, 0x50003
    s_mul_i32 s47, s47, 3072
    v_lshlrev_b32 v69, 7, v0
    v_cmp_gt_u32 vcc, 3072, v69
    s_nop 1
    v_cndmask_b32 v69, -16, v69, vcc
    buffer_load_dword v70, v69, s[28:31], s47 offen
    s_mov_b32 s10, 2359296
    s_mov_b32 s11, 0x00020000
    s_mov_b32 s26, 268435456
    s_mov_b32 s27, 0x00020000
    s_waitcnt lgkmcnt(0)
    s_mov_b64 s[8:9], s[64:65]
    s_mov_b64 s[24:25], s[82:83]
    buffer_load_dwordx4 v[72:75], v92, s[8:11], s56 offen offset:0
    buffer_load_dwordx4 v[76:79], v92, s[8:11], s56 offen offset:128
    buffer_load_dwordx4 v[80:83], v92, s[8:11], s56 offen offset:256
    buffer_load_dword v68, v67, s[24:27], s55 offen sc1
    s_lshl_b32 s6, s2, 11
    s_add_u32 s6, s6, 54525952
    s_lshl_b32 s46, s3, 12
    s_bfe_u32 s84, s2, 0x30003
    s_lshl_b32 s84, s84, 2
    s_lshr_b32 s84, 0x0, s84
    s_and_b32 s84, s84, 15
    s_lshr_b32 s47, s2, 6
    s_lshl_b32 s47, s47, 1
    s_add_u32 s84, s84, s47
    s_and_b32 s47, s2, 1
    s_add_u32 s84, s84, s47
    s_sub_u32 s47, s84, 9
    s_cselect_b32 s84, s84, s47
    s_add_u32 s85, s84, 1
    s_sub_u32 s47, s85, 9
    s_cselect_b32 s85, s85, s47
    s_add_u32 s86, s85, 1
    s_sub_u32 s47, s86, 9
    s_cselect_b32 s86, s86, s47
    s_add_u32 s87, s86, 1
    s_sub_u32 s47, s87, 9
    s_cselect_b32 s87, s87, s47
    s_add_u32 s88, s87, 1
    s_sub_u32 s47, s88, 9
    s_cselect_b32 s88, s88, s47
    s_add_u32 s89, s88, 1
    s_sub_u32 s47, s89, 9
    s_cselect_b32 s89, s89, s47
    s_add_u32 s90, s89, 1
    s_sub_u32 s47, s90, 9
    s_cselect_b32 s90, s90, s47
    s_add_u32 s91, s90, 1
    s_sub_u32 s47, s91, 9
    s_cselect_b32 s91, s91, s47
    s_add_u32 s92, s91, 1
    s_sub_u32 s47, s92, 9
    s_cselect_b32 s92, s92, s47
    s_mov_b32 s12, s72
    s_mov_b32 s13, s73
    s_mov_b32 s14, 5308416
    s_mov_b32 s15, 0x00020000
    s_mov_b32 s16, s74
    s_mov_b32 s17, s75
    s_mov_b32 s18, 5308416
    s_mov_b32 s19, 0x00020000
    v_and_b32 v67, 2, v66
    v_xor_b32 v67, v67, v65
    v_lshlrev_b32 v67, 4, v67
    s_lshl_b32 s47, s3, 4
    v_add_u32 v69, s47, v66
    v_mul_u32_u24 v17, 9216, v69
    v_mul_u32_u24 v19, 3456, v69
    v_xor_b32 v69, 64, v67
    v_add_u32 v18, v17, v69
    v_add_u32 v18, 73728, v18
    v_add_u32 v17, v17, v67
    s_bfe_u32 s47, s2, 0x20001
    s_mul_i32 s52, s47, 2304
    s_bfe_u32 s5, s2, 0x30003
    s_lshl_b32 s53, s5, 5
    s_add_u32 s53, s53, s52
    s_add_u32 s53, s53, 2048
    s_lshl_b32 s55, s5, 7
    s_add_u32 s52, s52, s55
    s_mov_b32 s58, s52
    s_lshl_b32 s5, s5, 2
    s_add_u32 s5, s5, s47
    s_mov_b32 s62, 0xffff0000
    s_mov_b32 s63, 0x3f803f80
    s_cmp_eq_u32 s3, 3
    s_cbranch_scc1 L_mk_ld
    v_lshlrev_b32 v93, 4, v65
    v_lshl_add_u32 v93, v66, 8, v93
    s_lshr_b32 s50, s2, 1
    s_mul_i32 s50, s50, 18432
    s_and_b32 s47, s2, 1
    s_lshl_b32 s47, s47, 7
    s_add_u32 s50, s50, s47
    s_mul_i32 s47, s3, 6144
    s_add_u32 s50, s50, s47
    s_add_u32 s50, s50, 56623104
    s_add_u32 s51, s50, 4096
    v_lshlrev_b32 v94, 3, v65
    v_add_u32 v94, 147456, v94
    s_lshl_b32 s47, s3, 6
    v_add_u32 v95, s47, v94
    s_lshl_b32 s47, s3, 7
    s_add_u32 s47, s47, 128
    v_lshl_add_u32 v71, v64, 2, s47
    v_cmp_gt_u32 vcc, 32, v64
    v_mov_b32 v84, 0
    v_mov_b32 v85, 0
    v_mov_b32 v86, 0
    v_mov_b32 v87, 0
    v_cndmask_b32 v71, -16, v71, vcc
    s_waitcnt vmcnt(0)
    v_dot2_f32_bf16 v84, v72, s63, v84
    v_dot2_f32_bf16 v85, v72, v72, v85
    v_dot2_f32_bf16 v86, v73, s63, v86
    v_dot2_f32_bf16 v87, v73, v73, v87
    v_dot2_f32_bf16 v84, v74, s63, v84
    v_dot2_f32_bf16 v85, v74, v74, v85
    v_dot2_f32_bf16 v86, v75, s63, v86
    v_dot2_f32_bf16 v87, v75, v75, v87
    v_dot2_f32_bf16 v84, v76, s63, v84
    v_dot2_f32_bf16 v85, v76, v76, v85
    v_dot2_f32_bf16 v86, v77, s63, v86
    v_dot2_f32_bf16 v87, v77, v77, v87
    v_dot2_f32_bf16 v84, v78, s63, v84
    v_dot2_f32_bf16 v85, v78, v78, v85
    v_dot2_f32_bf16 v86, v79, s63, v86
    v_dot2_f32_bf16 v87, v79, v79, v87
    v_dot2_f32_bf16 v84, v80, s63, v84
    v_dot2_f32_bf16 v85, v80, v80, v85
    v_dot2_f32_bf16 v86, v81, s63, v86
    v_dot2_f32_bf16 v87, v81, v81, v87
    v_dot2_f32_bf16 v84, v82, s63, v84
    v_dot2_f32_bf16 v85, v82, v82, v85
    v_dot2_f32_bf16 v86, v83, s63, v86
    v_dot2_f32_bf16 v87, v83, v83, v87
    v_readfirstlane_b32 s45, v68
    v_lshlrev_b32 v96, 16, v72
    v_and_b32 v97, s62, v72
    v_add_f32 v84, v84, v86
    v_add_f32 v85, v85, v87
    v_lshlrev_b32 v98, 16, v73
    v_and_b32 v99, s62, v73
    v_add_f32_dpp v84, v84, v84 row_ror:8 row_mask:0xf bank_mask:0xf
    v_add_f32_dpp v85, v85, v85 row_ror:8 row_mask:0xf bank_mask:0xf
    v_mov_b32 v86, v84
    v_mov_b32 v87, v85
    v_lshlrev_b32 v100, 16, v74
    v_and_b32 v101, s62, v74
    v_permlane16_swap_b32 v84, v86
    v_permlane16_swap_b32 v85, v87
    v_add_f32 v84, v84, v86
    v_add_f32 v85, v85, v87
    v_mov_b32 v86, v84
    v_mov_b32 v87, v85
    v_lshlrev_b32 v102, 16, v75
    v_and_b32 v103, s62, v75
    v_permlane32_swap_b32 v84, v86
    v_permlane32_swap_b32 v85, v87
    v_add_f32 v84, v84, v86
    v_add_f32 v85, v85, v87
    ds_write_b64 v95, v[84:85]
    v_lshlrev_b32 v104, 16, v76
    v_and_b32 v105, s62, v76
    v_lshlrev_b32 v106, 16, v77
    v_and_b32 v107, s62, v77
    v_lshlrev_b32 v108, 16, v78
    v_and_b32 v109, s62, v78
    v_lshlrev_b32 v110, 16, v79
    v_and_b32 v111, s62, v79
    s_waitcnt lgkmcnt(0)
    s_barrier
    ds_read_b64 v[84:85], v94 offset:0
    ds_read_b64 v[86:87], v94 offset:64
    ds_read_b64 v[88:89], v94 offset:128
    v_lshlrev_b32 v112, 16, v80
    v_and_b32 v113, s62, v80
    v_lshlrev_b32 v114, 16, v81
    v_and_b32 v115, s62, v81
    v_lshlrev_b32 v116, 16, v82
    v_and_b32 v117, s62, v82
    v_lshlrev_b32 v118, 16, v83
    v_and_b32 v119, s62, v83
    s_mul_i32 s7, s45, 0x9e3779b1
    s_add_u32 s7, s7, 0x7f4a7c15
    s_waitcnt lgkmcnt(0)
    v_add_f32 v84, v84, v86
    v_add_f32 v85, v85, v87
    v_add_f32 v84, v84, v88
    v_add_f32 v85, v85, v89
    v_mul_f32 v84, 0x3ae38e39, v84
    v_mul_f32 v85, 0x3ae38e39, v85
    v_fma_f32 v85, -v84, v84, v85
    v_max_f32 v85, 0, v85
    v_cvt_pk_bf16_f32 v86, v84, v85
    v_lshlrev_b32 v84, 16, v86
    v_and_b32 v85, s62, v86
    v_add_f32 v85, 0x3727c5ac, v85
    v_cvt_pk_bf16_f32 v85, v85, v85
    v_and_b32 v85, s62, v85
    v_sqrt_f32 v85, v85
    v_mov_b32 v87, s7
    v_cvt_pk_bf16_f32 v85, v85, v85
    v_and_b32 v85, s62, v85
    v_rcp_f32 v85, v85
    v_add_u32 v87, 1, v87
    v_mul_f32 v84, v84, v85
    v_fma_f32 v96, v96, v85, -v84
    v_fma_f32 v97, v97, v85, -v84
    v_fma_f32 v98, v98, v85, -v84
    v_fma_f32 v99, v99, v85, -v84
    v_fma_f32 v100, v100, v85, -v84
    v_fma_f32 v101, v101, v85, -v84
    v_fma_f32 v102, v102, v85, -v84
    v_fma_f32 v103, v103, v85, -v84
    v_cvt_pk_bf16_f32 v120, v96, v97
    v_cvt_pk_bf16_f32 v121, v98, v99
    v_cvt_pk_bf16_f32 v122, v100, v101
    v_cvt_pk_bf16_f32 v123, v102, v103
    buffer_store_dwordx4 v[120:123], v93, s[24:27], s50 offen offset:0 sc1
    v_fma_f32 v104, v104, v85, -v84
    v_fma_f32 v105, v105, v85, -v84
    v_fma_f32 v106, v106, v85, -v84
    v_fma_f32 v107, v107, v85, -v84
    v_fma_f32 v108, v108, v85, -v84
    v_fma_f32 v109, v109, v85, -v84
    v_fma_f32 v110, v110, v85, -v84
    v_fma_f32 v111, v111, v85, -v84
    v_cvt_pk_bf16_f32 v124, v104, v105
    v_cvt_pk_bf16_f32 v125, v106, v107
    v_cvt_pk_bf16_f32 v126, v108, v109
    v_cvt_pk_bf16_f32 v127, v110, v111
    buffer_store_dwordx4 v[124:127], v93, s[24:27], s50 offen offset:2048 sc1
    v_fma_f32 v112, v112, v85, -v84
    v_fma_f32 v113, v113, v85, -v84
    v_fma_f32 v114, v114, v85, -v84
    v_fma_f32 v115, v115, v85, -v84
    v_fma_f32 v116, v116, v85, -v84
    v_fma_f32 v117, v117, v85, -v84
    v_fma_f32 v118, v118, v85, -v84
    v_fma_f32 v119, v119, v85, -v84
    v_cvt_pk_bf16_f32 v128, v112, v113
    v_cvt_pk_bf16_f32 v129, v114, v115
    v_cvt_pk_bf16_f32 v130, v116, v117
    v_cvt_pk_bf16_f32 v131, v118, v119
    buffer_store_dwordx4 v[128:131], v93, s[24:27], s51 offen offset:0 sc1
    s_barrier
    s_branch L_mk_su
L_mk_ld:
    v_subrev_u32 v96, 442368, v17
    v_subrev_u32 v97, 442368, v18
    s_mul_i32 s56, s84, 589824
    s_add_u32 s56, s56, s52
    s_add_u32 s57, s56, 0
    s_mov_b32 m0, 0
    s_nop 0
    buffer_load_dwordx4 v96, s[12:15], s57 offen  lds
    s_mov_b32 m0, 1024
    s_nop 0
    buffer_load_dwordx4 v97, s[12:15], s57 offen  lds
    s_add_u32 s57, s56, 147456
    s_mov_b32 m0, 4096
    s_nop 0
    buffer_load_dwordx4 v96, s[12:15], s57 offen  lds
    s_mov_b32 m0, 5120
    s_nop 0
    buffer_load_dwordx4 v97, s[12:15], s57 offen  lds
    s_add_u32 s57, s56, 294912
    s_mov_b32 m0, 8192
    s_nop 0
    buffer_load_dwordx4 v96, s[12:15], s57 offen  lds
    s_mov_b32 m0, 9216
    s_nop 0
    buffer_load_dwordx4 v97, s[12:15], s57 offen  lds
    s_add_u32 s57, s56, 442368
    s_mov_b32 m0, 12288
    s_nop 0
    buffer_load_dwordx4 v96, s[12:15], s57 offen  lds
    s_mov_b32 m0, 13312
    s_nop 0
    buffer_load_dwordx4 v97, s[12:15], s57 offen  lds
    s_add_u32 s57, s56, 0
    s_mov_b32 m0, 2048
    s_nop 0
    buffer_load_dwordx4 v96, s[16:19], s57 offen  lds
    s_mov_b32 m0, 3072
    s_nop 0
    buffer_load_dwordx4 v97, s[16:19], s57 offen  lds
    s_add_u32 s57, s56, 147456
    s_mov_b32 m0, 6144
    s_nop 0
    buffer_load_dwordx4 v96, s[16:19], s57 offen  lds
    s_mov_b32 m0, 7168
    s_nop 0
    buffer_load_dwordx4 v97, s[16:19], s57 offen  lds
    s_add_u32 s57, s56, 294912
    s_mov_b32 m0, 10240
    s_nop 0
    buffer_load_dwordx4 v96, s[16:19], s57 offen  lds
    s_mov_b32 m0, 11264
    s_nop 0
    buffer_load_dwordx4 v97, s[16:19], s57 offen  lds
    s_add_u32 s57, s56, 442368
    s_mov_b32 m0, 14336
    s_nop 0
    buffer_load_dwordx4 v96, s[16:19], s57 offen  lds
    s_mov_b32 m0, 15360
    s_nop 0
    buffer_load_dwordx4 v97, s[16:19], s57 offen  lds
    s_barrier
    s_waitcnt vmcnt(16)
    s_barrier
    s_mul_i32 s56, s85, 589824
    s_add_u32 s56, s56, s52
    s_add_u32 s57, s56, 0
    s_mov_b32 m0, 16384
    s_nop 0
    buffer_load_dwordx4 v96, s[12:15], s57 offen  lds
    s_mov_b32 m0, 17408
    s_nop 0
    buffer_load_dwordx4 v97, s[12:15], s57 offen  lds
    s_mov_b32 m0, 18432
    s_nop 0
    buffer_load_dwordx4 v96, s[16:19], s57 offen  lds
    s_mov_b32 m0, 19456
    s_nop 0
    buffer_load_dwordx4 v97, s[16:19], s57 offen  lds
    s_add_u32 s57, s56, 147456
    s_mov_b32 m0, 20480
    s_nop 0
    buffer_load_dwordx4 v96, s[12:15], s57 offen  lds
    s_mov_b32 m0, 21504
    s_nop 0
    buffer_load_dwordx4 v97, s[12:15], s57 offen  lds
    s_mov_b32 m0, 22528
    s_nop 0
    buffer_load_dwordx4 v96, s[16:19], s57 offen  lds
    s_mov_b32 m0, 23552
    s_nop 0
    buffer_load_dwordx4 v97, s[16:19], s57 offen  lds
    s_add_u32 s57, s56, 294912
    s_mov_b32 m0, 24576
    s_nop 0
    buffer_load_dwordx4 v96, s[12:15], s57 offen  lds
    s_mov_b32 m0, 25600
    s_nop 0
    buffer_load_dwordx4 v97, s[12:15], s57 offen  lds
    s_mov_b32 m0, 26624
    s_nop 0
    buffer_load_dwordx4 v96, s[16:19], s57 offen  lds
    s_mov_b32 m0, 27648
    s_nop 0
    buffer_load_dwordx4 v97, s[16:19], s57 offen  lds
    s_add_u32 s57, s56, 442368
    s_mov_b32 m0, 28672
    s_nop 0
    buffer_load_dwordx4 v96, s[12:15], s57 offen  lds
    s_mov_b32 m0, 29696
    s_nop 0
    buffer_load_dwordx4 v97, s[12:15], s57 offen  lds
    s_mov_b32 m0, 30720
    s_nop 0
    buffer_load_dwordx4 v96, s[16:19], s57 offen  lds
    s_mov_b32 m0, 31744
    s_nop 0
    buffer_load_dwordx4 v97, s[16:19], s57 offen  lds
    v_readfirstlane_b32 s45, v68
    v_mov_b32 v71, -16
    s_mul_i32 s7, s45, 0x9e3779b1
    s_add_u32 s7, s7, 0x7f4a7c15
L_mk_su:
    s_and_b32 s4, s2, 1
    s_lshl_b32 s4, s4, 2
    s_lshr_b32 s47, s2, 6
    s_add_u32 s4, s4, s47
    s_lshl_b32 s44, s4, 16
    s_add_u32 s44, s44, 54526080
    s_lshl_b32 s47, s4, 1
    s_lshr_b32 s55, s3, 1
    s_add_u32 s47, s47, s55
    s_mul_i32 s47, s47, 1179648
    s_and_b32 s55, s3, 1
    s_lshl_b32 s55, s55, 12
    s_add_u32 s47, s47, s55
    s_lshl_b32 s58, s58, 7
    s_add_u32 s58, s58, s47
    s_mov_b32 s20, s66
    s_mov_b32 s21, s67
    s_mov_b32 s22, 1990656
    s_mov_b32 s23, 0x00020000
    s_mov_b32 s32, s76
    s_mov_b32 s33, s77
    s_mov_b32 s34, 5308416
    s_mov_b32 s35, 0x00020000
    s_mov_b32 s36, s80
    s_mov_b32 s37, s81
    s_mov_b32 s38, 256
    s_mov_b32 s39, 0x00020000
    s_mov_b32 s40, s78
    s_mov_b32 s41, s79
    s_mov_b32 s42, 2359296
    s_mov_b32 s43, 0x00020000
    s_mov_b32 s28, s68
    s_mov_b32 s29, s69
    s_mov_b32 s30, 663552
    s_mov_b32 s31, 0x00020000
    s_cmp_ge_u32 s3, 2
    s_cselect_b64 s[64:65], s[74:75], s[72:73]
    s_mov_b32 s66, 5308416
    s_mov_b32 s67, 0x00020000
    s_and_b32 s72, s53, 0xffffffc0
    s_lshl_b32 s72, s72, 7
    s_add_u32 s72, s72, s47
    s_bfe_u32 s47, s53, 0x10005
    s_lshl_b32 s47, s47, 9
    s_add_u32 s72, s72, s47
    v_add_u32 v20, v19, v69
    v_add_u32 v20, 27648, v20
    v_add_u32 v19, v19, v67
    s_and_b32 s55, s3, 1
    s_lshl_b32 s55, s55, 3
    v_and_b32 v67, 24, v64
    v_lshrrev_b32 v69, 5, v64
    v_lshl_add_u32 v67, v69, 2, v67
    v_bfe_u32 v69, v64, 1, 2
    s_lshl_b32 s55, s55, 2
    v_add3_u32 v67, v67, v69, s55
    v_mul_u32_u24 v21, 9216, v67
    v_and_b32 v69, 1, v64
    v_lshl_add_u32 v21, v69, 4, v21
    s_cmp_eq_u32 s3, 3
    s_cbranch_scc1 L_mk_nf
    s_waitcnt vmcnt(0)
    buffer_store_dword v87, v71, s[24:27], s6 offen sc1
L_mk_nf:
    v_bfe_u32 v65, v64, 2, 2
    v_and_b32 v67, 3, v64
    v_lshlrev_b32 v67, 3, v67
    v_lshrrev_b32 v66, 4, v64
    v_lshl_add_u32 v5, v66, 7, v67
    v_lshl_add_u32 v5, v65, 5, v5
    v_and_b32 v69, 1, v66
    v_mul_u32_u24 v1, 1088, v69
    v_lshl_add_u32 v1, v65, 7, v1
    v_lshrrev_b32 v65, 1, v65
    v_lshl_add_u32 v1, v65, 5, v1
    v_add_u32 v1, v1, v67
    v_lshrrev_b32 v65, 5, v64
    v_lshl_add_u32 v1, v65, 12, v1
    v_xor_b32 v2, 32, v1
    v_xor_b32 v3, 64, v1
    v_xor_b32 v4, 96, v1
    v_lshlrev_b32 v16, 4, v64
    v_bfrev_b32 v66, v66
    v_lshrrev_b32 v66, 30, v66
    v_and_b32 v67, 0xf0, v16
    v_lshl_add_u32 v22, v66, 9, v67
    v_mul_u32_u24 v23, 9344, v69
    v_add_u32 v23, v23, v67
    v_lshl_add_u32 v23, v65, 8, v23
    v_add_u32 v24, 18688, v23
    v_cmp_gt_u32 vcc, 32, v0
    v_lshlrev_b32 v30, 2, v0
    s_lshl_b32 s54, s5, 7
    v_cndmask_b32 v30, -16, v30, vcc
    s_cmp_ge_u32 s5, 27
    s_cselect_b32 s54, 1073741824, s54
    s_lshl_b32 s47, s4, 2
    s_add_u32 s47, s47, s3
    s_mul_i32 s48, s47, 73728
    s_add_u32 s48, s48, 56623104
    s_mul_i32 s68, s47, 147712
    s_add_u32 s76, s68, 18948096
    s_lshl_b32 s55, s5, 12
    s_add_u32 s68, s68, s55
    s_add_u32 s68, s68, 18874368
    s_mul_i32 s69, s47, 74752
    s_add_u32 s77, s69, 24126464
    s_lshl_b32 s55, s5, 10
    s_add_u32 s69, s69, s55
    s_add_u32 s69, s69, 24098816
    s_cmp_ge_u32 s5, 18
    s_cselect_b32 s68, s69, s68
    s_cselect_b32 s69, 37376, 0
    s_cselect_b32 s47, 0, 73856
    s_add_u32 s69, s69, s47
    s_cmp_ge_u32 s5, 27
    s_cselect_b32 s68, 1073741824, s68
    s_add_u32 s69, s69, s68
    s_cmp_ge_u32 s5, 18
    s_cselect_b32 s47, 512, 0
    s_cselect_b32 s55, 0, 2048
    s_cselect_b64 vcc, -1, 0
    s_add_u32 s47, s47, s55
    s_add_u32 s70, s68, s47
    s_add_u32 s71, s69, s47
    v_cndmask_b32 v23, v22, v23, vcc
    v_add_u32 v22, 256, v22
    v_cndmask_b32 v24, v22, v24, vcc
    s_cmp_eq_u32 s5, 17
    s_cselect_b32 s76, s76, 1073741824
    s_mov_b32 s78, 73856
    s_mov_b32 s79, 16
    s_cmp_eq_u32 s5, 26
    s_cselect_b32 s76, s77, s76
    s_cselect_b32 s78, 9344, s78
    s_cselect_b32 s79, 64, s79
    s_cselect_b32 s77, s63, 0
    v_mov_b32 v102, s77
    v_mov_b32 v103, s77
    v_mov_b32 v101, s63
    s_cselect_b32 s77, s63, 1.0
    v_mov_b32 v100, s77
    v_lshrrev_b32 v65, 3, v64
    v_mul_lo_u32 v65, v65, s78
    v_and_b32 v66, 0x70, v16
    v_add_u32 v65, v65, v66
    v_cmp_gt_u32 vcc, s79, v64
    s_cmp_lt_u32 s5, 9
    s_cselect_b32 s55, 0x3eae1a93, 1.0
    v_cndmask_b32 v65, -16, v65, vcc
    buffer_store_dwordx4 v[100:103], v65, s[24:27], s76 offen sc1
    s_mov_b32 s59, s55
    s_mov_b32 s50, 1152
    s_mov_b32 s51, 320
    v_add_u32 v6, 0, v16
    v_lshrrev_b32 v28, 6, v6
    v_mul_u32_u24 v28, 205, v28
    v_lshrrev_b32 v28, 10, v28
    v_mul_u32_u24 v29, s51, v28
    v_sub_u32 v6, v6, v29
    v_and_b32 v29, 4, v28
    v_lshlrev_b32 v29, 3, v29
    v_xor_b32 v6, v6, v29
    v_and_b32 v29, 8, v28
    v_add_u32 v28, v28, v29
    v_mad_u32_u24 v6, v28, s50, v6
    v_add_u32 v7, 1024, v16
    v_lshrrev_b32 v28, 6, v7
    v_mul_u32_u24 v28, 205, v28
    v_lshrrev_b32 v28, 10, v28
    v_mul_u32_u24 v29, s51, v28
    v_sub_u32 v7, v7, v29
    v_and_b32 v29, 4, v28
    v_lshlrev_b32 v29, 3, v29
    v_xor_b32 v7, v7, v29
    v_and_b32 v29, 8, v28
    v_add_u32 v28, v28, v29
    v_mad_u32_u24 v7, v28, s50, v7
    v_subrev_u32 v7, 1024, v7
    v_add_u32 v8, 2048, v16
    v_lshrrev_b32 v28, 6, v8
    v_mul_u32_u24 v28, 205, v28
    v_lshrrev_b32 v28, 10, v28
    v_mul_u32_u24 v29, s51, v28
    v_sub_u32 v8, v8, v29
    v_and_b32 v29, 4, v28
    v_lshlrev_b32 v29, 3, v29
    v_xor_b32 v8, v8, v29
    v_and_b32 v29, 8, v28
    v_add_u32 v28, v28, v29
    v_mad_u32_u24 v8, v28, s50, v8
    v_subrev_u32 v8, 2048, v8
    v_add_u32 v9, 3072, v16
    v_lshrrev_b32 v28, 6, v9
    v_mul_u32_u24 v28, 205, v28
    v_lshrrev_b32 v28, 10, v28
    v_mul_u32_u24 v29, s51, v28
    v_sub_u32 v9, v9, v29
    v_and_b32 v29, 4, v28
    v_lshlrev_b32 v29, 3, v29
    v_xor_b32 v9, v9, v29
    v_and_b32 v29, 8, v28
    v_add_u32 v28, v28, v29
    v_mad_u32_u24 v9, v28, s50, v9
    v_subrev_u32 v9, 3072, v9
    v_add_u32 v10, 4096, v16
    v_lshrrev_b32 v28, 6, v10
    v_mul_u32_u24 v28, 205, v28
    v_lshrrev_b32 v28, 10, v28
    v_mul_u32_u24 v29, s51, v28
    v_sub_u32 v10, v10, v29
    v_and_b32 v29, 4, v28
    v_lshlrev_b32 v29, 3, v29
    v_xor_b32 v10, v10, v29
    v_and_b32 v29, 8, v28
    v_add_u32 v28, v28, v29
    v_mad_u32_u24 v10, v28, s50, v10
    v_bfe_u32 v28, v0, 2, 4
    v_mul_u32_u24 v11, s51, v28
    v_and_b32 v29, 3, v0
    v_lshl_add_u32 v11, v29, 3, v11
    v_and_b32 v28, 4, v28
    v_lshlrev_b32 v28, 3, v28
    v_add_u32 v14, v11, v28
    v_sub_u32 v11, v11, v28
    s_bitcmp1_b32 s2, 6
    s_cselect_b64 vcc, -1, 0
    s_cselect_b32 s50, 32, 0
    v_cndmask_b32 v28, v14, v11, vcc
    v_cndmask_b32 v14, v11, v14, vcc
    v_add_u32 v11, s50, v28
    v_add_u32 v14, s50, v14
    s_lshr_b32 s50, s2, 5
    v_lshrrev_b32 v67, 7, v0
    v_sub_u32 v65, s50, v67
    v_max_i32 v65, 0, v65
    v_lshrrev_b32 v66, 2, v65
    v_and_b32 v65, 3, v65
    v_lshl_add_u32 v66, v65, 6, v66
    v_bfe_u32 v65, v0, 6, 1
    v_and_b32 v67, 15, v0
    v_lshl_add_u32 v65, v65, 4, v67
    v_min_u32 v65, 26, v65
    v_lshrrev_b32 v67, 5, v64
    v_lshl_add_u32 v66, v65, 1, v66
    v_lshlrev_b32 v15, 11, v66
    v_add_u32 v15, 54525952, v15
    s_and_b32 s50, s2, 7
    s_lshl_b32 s50, s50, 2
    s_bfe_u32 s51, s2, 0x20003
    s_add_u32 s50, s50, s51
    s_mul_i32 s51, s50, 9
    s_lshr_b32 s51, s51, 2
    s_add_u32 s51, s51, 72
    s_lshl_b32 s51, s51, 9
    v_add_u32 v25, s51, v16
    v_bfe_u32 v65, v64, 2, 2
    v_bfrev_b32 v65, v65
    v_lshrrev_b32 v65, 30, v65
    v_and_b32 v66, 0x13, v64
    v_lshl_add_u32 v66, v65, 2, v66
    s_mul_i32 s50, s50, 18
    v_add_u32 v66, s50, v66
    v_and_b32 v65, 31, v64
    v_cmp_gt_u32 vcc, 18, v65
    v_mov_b32 v65, 576
    s_nop 0
    v_cndmask_b32 v66, v65, v66, vcc
    v_lshlrev_b32 v26, 4, v66
    v_mul_u32_u24 v65, 9344, v67
    v_add_u32 v26, v26, v65
    v_add_u32 v27, 18688, v26
    v_lshrrev_b32 v13, 5, v0
    v_lshlrev_b32 v13, 14, v13
    v_and_b32 v28, 7, v64
    v_lshlrev_b32 v28, 11, v28
    v_bfe_u32 v29, v64, 3, 2
    v_min_u32 v29, 2, v29
    v_lshl_add_u32 v28, v29, 7, v28
    s_lshl_b32 s47, s3, 14
    s_add_u32 s44, s44, s47
    buffer_load_dword v29, v28, s[24:27], s44 offen sc1
    s_add_u32 s82, s7, 1
    s_waitcnt vmcnt(0)
    v_subrev_u32 v29, s82, v29
    v_cmp_lt_u32 vcc, 7, v29
    s_cbranch_vccz L_poll0_ok
    s_mov_b32 s83, 0
L_poll0:
    buffer_load_dword v29, v28, s[24:27], s44 offen sc1
    s_add_u32 s83, s83, 1
    s_waitcnt vmcnt(0)
    v_subrev_u32 v29, s82, v29
    v_cmp_lt_u32 vcc, 7, v29
    s_cbranch_vccz L_poll0_ok
    s_cmp_lt_u32 s83, 0x40000
    s_cbranch_scc1 L_poll0
L_poll0_ok:
    s_lshl_b32 s49, s84, 11
    s_add_u32 s49, s49, s48
    buffer_load_dwordx4 v[192:195], v16, s[24:27], s49 offen offset:0 sc1
    buffer_load_dwordx4 v[208:211], v16, s[24:27], s49 offen offset:1024 sc1
    s_add_u32 s49, s49, 18432
    buffer_load_dwordx4 v[196:199], v16, s[24:27], s49 offen offset:0 sc1
    buffer_load_dwordx4 v[212:215], v16, s[24:27], s49 offen offset:1024 sc1
    s_add_u32 s49, s49, 18432
    buffer_load_dwordx4 v[200:203], v16, s[24:27], s49 offen offset:0 sc1
    buffer_load_dwordx4 v[216:219], v16, s[24:27], s49 offen offset:1024 sc1
    s_add_u32 s49, s49, 18432
    buffer_load_dwordx4 v[204:207], v16, s[24:27], s49 offen offset:0 sc1
    buffer_load_dwordx4 v[220:223], v16, s[24:27], s49 offen offset:1024 sc1
    s_waitcnt vmcnt(9)
    s_barrier
    ds_read_b64_tr_b16 a[0:1], v1 offset:0
    ds_read_b64_tr_b16 a[2:3], v1 offset:512
    ds_read_b64_tr_b16 a[4:5], v1 offset:8192
    ds_read_b64_tr_b16 a[6:7], v1 offset:8704
    ds_read_b64_tr_b16 a[8:9], v1 offset:2048
    ds_read_b64_tr_b16 a[10:11], v1 offset:2560
    ds_read_b64_tr_b16 a[12:13], v1 offset:10240
    ds_read_b64_tr_b16 a[14:15], v1 offset:10752
    s_waitcnt vmcnt(0)
    s_waitcnt lgkmcnt(4)
    v_mfma_f32_16x16x32_bf16 v[64:67], a[0:3], v[192:195], 0
    ds_read_b64_tr_b16 a[16:17], v2 offset:0
    v_mfma_f32_16x16x32_bf16 v[64:67], a[4:7], v[208:211], v[64:67]
    s_lshl_b32 s49, s85, 11
    s_add_u32 s49, s49, s48
    v_mfma_f32_16x16x32_bf16 v[68:71], a[4:7], v[212:215], 0
    ds_read_b64_tr_b16 a[18:19], v2 offset:512
    v_mfma_f32_16x16x32_bf16 v[68:71], a[0:3], v[196:199], v[68:71]
    buffer_load_dwordx4 v[224:227], v16, s[24:27], s49 offen offset:0 sc1
    v_mfma_f32_16x16x32_bf16 v[72:75], a[0:3], v[200:203], 0
    ds_read_b64_tr_b16 a[20:21], v2 offset:8192
    buffer_load_dwordx4 v[240:243], v16, s[24:27], s49 offen offset:1024 sc1
    v_mfma_f32_16x16x32_bf16 v[72:75], a[4:7], v[216:219], v[72:75]
    v_mfma_f32_16x16x32_bf16 v[76:79], a[4:7], v[220:223], 0
    ds_read_b64_tr_b16 a[22:23], v2 offset:8704
    s_add_u32 s49, s49, 18432
    v_mfma_f32_16x16x32_bf16 v[76:79], a[0:3], v[204:207], v[76:79]
    s_waitcnt lgkmcnt(4)
    v_mfma_f32_16x16x32_bf16 v[80:83], a[8:11], v[192:195], 0
    ds_read_b64_tr_b16 a[24:25], v2 offset:2048
    buffer_load_dwordx4 v[228:231], v16, s[24:27], s49 offen offset:0 sc1
    v_mfma_f32_16x16x32_bf16 v[80:83], a[12:15], v[208:211], v[80:83]
    buffer_load_dwordx4 v[244:247], v16, s[24:27], s49 offen offset:1024 sc1
    v_mfma_f32_16x16x32_bf16 v[84:87], a[12:15], v[212:215], 0
    ds_read_b64_tr_b16 a[26:27], v2 offset:2560
    v_mfma_f32_16x16x32_bf16 v[84:87], a[8:11], v[196:199], v[84:87]
    s_add_u32 s49, s49, 18432
    v_mfma_f32_16x16x32_bf16 v[88:91], a[8:11], v[200:203], 0
    ds_read_b64_tr_b16 a[28:29], v2 offset:10240
    v_mfma_f32_16x16x32_bf16 v[88:91], a[12:15], v[216:219], v[88:91]
    buffer_load_dwordx4 v[232:235], v16, s[24:27], s49 offen offset:0 sc1
    v_mfma_f32_16x16x32_bf16 v[92:95], a[12:15], v[220:223], 0
    ds_read_b64_tr_b16 a[30:31], v2 offset:10752
    buffer_load_dwordx4 v[248:251], v16, s[24:27], s49 offen offset:1024 sc1
    v_mfma_f32_16x16x32_bf16 v[92:95], a[8:11], v[204:207], v[92:95]
    s_waitcnt lgkmcnt(4)
    v_mfma_f32_16x16x32_bf16 v[96:99], a[16:19], v[192:195], 0
    ds_read_b64_tr_b16 a[0:1], v3 offset:0
    s_add_u32 s49, s49, 18432
    v_mfma_f32_16x16x32_bf16 v[96:99], a[20:23], v[208:211], v[96:99]
    v_mfma_f32_16x16x32_bf16 v[100:103], a[20:23], v[212:215], 0
    ds_read_b64_tr_b16 a[2:3], v3 offset:512
    buffer_load_dwordx4 v[236:239], v16, s[24:27], s49 offen offset:0 sc1
    v_mfma_f32_16x16x32_bf16 v[100:103], a[16:19], v[196:199], v[100:103]
    buffer_load_dwordx4 v[252:255], v16, s[24:27], s49 offen offset:1024 sc1
    v_mfma_f32_16x16x32_bf16 v[104:107], a[16:19], v[200:203], 0
    ds_read_b64_tr_b16 a[4:5], v3 offset:8192
    v_mfma_f32_16x16x32_bf16 v[104:107], a[20:23], v[216:219], v[104:107]
    s_lshl_b32 s49, s86, 11
    s_add_u32 s49, s49, s48
    v_mfma_f32_16x16x32_bf16 v[108:111], a[20:23], v[220:223], 0
    ds_read_b64_tr_b16 a[6:7], v3 offset:8704
    v_mfma_f32_16x16x32_bf16 v[108:111], a[16:19], v[204:207], v[108:111]
    s_waitcnt lgkmcnt(4)
    v_mfma_f32_16x16x32_bf16 v[112:115], a[24:27], v[192:195], 0
    ds_read_b64_tr_b16 a[8:9], v3 offset:2048
    buffer_load_dwordx4 a[32:35], v16, s[24:27], s49 offen offset:0 sc1
    v_mfma_f32_16x16x32_bf16 v[112:115], a[28:31], v[208:211], v[112:115]
    v_mfma_f32_16x16x32_bf16 v[116:119], a[28:31], v[212:215], 0
    ds_read_b64_tr_b16 a[10:11], v3 offset:2560
    buffer_load_dwordx4 a[48:51], v16, s[24:27], s49 offen offset:1024 sc1
    v_mfma_f32_16x16x32_bf16 v[116:119], a[24:27], v[196:199], v[116:119]
    s_add_u32 s49, s49, 18432
    v_mfma_f32_16x16x32_bf16 v[120:123], a[24:27], v[200:203], 0
    ds_read_b64_tr_b16 a[12:13], v3 offset:10240
    v_mfma_f32_16x16x32_bf16 v[120:123], a[28:31], v[216:219], v[120:123]
    buffer_load_dwordx4 a[36:39], v16, s[24:27], s49 offen offset:0 sc1
    v_mfma_f32_16x16x32_bf16 v[124:127], a[28:31], v[220:223], 0
    ds_read_b64_tr_b16 a[14:15], v3 offset:10752
    v_mfma_f32_16x16x32_bf16 v[124:127], a[24:27], v[204:207], v[124:127]
    buffer_load_dwordx4 a[52:55], v16, s[24:27], s49 offen offset:1024 sc1
    s_waitcnt lgkmcnt(4)
    v_mfma_f32_16x16x32_bf16 v[128:131], a[0:3], v[192:195], 0
    ds_read_b64_tr_b16 a[16:17], v4 offset:0
    s_add_u32 s49, s49, 18432
    v_mfma_f32_16x16x32_bf16 v[128:131], a[4:7], v[208:211], v[128:131]
    v_mfma_f32_16x16x32_bf16 v[132:135], a[4:7], v[212:215], 0
    ds_read_b64_tr_b16 a[18:19], v4 offset:512
    buffer_load_dwordx4 a[40:43], v16, s[24:27], s49 offen offset:0 sc1
    v_mfma_f32_16x16x32_bf16 v[132:135], a[0:3], v[196:199], v[132:135]
    v_mfma_f32_16x16x32_bf16 v[136:139], a[0:3], v[200:203], 0
    ds_read_b64_tr_b16 a[20:21], v4 offset:8192
    buffer_load_dwordx4 a[56:59], v16, s[24:27], s49 offen offset:1024 sc1
    v_mfma_f32_16x16x32_bf16 v[136:139], a[4:7], v[216:219], v[136:139]
    s_add_u32 s49, s49, 18432
    v_mfma_f32_16x16x32_bf16 v[140:143], a[4:7], v[220:223], 0
    ds_read_b64_tr_b16 a[22:23], v4 offset:8704
    v_mfma_f32_16x16x32_bf16 v[140:143], a[0:3], v[204:207], v[140:143]
    buffer_load_dwordx4 a[44:47], v16, s[24:27], s49 offen offset:0 sc1
    s_waitcnt lgkmcnt(4)
    v_mfma_f32_16x16x32_bf16 v[144:147], a[8:11], v[192:195], 0
    ds_read_b64_tr_b16 a[24:25], v4 offset:2048
    buffer_load_dwordx4 a[60:63], v16, s[24:27], s49 offen offset:1024 sc1
    v_mfma_f32_16x16x32_bf16 v[144:147], a[12:15], v[208:211], v[144:147]
    v_mfma_f32_16x16x32_bf16 v[148:151], a[12:15], v[212:215], 0
    ds_read_b64_tr_b16 a[26:27], v4 offset:2560
    v_mfma_f32_16x16x32_bf16 v[148:151], a[8:11], v[196:199], v[148:151]
    s_mul_i32 s56, s86, 589824
    s_add_u32 s56, s56, s52
    s_add_u32 m0, s46, 32768
    v_mfma_f32_16x16x32_bf16 v[152:155], a[8:11], v[200:203], 0
    ds_read_b64_tr_b16 a[28:29], v4 offset:10240
    v_mfma_f32_16x16x32_bf16 v[152:155], a[12:15], v[216:219], v[152:155]
    v_mfma_f32_16x16x32_bf16 v[156:159], a[12:15], v[220:223], 0
    ds_read_b64_tr_b16 a[30:31], v4 offset:10752
    v_mfma_f32_16x16x32_bf16 v[156:159], a[8:11], v[204:207], v[156:159]
    s_waitcnt vmcnt(24)
    s_barrier
    s_waitcnt lgkmcnt(4)
    v_mfma_f32_16x16x32_bf16 v[160:163], a[16:19], v[192:195], 0
    ds_read_b64_tr_b16 a[0:1], v1 offset:16384
    buffer_load_dwordx4 v17, s[12:15], s56 offen  lds
    v_mfma_f32_16x16x32_bf16 v[160:163], a[20:23], v[208:211], v[160:163]
    s_add_u32 m0, s46, 33792
    v_mfma_f32_16x16x32_bf16 v[164:167], a[20:23], v[212:215], 0
    ds_read_b64_tr_b16 a[2:3], v1 offset:16896
    buffer_load_dwordx4 v18, s[12:15], s56 offen  lds
    v_mfma_f32_16x16x32_bf16 v[164:167], a[16:19], v[196:199], v[164:167]
    v_mfma_f32_16x16x32_bf16 v[168:171], a[16:19], v[200:203], 0
    ds_read_b64_tr_b16 a[4:5], v1 offset:24576
    s_add_u32 m0, s46, 34816
    v_mfma_f32_16x16x32_bf16 v[168:171], a[20:23], v[216:219], v[168:171]
    v_mfma_f32_16x16x32_bf16 v[172:175], a[20:23], v[220:223], 0
    ds_read_b64_tr_b16 a[6:7], v1 offset:25088
    buffer_load_dwordx4 v17, s[16:19], s56 offen  lds
    v_mfma_f32_16x16x32_bf16 v[172:175], a[16:19], v[204:207], v[172:175]
    s_add_u32 m0, s46, 35840
    s_waitcnt lgkmcnt(4)
    v_mfma_f32_16x16x32_bf16 v[176:179], a[24:27], v[192:195], 0
    ds_read_b64_tr_b16 a[8:9], v1 offset:18432
    v_mfma_f32_16x16x32_bf16 v[176:179], a[28:31], v[208:211], v[176:179]
    buffer_load_dwordx4 v18, s[16:19], s56 offen  lds
    v_mfma_f32_16x16x32_bf16 v[180:183], a[28:31], v[212:215], 0
    ds_read_b64_tr_b16 a[10:11], v1 offset:18944
    v_mfma_f32_16x16x32_bf16 v[180:183], a[24:27], v[196:199], v[180:183]
    v_mfma_f32_16x16x32_bf16 v[184:187], a[24:27], v[200:203], 0
    ds_read_b64_tr_b16 a[12:13], v1 offset:26624
    v_mfma_f32_16x16x32_bf16 v[184:187], a[28:31], v[216:219], v[184:187]
    v_mfma_f32_16x16x32_bf16 v[188:191], a[28:31], v[220:223], 0
    ds_read_b64_tr_b16 a[14:15], v1 offset:27136
    v_mfma_f32_16x16x32_bf16 v[188:191], a[24:27], v[204:207], v[188:191]
    s_waitcnt vmcnt(12)
    s_waitcnt lgkmcnt(4)
    v_mfma_f32_16x16x32_bf16 v[64:67], a[0:3], v[224:227], v[64:67]
    ds_read_b64_tr_b16 a[16:17], v2 offset:16384
    v_mfma_f32_16x16x32_bf16 v[64:67], a[4:7], v[240:243], v[64:67]
    s_lshl_b32 s49, s87, 11
    s_add_u32 s49, s49, s48
    v_mfma_f32_16x16x32_bf16 v[68:71], a[4:7], v[244:247], v[68:71]
    ds_read_b64_tr_b16 a[18:19], v2 offset:16896
    v_mfma_f32_16x16x32_bf16 v[68:71], a[0:3], v[228:231], v[68:71]
    buffer_load_dwordx4 a[64:67], v16, s[24:27], s49 offen offset:0 sc1
    v_mfma_f32_16x16x32_bf16 v[72:75], a[0:3], v[232:235], v[72:75]
    ds_read_b64_tr_b16 a[20:21], v2 offset:24576
    buffer_load_dwordx4 a[80:83], v16, s[24:27], s49 offen offset:1024 sc1
    v_mfma_f32_16x16x32_bf16 v[72:75], a[4:7], v[248:251], v[72:75]
    v_mfma_f32_16x16x32_bf16 v[76:79], a[4:7], v[252:255], v[76:79]
    ds_read_b64_tr_b16 a[22:23], v2 offset:25088
    s_add_u32 s49, s49, 18432
    v_mfma_f32_16x16x32_bf16 v[76:79], a[0:3], v[236:239], v[76:79]
    s_waitcnt lgkmcnt(4)
    v_mfma_f32_16x16x32_bf16 v[80:83], a[8:11], v[224:227], v[80:83]
    ds_read_b64_tr_b16 a[24:25], v2 offset:18432
    buffer_load_dwordx4 a[68:71], v16, s[24:27], s49 offen offset:0 sc1
    v_mfma_f32_16x16x32_bf16 v[80:83], a[12:15], v[240:243], v[80:83]
    buffer_load_dwordx4 a[84:87], v16, s[24:27], s49 offen offset:1024 sc1
    v_mfma_f32_16x16x32_bf16 v[84:87], a[12:15], v[244:247], v[84:87]
    ds_read_b64_tr_b16 a[26:27], v2 offset:18944
    v_mfma_f32_16x16x32_bf16 v[84:87], a[8:11], v[228:231], v[84:87]
    s_add_u32 s49, s49, 18432
    v_mfma_f32_16x16x32_bf16 v[88:91], a[8:11], v[232:235], v[88:91]
    ds_read_b64_tr_b16 a[28:29], v2 offset:26624
    v_mfma_f32_16x16x32_bf16 v[88:91], a[12:15], v[248:251], v[88:91]
    buffer_load_dwordx4 a[72:75], v16, s[24:27], s49 offen offset:0 sc1
    v_mfma_f32_16x16x32_bf16 v[92:95], a[12:15], v[252:255], v[92:95]
    ds_read_b64_tr_b16 a[30:31], v2 offset:27136
    buffer_load_dwordx4 a[88:91], v16, s[24:27], s49 offen offset:1024 sc1
    v_mfma_f32_16x16x32_bf16 v[92:95], a[8:11], v[236:239], v[92:95]
    s_waitcnt lgkmcnt(4)
    v_mfma_f32_16x16x32_bf16 v[96:99], a[16:19], v[224:227], v[96:99]
    ds_read_b64_tr_b16 a[0:1], v3 offset:16384
    s_add_u32 s49, s49, 18432
    v_mfma_f32_16x16x32_bf16 v[96:99], a[20:23], v[240:243], v[96:99]
    v_mfma_f32_16x16x32_bf16 v[100:103], a[20:23], v[244:247], v[100:103]
    ds_read_b64_tr_b16 a[2:3], v3 offset:16896
    buffer_load_dwordx4 a[76:79], v16, s[24:27], s49 offen offset:0 sc1
    v_mfma_f32_16x16x32_bf16 v[100:103], a[16:19], v[228:231], v[100:103]
    buffer_load_dwordx4 a[92:95], v16, s[24:27], s49 offen offset:1024 sc1
    v_mfma_f32_16x16x32_bf16 v[104:107], a[16:19], v[232:235], v[104:107]
    ds_read_b64_tr_b16 a[4:5], v3 offset:24576
    v_mfma_f32_16x16x32_bf16 v[104:107], a[20:23], v[248:251], v[104:107]
    s_lshl_b32 s49, s88, 11
    s_add_u32 s49, s49, s48
    v_mfma_f32_16x16x32_bf16 v[108:111], a[20:23], v[252:255], v[108:111]
    ds_read_b64_tr_b16 a[6:7], v3 offset:25088
    v_mfma_f32_16x16x32_bf16 v[108:111], a[16:19], v[236:239], v[108:111]
    s_waitcnt lgkmcnt(4)
    v_mfma_f32_16x16x32_bf16 v[112:115], a[24:27], v[224:227], v[112:115]
    ds_read_b64_tr_b16 a[8:9], v3 offset:18432
    buffer_load_dwordx4 a[96:99], v16, s[24:27], s49 offen offset:0 sc1
    v_mfma_f32_16x16x32_bf16 v[112:115], a[28:31], v[240:243], v[112:115]
    v_mfma_f32_16x16x32_bf16 v[116:119], a[28:31], v[244:247], v[116:119]
    ds_read_b64_tr_b16 a[10:11], v3 offset:18944
    buffer_load_dwordx4 a[112:115], v16, s[24:27], s49 offen offset:1024 sc1
    v_mfma_f32_16x16x32_bf16 v[116:119], a[24:27], v[228:231], v[116:119]
    s_add_u32 s49, s49, 18432
    v_mfma_f32_16x16x32_bf16 v[120:123], a[24:27], v[232:235], v[120:123]
    ds_read_b64_tr_b16 a[12:13], v3 offset:26624
    v_mfma_f32_16x16x32_bf16 v[120:123], a[28:31], v[248:251], v[120:123]
    buffer_load_dwordx4 a[100:103], v16, s[24:27], s49 offen offset:0 sc1
    v_mfma_f32_16x16x32_bf16 v[124:127], a[28:31], v[252:255], v[124:127]
    ds_read_b64_tr_b16 a[14:15], v3 offset:27136
    v_mfma_f32_16x16x32_bf16 v[124:127], a[24:27], v[236:239], v[124:127]
    buffer_load_dwordx4 a[116:119], v16, s[24:27], s49 offen offset:1024 sc1
    s_waitcnt lgkmcnt(4)
    v_mfma_f32_16x16x32_bf16 v[128:131], a[0:3], v[224:227], v[128:131]
    ds_read_b64_tr_b16 a[16:17], v4 offset:16384
    s_add_u32 s49, s49, 18432
    v_mfma_f32_16x16x32_bf16 v[128:131], a[4:7], v[240:243], v[128:131]
    v_mfma_f32_16x16x32_bf16 v[132:135], a[4:7], v[244:247], v[132:135]
    ds_read_b64_tr_b16 a[18:19], v4 offset:16896
    buffer_load_dwordx4 a[104:107], v16, s[24:27], s49 offen offset:0 sc1
    v_mfma_f32_16x16x32_bf16 v[132:135], a[0:3], v[228:231], v[132:135]
    v_mfma_f32_16x16x32_bf16 v[136:139], a[0:3], v[232:235], v[136:139]
    ds_read_b64_tr_b16 a[20:21], v4 offset:24576
    buffer_load_dwordx4 a[120:123], v16, s[24:27], s49 offen offset:1024 sc1
    v_mfma_f32_16x16x32_bf16 v[136:139], a[4:7], v[248:251], v[136:139]
    s_add_u32 s49, s49, 18432
    v_mfma_f32_16x16x32_bf16 v[140:143], a[4:7], v[252:255], v[140:143]
    ds_read_b64_tr_b16 a[22:23], v4 offset:25088
    v_mfma_f32_16x16x32_bf16 v[140:143], a[0:3], v[236:239], v[140:143]
    buffer_load_dwordx4 a[108:111], v16, s[24:27], s49 offen offset:0 sc1
    s_waitcnt lgkmcnt(4)
    v_mfma_f32_16x16x32_bf16 v[144:147], a[8:11], v[224:227], v[144:147]
    ds_read_b64_tr_b16 a[24:25], v4 offset:18432
    buffer_load_dwordx4 a[124:127], v16, s[24:27], s49 offen offset:1024 sc1
    v_mfma_f32_16x16x32_bf16 v[144:147], a[12:15], v[240:243], v[144:147]
    v_mfma_f32_16x16x32_bf16 v[148:151], a[12:15], v[244:247], v[148:151]
    ds_read_b64_tr_b16 a[26:27], v4 offset:18944
    v_mfma_f32_16x16x32_bf16 v[148:151], a[8:11], v[228:231], v[148:151]
    s_mul_i32 s56, s87, 589824
    s_add_u32 s56, s56, s52
    s_add_u32 m0, s46, 49152
    v_mfma_f32_16x16x32_bf16 v[152:155], a[8:11], v[232:235], v[152:155]
    ds_read_b64_tr_b16 a[28:29], v4 offset:26624
    v_mfma_f32_16x16x32_bf16 v[152:155], a[12:15], v[248:251], v[152:155]
    v_mfma_f32_16x16x32_bf16 v[156:159], a[12:15], v[252:255], v[156:159]
    ds_read_b64_tr_b16 a[30:31], v4 offset:27136
    v_mfma_f32_16x16x32_bf16 v[156:159], a[8:11], v[236:239], v[156:159]
    s_waitcnt vmcnt(16)
    s_barrier
    s_waitcnt lgkmcnt(4)
    v_mfma_f32_16x16x32_bf16 v[160:163], a[16:19], v[224:227], v[160:163]
    ds_read_b64_tr_b16 a[0:1], v1 offset:32768
    buffer_load_dwordx4 v17, s[12:15], s56 offen  lds
    v_mfma_f32_16x16x32_bf16 v[160:163], a[20:23], v[240:243], v[160:163]
    s_add_u32 m0, s46, 50176
    v_mfma_f32_16x16x32_bf16 v[164:167], a[20:23], v[244:247], v[164:167]
    ds_read_b64_tr_b16 a[2:3], v1 offset:33280
    buffer_load_dwordx4 v18, s[12:15], s56 offen  lds
    v_mfma_f32_16x16x32_bf16 v[164:167], a[16:19], v[228:231], v[164:167]
    v_mfma_f32_16x16x32_bf16 v[168:171], a[16:19], v[232:235], v[168:171]
    ds_read_b64_tr_b16 a[4:5], v1 offset:40960
    s_add_u32 m0, s46, 51200
    v_mfma_f32_16x16x32_bf16 v[168:171], a[20:23], v[248:251], v[168:171]
    v_mfma_f32_16x16x32_bf16 v[172:175], a[20:23], v[252:255], v[172:175]
    ds_read_b64_tr_b16 a[6:7], v1 offset:41472
    buffer_load_dwordx4 v17, s[16:19], s56 offen  lds
    v_mfma_f32_16x16x32_bf16 v[172:175], a[16:19], v[236:239], v[172:175]
    s_add_u32 m0, s46, 52224
    s_waitcnt lgkmcnt(4)
    v_mfma_f32_16x16x32_bf16 v[176:179], a[24:27], v[224:227], v[176:179]
    ds_read_b64_tr_b16 a[8:9], v1 offset:34816
    v_mfma_f32_16x16x32_bf16 v[176:179], a[28:31], v[240:243], v[176:179]
    buffer_load_dwordx4 v18, s[16:19], s56 offen  lds
    v_mfma_f32_16x16x32_bf16 v[180:183], a[28:31], v[244:247], v[180:183]
    ds_read_b64_tr_b16 a[10:11], v1 offset:35328
    v_mfma_f32_16x16x32_bf16 v[180:183], a[24:27], v[228:231], v[180:183]
    v_mfma_f32_16x16x32_bf16 v[184:187], a[24:27], v[232:235], v[184:187]
    ds_read_b64_tr_b16 a[12:13], v1 offset:43008
    v_mfma_f32_16x16x32_bf16 v[184:187], a[28:31], v[248:251], v[184:187]
    v_mfma_f32_16x16x32_bf16 v[188:191], a[28:31], v[252:255], v[188:191]
    ds_read_b64_tr_b16 a[14:15], v1 offset:43520
    v_mfma_f32_16x16x32_bf16 v[188:191], a[24:27], v[236:239], v[188:191]
    s_waitcnt vmcnt(24)
    s_waitcnt lgkmcnt(4)
    v_mfma_f32_16x16x32_bf16 v[64:67], a[0:3], a[32:35], v[64:67]
    ds_read_b64_tr_b16 a[16:17], v2 offset:32768
    v_mfma_f32_16x16x32_bf16 v[64:67], a[4:7], a[48:51], v[64:67]
    s_lshl_b32 s49, s89, 11
    s_add_u32 s49, s49, s48
    v_mfma_f32_16x16x32_bf16 v[68:71], a[4:7], a[52:55], v[68:71]
    ds_read_b64_tr_b16 a[18:19], v2 offset:33280
    v_mfma_f32_16x16x32_bf16 v[68:71], a[0:3], a[36:39], v[68:71]
    v_mfma_f32_16x16x32_bf16 v[72:75], a[0:3], a[40:43], v[72:75]
    ds_read_b64_tr_b16 a[20:21], v2 offset:40960
    v_mfma_f32_16x16x32_bf16 v[72:75], a[4:7], a[56:59], v[72:75]
    buffer_load_dwordx4 a[128:131], v16, s[24:27], s49 offen offset:0 sc1
    v_mfma_f32_16x16x32_bf16 v[76:79], a[4:7], a[60:63], v[76:79]
    ds_read_b64_tr_b16 a[22:23], v2 offset:41472
    v_mfma_f32_16x16x32_bf16 v[76:79], a[0:3], a[44:47], v[76:79]
    buffer_load_dwordx4 a[144:147], v16, s[24:27], s49 offen offset:1024 sc1
    s_waitcnt lgkmcnt(4)
    v_mfma_f32_16x16x32_bf16 v[80:83], a[8:11], a[32:35], v[80:83]
    ds_read_b64_tr_b16 a[24:25], v2 offset:34816
    v_mfma_f32_16x16x32_bf16 v[80:83], a[12:15], a[48:51], v[80:83]
    v_mfma_f32_16x16x32_bf16 v[84:87], a[12:15], a[52:55], v[84:87]
    ds_read_b64_tr_b16 a[26:27], v2 offset:35328
    s_add_u32 s49, s49, 18432
    v_mfma_f32_16x16x32_bf16 v[84:87], a[8:11], a[36:39], v[84:87]
    v_mfma_f32_16x16x32_bf16 v[88:91], a[8:11], a[40:43], v[88:91]
    ds_read_b64_tr_b16 a[28:29], v2 offset:43008
    buffer_load_dwordx4 a[132:135], v16, s[24:27], s49 offen offset:0 sc1
    v_mfma_f32_16x16x32_bf16 v[88:91], a[12:15], a[56:59], v[88:91]
    v_mfma_f32_16x16x32_bf16 v[92:95], a[12:15], a[60:63], v[92:95]
    ds_read_b64_tr_b16 a[30:31], v2 offset:43520
    v_mfma_f32_16x16x32_bf16 v[92:95], a[8:11], a[44:47], v[92:95]
    buffer_load_dwordx4 a[148:151], v16, s[24:27], s49 offen offset:1024 sc1
    s_waitcnt lgkmcnt(4)
    v_mfma_f32_16x16x32_bf16 v[96:99], a[16:19], a[32:35], v[96:99]
    ds_read_b64_tr_b16 a[0:1], v3 offset:32768
    v_mfma_f32_16x16x32_bf16 v[96:99], a[20:23], a[48:51], v[96:99]
    s_add_u32 s49, s49, 18432
    v_mfma_f32_16x16x32_bf16 v[100:103], a[20:23], a[52:55], v[100:103]
    ds_read_b64_tr_b16 a[2:3], v3 offset:33280
    v_mfma_f32_16x16x32_bf16 v[100:103], a[16:19], a[36:39], v[100:103]
    v_mfma_f32_16x16x32_bf16 v[104:107], a[16:19], a[40:43], v[104:107]
    ds_read_b64_tr_b16 a[4:5], v3 offset:40960
    buffer_load_dwordx4 a[136:139], v16, s[24:27], s49 offen offset:0 sc1
    v_mfma_f32_16x16x32_bf16 v[104:107], a[20:23], a[56:59], v[104:107]
    v_mfma_f32_16x16x32_bf16 v[108:111], a[20:23], a[60:63], v[108:111]
    ds_read_b64_tr_b16 a[6:7], v3 offset:41472
    v_mfma_f32_16x16x32_bf16 v[108:111], a[16:19], a[44:47], v[108:111]
    buffer_load_dwordx4 a[152:155], v16, s[24:27], s49 offen offset:1024 sc1
    s_waitcnt lgkmcnt(4)
    v_mfma_f32_16x16x32_bf16 v[112:115], a[24:27], a[32:35], v[112:115]
    ds_read_b64_tr_b16 a[8:9], v3 offset:34816
    v_mfma_f32_16x16x32_bf16 v[112:115], a[28:31], a[48:51], v[112:115]
    s_add_u32 s49, s49, 18432
    v_mfma_f32_16x16x32_bf16 v[116:119], a[28:31], a[52:55], v[116:119]
    ds_read_b64_tr_b16 a[10:11], v3 offset:35328
    v_mfma_f32_16x16x32_bf16 v[116:119], a[24:27], a[36:39], v[116:119]
    v_mfma_f32_16x16x32_bf16 v[120:123], a[24:27], a[40:43], v[120:123]
    ds_read_b64_tr_b16 a[12:13], v3 offset:43008
    buffer_load_dwordx4 a[140:143], v16, s[24:27], s49 offen offset:0 sc1
    v_mfma_f32_16x16x32_bf16 v[120:123], a[28:31], a[56:59], v[120:123]
    v_mfma_f32_16x16x32_bf16 v[124:127], a[28:31], a[60:63], v[124:127]
    ds_read_b64_tr_b16 a[14:15], v3 offset:43520
    buffer_load_dwordx4 a[156:159], v16, s[24:27], s49 offen offset:1024 sc1
    v_mfma_f32_16x16x32_bf16 v[124:127], a[24:27], a[44:47], v[124:127]
    s_waitcnt lgkmcnt(4)
    v_mfma_f32_16x16x32_bf16 v[128:131], a[0:3], a[32:35], v[128:131]
    ds_read_b64_tr_b16 a[16:17], v4 offset:32768
    v_mfma_f32_16x16x32_bf16 v[128:131], a[4:7], a[48:51], v[128:131]
    s_mul_i32 s56, s88, 589824
    s_add_u32 s56, s56, s52
    s_add_u32 m0, s46, 65536
    v_mfma_f32_16x16x32_bf16 v[132:135], a[4:7], a[52:55], v[132:135]
    ds_read_b64_tr_b16 a[18:19], v4 offset:33280
    v_mfma_f32_16x16x32_bf16 v[132:135], a[0:3], a[36:39], v[132:135]
    v_mfma_f32_16x16x32_bf16 v[136:139], a[0:3], a[40:43], v[136:139]
    ds_read_b64_tr_b16 a[20:21], v4 offset:40960
    v_mfma_f32_16x16x32_bf16 v[136:139], a[4:7], a[56:59], v[136:139]
    v_mfma_f32_16x16x32_bf16 v[140:143], a[4:7], a[60:63], v[140:143]
    ds_read_b64_tr_b16 a[22:23], v4 offset:41472
    v_mfma_f32_16x16x32_bf16 v[140:143], a[0:3], a[44:47], v[140:143]
    s_waitcnt lgkmcnt(4)
    v_mfma_f32_16x16x32_bf16 v[144:147], a[8:11], a[32:35], v[144:147]
    ds_read_b64_tr_b16 a[24:25], v4 offset:34816
    v_mfma_f32_16x16x32_bf16 v[144:147], a[12:15], a[48:51], v[144:147]
    buffer_load_dwordx4 v17, s[12:15], s56 offen  lds
    v_mfma_f32_16x16x32_bf16 v[148:151], a[12:15], a[52:55], v[148:151]
    ds_read_b64_tr_b16 a[26:27], v4 offset:35328
    v_mfma_f32_16x16x32_bf16 v[148:151], a[8:11], a[36:39], v[148:151]
    s_add_u32 m0, s46, 66560
    v_mfma_f32_16x16x32_bf16 v[152:155], a[8:11], a[40:43], v[152:155]
    ds_read_b64_tr_b16 a[28:29], v4 offset:43008
    v_mfma_f32_16x16x32_bf16 v[152:155], a[12:15], a[56:59], v[152:155]
    v_mfma_f32_16x16x32_bf16 v[156:159], a[12:15], a[60:63], v[156:159]
    ds_read_b64_tr_b16 a[30:31], v4 offset:43520
    buffer_load_dwordx4 v18, s[12:15], s56 offen  lds
    v_mfma_f32_16x16x32_bf16 v[156:159], a[8:11], a[44:47], v[156:159]
    s_waitcnt vmcnt(10)
    s_barrier
    s_waitcnt lgkmcnt(4)
    v_mfma_f32_16x16x32_bf16 v[160:163], a[16:19], a[32:35], v[160:163]
    ds_read_b64_tr_b16 a[0:1], v1 offset:49152
    s_add_u32 m0, s46, 67584
    v_mfma_f32_16x16x32_bf16 v[160:163], a[20:23], a[48:51], v[160:163]
    v_mfma_f32_16x16x32_bf16 v[164:167], a[20:23], a[52:55], v[164:167]
    ds_read_b64_tr_b16 a[2:3], v1 offset:49664
    v_mfma_f32_16x16x32_bf16 v[164:167], a[16:19], a[36:39], v[164:167]
    buffer_load_dwordx4 v17, s[16:19], s56 offen  lds
    v_mfma_f32_16x16x32_bf16 v[168:171], a[16:19], a[40:43], v[168:171]
    ds_read_b64_tr_b16 a[4:5], v1 offset:57344
    v_mfma_f32_16x16x32_bf16 v[168:171], a[20:23], a[56:59], v[168:171]
    s_add_u32 m0, s46, 68608
    v_mfma_f32_16x16x32_bf16 v[172:175], a[20:23], a[60:63], v[172:175]
    ds_read_b64_tr_b16 a[6:7], v1 offset:57856
    v_mfma_f32_16x16x32_bf16 v[172:175], a[16:19], a[44:47], v[172:175]
    s_waitcnt lgkmcnt(4)
    v_mfma_f32_16x16x32_bf16 v[176:179], a[24:27], a[32:35], v[176:179]
    ds_read_b64_tr_b16 a[8:9], v1 offset:51200
    buffer_load_dwordx4 v18, s[16:19], s56 offen  lds
    v_mfma_f32_16x16x32_bf16 v[176:179], a[28:31], a[48:51], v[176:179]
    v_mfma_f32_16x16x32_bf16 v[180:183], a[28:31], a[52:55], v[180:183]
    ds_read_b64_tr_b16 a[10:11], v1 offset:51712
    v_mfma_f32_16x16x32_bf16 v[180:183], a[24:27], a[36:39], v[180:183]
    v_mfma_f32_16x16x32_bf16 v[184:187], a[24:27], a[40:43], v[184:187]
    ds_read_b64_tr_b16 a[12:13], v1 offset:59392
    v_mfma_f32_16x16x32_bf16 v[184:187], a[28:31], a[56:59], v[184:187]
    v_mfma_f32_16x16x32_bf16 v[188:191], a[28:31], a[60:63], v[188:191]
    ds_read_b64_tr_b16 a[14:15], v1 offset:59904
    v_mfma_f32_16x16x32_bf16 v[188:191], a[24:27], a[44:47], v[188:191]
    s_waitcnt vmcnt(24)
    s_waitcnt lgkmcnt(4)
    v_mfma_f32_16x16x32_bf16 v[64:67], a[0:3], a[64:67], v[64:67]
    ds_read_b64_tr_b16 a[16:17], v2 offset:49152
    v_mfma_f32_16x16x32_bf16 v[64:67], a[4:7], a[80:83], v[64:67]
    s_lshl_b32 s49, s90, 11
    s_add_u32 s49, s49, s48
    v_mfma_f32_16x16x32_bf16 v[68:71], a[4:7], a[84:87], v[68:71]
    ds_read_b64_tr_b16 a[18:19], v2 offset:49664
    v_mfma_f32_16x16x32_bf16 v[68:71], a[0:3], a[68:71], v[68:71]
    v_mfma_f32_16x16x32_bf16 v[72:75], a[0:3], a[72:75], v[72:75]
    ds_read_b64_tr_b16 a[20:21], v2 offset:57344
    v_mfma_f32_16x16x32_bf16 v[72:75], a[4:7], a[88:91], v[72:75]
    buffer_load_dwordx4 a[160:163], v16, s[24:27], s49 offen offset:0 sc1
    v_mfma_f32_16x16x32_bf16 v[76:79], a[4:7], a[92:95], v[76:79]
    ds_read_b64_tr_b16 a[22:23], v2 offset:57856
    v_mfma_f32_16x16x32_bf16 v[76:79], a[0:3], a[76:79], v[76:79]
    buffer_load_dwordx4 a[176:179], v16, s[24:27], s49 offen offset:1024 sc1
    s_waitcnt lgkmcnt(4)
    v_mfma_f32_16x16x32_bf16 v[80:83], a[8:11], a[64:67], v[80:83]
    ds_read_b64_tr_b16 a[24:25], v2 offset:51200
    v_mfma_f32_16x16x32_bf16 v[80:83], a[12:15], a[80:83], v[80:83]
    v_mfma_f32_16x16x32_bf16 v[84:87], a[12:15], a[84:87], v[84:87]
    ds_read_b64_tr_b16 a[26:27], v2 offset:51712
    s_add_u32 s49, s49, 18432
    v_mfma_f32_16x16x32_bf16 v[84:87], a[8:11], a[68:71], v[84:87]
    v_mfma_f32_16x16x32_bf16 v[88:91], a[8:11], a[72:75], v[88:91]
    ds_read_b64_tr_b16 a[28:29], v2 offset:59392
    buffer_load_dwordx4 a[164:167], v16, s[24:27], s49 offen offset:0 sc1
    v_mfma_f32_16x16x32_bf16 v[88:91], a[12:15], a[88:91], v[88:91]
    v_mfma_f32_16x16x32_bf16 v[92:95], a[12:15], a[92:95], v[92:95]
    ds_read_b64_tr_b16 a[30:31], v2 offset:59904
    v_mfma_f32_16x16x32_bf16 v[92:95], a[8:11], a[76:79], v[92:95]
    buffer_load_dwordx4 a[180:183], v16, s[24:27], s49 offen offset:1024 sc1
    s_waitcnt lgkmcnt(4)
    v_mfma_f32_16x16x32_bf16 v[96:99], a[16:19], a[64:67], v[96:99]
    ds_read_b64_tr_b16 a[0:1], v3 offset:49152
    v_mfma_f32_16x16x32_bf16 v[96:99], a[20:23], a[80:83], v[96:99]
    s_add_u32 s49, s49, 18432
    v_mfma_f32_16x16x32_bf16 v[100:103], a[20:23], a[84:87], v[100:103]
    ds_read_b64_tr_b16 a[2:3], v3 offset:49664
    v_mfma_f32_16x16x32_bf16 v[100:103], a[16:19], a[68:71], v[100:103]
    v_mfma_f32_16x16x32_bf16 v[104:107], a[16:19], a[72:75], v[104:107]
    ds_read_b64_tr_b16 a[4:5], v3 offset:57344
    buffer_load_dwordx4 a[168:171], v16, s[24:27], s49 offen offset:0 sc1
    v_mfma_f32_16x16x32_bf16 v[104:107], a[20:23], a[88:91], v[104:107]
    v_mfma_f32_16x16x32_bf16 v[108:111], a[20:23], a[92:95], v[108:111]
    ds_read_b64_tr_b16 a[6:7], v3 offset:57856
    v_mfma_f32_16x16x32_bf16 v[108:111], a[16:19], a[76:79], v[108:111]
    buffer_load_dwordx4 a[184:187], v16, s[24:27], s49 offen offset:1024 sc1
    s_waitcnt lgkmcnt(4)
    v_mfma_f32_16x16x32_bf16 v[112:115], a[24:27], a[64:67], v[112:115]
    ds_read_b64_tr_b16 a[8:9], v3 offset:51200
    v_mfma_f32_16x16x32_bf16 v[112:115], a[28:31], a[80:83], v[112:115]
    s_add_u32 s49, s49, 18432
    v_mfma_f32_16x16x32_bf16 v[116:119], a[28:31], a[84:87], v[116:119]
    ds_read_b64_tr_b16 a[10:11], v3 offset:51712
    v_mfma_f32_16x16x32_bf16 v[116:119], a[24:27], a[68:71], v[116:119]
    v_mfma_f32_16x16x32_bf16 v[120:123], a[24:27], a[72:75], v[120:123]
    ds_read_b64_tr_b16 a[12:13], v3 offset:59392
    buffer_load_dwordx4 a[172:175], v16, s[24:27], s49 offen offset:0 sc1
    v_mfma_f32_16x16x32_bf16 v[120:123], a[28:31], a[88:91], v[120:123]
    v_mfma_f32_16x16x32_bf16 v[124:127], a[28:31], a[92:95], v[124:127]
    ds_read_b64_tr_b16 a[14:15], v3 offset:59904
    buffer_load_dwordx4 a[188:191], v16, s[24:27], s49 offen offset:1024 sc1
    v_mfma_f32_16x16x32_bf16 v[124:127], a[24:27], a[76:79], v[124:127]
    s_waitcnt lgkmcnt(4)
    v_mfma_f32_16x16x32_bf16 v[128:131], a[0:3], a[64:67], v[128:131]
    ds_read_b64_tr_b16 a[16:17], v4 offset:49152
    v_mfma_f32_16x16x32_bf16 v[128:131], a[4:7], a[80:83], v[128:131]
    s_mul_i32 s56, s89, 589824
    s_add_u32 s56, s56, s52
    s_add_u32 m0, s46, 81920
    v_mfma_f32_16x16x32_bf16 v[132:135], a[4:7], a[84:87], v[132:135]
    ds_read_b64_tr_b16 a[18:19], v4 offset:49664
    v_mfma_f32_16x16x32_bf16 v[132:135], a[0:3], a[68:71], v[132:135]
    v_mfma_f32_16x16x32_bf16 v[136:139], a[0:3], a[72:75], v[136:139]
    ds_read_b64_tr_b16 a[20:21], v4 offset:57344
    v_mfma_f32_16x16x32_bf16 v[136:139], a[4:7], a[88:91], v[136:139]
    v_mfma_f32_16x16x32_bf16 v[140:143], a[4:7], a[92:95], v[140:143]
    ds_read_b64_tr_b16 a[22:23], v4 offset:57856
    v_mfma_f32_16x16x32_bf16 v[140:143], a[0:3], a[76:79], v[140:143]
    s_waitcnt lgkmcnt(4)
    v_mfma_f32_16x16x32_bf16 v[144:147], a[8:11], a[64:67], v[144:147]
    ds_read_b64_tr_b16 a[24:25], v4 offset:51200
    v_mfma_f32_16x16x32_bf16 v[144:147], a[12:15], a[80:83], v[144:147]
    buffer_load_dwordx4 v17, s[12:15], s56 offen  lds
    v_mfma_f32_16x16x32_bf16 v[148:151], a[12:15], a[84:87], v[148:151]
    ds_read_b64_tr_b16 a[26:27], v4 offset:51712
    v_mfma_f32_16x16x32_bf16 v[148:151], a[8:11], a[68:71], v[148:151]
    s_add_u32 m0, s46, 82944
    v_mfma_f32_16x16x32_bf16 v[152:155], a[8:11], a[72:75], v[152:155]
    ds_read_b64_tr_b16 a[28:29], v4 offset:59392
    v_mfma_f32_16x16x32_bf16 v[152:155], a[12:15], a[88:91], v[152:155]
    v_mfma_f32_16x16x32_bf16 v[156:159], a[12:15], a[92:95], v[156:159]
    ds_read_b64_tr_b16 a[30:31], v4 offset:59904
    buffer_load_dwordx4 v18, s[12:15], s56 offen  lds
    v_mfma_f32_16x16x32_bf16 v[156:159], a[8:11], a[76:79], v[156:159]
    s_waitcnt vmcnt(10)
    s_barrier
    s_waitcnt lgkmcnt(4)
    v_mfma_f32_16x16x32_bf16 v[160:163], a[16:19], a[64:67], v[160:163]
    v_add_u32 v1, 65536, v1
    ds_read_b64_tr_b16 a[0:1], v1 offset:0
    s_add_u32 m0, s46, 83968
    v_mfma_f32_16x16x32_bf16 v[160:163], a[20:23], a[80:83], v[160:163]
    v_mfma_f32_16x16x32_bf16 v[164:167], a[20:23], a[84:87], v[164:167]
    ds_read_b64_tr_b16 a[2:3], v1 offset:512
    v_mfma_f32_16x16x32_bf16 v[164:167], a[16:19], a[68:71], v[164:167]
    buffer_load_dwordx4 v17, s[16:19], s56 offen  lds
    v_mfma_f32_16x16x32_bf16 v[168:171], a[16:19], a[72:75], v[168:171]
    ds_read_b64_tr_b16 a[4:5], v1 offset:8192
    v_mfma_f32_16x16x32_bf16 v[168:171], a[20:23], a[88:91], v[168:171]
    s_add_u32 m0, s46, 84992
    v_mfma_f32_16x16x32_bf16 v[172:175], a[20:23], a[92:95], v[172:175]
    ds_read_b64_tr_b16 a[6:7], v1 offset:8704
    v_mfma_f32_16x16x32_bf16 v[172:175], a[16:19], a[76:79], v[172:175]
    s_waitcnt lgkmcnt(4)
    v_mfma_f32_16x16x32_bf16 v[176:179], a[24:27], a[64:67], v[176:179]
    ds_read_b64_tr_b16 a[8:9], v1 offset:2048
    buffer_load_dwordx4 v18, s[16:19], s56 offen  lds
    v_mfma_f32_16x16x32_bf16 v[176:179], a[28:31], a[80:83], v[176:179]
    v_mfma_f32_16x16x32_bf16 v[180:183], a[28:31], a[84:87], v[180:183]
    ds_read_b64_tr_b16 a[10:11], v1 offset:2560
    v_mfma_f32_16x16x32_bf16 v[180:183], a[24:27], a[68:71], v[180:183]
    v_mfma_f32_16x16x32_bf16 v[184:187], a[24:27], a[72:75], v[184:187]
    ds_read_b64_tr_b16 a[12:13], v1 offset:10240
    v_mfma_f32_16x16x32_bf16 v[184:187], a[28:31], a[88:91], v[184:187]
    v_mfma_f32_16x16x32_bf16 v[188:191], a[28:31], a[92:95], v[188:191]
    ds_read_b64_tr_b16 a[14:15], v1 offset:10752
    v_mfma_f32_16x16x32_bf16 v[188:191], a[24:27], a[76:79], v[188:191]
    s_waitcnt vmcnt(28)
    s_waitcnt lgkmcnt(4)
    v_mfma_f32_16x16x32_bf16 v[64:67], a[0:3], a[96:99], v[64:67]
    v_add_u32 v2, 65536, v2
    ds_read_b64_tr_b16 a[16:17], v2 offset:0
    v_mfma_f32_16x16x32_bf16 v[64:67], a[4:7], a[112:115], v[64:67]
    s_lshl_b32 s49, s91, 11
    s_add_u32 s49, s49, s48
    v_mfma_f32_16x16x32_bf16 v[68:71], a[4:7], a[116:119], v[68:71]
    ds_read_b64_tr_b16 a[18:19], v2 offset:512
    v_mfma_f32_16x16x32_bf16 v[68:71], a[0:3], a[100:103], v[68:71]
    buffer_load_dwordx4 a[192:195], v16, s[24:27], s49 offen offset:0 sc1
    v_mfma_f32_16x16x32_bf16 v[72:75], a[0:3], a[104:107], v[72:75]
    ds_read_b64_tr_b16 a[20:21], v2 offset:8192
    v_mfma_f32_16x16x32_bf16 v[72:75], a[4:7], a[120:123], v[72:75]
    buffer_load_dwordx4 a[208:211], v16, s[24:27], s49 offen offset:1024 sc1
    v_mfma_f32_16x16x32_bf16 v[76:79], a[4:7], a[124:127], v[76:79]
    ds_read_b64_tr_b16 a[22:23], v2 offset:8704
    v_mfma_f32_16x16x32_bf16 v[76:79], a[0:3], a[108:111], v[76:79]
    s_add_u32 s49, s49, 18432
    s_waitcnt lgkmcnt(4)
    v_mfma_f32_16x16x32_bf16 v[80:83], a[8:11], a[96:99], v[80:83]
    ds_read_b64_tr_b16 a[24:25], v2 offset:2048
    buffer_load_dwordx4 a[196:199], v16, s[24:27], s49 offen offset:0 sc1
    v_mfma_f32_16x16x32_bf16 v[80:83], a[12:15], a[112:115], v[80:83]
    v_mfma_f32_16x16x32_bf16 v[84:87], a[12:15], a[116:119], v[84:87]
    ds_read_b64_tr_b16 a[26:27], v2 offset:2560
    buffer_load_dwordx4 a[212:215], v16, s[24:27], s49 offen offset:1024 sc1
    v_mfma_f32_16x16x32_bf16 v[84:87], a[8:11], a[100:103], v[84:87]
    v_mfma_f32_16x16x32_bf16 v[88:91], a[8:11], a[104:107], v[88:91]
    ds_read_b64_tr_b16 a[28:29], v2 offset:10240
    s_add_u32 s49, s49, 18432
    v_mfma_f32_16x16x32_bf16 v[88:91], a[12:15], a[120:123], v[88:91]
    v_mfma_f32_16x16x32_bf16 v[92:95], a[12:15], a[124:127], v[92:95]
    ds_read_b64_tr_b16 a[30:31], v2 offset:10752
    buffer_load_dwordx4 a[200:203], v16, s[24:27], s49 offen offset:0 sc1
    v_mfma_f32_16x16x32_bf16 v[92:95], a[8:11], a[108:111], v[92:95]
    s_waitcnt lgkmcnt(4)
    v_mfma_f32_16x16x32_bf16 v[96:99], a[16:19], a[96:99], v[96:99]
    v_add_u32 v3, 65536, v3
    ds_read_b64_tr_b16 a[0:1], v3 offset:0
    buffer_load_dwordx4 a[216:219], v16, s[24:27], s49 offen offset:1024 sc1
    v_mfma_f32_16x16x32_bf16 v[96:99], a[20:23], a[112:115], v[96:99]
    s_add_u32 s49, s49, 18432
    v_mfma_f32_16x16x32_bf16 v[100:103], a[20:23], a[116:119], v[100:103]
    ds_read_b64_tr_b16 a[2:3], v3 offset:512
    v_mfma_f32_16x16x32_bf16 v[100:103], a[16:19], a[100:103], v[100:103]
    buffer_load_dwordx4 a[204:207], v16, s[24:27], s49 offen offset:0 sc1
    v_mfma_f32_16x16x32_bf16 v[104:107], a[16:19], a[104:107], v[104:107]
    ds_read_b64_tr_b16 a[4:5], v3 offset:8192
    v_mfma_f32_16x16x32_bf16 v[104:107], a[20:23], a[120:123], v[104:107]
    buffer_load_dwordx4 a[220:223], v16, s[24:27], s49 offen offset:1024 sc1
    v_mfma_f32_16x16x32_bf16 v[108:111], a[20:23], a[124:127], v[108:111]
    ds_read_b64_tr_b16 a[6:7], v3 offset:8704
    v_mfma_f32_16x16x32_bf16 v[108:111], a[16:19], a[108:111], v[108:111]
    s_waitcnt lgkmcnt(4)
    v_mfma_f32_16x16x32_bf16 v[112:115], a[24:27], a[96:99], v[112:115]
    ds_read_b64_tr_b16 a[8:9], v3 offset:2048
    v_mfma_f32_16x16x32_bf16 v[112:115], a[28:31], a[112:115], v[112:115]
    s_mul_i32 s56, s90, 589824
    s_add_u32 s56, s56, s52
    s_add_u32 m0, s46, 98304
    v_mfma_f32_16x16x32_bf16 v[116:119], a[28:31], a[116:119], v[116:119]
    ds_read_b64_tr_b16 a[10:11], v3 offset:2560
    v_mfma_f32_16x16x32_bf16 v[116:119], a[24:27], a[100:103], v[116:119]
    v_mfma_f32_16x16x32_bf16 v[120:123], a[24:27], a[104:107], v[120:123]
    ds_read_b64_tr_b16 a[12:13], v3 offset:10240
    buffer_load_dwordx4 v17, s[12:15], s56 offen  lds
    v_mfma_f32_16x16x32_bf16 v[120:123], a[28:31], a[120:123], v[120:123]
    v_mfma_f32_16x16x32_bf16 v[124:127], a[28:31], a[124:127], v[124:127]
    ds_read_b64_tr_b16 a[14:15], v3 offset:10752
    s_add_u32 m0, s46, 99328
    v_mfma_f32_16x16x32_bf16 v[124:127], a[24:27], a[108:111], v[124:127]
    s_waitcnt lgkmcnt(4)
    v_mfma_f32_16x16x32_bf16 v[128:131], a[0:3], a[96:99], v[128:131]
    v_add_u32 v4, 65536, v4
    ds_read_b64_tr_b16 a[16:17], v4 offset:0
    buffer_load_dwordx4 v18, s[12:15], s56 offen  lds
    v_mfma_f32_16x16x32_bf16 v[128:131], a[4:7], a[112:115], v[128:131]
    s_add_u32 m0, s46, 100352
    v_mfma_f32_16x16x32_bf16 v[132:135], a[4:7], a[116:119], v[132:135]
    ds_read_b64_tr_b16 a[18:19], v4 offset:512
    v_mfma_f32_16x16x32_bf16 v[132:135], a[0:3], a[100:103], v[132:135]
    buffer_load_dwordx4 v17, s[16:19], s56 offen  lds
    v_mfma_f32_16x16x32_bf16 v[136:139], a[0:3], a[104:107], v[136:139]
    ds_read_b64_tr_b16 a[20:21], v4 offset:8192
    v_mfma_f32_16x16x32_bf16 v[136:139], a[4:7], a[120:123], v[136:139]
    s_add_u32 m0, s46, 101376
    v_mfma_f32_16x16x32_bf16 v[140:143], a[4:7], a[124:127], v[140:143]
    ds_read_b64_tr_b16 a[22:23], v4 offset:8704
    v_mfma_f32_16x16x32_bf16 v[140:143], a[0:3], a[108:111], v[140:143]
    buffer_load_dwordx4 v18, s[16:19], s56 offen  lds
    s_waitcnt lgkmcnt(4)
    v_mfma_f32_16x16x32_bf16 v[144:147], a[8:11], a[96:99], v[144:147]
    ds_read_b64_tr_b16 a[24:25], v4 offset:2048
    v_mfma_f32_16x16x32_bf16 v[144:147], a[12:15], a[112:115], v[144:147]
    s_mul_i32 s56, s91, 589824
    s_add_u32 s56, s56, s52
    s_add_u32 m0, s46, 114688
    v_mfma_f32_16x16x32_bf16 v[148:151], a[12:15], a[116:119], v[148:151]
    ds_read_b64_tr_b16 a[26:27], v4 offset:2560
    v_mfma_f32_16x16x32_bf16 v[148:151], a[8:11], a[100:103], v[148:151]
    v_mfma_f32_16x16x32_bf16 v[152:155], a[8:11], a[104:107], v[152:155]
    ds_read_b64_tr_b16 a[28:29], v4 offset:10240
    v_mfma_f32_16x16x32_bf16 v[152:155], a[12:15], a[120:123], v[152:155]
    v_mfma_f32_16x16x32_bf16 v[156:159], a[12:15], a[124:127], v[156:159]
    ds_read_b64_tr_b16 a[30:31], v4 offset:10752
    buffer_load_dwordx4 v17, s[12:15], s56 offen  lds
    v_mfma_f32_16x16x32_bf16 v[156:159], a[8:11], a[108:111], v[156:159]
    s_waitcnt vmcnt(13)
    s_barrier
    s_waitcnt lgkmcnt(4)
    v_mfma_f32_16x16x32_bf16 v[160:163], a[16:19], a[96:99], v[160:163]
    ds_read_b64_tr_b16 a[0:1], v1 offset:16384
    s_add_u32 m0, s46, 115712
    v_mfma_f32_16x16x32_bf16 v[160:163], a[20:23], a[112:115], v[160:163]
    v_mfma_f32_16x16x32_bf16 v[164:167], a[20:23], a[116:119], v[164:167]
    ds_read_b64_tr_b16 a[2:3], v1 offset:16896
    buffer_load_dwordx4 v18, s[12:15], s56 offen  lds
    v_mfma_f32_16x16x32_bf16 v[164:167], a[16:19], a[100:103], v[164:167]
    s_add_u32 m0, s46, 116736
    v_mfma_f32_16x16x32_bf16 v[168:171], a[16:19], a[104:107], v[168:171]
    ds_read_b64_tr_b16 a[4:5], v1 offset:24576
    v_mfma_f32_16x16x32_bf16 v[168:171], a[20:23], a[120:123], v[168:171]
    buffer_load_dwordx4 v17, s[16:19], s56 offen  lds
    v_mfma_f32_16x16x32_bf16 v[172:175], a[20:23], a[124:127], v[172:175]
    ds_read_b64_tr_b16 a[6:7], v1 offset:25088
    v_mfma_f32_16x16x32_bf16 v[172:175], a[16:19], a[108:111], v[172:175]
    s_add_u32 m0, s46, 117760
    s_waitcnt lgkmcnt(4)
    v_mfma_f32_16x16x32_bf16 v[176:179], a[24:27], a[96:99], v[176:179]
    ds_read_b64_tr_b16 a[8:9], v1 offset:18432
    v_mfma_f32_16x16x32_bf16 v[176:179], a[28:31], a[112:115], v[176:179]
    buffer_load_dwordx4 v18, s[16:19], s56 offen  lds
    v_mfma_f32_16x16x32_bf16 v[180:183], a[28:31], a[116:119], v[180:183]
    ds_read_b64_tr_b16 a[10:11], v1 offset:18944
    v_mfma_f32_16x16x32_bf16 v[180:183], a[24:27], a[100:103], v[180:183]
    v_mfma_f32_16x16x32_bf16 v[184:187], a[24:27], a[104:107], v[184:187]
    ds_read_b64_tr_b16 a[12:13], v1 offset:26624
    v_mfma_f32_16x16x32_bf16 v[184:187], a[28:31], a[120:123], v[184:187]
    v_mfma_f32_16x16x32_bf16 v[188:191], a[28:31], a[124:127], v[188:191]
    ds_read_b64_tr_b16 a[14:15], v1 offset:27136
    v_mfma_f32_16x16x32_bf16 v[188:191], a[24:27], a[108:111], v[188:191]
    s_waitcnt vmcnt(32)
    s_waitcnt lgkmcnt(4)
    v_mfma_f32_16x16x32_bf16 v[64:67], a[0:3], a[128:131], v[64:67]
    ds_read_b64_tr_b16 a[16:17], v2 offset:16384
    v_mfma_f32_16x16x32_bf16 v[64:67], a[4:7], a[144:147], v[64:67]
    s_lshl_b32 s49, s92, 11
    s_add_u32 s49, s49, s48
    v_mfma_f32_16x16x32_bf16 v[68:71], a[4:7], a[148:151], v[68:71]
    ds_read_b64_tr_b16 a[18:19], v2 offset:16896
    v_mfma_f32_16x16x32_bf16 v[68:71], a[0:3], a[132:135], v[68:71]
    v_mfma_f32_16x16x32_bf16 v[72:75], a[0:3], a[136:139], v[72:75]
    ds_read_b64_tr_b16 a[20:21], v2 offset:24576
    buffer_load_dwordx4 a[224:227], v16, s[24:27], s49 offen offset:0 sc1
    v_mfma_f32_16x16x32_bf16 v[72:75], a[4:7], a[152:155], v[72:75]
    v_mfma_f32_16x16x32_bf16 v[76:79], a[4:7], a[156:159], v[76:79]
    ds_read_b64_tr_b16 a[22:23], v2 offset:25088
    v_mfma_f32_16x16x32_bf16 v[76:79], a[0:3], a[140:143], v[76:79]
    buffer_load_dwordx4 a[240:243], v16, s[24:27], s49 offen offset:1024 sc1
    s_waitcnt lgkmcnt(4)
    v_mfma_f32_16x16x32_bf16 v[80:83], a[8:11], a[128:131], v[80:83]
    ds_read_b64_tr_b16 a[24:25], v2 offset:18432
    v_mfma_f32_16x16x32_bf16 v[80:83], a[12:15], a[144:147], v[80:83]
    s_add_u32 s49, s49, 18432
    v_mfma_f32_16x16x32_bf16 v[84:87], a[12:15], a[148:151], v[84:87]
    ds_read_b64_tr_b16 a[26:27], v2 offset:18944
    v_mfma_f32_16x16x32_bf16 v[84:87], a[8:11], a[132:135], v[84:87]
    v_mfma_f32_16x16x32_bf16 v[88:91], a[8:11], a[136:139], v[88:91]
    ds_read_b64_tr_b16 a[28:29], v2 offset:26624
    buffer_load_dwordx4 a[228:231], v16, s[24:27], s49 offen offset:0 sc1
    v_mfma_f32_16x16x32_bf16 v[88:91], a[12:15], a[152:155], v[88:91]
    v_mfma_f32_16x16x32_bf16 v[92:95], a[12:15], a[156:159], v[92:95]
    ds_read_b64_tr_b16 a[30:31], v2 offset:27136
    buffer_load_dwordx4 a[244:247], v16, s[24:27], s49 offen offset:1024 sc1
    v_mfma_f32_16x16x32_bf16 v[92:95], a[8:11], a[140:143], v[92:95]
    s_waitcnt lgkmcnt(4)
    v_mfma_f32_16x16x32_bf16 v[96:99], a[16:19], a[128:131], v[96:99]
    ds_read_b64_tr_b16 a[0:1], v3 offset:16384
    v_mfma_f32_16x16x32_bf16 v[96:99], a[20:23], a[144:147], v[96:99]
    s_add_u32 s49, s49, 18432
    v_mfma_f32_16x16x32_bf16 v[100:103], a[20:23], a[148:151], v[100:103]
    ds_read_b64_tr_b16 a[2:3], v3 offset:16896
    v_mfma_f32_16x16x32_bf16 v[100:103], a[16:19], a[132:135], v[100:103]
    buffer_load_dwordx4 a[232:235], v16, s[24:27], s49 offen offset:0 sc1
    v_mfma_f32_16x16x32_bf16 v[104:107], a[16:19], a[136:139], v[104:107]
    ds_read_b64_tr_b16 a[4:5], v3 offset:24576
    v_mfma_f32_16x16x32_bf16 v[104:107], a[20:23], a[152:155], v[104:107]
    v_mfma_f32_16x16x32_bf16 v[108:111], a[20:23], a[156:159], v[108:111]
    ds_read_b64_tr_b16 a[6:7], v3 offset:25088
    buffer_load_dwordx4 a[248:251], v16, s[24:27], s49 offen offset:1024 sc1
    v_mfma_f32_16x16x32_bf16 v[108:111], a[16:19], a[140:143], v[108:111]
    s_waitcnt lgkmcnt(4)
    v_mfma_f32_16x16x32_bf16 v[112:115], a[24:27], a[128:131], v[112:115]
    ds_read_b64_tr_b16 a[8:9], v3 offset:18432
    s_add_u32 s49, s49, 18432
    v_mfma_f32_16x16x32_bf16 v[112:115], a[28:31], a[144:147], v[112:115]
    v_mfma_f32_16x16x32_bf16 v[116:119], a[28:31], a[148:151], v[116:119]
    ds_read_b64_tr_b16 a[10:11], v3 offset:18944
    v_mfma_f32_16x16x32_bf16 v[116:119], a[24:27], a[132:135], v[116:119]
    buffer_load_dwordx4 a[236:239], v16, s[24:27], s49 offen offset:0 sc1
    v_mfma_f32_16x16x32_bf16 v[120:123], a[24:27], a[136:139], v[120:123]
    ds_read_b64_tr_b16 a[12:13], v3 offset:26624
    v_mfma_f32_16x16x32_bf16 v[120:123], a[28:31], a[152:155], v[120:123]
    buffer_load_dwordx4 a[252:255], v16, s[24:27], s49 offen offset:1024 sc1
    v_mfma_f32_16x16x32_bf16 v[124:127], a[28:31], a[156:159], v[124:127]
    ds_read_b64_tr_b16 a[14:15], v3 offset:27136
    v_mfma_f32_16x16x32_bf16 v[124:127], a[24:27], a[140:143], v[124:127]
    s_waitcnt lgkmcnt(4)
    v_mfma_f32_16x16x32_bf16 v[128:131], a[0:3], a[128:131], v[128:131]
    ds_read_b64_tr_b16 a[16:17], v4 offset:16384
    v_mfma_f32_16x16x32_bf16 v[128:131], a[4:7], a[144:147], v[128:131]
    s_mul_i32 s56, s92, 589824
    s_add_u32 s56, s56, s52
    s_add_u32 s52, s52, 1024
    s_add_u32 m0, s46, 131072
    v_mfma_f32_16x16x32_bf16 v[132:135], a[4:7], a[148:151], v[132:135]
    ds_read_b64_tr_b16 a[18:19], v4 offset:16896
    v_mfma_f32_16x16x32_bf16 v[132:135], a[0:3], a[132:135], v[132:135]
    v_mfma_f32_16x16x32_bf16 v[136:139], a[0:3], a[136:139], v[136:139]
    ds_read_b64_tr_b16 a[20:21], v4 offset:24576
    v_mfma_f32_16x16x32_bf16 v[136:139], a[4:7], a[152:155], v[136:139]
    v_mfma_f32_16x16x32_bf16 v[140:143], a[4:7], a[156:159], v[140:143]
    ds_read_b64_tr_b16 a[22:23], v4 offset:25088
    v_mfma_f32_16x16x32_bf16 v[140:143], a[0:3], a[140:143], v[140:143]
    s_waitcnt lgkmcnt(4)
    v_mfma_f32_16x16x32_bf16 v[144:147], a[8:11], a[128:131], v[144:147]
    ds_read_b64_tr_b16 a[24:25], v4 offset:18432
    v_mfma_f32_16x16x32_bf16 v[144:147], a[12:15], a[144:147], v[144:147]
    buffer_load_dwordx4 v17, s[12:15], s56 offen  lds
    v_mfma_f32_16x16x32_bf16 v[148:151], a[12:15], a[148:151], v[148:151]
    ds_read_b64_tr_b16 a[26:27], v4 offset:18944
    v_mfma_f32_16x16x32_bf16 v[148:151], a[8:11], a[132:135], v[148:151]
    v_mfma_f32_16x16x32_bf16 v[152:155], a[8:11], a[136:139], v[152:155]
    ds_read_b64_tr_b16 a[28:29], v4 offset:26624
    s_add_u32 m0, s46, 132096
    v_mfma_f32_16x16x32_bf16 v[152:155], a[12:15], a[152:155], v[152:155]
    v_mfma_f32_16x16x32_bf16 v[156:159], a[12:15], a[156:159], v[156:159]
    ds_read_b64_tr_b16 a[30:31], v4 offset:27136
    buffer_load_dwordx4 v18, s[12:15], s56 offen  lds
    v_mfma_f32_16x16x32_bf16 v[156:159], a[8:11], a[140:143], v[156:159]
    s_waitcnt vmcnt(14)
    s_barrier
    s_waitcnt lgkmcnt(4)
    v_mfma_f32_16x16x32_bf16 v[160:163], a[16:19], a[128:131], v[160:163]
    ds_read_b64_tr_b16 a[0:1], v1 offset:32768
    v_mfma_f32_16x16x32_bf16 v[160:163], a[20:23], a[144:147], v[160:163]
    s_add_u32 m0, s46, 133120
    v_mfma_f32_16x16x32_bf16 v[164:167], a[20:23], a[148:151], v[164:167]
    ds_read_b64_tr_b16 a[2:3], v1 offset:33280
    v_mfma_f32_16x16x32_bf16 v[164:167], a[16:19], a[132:135], v[164:167]
    buffer_load_dwordx4 v17, s[16:19], s56 offen  lds
    v_mfma_f32_16x16x32_bf16 v[168:171], a[16:19], a[136:139], v[168:171]
    ds_read_b64_tr_b16 a[4:5], v1 offset:40960
    v_mfma_f32_16x16x32_bf16 v[168:171], a[20:23], a[152:155], v[168:171]
    v_mfma_f32_16x16x32_bf16 v[172:175], a[20:23], a[156:159], v[172:175]
    ds_read_b64_tr_b16 a[6:7], v1 offset:41472
    s_add_u32 m0, s46, 134144
    v_mfma_f32_16x16x32_bf16 v[172:175], a[16:19], a[140:143], v[172:175]
    s_waitcnt lgkmcnt(4)
    v_mfma_f32_16x16x32_bf16 v[176:179], a[24:27], a[128:131], v[176:179]
    ds_read_b64_tr_b16 a[8:9], v1 offset:34816
    buffer_load_dwordx4 v18, s[16:19], s56 offen  lds
    v_mfma_f32_16x16x32_bf16 v[176:179], a[28:31], a[144:147], v[176:179]
    v_mfma_f32_16x16x32_bf16 v[180:183], a[28:31], a[148:151], v[180:183]
    ds_read_b64_tr_b16 a[10:11], v1 offset:35328
    v_mfma_f32_16x16x32_bf16 v[180:183], a[24:27], a[132:135], v[180:183]
    v_mfma_f32_16x16x32_bf16 v[184:187], a[24:27], a[136:139], v[184:187]
    ds_read_b64_tr_b16 a[12:13], v1 offset:43008
    v_mfma_f32_16x16x32_bf16 v[184:187], a[28:31], a[152:155], v[184:187]
    v_mfma_f32_16x16x32_bf16 v[188:191], a[28:31], a[156:159], v[188:191]
    ds_read_b64_tr_b16 a[14:15], v1 offset:43520
    v_mfma_f32_16x16x32_bf16 v[188:191], a[24:27], a[140:143], v[188:191]
    s_waitcnt vmcnt(32)
    s_waitcnt lgkmcnt(4)
    v_mfma_f32_16x16x32_bf16 v[64:67], a[0:3], a[160:163], v[64:67]
    ds_read_b64_tr_b16 a[16:17], v2 offset:32768
    v_mfma_f32_16x16x32_bf16 v[64:67], a[4:7], a[176:179], v[64:67]
    s_mul_i32 s56, s84, 589824
    s_add_u32 s56, s56, s52
    s_add_u32 m0, s46, 0
    v_mfma_f32_16x16x32_bf16 v[68:71], a[4:7], a[180:183], v[68:71]
    ds_read_b64_tr_b16 a[18:19], v2 offset:33280
    buffer_load_dwordx4 v17, s[12:15], s56 offen  lds
    v_mfma_f32_16x16x32_bf16 v[68:71], a[0:3], a[164:167], v[68:71]
    s_add_u32 m0, s46, 1024
    v_mfma_f32_16x16x32_bf16 v[72:75], a[0:3], a[168:171], v[72:75]
    ds_read_b64_tr_b16 a[20:21], v2 offset:40960
    buffer_load_dwordx4 v18, s[12:15], s56 offen  lds
    v_mfma_f32_16x16x32_bf16 v[72:75], a[4:7], a[184:187], v[72:75]
    s_add_u32 m0, s46, 2048
    v_mfma_f32_16x16x32_bf16 v[76:79], a[4:7], a[188:191], v[76:79]
    ds_read_b64_tr_b16 a[22:23], v2 offset:41472
    buffer_load_dwordx4 v17, s[16:19], s56 offen  lds
    v_mfma_f32_16x16x32_bf16 v[76:79], a[0:3], a[172:175], v[76:79]
    s_add_u32 m0, s46, 3072
    s_waitcnt lgkmcnt(4)
    v_mfma_f32_16x16x32_bf16 v[80:83], a[8:11], a[160:163], v[80:83]
    ds_read_b64_tr_b16 a[24:25], v2 offset:34816
    buffer_load_dwordx4 v18, s[16:19], s56 offen  lds
    v_mfma_f32_16x16x32_bf16 v[80:83], a[12:15], a[176:179], v[80:83]
    s_lshl_b32 s73, s84, 3
    s_and_b32 s82, s3, 1
    s_lshl_b32 s82, s82, 2
    s_add_u32 s73, s73, s82
    s_add_u32 s73, s73, 512
    s_mul_i32 s73, s73, 9216
    s_add_u32 s73, s73, s52
    v_and_b32 v28, 3, v0
    v_mul_u32_u24 v28, 9216, v28
    buffer_load_dword v12, v28, s[64:67], s73 offen
    v_mfma_f32_16x16x32_bf16 v[84:87], a[12:15], a[180:183], v[84:87]
    ds_read_b64_tr_b16 a[26:27], v2 offset:35328
    v_mfma_f32_16x16x32_bf16 v[84:87], a[8:11], a[164:167], v[84:87]
    v_mfma_f32_16x16x32_bf16 v[88:91], a[8:11], a[168:171], v[88:91]
    ds_read_b64_tr_b16 a[28:29], v2 offset:43008
    v_mfma_f32_16x16x32_bf16 v[88:91], a[12:15], a[184:187], v[88:91]
    v_mfma_f32_16x16x32_bf16 v[92:95], a[12:15], a[188:191], v[92:95]
    ds_read_b64_tr_b16 a[30:31], v2 offset:43520
    v_mfma_f32_16x16x32_bf16 v[92:95], a[8:11], a[172:175], v[92:95]
    s_waitcnt lgkmcnt(4)
    v_mfma_f32_16x16x32_bf16 v[96:99], a[16:19], a[160:163], v[96:99]
    ds_read_b64_tr_b16 a[0:1], v3 offset:32768
    v_mfma_f32_16x16x32_bf16 v[96:99], a[20:23], a[176:179], v[96:99]
    v_mfma_f32_16x16x32_bf16 v[100:103], a[20:23], a[180:183], v[100:103]
    ds_read_b64_tr_b16 a[2:3], v3 offset:33280
    v_mfma_f32_16x16x32_bf16 v[100:103], a[16:19], a[164:167], v[100:103]
    v_lshlrev_b32 v28, 7, v0
    v_cmp_gt_u32 vcc, 21, v0
    s_mul_i32 s73, s2, 2688
    s_add_u32 s73, s73, 0
    v_cndmask_b32 v28, -16, v28, vcc
    buffer_load_dword v12, v28, s[28:31], s73 offen
    v_mfma_f32_16x16x32_bf16 v[104:107], a[16:19], a[168:171], v[104:107]
    ds_read_b64_tr_b16 a[4:5], v3 offset:40960
    v_mfma_f32_16x16x32_bf16 v[104:107], a[20:23], a[184:187], v[104:107]
    v_mfma_f32_16x16x32_bf16 v[108:111], a[20:23], a[188:191], v[108:111]
    ds_read_b64_tr_b16 a[6:7], v3 offset:41472
    v_mfma_f32_16x16x32_bf16 v[108:111], a[16:19], a[172:175], v[108:111]
    s_waitcnt lgkmcnt(4)
    v_mfma_f32_16x16x32_bf16 v[112:115], a[24:27], a[160:163], v[112:115]
    ds_read_b64_tr_b16 a[8:9], v3 offset:34816
    v_mfma_f32_16x16x32_bf16 v[112:115], a[28:31], a[176:179], v[112:115]
    v_mfma_f32_16x16x32_bf16 v[116:119], a[28:31], a[180:183], v[116:119]
    ds_read_b64_tr_b16 a[10:11], v3 offset:35328
    v_mfma_f32_16x16x32_bf16 v[116:119], a[24:27], a[164:167], v[116:119]
    v_mfma_f32_16x16x32_bf16 v[120:123], a[24:27], a[168:171], v[120:123]
    ds_read_b64_tr_b16 a[12:13], v3 offset:43008
    v_mfma_f32_16x16x32_bf16 v[120:123], a[28:31], a[184:187], v[120:123]
    v_mfma_f32_16x16x32_bf16 v[124:127], a[28:31], a[188:191], v[124:127]
    ds_read_b64_tr_b16 a[14:15], v3 offset:43520
    v_mfma_f32_16x16x32_bf16 v[124:127], a[24:27], a[172:175], v[124:127]
    s_waitcnt lgkmcnt(4)
    v_mfma_f32_16x16x32_bf16 v[128:131], a[0:3], a[160:163], v[128:131]
    ds_read_b64_tr_b16 a[16:17], v4 offset:32768
    v_mfma_f32_16x16x32_bf16 v[128:131], a[4:7], a[176:179], v[128:131]
    v_mfma_f32_16x16x32_bf16 v[132:135], a[4:7], a[180:183], v[132:135]
    ds_read_b64_tr_b16 a[18:19], v4 offset:33280
    v_mfma_f32_16x16x32_bf16 v[132:135], a[0:3], a[164:167], v[132:135]
    v_mfma_f32_16x16x32_bf16 v[136:139], a[0:3], a[168:171], v[136:139]
    ds_read_b64_tr_b16 a[20:21], v4 offset:40960
    v_mfma_f32_16x16x32_bf16 v[136:139], a[4:7], a[184:187], v[136:139]
    v_mfma_f32_16x16x32_bf16 v[140:143], a[4:7], a[188:191], v[140:143]
    ds_read_b64_tr_b16 a[22:23], v4 offset:41472
    v_mfma_f32_16x16x32_bf16 v[140:143], a[0:3], a[172:175], v[140:143]
    s_waitcnt lgkmcnt(4)
    v_mfma_f32_16x16x32_bf16 v[144:147], a[8:11], a[160:163], v[144:147]
    ds_read_b64_tr_b16 a[24:25], v4 offset:34816
    v_mfma_f32_16x16x32_bf16 v[144:147], a[12:15], a[176:179], v[144:147]
    v_mfma_f32_16x16x32_bf16 v[148:151], a[12:15], a[180:183], v[148:151]
    ds_read_b64_tr_b16 a[26:27], v4 offset:35328
    v_mfma_f32_16x16x32_bf16 v[148:151], a[8:11], a[164:167], v[148:151]
    v_mfma_f32_16x16x32_bf16 v[152:155], a[8:11], a[168:171], v[152:155]
    ds_read_b64_tr_b16 a[28:29], v4 offset:43008
    v_mfma_f32_16x16x32_bf16 v[152:155], a[12:15], a[184:187], v[152:155]
    v_mfma_f32_16x16x32_bf16 v[156:159], a[12:15], a[188:191], v[156:159]
    ds_read_b64_tr_b16 a[30:31], v4 offset:43520
    v_mfma_f32_16x16x32_bf16 v[156:159], a[8:11], a[172:175], v[156:159]
    s_waitcnt vmcnt(18)
    s_barrier
    s_waitcnt lgkmcnt(4)
    v_mfma_f32_16x16x32_bf16 v[160:163], a[16:19], a[160:163], v[160:163]
    ds_read_b64_tr_b16 a[0:1], v1 offset:49152
    v_mfma_f32_16x16x32_bf16 v[160:163], a[20:23], a[176:179], v[160:163]
    v_mfma_f32_16x16x32_bf16 v[164:167], a[20:23], a[180:183], v[164:167]
    ds_read_b64_tr_b16 a[2:3], v1 offset:49664
    v_mfma_f32_16x16x32_bf16 v[164:167], a[16:19], a[164:167], v[164:167]
    v_mfma_f32_16x16x32_bf16 v[168:171], a[16:19], a[168:171], v[168:171]
    ds_read_b64_tr_b16 a[4:5], v1 offset:57344
    v_mfma_f32_16x16x32_bf16 v[168:171], a[20:23], a[184:187], v[168:171]
    v_mfma_f32_16x16x32_bf16 v[172:175], a[20:23], a[188:191], v[172:175]
    ds_read_b64_tr_b16 a[6:7], v1 offset:57856
    v_mfma_f32_16x16x32_bf16 v[172:175], a[16:19], a[172:175], v[172:175]
    s_waitcnt lgkmcnt(4)
    v_mfma_f32_16x16x32_bf16 v[176:179], a[24:27], a[160:163], v[176:179]
    ds_read_b64_tr_b16 a[8:9], v1 offset:51200
    v_mfma_f32_16x16x32_bf16 v[176:179], a[28:31], a[176:179], v[176:179]
    v_mfma_f32_16x16x32_bf16 v[180:183], a[28:31], a[180:183], v[180:183]
    ds_read_b64_tr_b16 a[10:11], v1 offset:51712
    v_mfma_f32_16x16x32_bf16 v[180:183], a[24:27], a[164:167], v[180:183]
    v_mfma_f32_16x16x32_bf16 v[184:187], a[24:27], a[168:171], v[184:187]
    ds_read_b64_tr_b16 a[12:13], v1 offset:59392
    v_mfma_f32_16x16x32_bf16 v[184:187], a[28:31], a[184:187], v[184:187]
    v_mfma_f32_16x16x32_bf16 v[188:191], a[28:31], a[188:191], v[188:191]
    ds_read_b64_tr_b16 a[14:15], v1 offset:59904
    v_mfma_f32_16x16x32_bf16 v[188:191], a[24:27], a[172:175], v[188:191]
    s_waitcnt vmcnt(26)
    s_waitcnt lgkmcnt(4)
    v_mfma_f32_16x16x32_bf16 v[64:67], a[0:3], a[192:195], v[64:67]
    ds_read_b64_tr_b16 a[16:17], v2 offset:49152
    v_mfma_f32_16x16x32_bf16 v[64:67], a[4:7], a[208:211], v[64:67]
    v_mfma_f32_16x16x32_bf16 v[68:71], a[4:7], a[212:215], v[68:71]
    ds_read_b64_tr_b16 a[18:19], v2 offset:49664
    v_mfma_f32_16x16x32_bf16 v[68:71], a[0:3], a[196:199], v[68:71]
    v_mfma_f32_16x16x32_bf16 v[72:75], a[0:3], a[200:203], v[72:75]
    ds_read_b64_tr_b16 a[20:21], v2 offset:57344
    v_mfma_f32_16x16x32_bf16 v[72:75], a[4:7], a[216:219], v[72:75]
    v_mfma_f32_16x16x32_bf16 v[76:79], a[4:7], a[220:223], v[76:79]
    ds_read_b64_tr_b16 a[22:23], v2 offset:57856
    v_mfma_f32_16x16x32_bf16 v[76:79], a[0:3], a[204:207], v[76:79]
    s_waitcnt lgkmcnt(4)
    v_mfma_f32_16x16x32_bf16 v[80:83], a[8:11], a[192:195], v[80:83]
    ds_read_b64_tr_b16 a[24:25], v2 offset:51200
    v_mfma_f32_16x16x32_bf16 v[80:83], a[12:15], a[208:211], v[80:83]
    s_getpc_b64 s[76:77]
L_rw1:
    s_mov_b32 s78, L_mk_end-L_rw1
    s_mov_b32 s79, 0x00020000
    s_lshr_b32 s73, s2, 3
    s_mul_i32 s73, s73, 512
    v_lshlrev_b32 v28, 7, v0
    v_cmp_gt_u32 vcc, 512, v28
    s_nop 1
    v_cndmask_b32 v28, -16, v28, vcc
    buffer_load_dword v12, v28, s[76:79], s73 offen
    v_mfma_f32_16x16x32_bf16 v[84:87], a[12:15], a[212:215], v[84:87]
    ds_read_b64_tr_b16 a[26:27], v2 offset:51712
    v_mfma_f32_16x16x32_bf16 v[84:87], a[8:11], a[196:199], v[84:87]
    v_mfma_f32_16x16x32_bf16 v[88:91], a[8:11], a[200:203], v[88:91]
    ds_read_b64_tr_b16 a[28:29], v2 offset:59392
    v_mfma_f32_16x16x32_bf16 v[88:91], a[12:15], a[216:219], v[88:91]
    v_mfma_f32_16x16x32_bf16 v[92:95], a[12:15], a[220:223], v[92:95]
    ds_read_b64_tr_b16 a[30:31], v2 offset:59904
    v_mfma_f32_16x16x32_bf16 v[92:95], a[8:11], a[204:207], v[92:95]
    s_waitcnt lgkmcnt(4)
    v_mfma_f32_16x16x32_bf16 v[96:99], a[16:19], a[192:195], v[96:99]
    ds_read_b64_tr_b16 a[0:1], v3 offset:49152
    v_mfma_f32_16x16x32_bf16 v[96:99], a[20:23], a[208:211], v[96:99]
    v_mfma_f32_16x16x32_bf16 v[100:103], a[20:23], a[212:215], v[100:103]
    ds_read_b64_tr_b16 a[2:3], v3 offset:49664
    v_mfma_f32_16x16x32_bf16 v[100:103], a[16:19], a[196:199], v[100:103]
    v_mfma_f32_16x16x32_bf16 v[104:107], a[16:19], a[200:203], v[104:107]
    ds_read_b64_tr_b16 a[4:5], v3 offset:57344
    v_mfma_f32_16x16x32_bf16 v[104:107], a[20:23], a[216:219], v[104:107]
    v_mfma_f32_16x16x32_bf16 v[108:111], a[20:23], a[220:223], v[108:111]
    ds_read_b64_tr_b16 a[6:7], v3 offset:57856
    v_mfma_f32_16x16x32_bf16 v[108:111], a[16:19], a[204:207], v[108:111]
    s_waitcnt lgkmcnt(4)
    v_mfma_f32_16x16x32_bf16 v[112:115], a[24:27], a[192:195], v[112:115]
    ds_read_b64_tr_b16 a[8:9], v3 offset:51200
    v_mfma_f32_16x16x32_bf16 v[112:115], a[28:31], a[208:211], v[112:115]
    v_mfma_f32_16x16x32_bf16 v[116:119], a[28:31], a[212:215], v[116:119]
    ds_read_b64_tr_b16 a[10:11], v3 offset:51712
    v_mfma_f32_16x16x32_bf16 v[116:119], a[24:27], a[196:199], v[116:119]
    v_mfma_f32_16x16x32_bf16 v[120:123], a[24:27], a[200:203], v[120:123]
    ds_read_b64_tr_b16 a[12:13], v3 offset:59392
    v_mfma_f32_16x16x32_bf16 v[120:123], a[28:31], a[216:219], v[120:123]
    v_mfma_f32_16x16x32_bf16 v[124:127], a[28:31], a[220:223], v[124:127]
    ds_read_b64_tr_b16 a[14:15], v3 offset:59904
    v_mfma_f32_16x16x32_bf16 v[124:127], a[24:27], a[204:207], v[124:127]
    s_waitcnt lgkmcnt(4)
    v_mfma_f32_16x16x32_bf16 v[128:131], a[0:3], a[192:195], v[128:131]
    ds_read_b64_tr_b16 a[16:17], v4 offset:49152
    v_mfma_f32_16x16x32_bf16 v[128:131], a[4:7], a[208:211], v[128:131]
    v_mfma_f32_16x16x32_bf16 v[132:135], a[4:7], a[212:215], v[132:135]
    ds_read_b64_tr_b16 a[18:19], v4 offset:49664
    v_mfma_f32_16x16x32_bf16 v[132:135], a[0:3], a[196:199], v[132:135]
    v_mfma_f32_16x16x32_bf16 v[136:139], a[0:3], a[200:203], v[136:139]
    ds_read_b64_tr_b16 a[20:21], v4 offset:57344
    v_mfma_f32_16x16x32_bf16 v[136:139], a[4:7], a[216:219], v[136:139]
    v_mfma_f32_16x16x32_bf16 v[140:143], a[4:7], a[220:223], v[140:143]
    ds_read_b64_tr_b16 a[22:23], v4 offset:57856
    v_mfma_f32_16x16x32_bf16 v[140:143], a[0:3], a[204:207], v[140:143]
    s_waitcnt lgkmcnt(4)
    v_mfma_f32_16x16x32_bf16 v[144:147], a[8:11], a[192:195], v[144:147]
    ds_read_b64_tr_b16 a[24:25], v4 offset:51200
    v_mfma_f32_16x16x32_bf16 v[144:147], a[12:15], a[208:211], v[144:147]
    s_mul_i32 s56, s85, 589824
    s_add_u32 s56, s56, s52
    s_add_u32 m0, s46, 16384
    v_mfma_f32_16x16x32_bf16 v[148:151], a[12:15], a[212:215], v[148:151]
    ds_read_b64_tr_b16 a[26:27], v4 offset:51712
    v_mfma_f32_16x16x32_bf16 v[148:151], a[8:11], a[196:199], v[148:151]
    v_mfma_f32_16x16x32_bf16 v[152:155], a[8:11], a[200:203], v[152:155]
    ds_read_b64_tr_b16 a[28:29], v4 offset:59392
    buffer_load_dwordx4 v17, s[12:15], s56 offen  lds
    v_mfma_f32_16x16x32_bf16 v[152:155], a[12:15], a[216:219], v[152:155]
    v_mfma_f32_16x16x32_bf16 v[156:159], a[12:15], a[220:223], v[156:159]
    ds_read_b64_tr_b16 a[30:31], v4 offset:59904
    s_add_u32 m0, s46, 17408
    v_mfma_f32_16x16x32_bf16 v[156:159], a[8:11], a[204:207], v[156:159]
    s_waitcnt vmcnt(8)
    s_barrier
    s_waitcnt lgkmcnt(4)
    v_mfma_f32_16x16x32_bf16 v[160:163], a[16:19], a[192:195], v[160:163]
    v_add_u32 v1, 65536, v1
    ds_read_b64_tr_b16 a[0:1], v1 offset:0
    v_mfma_f32_16x16x32_bf16 v[160:163], a[20:23], a[208:211], v[160:163]
    buffer_load_dwordx4 v18, s[12:15], s56 offen  lds
    v_mfma_f32_16x16x32_bf16 v[164:167], a[20:23], a[212:215], v[164:167]
    ds_read_b64_tr_b16 a[2:3], v1 offset:512
    v_mfma_f32_16x16x32_bf16 v[164:167], a[16:19], a[196:199], v[164:167]
    s_add_u32 m0, s46, 18432
    v_mfma_f32_16x16x32_bf16 v[168:171], a[16:19], a[200:203], v[168:171]
    ds_read_b64_tr_b16 a[4:5], v1 offset:8192
    v_mfma_f32_16x16x32_bf16 v[168:171], a[20:23], a[216:219], v[168:171]
    buffer_load_dwordx4 v17, s[16:19], s56 offen  lds
    v_mfma_f32_16x16x32_bf16 v[172:175], a[20:23], a[220:223], v[172:175]
    ds_read_b64_tr_b16 a[6:7], v1 offset:8704
    v_mfma_f32_16x16x32_bf16 v[172:175], a[16:19], a[204:207], v[172:175]
    s_add_u32 m0, s46, 19456
    s_waitcnt lgkmcnt(4)
    v_mfma_f32_16x16x32_bf16 v[176:179], a[24:27], a[192:195], v[176:179]
    ds_read_b64_tr_b16 a[8:9], v1 offset:2048
    v_mfma_f32_16x16x32_bf16 v[176:179], a[28:31], a[208:211], v[176:179]
    buffer_load_dwordx4 v18, s[16:19], s56 offen  lds
    v_mfma_f32_16x16x32_bf16 v[180:183], a[28:31], a[212:215], v[180:183]
    ds_read_b64_tr_b16 a[10:11], v1 offset:2560
    v_mfma_f32_16x16x32_bf16 v[180:183], a[24:27], a[196:199], v[180:183]
    v_mfma_f32_16x16x32_bf16 v[184:187], a[24:27], a[200:203], v[184:187]
    ds_read_b64_tr_b16 a[12:13], v1 offset:10240
    v_mfma_f32_16x16x32_bf16 v[184:187], a[28:31], a[216:219], v[184:187]
    v_mfma_f32_16x16x32_bf16 v[188:191], a[28:31], a[220:223], v[188:191]
    ds_read_b64_tr_b16 a[14:15], v1 offset:10752
    v_mfma_f32_16x16x32_bf16 v[188:191], a[24:27], a[204:207], v[188:191]
    s_waitcnt vmcnt(15)
    s_waitcnt lgkmcnt(4)
    v_mfma_f32_16x16x32_bf16 v[64:67], a[0:3], a[224:227], v[64:67]
    v_add_u32 v2, 65536, v2
    ds_read_b64_tr_b16 a[16:17], v2 offset:0
    v_mfma_f32_16x16x32_bf16 v[64:67], a[4:7], a[240:243], v[64:67]
    s_mul_i32 s56, s86, 589824
    s_add_u32 s56, s56, s52
    s_add_u32 m0, s46, 32768
    v_mfma_f32_16x16x32_bf16 v[68:71], a[4:7], a[244:247], v[68:71]
    ds_read_b64_tr_b16 a[18:19], v2 offset:512
    v_mfma_f32_16x16x32_bf16 v[68:71], a[0:3], a[228:231], v[68:71]
    v_mfma_f32_16x16x32_bf16 v[72:75], a[0:3], a[232:235], v[72:75]
    ds_read_b64_tr_b16 a[20:21], v2 offset:8192
    v_mfma_f32_16x16x32_bf16 v[72:75], a[4:7], a[248:251], v[72:75]
    v_mfma_f32_16x16x32_bf16 v[76:79], a[4:7], a[252:255], v[76:79]
    ds_read_b64_tr_b16 a[22:23], v2 offset:8704
    v_mfma_f32_16x16x32_bf16 v[76:79], a[0:3], a[236:239], v[76:79]
    s_waitcnt lgkmcnt(4)
    v_mfma_f32_16x16x32_bf16 v[80:83], a[8:11], a[224:227], v[80:83]
    ds_read_b64_tr_b16 a[24:25], v2 offset:2048
    buffer_load_dwordx4 v17, s[12:15], s56 offen  lds
    v_mfma_f32_16x16x32_bf16 v[80:83], a[12:15], a[240:243], v[80:83]
    v_mfma_f32_16x16x32_bf16 v[84:87], a[12:15], a[244:247], v[84:87]
    ds_read_b64_tr_b16 a[26:27], v2 offset:2560
    v_mfma_f32_16x16x32_bf16 v[84:87], a[8:11], a[228:231], v[84:87]
    s_add_u32 m0, s46, 33792
    v_mfma_f32_16x16x32_bf16 v[88:91], a[8:11], a[232:235], v[88:91]
    ds_read_b64_tr_b16 a[28:29], v2 offset:10240
    v_mfma_f32_16x16x32_bf16 v[88:91], a[12:15], a[248:251], v[88:91]
    v_mfma_f32_16x16x32_bf16 v[92:95], a[12:15], a[252:255], v[92:95]
    ds_read_b64_tr_b16 a[30:31], v2 offset:10752
    buffer_load_dwordx4 v18, s[12:15], s56 offen  lds
    v_mfma_f32_16x16x32_bf16 v[92:95], a[8:11], a[236:239], v[92:95]
    s_waitcnt lgkmcnt(4)
    v_mfma_f32_16x16x32_bf16 v[96:99], a[16:19], a[224:227], v[96:99]
    v_add_u32 v3, 65536, v3
    ds_read_b64_tr_b16 a[0:1], v3 offset:0
    v_mfma_f32_16x16x32_bf16 v[96:99], a[20:23], a[240:243], v[96:99]
    s_add_u32 m0, s46, 34816
    v_mfma_f32_16x16x32_bf16 v[100:103], a[20:23], a[244:247], v[100:103]
    ds_read_b64_tr_b16 a[2:3], v3 offset:512
    v_mfma_f32_16x16x32_bf16 v[100:103], a[16:19], a[228:231], v[100:103]
    v_mfma_f32_16x16x32_bf16 v[104:107], a[16:19], a[232:235], v[104:107]
    ds_read_b64_tr_b16 a[4:5], v3 offset:8192
    buffer_load_dwordx4 v17, s[16:19], s56 offen  lds
    v_mfma_f32_16x16x32_bf16 v[104:107], a[20:23], a[248:251], v[104:107]
    v_mfma_f32_16x16x32_bf16 v[108:111], a[20:23], a[252:255], v[108:111]
    ds_read_b64_tr_b16 a[6:7], v3 offset:8704
    v_mfma_f32_16x16x32_bf16 v[108:111], a[16:19], a[236:239], v[108:111]
    s_add_u32 m0, s46, 35840
    s_waitcnt lgkmcnt(4)
    v_mfma_f32_16x16x32_bf16 v[112:115], a[24:27], a[224:227], v[112:115]
    ds_read_b64_tr_b16 a[8:9], v3 offset:2048
    v_mfma_f32_16x16x32_bf16 v[112:115], a[28:31], a[240:243], v[112:115]
    v_mfma_f32_16x16x32_bf16 v[116:119], a[28:31], a[244:247], v[116:119]
    ds_read_b64_tr_b16 a[10:11], v3 offset:2560
    buffer_load_dwordx4 v18, s[16:19], s56 offen  lds
    v_mfma_f32_16x16x32_bf16 v[116:119], a[24:27], a[228:231], v[116:119]
    v_mfma_f32_16x16x32_bf16 v[120:123], a[24:27], a[232:235], v[120:123]
    ds_read_b64_tr_b16 a[12:13], v3 offset:10240
    v_mfma_f32_16x16x32_bf16 v[120:123], a[28:31], a[248:251], v[120:123]
    s_mul_i32 s56, s87, 589824
    s_add_u32 s56, s56, s52
    s_add_u32 m0, s46, 49152
    v_mfma_f32_16x16x32_bf16 v[124:127], a[28:31], a[252:255], v[124:127]
    ds_read_b64_tr_b16 a[14:15], v3 offset:10752
    v_mfma_f32_16x16x32_bf16 v[124:127], a[24:27], a[236:239], v[124:127]
    s_waitcnt lgkmcnt(4)
    v_mfma_f32_16x16x32_bf16 v[128:131], a[0:3], a[224:227], v[128:131]
    v_add_u32 v4, 65536, v4
    ds_read_b64_tr_b16 a[16:17], v4 offset:0
    v_mul_f32 v80, v64, v80
    v_mfma_f32_16x16x32_bf16 v[128:131], a[4:7], a[240:243], v[128:131]
    v_mul_f32 v81, v65, v81
    v_mul_f32 v82, v66, v82
    v_mfma_f32_16x16x32_bf16 v[132:135], a[4:7], a[244:247], v[132:135]
    ds_read_b64_tr_b16 a[18:19], v4 offset:512
    v_mul_f32 v83, v67, v83
    v_mfma_f32_16x16x32_bf16 v[132:135], a[0:3], a[228:231], v[132:135]
    v_cvt_pk_bf16_f32 v32, v80, v81
    v_cvt_pk_bf16_f32 v33, v82, v83
    v_mfma_f32_16x16x32_bf16 v[136:139], a[0:3], a[232:235], v[136:139]
    ds_read_b64_tr_b16 a[20:21], v4 offset:8192
    v_mul_f32 v84, v68, v84
    v_mfma_f32_16x16x32_bf16 v[136:139], a[4:7], a[248:251], v[136:139]
    v_mul_f32 v85, v69, v85
    v_mul_f32 v86, v70, v86
    v_mfma_f32_16x16x32_bf16 v[140:143], a[4:7], a[252:255], v[140:143]
    ds_read_b64_tr_b16 a[22:23], v4 offset:8704
    buffer_load_dwordx4 v17, s[12:15], s56 offen  lds
    v_mfma_f32_16x16x32_bf16 v[140:143], a[0:3], a[236:239], v[140:143]
    v_mul_f32 v87, v71, v87
    s_waitcnt lgkmcnt(4)
    v_mfma_f32_16x16x32_bf16 v[144:147], a[8:11], a[224:227], v[144:147]
    ds_read_b64_tr_b16 a[24:25], v4 offset:2048
    v_cvt_pk_bf16_f32 v36, v84, v85
    v_cvt_pk_bf16_f32 v37, v86, v87
    v_mfma_f32_16x16x32_bf16 v[144:147], a[12:15], a[240:243], v[144:147]
    s_add_u32 m0, s46, 50176
    v_mul_f32 v88, v72, v88
    v_mul_f32 v89, v73, v89
    v_mfma_f32_16x16x32_bf16 v[148:151], a[12:15], a[244:247], v[148:151]
    ds_read_b64_tr_b16 a[26:27], v4 offset:2560
    v_mul_f32 v90, v74, v90
    v_mul_f32 v91, v75, v91
    v_mfma_f32_16x16x32_bf16 v[148:151], a[8:11], a[228:231], v[148:151]
    v_cvt_pk_bf16_f32 v40, v88, v89
    v_cvt_pk_bf16_f32 v41, v90, v91
    v_mul_f32 v92, v76, v92
    v_mfma_f32_16x16x32_bf16 v[152:155], a[8:11], a[232:235], v[152:155]
    ds_read_b64_tr_b16 a[28:29], v4 offset:10240
    buffer_load_dwordx4 v18, s[12:15], s56 offen  lds
    v_mfma_f32_16x16x32_bf16 v[152:155], a[12:15], a[248:251], v[152:155]
    v_mul_f32 v93, v77, v93
    v_mul_f32 v94, v78, v94
    v_mfma_f32_16x16x32_bf16 v[156:159], a[12:15], a[252:255], v[156:159]
    ds_read_b64_tr_b16 a[30:31], v4 offset:10752
    v_mul_f32 v95, v79, v95
    v_cvt_pk_bf16_f32 v44, v92, v93
    v_cvt_pk_bf16_f32 v45, v94, v95
    v_mfma_f32_16x16x32_bf16 v[156:159], a[8:11], a[236:239], v[156:159]
    s_waitcnt vmcnt(13)
    s_barrier
    s_waitcnt lgkmcnt(4)
    v_mfma_f32_16x16x32_bf16 v[160:163], a[16:19], a[224:227], v[160:163]
    v_subrev_u32 v1, 131072, v1
    ds_read_b64_tr_b16 a[0:1], v1 offset:0
    s_add_u32 m0, s46, 51200
    v_mul_f32 v112, v96, v112
    v_mul_f32 v113, v97, v113
    v_mfma_f32_16x16x32_bf16 v[160:163], a[20:23], a[240:243], v[160:163]
    v_mul_f32 v114, v98, v114
    v_mul_f32 v115, v99, v115
    v_cvt_pk_bf16_f32 v34, v112, v113
    v_mfma_f32_16x16x32_bf16 v[164:167], a[20:23], a[244:247], v[164:167]
    ds_read_b64_tr_b16 a[2:3], v1 offset:512
    buffer_load_dwordx4 v17, s[16:19], s56 offen  lds
    v_cvt_pk_bf16_f32 v35, v114, v115
    v_mfma_f32_16x16x32_bf16 v[164:167], a[16:19], a[228:231], v[164:167]
    v_mul_f32 v116, v100, v116
    v_mul_f32 v117, v101, v117
    v_mfma_f32_16x16x32_bf16 v[168:171], a[16:19], a[232:235], v[168:171]
    ds_read_b64_tr_b16 a[4:5], v1 offset:8192
    v_mul_f32 v118, v102, v118
    v_mfma_f32_16x16x32_bf16 v[168:171], a[20:23], a[248:251], v[168:171]
    s_add_u32 m0, s46, 52224
    v_mul_f32 v119, v103, v119
    v_cvt_pk_bf16_f32 v38, v116, v117
    v_mfma_f32_16x16x32_bf16 v[172:175], a[20:23], a[252:255], v[172:175]
    ds_read_b64_tr_b16 a[6:7], v1 offset:8704
    v_cvt_pk_bf16_f32 v39, v118, v119
    v_permlane32_swap_b32 v32, v34
    v_mfma_f32_16x16x32_bf16 v[172:175], a[16:19], a[236:239], v[172:175]
    v_permlane32_swap_b32 v33, v35
    v_mul_f32 v120, v104, v120
    s_waitcnt lgkmcnt(4)
    v_mfma_f32_16x16x32_bf16 v[176:179], a[24:27], a[224:227], v[176:179]
    ds_read_b64_tr_b16 a[8:9], v1 offset:2048
    buffer_load_dwordx4 v18, s[16:19], s56 offen  lds
    v_mul_f32 v121, v105, v121
    v_mfma_f32_16x16x32_bf16 v[176:179], a[28:31], a[240:243], v[176:179]
    v_mul_f32 v122, v106, v122
    v_mul_f32 v123, v107, v123
    v_mfma_f32_16x16x32_bf16 v[180:183], a[28:31], a[244:247], v[180:183]
    ds_read_b64_tr_b16 a[10:11], v1 offset:2560
    v_cvt_pk_bf16_f32 v42, v120, v121
    v_cvt_pk_bf16_f32 v43, v122, v123
    v_mfma_f32_16x16x32_bf16 v[180:183], a[24:27], a[228:231], v[180:183]
    v_permlane32_swap_b32 v36, v38
    v_permlane32_swap_b32 v37, v39
    v_mfma_f32_16x16x32_bf16 v[184:187], a[24:27], a[232:235], v[184:187]
    ds_read_b64_tr_b16 a[12:13], v1 offset:10240
    v_mul_f32 v124, v108, v124
    v_mul_f32 v125, v109, v125
    v_mfma_f32_16x16x32_bf16 v[184:187], a[28:31], a[248:251], v[184:187]
    v_mul_f32 v126, v110, v126
    v_mul_f32 v127, v111, v127
    v_mfma_f32_16x16x32_bf16 v[188:191], a[28:31], a[252:255], v[188:191]
    ds_read_b64_tr_b16 a[14:15], v1 offset:10752
    v_cvt_pk_bf16_f32 v46, v124, v125
    v_mfma_f32_16x16x32_bf16 v[188:191], a[24:27], a[236:239], v[188:191]
    v_cvt_pk_bf16_f32 v47, v126, v127
    v_permlane32_swap_b32 v40, v42
    v_permlane32_swap_b32 v41, v43
    s_nop 0
    v_permlane32_swap_b32 v44, v46
    v_permlane32_swap_b32 v45, v47
    s_waitcnt lgkmcnt(4)
    v_mfma_f32_16x16x32_bf16 v[64:67], a[0:3], v[192:195], 0
    v_subrev_u32 v2, 131072, v2
    ds_read_b64_tr_b16 a[16:17], v2 offset:0
    v_mul_f32 v144, v128, v144
    v_mfma_f32_16x16x32_bf16 v[64:67], a[4:7], v[208:211], v[64:67]
    s_mul_i32 s56, s88, 589824
    s_add_u32 s56, s56, s52
    s_add_u32 m0, s46, 65536
    v_mfma_f32_16x16x32_bf16 v[68:71], a[4:7], v[212:215], 0
    ds_read_b64_tr_b16 a[18:19], v2 offset:512
    v_mul_f32 v145, v129, v145
    v_mfma_f32_16x16x32_bf16 v[68:71], a[0:3], v[196:199], v[68:71]
    v_mul_f32 v146, v130, v146
    v_mul_f32 v147, v131, v147
    v_mfma_f32_16x16x32_bf16 v[72:75], a[0:3], v[200:203], 0
    ds_read_b64_tr_b16 a[20:21], v2 offset:8192
    v_cvt_pk_bf16_f32 v48, v144, v145
    v_mfma_f32_16x16x32_bf16 v[72:75], a[4:7], v[216:219], v[72:75]
    v_cvt_pk_bf16_f32 v49, v146, v147
    v_mul_f32 v148, v132, v148
    v_mfma_f32_16x16x32_bf16 v[76:79], a[4:7], v[220:223], 0
    ds_read_b64_tr_b16 a[22:23], v2 offset:8704
    v_mul_f32 v149, v133, v149
    v_mfma_f32_16x16x32_bf16 v[76:79], a[0:3], v[204:207], v[76:79]
    v_mul_f32 v150, v134, v150
    v_mul_f32 v151, v135, v151
    s_waitcnt lgkmcnt(4)
    v_mfma_f32_16x16x32_bf16 v[80:83], a[8:11], v[192:195], 0
    ds_read_b64_tr_b16 a[24:25], v2 offset:2048
    v_cvt_pk_bf16_f32 v52, v148, v149
    v_cvt_pk_bf16_f32 v53, v150, v151
    v_mfma_f32_16x16x32_bf16 v[80:83], a[12:15], v[208:211], v[80:83]
    v_mul_f32 v152, v136, v152
    v_mul_f32 v153, v137, v153
    v_mfma_f32_16x16x32_bf16 v[84:87], a[12:15], v[212:215], 0
    ds_read_b64_tr_b16 a[26:27], v2 offset:2560
    v_mul_f32 v154, v138, v154
    v_mul_f32 v155, v139, v155
    v_mfma_f32_16x16x32_bf16 v[84:87], a[8:11], v[196:199], v[84:87]
    v_cvt_pk_bf16_f32 v56, v152, v153
    v_cvt_pk_bf16_f32 v57, v154, v155
    v_mfma_f32_16x16x32_bf16 v[88:91], a[8:11], v[200:203], 0
    ds_read_b64_tr_b16 a[28:29], v2 offset:10240
    v_mul_f32 v156, v140, v156
    v_mfma_f32_16x16x32_bf16 v[88:91], a[12:15], v[216:219], v[88:91]
    v_mul_f32 v157, v141, v157
    v_mul_f32 v158, v142, v158
    v_mfma_f32_16x16x32_bf16 v[92:95], a[12:15], v[220:223], 0
    ds_read_b64_tr_b16 a[30:31], v2 offset:10752
    v_mul_f32 v159, v143, v159
    v_cvt_pk_bf16_f32 v60, v156, v157
    v_mfma_f32_16x16x32_bf16 v[92:95], a[8:11], v[204:207], v[92:95]
    v_cvt_pk_bf16_f32 v61, v158, v159
    s_waitcnt lgkmcnt(4)
    v_mfma_f32_16x16x32_bf16 v[96:99], a[16:19], v[192:195], 0
    v_subrev_u32 v3, 131072, v3
    ds_read_b64_tr_b16 a[0:1], v3 offset:0
    v_mul_f32 v176, v160, v176
    v_mul_f32 v177, v161, v177
    v_mfma_f32_16x16x32_bf16 v[96:99], a[20:23], v[208:211], v[96:99]
    buffer_load_dwordx4 v17, s[12:15], s56 offen  lds
    v_mul_f32 v178, v162, v178
    v_mul_f32 v179, v163, v179
    v_mfma_f32_16x16x32_bf16 v[100:103], a[20:23], v[212:215], 0
    ds_read_b64_tr_b16 a[2:3], v3 offset:512
    v_cvt_pk_bf16_f32 v50, v176, v177
    v_cvt_pk_bf16_f32 v51, v178, v179
    v_mfma_f32_16x16x32_bf16 v[100:103], a[16:19], v[196:199], v[100:103]
    v_mul_f32 v180, v164, v180
    v_mul_f32 v181, v165, v181
    v_mfma_f32_16x16x32_bf16 v[104:107], a[16:19], v[200:203], 0
    ds_read_b64_tr_b16 a[4:5], v3 offset:8192
    v_mul_f32 v182, v166, v182
    v_mfma_f32_16x16x32_bf16 v[104:107], a[20:23], v[216:219], v[104:107]
    v_mul_f32 v183, v167, v183
    v_cvt_pk_bf16_f32 v54, v180, v181
    v_mfma_f32_16x16x32_bf16 v[108:111], a[20:23], v[220:223], 0
    ds_read_b64_tr_b16 a[6:7], v3 offset:8704
    v_cvt_pk_bf16_f32 v55, v182, v183
    v_permlane32_swap_b32 v48, v50
    v_mfma_f32_16x16x32_bf16 v[108:111], a[16:19], v[204:207], v[108:111]
    s_add_u32 m0, s46, 66560
    v_permlane32_swap_b32 v49, v51
    v_mul_f32 v184, v168, v184
    s_waitcnt lgkmcnt(4)
    v_mfma_f32_16x16x32_bf16 v[112:115], a[24:27], v[192:195], 0
    ds_read_b64_tr_b16 a[8:9], v3 offset:2048
    v_mul_f32 v185, v169, v185
    v_mfma_f32_16x16x32_bf16 v[112:115], a[28:31], v[208:211], v[112:115]
    v_mul_f32 v186, v170, v186
    v_mul_f32 v187, v171, v187
    v_mfma_f32_16x16x32_bf16 v[116:119], a[28:31], v[212:215], 0
    ds_read_b64_tr_b16 a[10:11], v3 offset:2560
    v_cvt_pk_bf16_f32 v58, v184, v185
    v_cvt_pk_bf16_f32 v59, v186, v187
    v_mfma_f32_16x16x32_bf16 v[116:119], a[24:27], v[196:199], v[116:119]
    v_permlane32_swap_b32 v52, v54
    v_permlane32_swap_b32 v53, v55
    v_mfma_f32_16x16x32_bf16 v[120:123], a[24:27], v[200:203], 0
    ds_read_b64_tr_b16 a[12:13], v3 offset:10240
    v_mul_f32 v188, v172, v188
    v_mul_f32 v189, v173, v189
    v_mfma_f32_16x16x32_bf16 v[120:123], a[28:31], v[216:219], v[120:123]
    buffer_load_dwordx4 v18, s[12:15], s56 offen  lds
    v_mul_f32 v190, v174, v190
    v_mfma_f32_16x16x32_bf16 v[124:127], a[28:31], v[220:223], 0
    ds_read_b64_tr_b16 a[14:15], v3 offset:10752
    v_mul_f32 v191, v175, v191
    v_cvt_pk_bf16_f32 v62, v188, v189
    v_mfma_f32_16x16x32_bf16 v[124:127], a[24:27], v[204:207], v[124:127]
    v_cvt_pk_bf16_f32 v63, v190, v191
    v_permlane32_swap_b32 v56, v58
    v_permlane32_swap_b32 v57, v59
    s_nop 0
    v_permlane32_swap_b32 v60, v62
    v_permlane32_swap_b32 v61, v63
    s_waitcnt lgkmcnt(4)
    v_mfma_f32_16x16x32_bf16 v[128:131], a[0:3], v[192:195], 0
    v_subrev_u32 v4, 131072, v4
    ds_read_b64_tr_b16 a[16:17], v4 offset:0
    v_mfma_f32_16x16x32_bf16 v[128:131], a[4:7], v[208:211], v[128:131]
    s_add_u32 s47, s58, 0
    buffer_store_dwordx4 v[32:35], v16, s[24:27], s47 offen offset:0 sc1
    v_mfma_f32_16x16x32_bf16 v[132:135], a[4:7], v[212:215], 0
    ds_read_b64_tr_b16 a[18:19], v4 offset:512
    v_mfma_f32_16x16x32_bf16 v[132:135], a[0:3], v[196:199], v[132:135]
    s_add_u32 m0, s46, 67584
    v_mfma_f32_16x16x32_bf16 v[136:139], a[0:3], v[200:203], 0
    ds_read_b64_tr_b16 a[20:21], v4 offset:8192
    v_mfma_f32_16x16x32_bf16 v[136:139], a[4:7], v[216:219], v[136:139]
    s_add_u32 s47, s58, 0
    buffer_store_dwordx4 v[36:39], v16, s[24:27], s47 offen offset:1024 sc1
    v_mfma_f32_16x16x32_bf16 v[140:143], a[4:7], v[220:223], 0
    ds_read_b64_tr_b16 a[22:23], v4 offset:8704
    v_mfma_f32_16x16x32_bf16 v[140:143], a[0:3], v[204:207], v[140:143]
    s_waitcnt lgkmcnt(4)
    v_mfma_f32_16x16x32_bf16 v[144:147], a[8:11], v[192:195], 0
    ds_read_b64_tr_b16 a[24:25], v4 offset:2048
    v_mfma_f32_16x16x32_bf16 v[144:147], a[12:15], v[208:211], v[144:147]
    buffer_load_dwordx4 v17, s[16:19], s56 offen  lds
    v_mfma_f32_16x16x32_bf16 v[148:151], a[12:15], v[212:215], 0
    ds_read_b64_tr_b16 a[26:27], v4 offset:2560
    v_mfma_f32_16x16x32_bf16 v[148:151], a[8:11], v[196:199], v[148:151]
    v_mfma_f32_16x16x32_bf16 v[152:155], a[8:11], v[200:203], 0
    ds_read_b64_tr_b16 a[28:29], v4 offset:10240
    v_mfma_f32_16x16x32_bf16 v[152:155], a[12:15], v[216:219], v[152:155]
    v_mfma_f32_16x16x32_bf16 v[156:159], a[12:15], v[220:223], 0
    ds_read_b64_tr_b16 a[30:31], v4 offset:10752
    v_mfma_f32_16x16x32_bf16 v[156:159], a[8:11], v[204:207], v[156:159]
    s_waitcnt vmcnt(13)
    s_barrier
    s_waitcnt lgkmcnt(4)
    v_mfma_f32_16x16x32_bf16 v[160:163], a[16:19], v[192:195], 0
    ds_read_b64_tr_b16 a[0:1], v1 offset:16384
    s_add_u32 m0, s46, 68608
    v_mfma_f32_16x16x32_bf16 v[160:163], a[20:23], v[208:211], v[160:163]
    v_mfma_f32_16x16x32_bf16 v[164:167], a[20:23], v[212:215], 0
    ds_read_b64_tr_b16 a[2:3], v1 offset:16896
    v_mfma_f32_16x16x32_bf16 v[164:167], a[16:19], v[196:199], v[164:167]
    v_mfma_f32_16x16x32_bf16 v[168:171], a[16:19], v[200:203], 0
    ds_read_b64_tr_b16 a[4:5], v1 offset:24576
    v_mfma_f32_16x16x32_bf16 v[168:171], a[20:23], v[216:219], v[168:171]
    buffer_load_dwordx4 v18, s[16:19], s56 offen  lds
    v_mfma_f32_16x16x32_bf16 v[172:175], a[20:23], v[220:223], 0
    ds_read_b64_tr_b16 a[6:7], v1 offset:25088
    v_mfma_f32_16x16x32_bf16 v[172:175], a[16:19], v[204:207], v[172:175]
    s_waitcnt lgkmcnt(4)
    v_mfma_f32_16x16x32_bf16 v[176:179], a[24:27], v[192:195], 0
    ds_read_b64_tr_b16 a[8:9], v1 offset:18432
    v_mfma_f32_16x16x32_bf16 v[176:179], a[28:31], v[208:211], v[176:179]
    v_mfma_f32_16x16x32_bf16 v[180:183], a[28:31], v[212:215], 0
    ds_read_b64_tr_b16 a[10:11], v1 offset:18944
    v_mfma_f32_16x16x32_bf16 v[180:183], a[24:27], v[196:199], v[180:183]
    v_mfma_f32_16x16x32_bf16 v[184:187], a[24:27], v[200:203], 0
    ds_read_b64_tr_b16 a[12:13], v1 offset:26624
    v_mfma_f32_16x16x32_bf16 v[184:187], a[28:31], v[216:219], v[184:187]
    v_mfma_f32_16x16x32_bf16 v[188:191], a[28:31], v[220:223], 0
    ds_read_b64_tr_b16 a[14:15], v1 offset:27136
    v_mfma_f32_16x16x32_bf16 v[188:191], a[24:27], v[204:207], v[188:191]
    s_waitcnt lgkmcnt(4)
    v_mfma_f32_16x16x32_bf16 v[64:67], a[0:3], v[224:227], v[64:67]
    ds_read_b64_tr_b16 a[16:17], v2 offset:16384
    v_mfma_f32_16x16x32_bf16 v[64:67], a[4:7], v[240:243], v[64:67]
    s_mul_i32 s56, s89, 589824
    s_add_u32 s56, s56, s52
    s_add_u32 m0, s46, 81920
    v_mfma_f32_16x16x32_bf16 v[68:71], a[4:7], v[244:247], v[68:71]
    ds_read_b64_tr_b16 a[18:19], v2 offset:16896
    v_mfma_f32_16x16x32_bf16 v[68:71], a[0:3], v[228:231], v[68:71]
    v_mfma_f32_16x16x32_bf16 v[72:75], a[0:3], v[232:235], v[72:75]
    ds_read_b64_tr_b16 a[20:21], v2 offset:24576
    v_mfma_f32_16x16x32_bf16 v[72:75], a[4:7], v[248:251], v[72:75]
    v_mfma_f32_16x16x32_bf16 v[76:79], a[4:7], v[252:255], v[76:79]
    ds_read_b64_tr_b16 a[22:23], v2 offset:25088
    v_mfma_f32_16x16x32_bf16 v[76:79], a[0:3], v[236:239], v[76:79]
    s_waitcnt lgkmcnt(4)
    v_mfma_f32_16x16x32_bf16 v[80:83], a[8:11], v[224:227], v[80:83]
    ds_read_b64_tr_b16 a[24:25], v2 offset:18432
    v_mfma_f32_16x16x32_bf16 v[80:83], a[12:15], v[240:243], v[80:83]
    s_add_u32 s47, s58, 0
    buffer_store_dwordx4 v[40:43], v16, s[24:27], s47 offen offset:2048 sc1
    v_mfma_f32_16x16x32_bf16 v[84:87], a[12:15], v[244:247], v[84:87]
    ds_read_b64_tr_b16 a[26:27], v2 offset:18944
    v_mfma_f32_16x16x32_bf16 v[84:87], a[8:11], v[228:231], v[84:87]
    v_mfma_f32_16x16x32_bf16 v[88:91], a[8:11], v[232:235], v[88:91]
    ds_read_b64_tr_b16 a[28:29], v2 offset:26624
    v_mfma_f32_16x16x32_bf16 v[88:91], a[12:15], v[248:251], v[88:91]
    v_mfma_f32_16x16x32_bf16 v[92:95], a[12:15], v[252:255], v[92:95]
    ds_read_b64_tr_b16 a[30:31], v2 offset:27136
    v_mfma_f32_16x16x32_bf16 v[92:95], a[8:11], v[236:239], v[92:95]
    s_waitcnt lgkmcnt(4)
    v_mfma_f32_16x16x32_bf16 v[96:99], a[16:19], v[224:227], v[96:99]
    ds_read_b64_tr_b16 a[0:1], v3 offset:16384
    v_mfma_f32_16x16x32_bf16 v[96:99], a[20:23], v[240:243], v[96:99]
    buffer_load_dwordx4 v17, s[12:15], s56 offen  lds
    v_mfma_f32_16x16x32_bf16 v[100:103], a[20:23], v[244:247], v[100:103]
    ds_read_b64_tr_b16 a[2:3], v3 offset:16896
    v_mfma_f32_16x16x32_bf16 v[100:103], a[16:19], v[228:231], v[100:103]
    v_mfma_f32_16x16x32_bf16 v[104:107], a[16:19], v[232:235], v[104:107]
    ds_read_b64_tr_b16 a[4:5], v3 offset:24576
    v_mfma_f32_16x16x32_bf16 v[104:107], a[20:23], v[248:251], v[104:107]
    v_mfma_f32_16x16x32_bf16 v[108:111], a[20:23], v[252:255], v[108:111]
    ds_read_b64_tr_b16 a[6:7], v3 offset:25088
    v_mfma_f32_16x16x32_bf16 v[108:111], a[16:19], v[236:239], v[108:111]
    s_add_u32 m0, s46, 82944
    s_waitcnt lgkmcnt(4)
    v_mfma_f32_16x16x32_bf16 v[112:115], a[24:27], v[224:227], v[112:115]
    ds_read_b64_tr_b16 a[8:9], v3 offset:18432
    v_mfma_f32_16x16x32_bf16 v[112:115], a[28:31], v[240:243], v[112:115]
    v_mfma_f32_16x16x32_bf16 v[116:119], a[28:31], v[244:247], v[116:119]
    ds_read_b64_tr_b16 a[10:11], v3 offset:18944
    v_mfma_f32_16x16x32_bf16 v[116:119], a[24:27], v[228:231], v[116:119]
    v_mfma_f32_16x16x32_bf16 v[120:123], a[24:27], v[232:235], v[120:123]
    ds_read_b64_tr_b16 a[12:13], v3 offset:26624
    v_mfma_f32_16x16x32_bf16 v[120:123], a[28:31], v[248:251], v[120:123]
    buffer_load_dwordx4 v18, s[12:15], s56 offen  lds
    v_mfma_f32_16x16x32_bf16 v[124:127], a[28:31], v[252:255], v[124:127]
    ds_read_b64_tr_b16 a[14:15], v3 offset:27136
    v_mfma_f32_16x16x32_bf16 v[124:127], a[24:27], v[236:239], v[124:127]
    s_waitcnt lgkmcnt(4)
    v_mfma_f32_16x16x32_bf16 v[128:131], a[0:3], v[224:227], v[128:131]
    ds_read_b64_tr_b16 a[16:17], v4 offset:16384
    v_mfma_f32_16x16x32_bf16 v[128:131], a[4:7], v[240:243], v[128:131]
    v_mfma_f32_16x16x32_bf16 v[132:135], a[4:7], v[244:247], v[132:135]
    ds_read_b64_tr_b16 a[18:19], v4 offset:16896
    v_mfma_f32_16x16x32_bf16 v[132:135], a[0:3], v[228:231], v[132:135]
    s_add_u32 m0, s46, 83968
    v_mfma_f32_16x16x32_bf16 v[136:139], a[0:3], v[232:235], v[136:139]
    ds_read_b64_tr_b16 a[20:21], v4 offset:24576
    v_mfma_f32_16x16x32_bf16 v[136:139], a[4:7], v[248:251], v[136:139]
    s_add_u32 s47, s58, 0
    buffer_store_dwordx4 v[44:47], v16, s[24:27], s47 offen offset:3072 sc1
    v_mfma_f32_16x16x32_bf16 v[140:143], a[4:7], v[252:255], v[140:143]
    ds_read_b64_tr_b16 a[22:23], v4 offset:25088
    v_mfma_f32_16x16x32_bf16 v[140:143], a[0:3], v[236:239], v[140:143]
    s_waitcnt lgkmcnt(4)
    v_mfma_f32_16x16x32_bf16 v[144:147], a[8:11], v[224:227], v[144:147]
    ds_read_b64_tr_b16 a[24:25], v4 offset:18432
    v_mfma_f32_16x16x32_bf16 v[144:147], a[12:15], v[240:243], v[144:147]
    buffer_load_dwordx4 v17, s[16:19], s56 offen  lds
    v_mfma_f32_16x16x32_bf16 v[148:151], a[12:15], v[244:247], v[148:151]
    ds_read_b64_tr_b16 a[26:27], v4 offset:18944
    v_mfma_f32_16x16x32_bf16 v[148:151], a[8:11], v[228:231], v[148:151]
    v_mfma_f32_16x16x32_bf16 v[152:155], a[8:11], v[232:235], v[152:155]
    ds_read_b64_tr_b16 a[28:29], v4 offset:26624
    v_mfma_f32_16x16x32_bf16 v[152:155], a[12:15], v[248:251], v[152:155]
    v_mfma_f32_16x16x32_bf16 v[156:159], a[12:15], v[252:255], v[156:159]
    ds_read_b64_tr_b16 a[30:31], v4 offset:27136
    v_mfma_f32_16x16x32_bf16 v[156:159], a[8:11], v[236:239], v[156:159]
    s_waitcnt vmcnt(15)
    s_barrier
    s_waitcnt lgkmcnt(4)
    v_mfma_f32_16x16x32_bf16 v[160:163], a[16:19], v[224:227], v[160:163]
    ds_read_b64_tr_b16 a[0:1], v1 offset:32768
    s_add_u32 m0, s46, 84992
    v_mfma_f32_16x16x32_bf16 v[160:163], a[20:23], v[240:243], v[160:163]
    v_mfma_f32_16x16x32_bf16 v[164:167], a[20:23], v[244:247], v[164:167]
    ds_read_b64_tr_b16 a[2:3], v1 offset:33280
    v_mfma_f32_16x16x32_bf16 v[164:167], a[16:19], v[228:231], v[164:167]
    v_mfma_f32_16x16x32_bf16 v[168:171], a[16:19], v[232:235], v[168:171]
    ds_read_b64_tr_b16 a[4:5], v1 offset:40960
    v_mfma_f32_16x16x32_bf16 v[168:171], a[20:23], v[248:251], v[168:171]
    buffer_load_dwordx4 v18, s[16:19], s56 offen  lds
    v_mfma_f32_16x16x32_bf16 v[172:175], a[20:23], v[252:255], v[172:175]
    ds_read_b64_tr_b16 a[6:7], v1 offset:41472
    v_mfma_f32_16x16x32_bf16 v[172:175], a[16:19], v[236:239], v[172:175]
    s_waitcnt lgkmcnt(4)
    v_mfma_f32_16x16x32_bf16 v[176:179], a[24:27], v[224:227], v[176:179]
    ds_read_b64_tr_b16 a[8:9], v1 offset:34816
    v_mfma_f32_16x16x32_bf16 v[176:179], a[28:31], v[240:243], v[176:179]
    v_mfma_f32_16x16x32_bf16 v[180:183], a[28:31], v[244:247], v[180:183]
    ds_read_b64_tr_b16 a[10:11], v1 offset:35328
    v_mfma_f32_16x16x32_bf16 v[180:183], a[24:27], v[228:231], v[180:183]
    v_mfma_f32_16x16x32_bf16 v[184:187], a[24:27], v[232:235], v[184:187]
    ds_read_b64_tr_b16 a[12:13], v1 offset:43008
    v_mfma_f32_16x16x32_bf16 v[184:187], a[28:31], v[248:251], v[184:187]
    v_mfma_f32_16x16x32_bf16 v[188:191], a[28:31], v[252:255], v[188:191]
    ds_read_b64_tr_b16 a[14:15], v1 offset:43520
    v_mfma_f32_16x16x32_bf16 v[188:191], a[24:27], v[236:239], v[188:191]
    s_waitcnt lgkmcnt(4)
    v_mfma_f32_16x16x32_bf16 v[64:67], a[0:3], a[32:35], v[64:67]
    ds_read_b64_tr_b16 a[16:17], v2 offset:32768
    v_mfma_f32_16x16x32_bf16 v[64:67], a[4:7], a[48:51], v[64:67]
    s_mul_i32 s56, s90, 589824
    s_add_u32 s56, s56, s52
    s_add_u32 m0, s46, 98304
    v_mfma_f32_16x16x32_bf16 v[68:71], a[4:7], a[52:55], v[68:71]
    ds_read_b64_tr_b16 a[18:19], v2 offset:33280
    v_mfma_f32_16x16x32_bf16 v[68:71], a[0:3], a[36:39], v[68:71]
    v_mfma_f32_16x16x32_bf16 v[72:75], a[0:3], a[40:43], v[72:75]
    ds_read_b64_tr_b16 a[20:21], v2 offset:40960
    v_mfma_f32_16x16x32_bf16 v[72:75], a[4:7], a[56:59], v[72:75]
    v_mfma_f32_16x16x32_bf16 v[76:79], a[4:7], a[60:63], v[76:79]
    ds_read_b64_tr_b16 a[22:23], v2 offset:41472
    v_mfma_f32_16x16x32_bf16 v[76:79], a[0:3], a[44:47], v[76:79]
    s_waitcnt lgkmcnt(4)
    v_mfma_f32_16x16x32_bf16 v[80:83], a[8:11], a[32:35], v[80:83]
    ds_read_b64_tr_b16 a[24:25], v2 offset:34816
    v_mfma_f32_16x16x32_bf16 v[80:83], a[12:15], a[48:51], v[80:83]
    s_add_u32 s47, s58, 8192
    buffer_store_dwordx4 v[48:51], v16, s[24:27], s47 offen offset:0 sc1
    v_mfma_f32_16x16x32_bf16 v[84:87], a[12:15], a[52:55], v[84:87]
    ds_read_b64_tr_b16 a[26:27], v2 offset:35328
    v_mfma_f32_16x16x32_bf16 v[84:87], a[8:11], a[36:39], v[84:87]
    v_mfma_f32_16x16x32_bf16 v[88:91], a[8:11], a[40:43], v[88:91]
    ds_read_b64_tr_b16 a[28:29], v2 offset:43008
    v_mfma_f32_16x16x32_bf16 v[88:91], a[12:15], a[56:59], v[88:91]
    v_mfma_f32_16x16x32_bf16 v[92:95], a[12:15], a[60:63], v[92:95]
    ds_read_b64_tr_b16 a[30:31], v2 offset:43520
    v_mfma_f32_16x16x32_bf16 v[92:95], a[8:11], a[44:47], v[92:95]
    s_waitcnt lgkmcnt(4)
    v_mfma_f32_16x16x32_bf16 v[96:99], a[16:19], a[32:35], v[96:99]
    ds_read_b64_tr_b16 a[0:1], v3 offset:32768
    v_mfma_f32_16x16x32_bf16 v[96:99], a[20:23], a[48:51], v[96:99]
    buffer_load_dwordx4 v17, s[12:15], s56 offen  lds
    v_mfma_f32_16x16x32_bf16 v[100:103], a[20:23], a[52:55], v[100:103]
    ds_read_b64_tr_b16 a[2:3], v3 offset:33280
    v_mfma_f32_16x16x32_bf16 v[100:103], a[16:19], a[36:39], v[100:103]
    v_mfma_f32_16x16x32_bf16 v[104:107], a[16:19], a[40:43], v[104:107]
    ds_read_b64_tr_b16 a[4:5], v3 offset:40960
    v_mfma_f32_16x16x32_bf16 v[104:107], a[20:23], a[56:59], v[104:107]
    v_mfma_f32_16x16x32_bf16 v[108:111], a[20:23], a[60:63], v[108:111]
    ds_read_b64_tr_b16 a[6:7], v3 offset:41472
    v_mfma_f32_16x16x32_bf16 v[108:111], a[16:19], a[44:47], v[108:111]
    s_add_u32 m0, s46, 99328
    s_waitcnt lgkmcnt(4)
    v_mfma_f32_16x16x32_bf16 v[112:115], a[24:27], a[32:35], v[112:115]
    ds_read_b64_tr_b16 a[8:9], v3 offset:34816
    v_mfma_f32_16x16x32_bf16 v[112:115], a[28:31], a[48:51], v[112:115]
    v_mfma_f32_16x16x32_bf16 v[116:119], a[28:31], a[52:55], v[116:119]
    ds_read_b64_tr_b16 a[10:11], v3 offset:35328
    v_mfma_f32_16x16x32_bf16 v[116:119], a[24:27], a[36:39], v[116:119]
    v_mfma_f32_16x16x32_bf16 v[120:123], a[24:27], a[40:43], v[120:123]
    ds_read_b64_tr_b16 a[12:13], v3 offset:43008
    v_mfma_f32_16x16x32_bf16 v[120:123], a[28:31], a[56:59], v[120:123]
    buffer_load_dwordx4 v18, s[12:15], s56 offen  lds
    v_mfma_f32_16x16x32_bf16 v[124:127], a[28:31], a[60:63], v[124:127]
    ds_read_b64_tr_b16 a[14:15], v3 offset:43520
    v_mfma_f32_16x16x32_bf16 v[124:127], a[24:27], a[44:47], v[124:127]
    s_waitcnt lgkmcnt(4)
    v_mfma_f32_16x16x32_bf16 v[128:131], a[0:3], a[32:35], v[128:131]
    ds_read_b64_tr_b16 a[16:17], v4 offset:32768
    v_mfma_f32_16x16x32_bf16 v[128:131], a[4:7], a[48:51], v[128:131]
    v_mfma_f32_16x16x32_bf16 v[132:135], a[4:7], a[52:55], v[132:135]
    ds_read_b64_tr_b16 a[18:19], v4 offset:33280
    v_mfma_f32_16x16x32_bf16 v[132:135], a[0:3], a[36:39], v[132:135]
    s_add_u32 m0, s46, 100352
    v_mfma_f32_16x16x32_bf16 v[136:139], a[0:3], a[40:43], v[136:139]
    ds_read_b64_tr_b16 a[20:21], v4 offset:40960
    v_mfma_f32_16x16x32_bf16 v[136:139], a[4:7], a[56:59], v[136:139]
    s_add_u32 s47, s58, 8192
    buffer_store_dwordx4 v[52:55], v16, s[24:27], s47 offen offset:1024 sc1
    v_mfma_f32_16x16x32_bf16 v[140:143], a[4:7], a[60:63], v[140:143]
    ds_read_b64_tr_b16 a[22:23], v4 offset:41472
    v_mfma_f32_16x16x32_bf16 v[140:143], a[0:3], a[44:47], v[140:143]
    s_waitcnt lgkmcnt(4)
    v_mfma_f32_16x16x32_bf16 v[144:147], a[8:11], a[32:35], v[144:147]
    ds_read_b64_tr_b16 a[24:25], v4 offset:34816
    v_mfma_f32_16x16x32_bf16 v[144:147], a[12:15], a[48:51], v[144:147]
    buffer_load_dwordx4 v17, s[16:19], s56 offen  lds
    v_mfma_f32_16x16x32_bf16 v[148:151], a[12:15], a[52:55], v[148:151]
    ds_read_b64_tr_b16 a[26:27], v4 offset:35328
    v_mfma_f32_16x16x32_bf16 v[148:151], a[8:11], a[36:39], v[148:151]
    v_mfma_f32_16x16x32_bf16 v[152:155], a[8:11], a[40:43], v[152:155]
    ds_read_b64_tr_b16 a[28:29], v4 offset:43008
    v_mfma_f32_16x16x32_bf16 v[152:155], a[12:15], a[56:59], v[152:155]
    v_mfma_f32_16x16x32_bf16 v[156:159], a[12:15], a[60:63], v[156:159]
    ds_read_b64_tr_b16 a[30:31], v4 offset:43520
    v_mfma_f32_16x16x32_bf16 v[156:159], a[8:11], a[44:47], v[156:159]
    s_waitcnt vmcnt(17)
    s_barrier
    s_waitcnt lgkmcnt(4)
    v_mfma_f32_16x16x32_bf16 v[160:163], a[16:19], a[32:35], v[160:163]
    ds_read_b64_tr_b16 a[0:1], v1 offset:49152
    s_add_u32 m0, s46, 101376
    v_mfma_f32_16x16x32_bf16 v[160:163], a[20:23], a[48:51], v[160:163]
    v_mfma_f32_16x16x32_bf16 v[164:167], a[20:23], a[52:55], v[164:167]
    ds_read_b64_tr_b16 a[2:3], v1 offset:49664
    v_mfma_f32_16x16x32_bf16 v[164:167], a[16:19], a[36:39], v[164:167]
    v_mfma_f32_16x16x32_bf16 v[168:171], a[16:19], a[40:43], v[168:171]
    ds_read_b64_tr_b16 a[4:5], v1 offset:57344
    v_mfma_f32_16x16x32_bf16 v[168:171], a[20:23], a[56:59], v[168:171]
    buffer_load_dwordx4 v18, s[16:19], s56 offen  lds
    v_mfma_f32_16x16x32_bf16 v[172:175], a[20:23], a[60:63], v[172:175]
    ds_read_b64_tr_b16 a[6:7], v1 offset:57856
    v_mfma_f32_16x16x32_bf16 v[172:175], a[16:19], a[44:47], v[172:175]
    s_waitcnt lgkmcnt(4)
    v_mfma_f32_16x16x32_bf16 v[176:179], a[24:27], a[32:35], v[176:179]
    ds_read_b64_tr_b16 a[8:9], v1 offset:51200
    v_mfma_f32_16x16x32_bf16 v[176:179], a[28:31], a[48:51], v[176:179]
    v_mfma_f32_16x16x32_bf16 v[180:183], a[28:31], a[52:55], v[180:183]
    ds_read_b64_tr_b16 a[10:11], v1 offset:51712
    v_mfma_f32_16x16x32_bf16 v[180:183], a[24:27], a[36:39], v[180:183]
    v_mfma_f32_16x16x32_bf16 v[184:187], a[24:27], a[40:43], v[184:187]
    ds_read_b64_tr_b16 a[12:13], v1 offset:59392
    v_mfma_f32_16x16x32_bf16 v[184:187], a[28:31], a[56:59], v[184:187]
    v_mfma_f32_16x16x32_bf16 v[188:191], a[28:31], a[60:63], v[188:191]
    ds_read_b64_tr_b16 a[14:15], v1 offset:59904
    v_mfma_f32_16x16x32_bf16 v[188:191], a[24:27], a[44:47], v[188:191]
    s_waitcnt lgkmcnt(4)
    v_mfma_f32_16x16x32_bf16 v[64:67], a[0:3], a[64:67], v[64:67]
    ds_read_b64_tr_b16 a[16:17], v2 offset:49152
    v_mfma_f32_16x16x32_bf16 v[64:67], a[4:7], a[80:83], v[64:67]
    s_mul_i32 s56, s91, 589824
    s_add_u32 s56, s56, s52
    s_add_u32 m0, s46, 114688
    v_mfma_f32_16x16x32_bf16 v[68:71], a[4:7], a[84:87], v[68:71]
    ds_read_b64_tr_b16 a[18:19], v2 offset:49664
    v_mfma_f32_16x16x32_bf16 v[68:71], a[0:3], a[68:71], v[68:71]
    v_mfma_f32_16x16x32_bf16 v[72:75], a[0:3], a[72:75], v[72:75]
    ds_read_b64_tr_b16 a[20:21], v2 offset:57344
    v_mfma_f32_16x16x32_bf16 v[72:75], a[4:7], a[88:91], v[72:75]
    v_mfma_f32_16x16x32_bf16 v[76:79], a[4:7], a[92:95], v[76:79]
    ds_read_b64_tr_b16 a[22:23], v2 offset:57856
    v_mfma_f32_16x16x32_bf16 v[76:79], a[0:3], a[76:79], v[76:79]
    s_waitcnt lgkmcnt(4)
    v_mfma_f32_16x16x32_bf16 v[80:83], a[8:11], a[64:67], v[80:83]
    ds_read_b64_tr_b16 a[24:25], v2 offset:51200
    buffer_load_dwordx4 v17, s[12:15], s56 offen  lds
    v_mfma_f32_16x16x32_bf16 v[80:83], a[12:15], a[80:83], v[80:83]
    s_add_u32 s47, s58, 8192
    buffer_store_dwordx4 v[56:59], v16, s[24:27], s47 offen offset:2048 sc1
    v_mfma_f32_16x16x32_bf16 v[84:87], a[12:15], a[84:87], v[84:87]
    ds_read_b64_tr_b16 a[26:27], v2 offset:51712
    v_mfma_f32_16x16x32_bf16 v[84:87], a[8:11], a[68:71], v[84:87]
    s_add_u32 m0, s46, 115712
    v_mfma_f32_16x16x32_bf16 v[88:91], a[8:11], a[72:75], v[88:91]
    ds_read_b64_tr_b16 a[28:29], v2 offset:59392
    v_mfma_f32_16x16x32_bf16 v[88:91], a[12:15], a[88:91], v[88:91]
    v_mfma_f32_16x16x32_bf16 v[92:95], a[12:15], a[92:95], v[92:95]
    ds_read_b64_tr_b16 a[30:31], v2 offset:59904
    buffer_load_dwordx4 v18, s[12:15], s56 offen  lds
    v_mfma_f32_16x16x32_bf16 v[92:95], a[8:11], a[76:79], v[92:95]
    s_waitcnt lgkmcnt(4)
    v_mfma_f32_16x16x32_bf16 v[96:99], a[16:19], a[64:67], v[96:99]
    ds_read_b64_tr_b16 a[0:1], v3 offset:49152
    s_add_u32 m0, s46, 116736
    v_mfma_f32_16x16x32_bf16 v[96:99], a[20:23], a[80:83], v[96:99]
    v_mfma_f32_16x16x32_bf16 v[100:103], a[20:23], a[84:87], v[100:103]
    ds_read_b64_tr_b16 a[2:3], v3 offset:49664
    v_mfma_f32_16x16x32_bf16 v[100:103], a[16:19], a[68:71], v[100:103]
    buffer_load_dwordx4 v17, s[16:19], s56 offen  lds
    v_mfma_f32_16x16x32_bf16 v[104:107], a[16:19], a[72:75], v[104:107]
    ds_read_b64_tr_b16 a[4:5], v3 offset:57344
    v_mfma_f32_16x16x32_bf16 v[104:107], a[20:23], a[88:91], v[104:107]
    v_mfma_f32_16x16x32_bf16 v[108:111], a[20:23], a[92:95], v[108:111]
    ds_read_b64_tr_b16 a[6:7], v3 offset:57856
    s_add_u32 m0, s46, 117760
    v_mfma_f32_16x16x32_bf16 v[108:111], a[16:19], a[76:79], v[108:111]
    s_waitcnt lgkmcnt(4)
    v_mfma_f32_16x16x32_bf16 v[112:115], a[24:27], a[64:67], v[112:115]
    ds_read_b64_tr_b16 a[8:9], v3 offset:51200
    v_mfma_f32_16x16x32_bf16 v[112:115], a[28:31], a[80:83], v[112:115]
    buffer_load_dwordx4 v18, s[16:19], s56 offen  lds
    v_mfma_f32_16x16x32_bf16 v[116:119], a[28:31], a[84:87], v[116:119]
    ds_read_b64_tr_b16 a[10:11], v3 offset:51712
    v_mfma_f32_16x16x32_bf16 v[116:119], a[24:27], a[68:71], v[116:119]
    v_mfma_f32_16x16x32_bf16 v[120:123], a[24:27], a[72:75], v[120:123]
    ds_read_b64_tr_b16 a[12:13], v3 offset:59392
    v_mfma_f32_16x16x32_bf16 v[120:123], a[28:31], a[88:91], v[120:123]
    s_mul_i32 s56, s92, 589824
    s_add_u32 s56, s56, s52
    s_add_u32 s52, s52, 1024
    s_add_u32 m0, s46, 131072
    v_mfma_f32_16x16x32_bf16 v[124:127], a[28:31], a[92:95], v[124:127]
    ds_read_b64_tr_b16 a[14:15], v3 offset:59904
    v_mfma_f32_16x16x32_bf16 v[124:127], a[24:27], a[76:79], v[124:127]
    s_waitcnt lgkmcnt(4)
    v_mfma_f32_16x16x32_bf16 v[128:131], a[0:3], a[64:67], v[128:131]
    ds_read_b64_tr_b16 a[16:17], v4 offset:49152
    v_mfma_f32_16x16x32_bf16 v[128:131], a[4:7], a[80:83], v[128:131]
    v_mfma_f32_16x16x32_bf16 v[132:135], a[4:7], a[84:87], v[132:135]
    ds_read_b64_tr_b16 a[18:19], v4 offset:49664
    v_mfma_f32_16x16x32_bf16 v[132:135], a[0:3], a[68:71], v[132:135]
    s_add_u32 s47, s58, 8192
    buffer_store_dwordx4 v[60:63], v16, s[24:27], s47 offen offset:3072 sc1
    v_mfma_f32_16x16x32_bf16 v[136:139], a[0:3], a[72:75], v[136:139]
    ds_read_b64_tr_b16 a[20:21], v4 offset:57344
    v_mfma_f32_16x16x32_bf16 v[136:139], a[4:7], a[88:91], v[136:139]
    v_mfma_f32_16x16x32_bf16 v[140:143], a[4:7], a[92:95], v[140:143]
    ds_read_b64_tr_b16 a[22:23], v4 offset:57856
    v_mfma_f32_16x16x32_bf16 v[140:143], a[0:3], a[76:79], v[140:143]
    buffer_load_dwordx4 v17, s[12:15], s56 offen  lds
    s_waitcnt lgkmcnt(4)
    v_mfma_f32_16x16x32_bf16 v[144:147], a[8:11], a[64:67], v[144:147]
    ds_read_b64_tr_b16 a[24:25], v4 offset:51200
    v_mfma_f32_16x16x32_bf16 v[144:147], a[12:15], a[80:83], v[144:147]
    v_mfma_f32_16x16x32_bf16 v[148:151], a[12:15], a[84:87], v[148:151]
    ds_read_b64_tr_b16 a[26:27], v4 offset:51712
    s_add_u32 m0, s46, 132096
    v_mfma_f32_16x16x32_bf16 v[148:151], a[8:11], a[68:71], v[148:151]
    v_mfma_f32_16x16x32_bf16 v[152:155], a[8:11], a[72:75], v[152:155]
    ds_read_b64_tr_b16 a[28:29], v4 offset:59392
    buffer_load_dwordx4 v18, s[12:15], s56 offen  lds
    v_mfma_f32_16x16x32_bf16 v[152:155], a[12:15], a[88:91], v[152:155]
    v_mfma_f32_16x16x32_bf16 v[156:159], a[12:15], a[92:95], v[156:159]
    ds_read_b64_tr_b16 a[30:31], v4 offset:59904
    v_mfma_f32_16x16x32_bf16 v[156:159], a[8:11], a[76:79], v[156:159]
    s_waitcnt vmcnt(20)
    s_barrier
    s_waitcnt lgkmcnt(4)
    v_mfma_f32_16x16x32_bf16 v[160:163], a[16:19], a[64:67], v[160:163]
    v_add_u32 v1, 65536, v1
    ds_read_b64_tr_b16 a[0:1], v1 offset:0
    s_add_u32 m0, s46, 133120
    v_mfma_f32_16x16x32_bf16 v[160:163], a[20:23], a[80:83], v[160:163]
    v_mfma_f32_16x16x32_bf16 v[164:167], a[20:23], a[84:87], v[164:167]
    ds_read_b64_tr_b16 a[2:3], v1 offset:512
    buffer_load_dwordx4 v17, s[16:19], s56 offen  lds
    v_mfma_f32_16x16x32_bf16 v[164:167], a[16:19], a[68:71], v[164:167]
    v_mfma_f32_16x16x32_bf16 v[168:171], a[16:19], a[72:75], v[168:171]
    ds_read_b64_tr_b16 a[4:5], v1 offset:8192
    v_mfma_f32_16x16x32_bf16 v[168:171], a[20:23], a[88:91], v[168:171]
    s_add_u32 m0, s46, 134144
    v_mfma_f32_16x16x32_bf16 v[172:175], a[20:23], a[92:95], v[172:175]
    ds_read_b64_tr_b16 a[6:7], v1 offset:8704
    v_mfma_f32_16x16x32_bf16 v[172:175], a[16:19], a[76:79], v[172:175]
    s_waitcnt lgkmcnt(4)
    v_mfma_f32_16x16x32_bf16 v[176:179], a[24:27], a[64:67], v[176:179]
    ds_read_b64_tr_b16 a[8:9], v1 offset:2048
    buffer_load_dwordx4 v18, s[16:19], s56 offen  lds
    v_mfma_f32_16x16x32_bf16 v[176:179], a[28:31], a[80:83], v[176:179]
    v_mfma_f32_16x16x32_bf16 v[180:183], a[28:31], a[84:87], v[180:183]
    ds_read_b64_tr_b16 a[10:11], v1 offset:2560
    v_mfma_f32_16x16x32_bf16 v[180:183], a[24:27], a[68:71], v[180:183]
    v_mfma_f32_16x16x32_bf16 v[184:187], a[24:27], a[72:75], v[184:187]
    ds_read_b64_tr_b16 a[12:13], v1 offset:10240
    v_mfma_f32_16x16x32_bf16 v[184:187], a[28:31], a[88:91], v[184:187]
    v_mfma_f32_16x16x32_bf16 v[188:191], a[28:31], a[92:95], v[188:191]
    ds_read_b64_tr_b16 a[14:15], v1 offset:10752
    v_mfma_f32_16x16x32_bf16 v[188:191], a[24:27], a[76:79], v[188:191]
    s_waitcnt lgkmcnt(4)
    v_mfma_f32_16x16x32_bf16 v[64:67], a[0:3], a[96:99], v[64:67]
    v_add_u32 v2, 65536, v2
    ds_read_b64_tr_b16 a[16:17], v2 offset:0
    v_mfma_f32_16x16x32_bf16 v[64:67], a[4:7], a[112:115], v[64:67]
    s_mul_i32 s56, s84, 589824
    s_add_u32 s56, s56, s53
    s_add_u32 m0, s46, 0
    v_mfma_f32_16x16x32_bf16 v[68:71], a[4:7], a[116:119], v[68:71]
    ds_read_b64_tr_b16 a[18:19], v2 offset:512
    buffer_load_dwordx4 v21, s[64:67], s56 offen  lds
    v_mfma_f32_16x16x32_bf16 v[68:71], a[0:3], a[100:103], v[68:71]
    s_mul_i32 s57, s84, 221184
    s_add_u32 s57, s57, s54
    s_add_u32 m0, s46, 1024
    v_mfma_f32_16x16x32_bf16 v[72:75], a[0:3], a[104:107], v[72:75]
    ds_read_b64_tr_b16 a[20:21], v2 offset:8192
    buffer_load_dwordx4 v19, s[20:23], s57 offen  lds
    v_mfma_f32_16x16x32_bf16 v[72:75], a[4:7], a[120:123], v[72:75]
    s_add_u32 m0, s46, 2048
    s_nop 0
    buffer_load_dwordx4 v20, s[20:23], s57 offen  lds
    v_mfma_f32_16x16x32_bf16 v[76:79], a[4:7], a[124:127], v[76:79]
    ds_read_b64_tr_b16 a[22:23], v2 offset:8704
    v_mfma_f32_16x16x32_bf16 v[76:79], a[0:3], a[108:111], v[76:79]
    s_waitcnt lgkmcnt(4)
    v_mfma_f32_16x16x32_bf16 v[80:83], a[8:11], a[96:99], v[80:83]
    ds_read_b64_tr_b16 a[24:25], v2 offset:2048
    v_mfma_f32_16x16x32_bf16 v[80:83], a[12:15], a[112:115], v[80:83]
    s_lshl_b32 s73, s84, 3
    s_and_b32 s82, s3, 1
    s_lshl_b32 s82, s82, 2
    s_add_u32 s73, s73, s82
    s_add_u32 s73, s73, 512
    s_mul_i32 s73, s73, 9216
    s_add_u32 s73, s73, s53
    v_and_b32 v28, 3, v0
    v_mul_u32_u24 v28, 9216, v28
    buffer_load_dword v12, v28, s[64:67], s73 offen
    v_mfma_f32_16x16x32_bf16 v[84:87], a[12:15], a[116:119], v[84:87]
    ds_read_b64_tr_b16 a[26:27], v2 offset:2560
    v_mfma_f32_16x16x32_bf16 v[84:87], a[8:11], a[100:103], v[84:87]
    v_mfma_f32_16x16x32_bf16 v[88:91], a[8:11], a[104:107], v[88:91]
    ds_read_b64_tr_b16 a[28:29], v2 offset:10240
    v_mfma_f32_16x16x32_bf16 v[88:91], a[12:15], a[120:123], v[88:91]
    s_lshl_b32 s73, s84, 3
    s_and_b32 s82, s3, 3
    s_lshl_b32 s82, s82, 1
    s_add_u32 s73, s73, s82
    s_add_u32 s73, s73, 512
    s_mul_i32 s73, s73, 3456
    s_add_u32 s73, s73, s54
    v_and_b32 v28, 1, v0
    v_mul_u32_u24 v28, 3456, v28
    buffer_load_dword v12, v28, s[20:23], s73 offen
    v_mfma_f32_16x16x32_bf16 v[92:95], a[12:15], a[124:127], v[92:95]
    ds_read_b64_tr_b16 a[30:31], v2 offset:10752
    v_mfma_f32_16x16x32_bf16 v[92:95], a[8:11], a[108:111], v[92:95]
    s_waitcnt lgkmcnt(4)
    v_mfma_f32_16x16x32_bf16 v[96:99], a[16:19], a[96:99], v[96:99]
    v_add_u32 v3, 65536, v3
    ds_read_b64_tr_b16 a[0:1], v3 offset:0
    v_mfma_f32_16x16x32_bf16 v[96:99], a[20:23], a[112:115], v[96:99]
    v_mfma_f32_16x16x32_bf16 v[100:103], a[20:23], a[116:119], v[100:103]
    ds_read_b64_tr_b16 a[2:3], v3 offset:512
    v_mfma_f32_16x16x32_bf16 v[100:103], a[16:19], a[100:103], v[100:103]
    v_mfma_f32_16x16x32_bf16 v[104:107], a[16:19], a[104:107], v[104:107]
    ds_read_b64_tr_b16 a[4:5], v3 offset:8192
    v_mfma_f32_16x16x32_bf16 v[104:107], a[20:23], a[120:123], v[104:107]
    v_mfma_f32_16x16x32_bf16 v[108:111], a[20:23], a[124:127], v[108:111]
    ds_read_b64_tr_b16 a[6:7], v3 offset:8704
    v_mfma_f32_16x16x32_bf16 v[108:111], a[16:19], a[108:111], v[108:111]
    s_waitcnt lgkmcnt(4)
    v_mfma_f32_16x16x32_bf16 v[112:115], a[24:27], a[96:99], v[112:115]
    ds_read_b64_tr_b16 a[8:9], v3 offset:2048
    v_mfma_f32_16x16x32_bf16 v[112:115], a[28:31], a[112:115], v[112:115]
    v_lshlrev_b32 v28, 7, v0
    v_cmp_gt_u32 vcc, 130, v0
    s_lshr_b32 s73, s2, 3
    s_lshl_b32 s73, s73, 1
    s_and_b32 s82, s2, 1
    s_add_u32 s73, s73, s82
    s_mul_i32 s73, s73, 16640
    s_bfe_u32 s82, s2, 0x20001
    s_mul_i32 s82, s82, 1327104
    s_add_u32 s73, s73, s82
    s_add_u32 s73, s73, 0
    v_cndmask_b32 v28, -16, v28, vcc
    buffer_load_dword v12, v28, s[32:35], s73 offen
    v_mfma_f32_16x16x32_bf16 v[116:119], a[28:31], a[116:119], v[116:119]
    ds_read_b64_tr_b16 a[10:11], v3 offset:2560
    v_mfma_f32_16x16x32_bf16 v[116:119], a[24:27], a[100:103], v[116:119]
    v_mfma_f32_16x16x32_bf16 v[120:123], a[24:27], a[104:107], v[120:123]
    ds_read_b64_tr_b16 a[12:13], v3 offset:10240
    v_mfma_f32_16x16x32_bf16 v[120:123], a[28:31], a[120:123], v[120:123]
    v_mfma_f32_16x16x32_bf16 v[124:127], a[28:31], a[124:127], v[124:127]
    ds_read_b64_tr_b16 a[14:15], v3 offset:10752
    v_mfma_f32_16x16x32_bf16 v[124:127], a[24:27], a[108:111], v[124:127]
    s_waitcnt lgkmcnt(4)
    v_mfma_f32_16x16x32_bf16 v[128:131], a[0:3], a[96:99], v[128:131]
    v_add_u32 v4, 65536, v4
    ds_read_b64_tr_b16 a[16:17], v4 offset:0
    v_mfma_f32_16x16x32_bf16 v[128:131], a[4:7], a[112:115], v[128:131]
    v_mfma_f32_16x16x32_bf16 v[132:135], a[4:7], a[116:119], v[132:135]
    ds_read_b64_tr_b16 a[18:19], v4 offset:512
    v_mfma_f32_16x16x32_bf16 v[132:135], a[0:3], a[100:103], v[132:135]
    v_mfma_f32_16x16x32_bf16 v[136:139], a[0:3], a[104:107], v[136:139]
    ds_read_b64_tr_b16 a[20:21], v4 offset:8192
    v_mfma_f32_16x16x32_bf16 v[136:139], a[4:7], a[120:123], v[136:139]
    v_mfma_f32_16x16x32_bf16 v[140:143], a[4:7], a[124:127], v[140:143]
    ds_read_b64_tr_b16 a[22:23], v4 offset:8704
    v_mfma_f32_16x16x32_bf16 v[140:143], a[0:3], a[108:111], v[140:143]
    s_waitcnt lgkmcnt(4)
    v_mfma_f32_16x16x32_bf16 v[144:147], a[8:11], a[96:99], v[144:147]
    ds_read_b64_tr_b16 a[24:25], v4 offset:2048
    v_mfma_f32_16x16x32_bf16 v[144:147], a[12:15], a[112:115], v[144:147]
    v_mfma_f32_16x16x32_bf16 v[148:151], a[12:15], a[116:119], v[148:151]
    ds_read_b64_tr_b16 a[26:27], v4 offset:2560
    v_mfma_f32_16x16x32_bf16 v[148:151], a[8:11], a[100:103], v[148:151]
    v_mfma_f32_16x16x32_bf16 v[152:155], a[8:11], a[104:107], v[152:155]
    ds_read_b64_tr_b16 a[28:29], v4 offset:10240
    v_mfma_f32_16x16x32_bf16 v[152:155], a[12:15], a[120:123], v[152:155]
    v_mfma_f32_16x16x32_bf16 v[156:159], a[12:15], a[124:127], v[156:159]
    ds_read_b64_tr_b16 a[30:31], v4 offset:10752
    v_mfma_f32_16x16x32_bf16 v[156:159], a[8:11], a[108:111], v[156:159]
    s_waitcnt vmcnt(10)
    s_barrier
    v_mov_b32 v29, s7
    v_add_u32 v29, 2, v29
    buffer_store_dword v29, v30, s[24:27], s6 offen sc1
    s_waitcnt lgkmcnt(4)
    v_mfma_f32_16x16x32_bf16 v[160:163], a[16:19], a[96:99], v[160:163]
    ds_read_b64_tr_b16 a[0:1], v1 offset:16384
    v_mfma_f32_16x16x32_bf16 v[160:163], a[20:23], a[112:115], v[160:163]
    v_mfma_f32_16x16x32_bf16 v[164:167], a[20:23], a[116:119], v[164:167]
    ds_read_b64_tr_b16 a[2:3], v1 offset:16896
    v_mfma_f32_16x16x32_bf16 v[164:167], a[16:19], a[100:103], v[164:167]
    v_mfma_f32_16x16x32_bf16 v[168:171], a[16:19], a[104:107], v[168:171]
    ds_read_b64_tr_b16 a[4:5], v1 offset:24576
    v_mfma_f32_16x16x32_bf16 v[168:171], a[20:23], a[120:123], v[168:171]
    v_mfma_f32_16x16x32_bf16 v[172:175], a[20:23], a[124:127], v[172:175]
    ds_read_b64_tr_b16 a[6:7], v1 offset:25088
    v_mfma_f32_16x16x32_bf16 v[172:175], a[16:19], a[108:111], v[172:175]
    s_waitcnt lgkmcnt(4)
    v_mfma_f32_16x16x32_bf16 v[176:179], a[24:27], a[96:99], v[176:179]
    ds_read_b64_tr_b16 a[8:9], v1 offset:18432
    v_mfma_f32_16x16x32_bf16 v[176:179], a[28:31], a[112:115], v[176:179]
    v_mfma_f32_16x16x32_bf16 v[180:183], a[28:31], a[116:119], v[180:183]
    ds_read_b64_tr_b16 a[10:11], v1 offset:18944
    v_mfma_f32_16x16x32_bf16 v[180:183], a[24:27], a[100:103], v[180:183]
    v_mfma_f32_16x16x32_bf16 v[184:187], a[24:27], a[104:107], v[184:187]
    ds_read_b64_tr_b16 a[12:13], v1 offset:26624
    v_mfma_f32_16x16x32_bf16 v[184:187], a[28:31], a[120:123], v[184:187]
    v_mfma_f32_16x16x32_bf16 v[188:191], a[28:31], a[124:127], v[188:191]
    ds_read_b64_tr_b16 a[14:15], v1 offset:27136
    v_mfma_f32_16x16x32_bf16 v[188:191], a[24:27], a[108:111], v[188:191]
    s_waitcnt lgkmcnt(4)
    v_mfma_f32_16x16x32_bf16 v[64:67], a[0:3], a[128:131], v[64:67]
    ds_read_b64_tr_b16 a[16:17], v2 offset:16384
    v_mfma_f32_16x16x32_bf16 v[64:67], a[4:7], a[144:147], v[64:67]
    v_mfma_f32_16x16x32_bf16 v[68:71], a[4:7], a[148:151], v[68:71]
    ds_read_b64_tr_b16 a[18:19], v2 offset:16896
    v_mfma_f32_16x16x32_bf16 v[68:71], a[0:3], a[132:135], v[68:71]
    v_mfma_f32_16x16x32_bf16 v[72:75], a[0:3], a[136:139], v[72:75]
    ds_read_b64_tr_b16 a[20:21], v2 offset:24576
    v_mfma_f32_16x16x32_bf16 v[72:75], a[4:7], a[152:155], v[72:75]
    v_mfma_f32_16x16x32_bf16 v[76:79], a[4:7], a[156:159], v[76:79]
    ds_read_b64_tr_b16 a[22:23], v2 offset:25088
    v_mfma_f32_16x16x32_bf16 v[76:79], a[0:3], a[140:143], v[76:79]
    s_waitcnt lgkmcnt(4)
    v_mfma_f32_16x16x32_bf16 v[80:83], a[8:11], a[128:131], v[80:83]
    ds_read_b64_tr_b16 a[24:25], v2 offset:18432
    v_mfma_f32_16x16x32_bf16 v[80:83], a[12:15], a[144:147], v[80:83]
    s_getpc_b64 s[76:77]
L_rw2:
    s_mov_b32 s78, L_mk_end-L_rw2
    s_mov_b32 s79, 0x00020000
    s_lshr_b32 s73, s2, 3
    s_mul_i32 s73, s73, 1536
    v_lshlrev_b32 v28, 7, v0
    v_cmp_gt_u32 vcc, 1536, v28
    s_nop 1
    v_cndmask_b32 v28, -16, v28, vcc
    buffer_load_dword v12, v28, s[76:79], s73 offen
    v_mfma_f32_16x16x32_bf16 v[84:87], a[12:15], a[148:151], v[84:87]
    ds_read_b64_tr_b16 a[26:27], v2 offset:18944
    v_mfma_f32_16x16x32_bf16 v[84:87], a[8:11], a[132:135], v[84:87]
    v_mfma_f32_16x16x32_bf16 v[88:91], a[8:11], a[136:139], v[88:91]
    ds_read_b64_tr_b16 a[28:29], v2 offset:26624
    v_mfma_f32_16x16x32_bf16 v[88:91], a[12:15], a[152:155], v[88:91]
    v_mfma_f32_16x16x32_bf16 v[92:95], a[12:15], a[156:159], v[92:95]
    ds_read_b64_tr_b16 a[30:31], v2 offset:27136
    v_mfma_f32_16x16x32_bf16 v[92:95], a[8:11], a[140:143], v[92:95]
    s_waitcnt lgkmcnt(4)
    v_mfma_f32_16x16x32_bf16 v[96:99], a[16:19], a[128:131], v[96:99]
    ds_read_b64_tr_b16 a[0:1], v3 offset:16384
    v_mfma_f32_16x16x32_bf16 v[96:99], a[20:23], a[144:147], v[96:99]
    v_mfma_f32_16x16x32_bf16 v[100:103], a[20:23], a[148:151], v[100:103]
    ds_read_b64_tr_b16 a[2:3], v3 offset:16896
    v_mfma_f32_16x16x32_bf16 v[100:103], a[16:19], a[132:135], v[100:103]
    v_mfma_f32_16x16x32_bf16 v[104:107], a[16:19], a[136:139], v[104:107]
    ds_read_b64_tr_b16 a[4:5], v3 offset:24576
    v_mfma_f32_16x16x32_bf16 v[104:107], a[20:23], a[152:155], v[104:107]
    v_mfma_f32_16x16x32_bf16 v[108:111], a[20:23], a[156:159], v[108:111]
    ds_read_b64_tr_b16 a[6:7], v3 offset:25088
    v_mfma_f32_16x16x32_bf16 v[108:111], a[16:19], a[140:143], v[108:111]
    s_waitcnt lgkmcnt(4)
    v_mfma_f32_16x16x32_bf16 v[112:115], a[24:27], a[128:131], v[112:115]
    ds_read_b64_tr_b16 a[8:9], v3 offset:18432
    v_mfma_f32_16x16x32_bf16 v[112:115], a[28:31], a[144:147], v[112:115]
    v_mfma_f32_16x16x32_bf16 v[116:119], a[28:31], a[148:151], v[116:119]
    ds_read_b64_tr_b16 a[10:11], v3 offset:18944
    v_mfma_f32_16x16x32_bf16 v[116:119], a[24:27], a[132:135], v[116:119]
    v_mfma_f32_16x16x32_bf16 v[120:123], a[24:27], a[136:139], v[120:123]
    ds_read_b64_tr_b16 a[12:13], v3 offset:26624
    v_mfma_f32_16x16x32_bf16 v[120:123], a[28:31], a[152:155], v[120:123]
    v_mfma_f32_16x16x32_bf16 v[124:127], a[28:31], a[156:159], v[124:127]
    ds_read_b64_tr_b16 a[14:15], v3 offset:27136
    v_mfma_f32_16x16x32_bf16 v[124:127], a[24:27], a[140:143], v[124:127]
    s_waitcnt lgkmcnt(4)
    v_mfma_f32_16x16x32_bf16 v[128:131], a[0:3], a[128:131], v[128:131]
    ds_read_b64_tr_b16 a[16:17], v4 offset:16384
    v_mfma_f32_16x16x32_bf16 v[128:131], a[4:7], a[144:147], v[128:131]
    v_mfma_f32_16x16x32_bf16 v[132:135], a[4:7], a[148:151], v[132:135]
    ds_read_b64_tr_b16 a[18:19], v4 offset:16896
    v_mfma_f32_16x16x32_bf16 v[132:135], a[0:3], a[132:135], v[132:135]
    v_mfma_f32_16x16x32_bf16 v[136:139], a[0:3], a[136:139], v[136:139]
    ds_read_b64_tr_b16 a[20:21], v4 offset:24576
    v_mfma_f32_16x16x32_bf16 v[136:139], a[4:7], a[152:155], v[136:139]
    v_mfma_f32_16x16x32_bf16 v[140:143], a[4:7], a[156:159], v[140:143]
    ds_read_b64_tr_b16 a[22:23], v4 offset:25088
    v_mfma_f32_16x16x32_bf16 v[140:143], a[0:3], a[140:143], v[140:143]
    s_waitcnt lgkmcnt(4)
    v_mfma_f32_16x16x32_bf16 v[144:147], a[8:11], a[128:131], v[144:147]
    ds_read_b64_tr_b16 a[24:25], v4 offset:18432
    v_mfma_f32_16x16x32_bf16 v[144:147], a[12:15], a[144:147], v[144:147]
    v_mfma_f32_16x16x32_bf16 v[148:151], a[12:15], a[148:151], v[148:151]
    ds_read_b64_tr_b16 a[26:27], v4 offset:18944
    v_mfma_f32_16x16x32_bf16 v[148:151], a[8:11], a[132:135], v[148:151]
    v_mfma_f32_16x16x32_bf16 v[152:155], a[8:11], a[136:139], v[152:155]
    ds_read_b64_tr_b16 a[28:29], v4 offset:26624
    v_mfma_f32_16x16x32_bf16 v[152:155], a[12:15], a[152:155], v[152:155]
    v_mfma_f32_16x16x32_bf16 v[156:159], a[12:15], a[156:159], v[156:159]
    ds_read_b64_tr_b16 a[30:31], v4 offset:27136
    v_mfma_f32_16x16x32_bf16 v[156:159], a[8:11], a[140:143], v[156:159]
    s_waitcnt vmcnt(18)
    s_barrier
    s_waitcnt lgkmcnt(4)
    v_mfma_f32_16x16x32_bf16 v[160:163], a[16:19], a[128:131], v[160:163]
    ds_read_b64_tr_b16 a[0:1], v1 offset:32768
    v_mfma_f32_16x16x32_bf16 v[160:163], a[20:23], a[144:147], v[160:163]
    v_mfma_f32_16x16x32_bf16 v[164:167], a[20:23], a[148:151], v[164:167]
    ds_read_b64_tr_b16 a[2:3], v1 offset:33280
    v_mfma_f32_16x16x32_bf16 v[164:167], a[16:19], a[132:135], v[164:167]
    v_mfma_f32_16x16x32_bf16 v[168:171], a[16:19], a[136:139], v[168:171]
    ds_read_b64_tr_b16 a[4:5], v1 offset:40960
    v_mfma_f32_16x16x32_bf16 v[168:171], a[20:23], a[152:155], v[168:171]
    v_mfma_f32_16x16x32_bf16 v[172:175], a[20:23], a[156:159], v[172:175]
    ds_read_b64_tr_b16 a[6:7], v1 offset:41472
    v_mfma_f32_16x16x32_bf16 v[172:175], a[16:19], a[140:143], v[172:175]
    s_waitcnt lgkmcnt(4)
    v_mfma_f32_16x16x32_bf16 v[176:179], a[24:27], a[128:131], v[176:179]
    ds_read_b64_tr_b16 a[8:9], v1 offset:34816
    v_mfma_f32_16x16x32_bf16 v[176:179], a[28:31], a[144:147], v[176:179]
    v_mfma_f32_16x16x32_bf16 v[180:183], a[28:31], a[148:151], v[180:183]
    ds_read_b64_tr_b16 a[10:11], v1 offset:35328
    v_mfma_f32_16x16x32_bf16 v[180:183], a[24:27], a[132:135], v[180:183]
    v_mfma_f32_16x16x32_bf16 v[184:187], a[24:27], a[136:139], v[184:187]
    ds_read_b64_tr_b16 a[12:13], v1 offset:43008
    v_mfma_f32_16x16x32_bf16 v[184:187], a[28:31], a[152:155], v[184:187]
    v_mfma_f32_16x16x32_bf16 v[188:191], a[28:31], a[156:159], v[188:191]
    ds_read_b64_tr_b16 a[14:15], v1 offset:43520
    v_mfma_f32_16x16x32_bf16 v[188:191], a[24:27], a[140:143], v[188:191]
    s_waitcnt lgkmcnt(4)
    v_mfma_f32_16x16x32_bf16 v[64:67], a[0:3], a[160:163], v[64:67]
    ds_read_b64_tr_b16 a[16:17], v2 offset:32768
    v_mfma_f32_16x16x32_bf16 v[64:67], a[4:7], a[176:179], v[64:67]
    v_mfma_f32_16x16x32_bf16 v[68:71], a[4:7], a[180:183], v[68:71]
    ds_read_b64_tr_b16 a[18:19], v2 offset:33280
    v_mfma_f32_16x16x32_bf16 v[68:71], a[0:3], a[164:167], v[68:71]
    v_mfma_f32_16x16x32_bf16 v[72:75], a[0:3], a[168:171], v[72:75]
    ds_read_b64_tr_b16 a[20:21], v2 offset:40960
    v_mfma_f32_16x16x32_bf16 v[72:75], a[4:7], a[184:187], v[72:75]
    v_mfma_f32_16x16x32_bf16 v[76:79], a[4:7], a[188:191], v[76:79]
    ds_read_b64_tr_b16 a[22:23], v2 offset:41472
    v_mfma_f32_16x16x32_bf16 v[76:79], a[0:3], a[172:175], v[76:79]
    s_waitcnt lgkmcnt(4)
    v_mfma_f32_16x16x32_bf16 v[80:83], a[8:11], a[160:163], v[80:83]
    ds_read_b64_tr_b16 a[24:25], v2 offset:34816
    v_mfma_f32_16x16x32_bf16 v[80:83], a[12:15], a[176:179], v[80:83]
    v_mfma_f32_16x16x32_bf16 v[84:87], a[12:15], a[180:183], v[84:87]
    ds_read_b64_tr_b16 a[26:27], v2 offset:35328
    v_mfma_f32_16x16x32_bf16 v[84:87], a[8:11], a[164:167], v[84:87]
    v_mfma_f32_16x16x32_bf16 v[88:91], a[8:11], a[168:171], v[88:91]
    ds_read_b64_tr_b16 a[28:29], v2 offset:43008
    v_mfma_f32_16x16x32_bf16 v[88:91], a[12:15], a[184:187], v[88:91]
    v_mfma_f32_16x16x32_bf16 v[92:95], a[12:15], a[188:191], v[92:95]
    ds_read_b64_tr_b16 a[30:31], v2 offset:43520
    v_mfma_f32_16x16x32_bf16 v[92:95], a[8:11], a[172:175], v[92:95]
    s_waitcnt lgkmcnt(4)
    v_mfma_f32_16x16x32_bf16 v[96:99], a[16:19], a[160:163], v[96:99]
    ds_read_b64_tr_b16 a[0:1], v3 offset:32768
    v_mfma_f32_16x16x32_bf16 v[96:99], a[20:23], a[176:179], v[96:99]
    v_mfma_f32_16x16x32_bf16 v[100:103], a[20:23], a[180:183], v[100:103]
    ds_read_b64_tr_b16 a[2:3], v3 offset:33280
    v_mfma_f32_16x16x32_bf16 v[100:103], a[16:19], a[164:167], v[100:103]
    v_mfma_f32_16x16x32_bf16 v[104:107], a[16:19], a[168:171], v[104:107]
    ds_read_b64_tr_b16 a[4:5], v3 offset:40960
    v_mfma_f32_16x16x32_bf16 v[104:107], a[20:23], a[184:187], v[104:107]
    v_mfma_f32_16x16x32_bf16 v[108:111], a[20:23], a[188:191], v[108:111]
    ds_read_b64_tr_b16 a[6:7], v3 offset:41472
    v_mfma_f32_16x16x32_bf16 v[108:111], a[16:19], a[172:175], v[108:111]
    s_waitcnt lgkmcnt(4)
    v_mfma_f32_16x16x32_bf16 v[112:115], a[24:27], a[160:163], v[112:115]
    ds_read_b64_tr_b16 a[8:9], v3 offset:34816
    v_mfma_f32_16x16x32_bf16 v[112:115], a[28:31], a[176:179], v[112:115]
    v_mfma_f32_16x16x32_bf16 v[116:119], a[28:31], a[180:183], v[116:119]
    ds_read_b64_tr_b16 a[10:11], v3 offset:35328
    v_mfma_f32_16x16x32_bf16 v[116:119], a[24:27], a[164:167], v[116:119]
    v_mfma_f32_16x16x32_bf16 v[120:123], a[24:27], a[168:171], v[120:123]
    ds_read_b64_tr_b16 a[12:13], v3 offset:43008
    v_mfma_f32_16x16x32_bf16 v[120:123], a[28:31], a[184:187], v[120:123]
    v_mfma_f32_16x16x32_bf16 v[124:127], a[28:31], a[188:191], v[124:127]
    ds_read_b64_tr_b16 a[14:15], v3 offset:43520
    v_mfma_f32_16x16x32_bf16 v[124:127], a[24:27], a[172:175], v[124:127]
    s_waitcnt lgkmcnt(4)
    v_mfma_f32_16x16x32_bf16 v[128:131], a[0:3], a[160:163], v[128:131]
    ds_read_b64_tr_b16 a[16:17], v4 offset:32768
    v_mfma_f32_16x16x32_bf16 v[128:131], a[4:7], a[176:179], v[128:131]
    v_mfma_f32_16x16x32_bf16 v[132:135], a[4:7], a[180:183], v[132:135]
    ds_read_b64_tr_b16 a[18:19], v4 offset:33280
    v_mfma_f32_16x16x32_bf16 v[132:135], a[0:3], a[164:167], v[132:135]
    v_mfma_f32_16x16x32_bf16 v[136:139], a[0:3], a[168:171], v[136:139]
    ds_read_b64_tr_b16 a[20:21], v4 offset:40960
    v_mfma_f32_16x16x32_bf16 v[136:139], a[4:7], a[184:187], v[136:139]
    v_mfma_f32_16x16x32_bf16 v[140:143], a[4:7], a[188:191], v[140:143]
    ds_read_b64_tr_b16 a[22:23], v4 offset:41472
    v_mfma_f32_16x16x32_bf16 v[140:143], a[0:3], a[172:175], v[140:143]
    s_waitcnt lgkmcnt(4)
    v_mfma_f32_16x16x32_bf16 v[144:147], a[8:11], a[160:163], v[144:147]
    ds_read_b64_tr_b16 a[24:25], v4 offset:34816
    v_mfma_f32_16x16x32_bf16 v[144:147], a[12:15], a[176:179], v[144:147]
    s_mul_i32 s56, s85, 589824
    s_add_u32 s56, s56, s53
    s_add_u32 m0, s46, 16384
    v_mfma_f32_16x16x32_bf16 v[148:151], a[12:15], a[180:183], v[148:151]
    ds_read_b64_tr_b16 a[26:27], v4 offset:35328
    v_mfma_f32_16x16x32_bf16 v[148:151], a[8:11], a[164:167], v[148:151]
    v_mfma_f32_16x16x32_bf16 v[152:155], a[8:11], a[168:171], v[152:155]
    ds_read_b64_tr_b16 a[28:29], v4 offset:43008
    buffer_load_dwordx4 v21, s[64:67], s56 offen  lds
    v_mfma_f32_16x16x32_bf16 v[152:155], a[12:15], a[184:187], v[152:155]
    v_mfma_f32_16x16x32_bf16 v[156:159], a[12:15], a[188:191], v[156:159]
    ds_read_b64_tr_b16 a[30:31], v4 offset:43520
    v_mfma_f32_16x16x32_bf16 v[156:159], a[8:11], a[172:175], v[156:159]
    s_waitcnt vmcnt(14)
    s_barrier
    s_waitcnt lgkmcnt(4)
    v_mfma_f32_16x16x32_bf16 v[160:163], a[16:19], a[160:163], v[160:163]
    ds_read_b64_tr_b16 a[0:1], v1 offset:49152
    v_mfma_f32_16x16x32_bf16 v[160:163], a[20:23], a[176:179], v[160:163]
    s_mul_i32 s57, s85, 221184
    s_add_u32 s57, s57, s54
    s_add_u32 m0, s46, 17408
    v_mfma_f32_16x16x32_bf16 v[164:167], a[20:23], a[180:183], v[164:167]
    ds_read_b64_tr_b16 a[2:3], v1 offset:49664
    v_mfma_f32_16x16x32_bf16 v[164:167], a[16:19], a[164:167], v[164:167]
    v_mfma_f32_16x16x32_bf16 v[168:171], a[16:19], a[168:171], v[168:171]
    ds_read_b64_tr_b16 a[4:5], v1 offset:57344
    v_mfma_f32_16x16x32_bf16 v[168:171], a[20:23], a[184:187], v[168:171]
    buffer_load_dwordx4 v19, s[20:23], s57 offen  lds
    v_mfma_f32_16x16x32_bf16 v[172:175], a[20:23], a[188:191], v[172:175]
    ds_read_b64_tr_b16 a[6:7], v1 offset:57856
    v_mfma_f32_16x16x32_bf16 v[172:175], a[16:19], a[172:175], v[172:175]
    s_add_u32 m0, s46, 18432
    s_waitcnt lgkmcnt(4)
    v_mfma_f32_16x16x32_bf16 v[176:179], a[24:27], a[160:163], v[176:179]
    ds_read_b64_tr_b16 a[8:9], v1 offset:51200
    v_mfma_f32_16x16x32_bf16 v[176:179], a[28:31], a[176:179], v[176:179]
    buffer_load_dwordx4 v20, s[20:23], s57 offen  lds
    v_mfma_f32_16x16x32_bf16 v[180:183], a[28:31], a[180:183], v[180:183]
    ds_read_b64_tr_b16 a[10:11], v1 offset:51712
    v_mfma_f32_16x16x32_bf16 v[180:183], a[24:27], a[164:167], v[180:183]
    v_mfma_f32_16x16x32_bf16 v[184:187], a[24:27], a[168:171], v[184:187]
    ds_read_b64_tr_b16 a[12:13], v1 offset:59392
    v_mfma_f32_16x16x32_bf16 v[184:187], a[28:31], a[184:187], v[184:187]
    v_mfma_f32_16x16x32_bf16 v[188:191], a[28:31], a[188:191], v[188:191]
    ds_read_b64_tr_b16 a[14:15], v1 offset:59904
    v_mfma_f32_16x16x32_bf16 v[188:191], a[24:27], a[172:175], v[188:191]
    s_waitcnt lgkmcnt(4)
    v_mfma_f32_16x16x32_bf16 v[64:67], a[0:3], a[192:195], v[64:67]
    ds_read_b64_tr_b16 a[16:17], v2 offset:49152
    s_and_b32 s50, s2, 1
    v_mfma_f32_16x16x32_bf16 v[64:67], a[4:7], a[208:211], v[64:67]
    s_mul_i32 s56, s86, 589824
    s_add_u32 s56, s56, s53
    s_add_u32 m0, s46, 32768
    v_mfma_f32_16x16x32_bf16 v[68:71], a[4:7], a[212:215], v[68:71]
    ds_read_b64_tr_b16 a[18:19], v2 offset:49664
    s_lshl_b32 s50, s50, 3
    v_mfma_f32_16x16x32_bf16 v[68:71], a[0:3], a[196:199], v[68:71]
    s_bfe_u32 s51, s2, 0x30003
    v_mfma_f32_16x16x32_bf16 v[72:75], a[0:3], a[200:203], v[72:75]
    ds_read_b64_tr_b16 a[20:21], v2 offset:57344
    v_mfma_f32_16x16x32_bf16 v[72:75], a[4:7], a[216:219], v[72:75]
    s_add_u32 s50, s50, s51
    v_mfma_f32_16x16x32_bf16 v[76:79], a[4:7], a[220:223], v[76:79]
    ds_read_b64_tr_b16 a[22:23], v2 offset:57856
    v_mfma_f32_16x16x32_bf16 v[76:79], a[0:3], a[204:207], v[76:79]
    s_mul_i32 s49, s50, 144
    s_waitcnt lgkmcnt(4)
    v_mfma_f32_16x16x32_bf16 v[80:83], a[8:11], a[192:195], v[80:83]
    ds_read_b64_tr_b16 a[24:25], v2 offset:51200
    buffer_load_dwordx4 v21, s[64:67], s56 offen  lds
    v_mfma_f32_16x16x32_bf16 v[80:83], a[12:15], a[208:211], v[80:83]
    s_bfe_u32 s50, s2, 0x20001
    v_mfma_f32_16x16x32_bf16 v[84:87], a[12:15], a[212:215], v[84:87]
    ds_read_b64_tr_b16 a[26:27], v2 offset:51712
    s_mul_i32 s50, s50, 36
    v_mfma_f32_16x16x32_bf16 v[84:87], a[8:11], a[196:199], v[84:87]
    s_mul_i32 s57, s86, 221184
    s_add_u32 s57, s57, s54
    s_add_u32 m0, s46, 33792
    v_mfma_f32_16x16x32_bf16 v[88:91], a[8:11], a[200:203], v[88:91]
    ds_read_b64_tr_b16 a[28:29], v2 offset:59392
    s_add_u32 s49, s49, s50
    v_mfma_f32_16x16x32_bf16 v[88:91], a[12:15], a[216:219], v[88:91]
    v_mfma_f32_16x16x32_bf16 v[92:95], a[12:15], a[220:223], v[92:95]
    ds_read_b64_tr_b16 a[30:31], v2 offset:59904
    s_lshl_b32 s49, s49, 13
    v_mfma_f32_16x16x32_bf16 v[92:95], a[8:11], a[204:207], v[92:95]
    s_waitcnt lgkmcnt(4)
    v_mfma_f32_16x16x32_bf16 v[96:99], a[16:19], a[192:195], v[96:99]
    ds_read_b64_tr_b16 a[0:1], v3 offset:49152
    s_lshr_b32 s50, s3, 1
    v_mfma_f32_16x16x32_bf16 v[96:99], a[20:23], a[208:211], v[96:99]
    s_lshl_b32 s50, s50, 12
    v_mfma_f32_16x16x32_bf16 v[100:103], a[20:23], a[212:215], v[100:103]
    ds_read_b64_tr_b16 a[2:3], v3 offset:49664
    v_mfma_f32_16x16x32_bf16 v[100:103], a[16:19], a[196:199], v[100:103]
    s_add_u32 s49, s49, s50
    v_mfma_f32_16x16x32_bf16 v[104:107], a[16:19], a[200:203], v[104:107]
    ds_read_b64_tr_b16 a[4:5], v3 offset:57344
    buffer_load_dwordx4 v19, s[20:23], s57 offen  lds
    v_mfma_f32_16x16x32_bf16 v[104:107], a[20:23], a[216:219], v[104:107]
    s_and_b32 s50, s3, 1
    v_mfma_f32_16x16x32_bf16 v[108:111], a[20:23], a[220:223], v[108:111]
    ds_read_b64_tr_b16 a[6:7], v3 offset:57856
    v_mfma_f32_16x16x32_bf16 v[108:111], a[16:19], a[204:207], v[108:111]
    s_add_u32 m0, s46, 34816
    s_waitcnt lgkmcnt(4)
    v_mfma_f32_16x16x32_bf16 v[112:115], a[24:27], a[192:195], v[112:115]
    ds_read_b64_tr_b16 a[8:9], v3 offset:51200
    s_lshl_b32 s50, s50, 10
    v_mfma_f32_16x16x32_bf16 v[112:115], a[28:31], a[208:211], v[112:115]
    s_add_u32 s49, s49, s50
    v_mfma_f32_16x16x32_bf16 v[116:119], a[28:31], a[212:215], v[116:119]
    ds_read_b64_tr_b16 a[10:11], v3 offset:51712
    buffer_load_dwordx4 v20, s[20:23], s57 offen  lds
    v_mfma_f32_16x16x32_bf16 v[116:119], a[24:27], a[196:199], v[116:119]
    s_lshr_b32 s50, s2, 6
    v_mfma_f32_16x16x32_bf16 v[120:123], a[24:27], a[200:203], v[120:123]
    ds_read_b64_tr_b16 a[12:13], v3 offset:59392
    s_add_u32 s51, s51, s50
    v_mfma_f32_16x16x32_bf16 v[120:123], a[28:31], a[216:219], v[120:123]
    s_mul_i32 s56, s87, 589824
    s_add_u32 s56, s56, s53
    s_add_u32 m0, s46, 49152
    v_mfma_f32_16x16x32_bf16 v[124:127], a[28:31], a[220:223], v[124:127]
    ds_read_b64_tr_b16 a[14:15], v3 offset:59904
    s_add_u32 s16, s51, 0
    v_mfma_f32_16x16x32_bf16 v[124:127], a[24:27], a[204:207], v[124:127]
    s_waitcnt lgkmcnt(4)
    v_mfma_f32_16x16x32_bf16 v[128:131], a[0:3], a[192:195], v[128:131]
    ds_read_b64_tr_b16 a[16:17], v4 offset:49152
    s_and_b32 s16, s16, 3
    v_mfma_f32_16x16x32_bf16 v[128:131], a[4:7], a[208:211], v[128:131]
    s_add_u32 s17, s51, 1
    v_mfma_f32_16x16x32_bf16 v[132:135], a[4:7], a[212:215], v[132:135]
    ds_read_b64_tr_b16 a[18:19], v4 offset:49664
    v_mfma_f32_16x16x32_bf16 v[132:135], a[0:3], a[196:199], v[132:135]
    s_and_b32 s17, s17, 3
    v_mfma_f32_16x16x32_bf16 v[136:139], a[0:3], a[200:203], v[136:139]
    ds_read_b64_tr_b16 a[20:21], v4 offset:57344
    v_mfma_f32_16x16x32_bf16 v[136:139], a[4:7], a[216:219], v[136:139]
    s_add_u32 s18, s51, 2
    v_mfma_f32_16x16x32_bf16 v[140:143], a[4:7], a[220:223], v[140:143]
    ds_read_b64_tr_b16 a[22:23], v4 offset:57856
    buffer_load_dwordx4 v21, s[64:67], s56 offen  lds
    v_mfma_f32_16x16x32_bf16 v[140:143], a[0:3], a[204:207], v[140:143]
    s_and_b32 s18, s18, 3
    s_waitcnt lgkmcnt(4)
    v_mfma_f32_16x16x32_bf16 v[144:147], a[8:11], a[192:195], v[144:147]
    ds_read_b64_tr_b16 a[24:25], v4 offset:51200
    s_add_u32 s19, s51, 3
    v_mfma_f32_16x16x32_bf16 v[144:147], a[12:15], a[208:211], v[144:147]
    s_mul_i32 s57, s87, 221184
    s_add_u32 s57, s57, s54
    s_add_u32 m0, s46, 50176
    v_mfma_f32_16x16x32_bf16 v[148:151], a[12:15], a[212:215], v[148:151]
    ds_read_b64_tr_b16 a[26:27], v4 offset:51712
    s_and_b32 s19, s19, 3
    v_mfma_f32_16x16x32_bf16 v[148:151], a[8:11], a[196:199], v[148:151]
    v_mfma_f32_16x16x32_bf16 v[152:155], a[8:11], a[200:203], v[152:155]
    ds_read_b64_tr_b16 a[28:29], v4 offset:59392
    s_bfe_u32 s74, s2, 0x20004
    v_mfma_f32_16x16x32_bf16 v[152:155], a[12:15], a[216:219], v[152:155]
    v_mfma_f32_16x16x32_bf16 v[156:159], a[12:15], a[220:223], v[156:159]
    ds_read_b64_tr_b16 a[30:31], v4 offset:59904
    s_lshl_b32 s74, s74, 6
    v_mfma_f32_16x16x32_bf16 v[156:159], a[8:11], a[204:207], v[156:159]
    s_waitcnt vmcnt(15)
    s_barrier
    s_waitcnt lgkmcnt(4)
    v_mfma_f32_16x16x32_bf16 v[160:163], a[16:19], a[192:195], v[160:163]
    v_add_u32 v1, 65536, v1
    ds_read_b64_tr_b16 a[0:1], v1 offset:0
    s_and_b32 s50, s2, 7
    v_mfma_f32_16x16x32_bf16 v[160:163], a[20:23], a[208:211], v[160:163]
    s_add_u32 s74, s74, s50
    v_mfma_f32_16x16x32_bf16 v[164:167], a[20:23], a[212:215], v[164:167]
    ds_read_b64_tr_b16 a[2:3], v1 offset:512
    buffer_load_dwordx4 v19, s[20:23], s57 offen  lds
    v_mfma_f32_16x16x32_bf16 v[164:167], a[16:19], a[196:199], v[164:167]
    v_and_b32 v28, 31, v0
    v_lshlrev_b32 v28, 7, v28
    v_bfe_u32 v29, v0, 5, 1
    v_lshl_add_u32 v28, v29, 13, v28
    v_and_b32 v29, 63, v0
    v_subrev_u32 v29, 0, v29
    v_cmp_gt_u32 vcc, 8, v29
    s_nop 1
    v_cndmask_b32 v28, -16, v28, vcc
    buffer_load_dword v12, v28, s[24:27], s58 offen sc1
    v_mfma_f32_16x16x32_bf16 v[168:171], a[16:19], a[200:203], v[168:171]
    ds_read_b64_tr_b16 a[4:5], v1 offset:8192
    s_lshl_b32 s74, s74, 11
    v_mfma_f32_16x16x32_bf16 v[168:171], a[20:23], a[216:219], v[168:171]
    s_add_u32 m0, s46, 51200
    s_add_u32 s74, s74, 54525952
    v_mfma_f32_16x16x32_bf16 v[172:175], a[20:23], a[220:223], v[172:175]
    ds_read_b64_tr_b16 a[6:7], v1 offset:8704
    v_mfma_f32_16x16x32_bf16 v[172:175], a[16:19], a[204:207], v[172:175]
    s_mov_b32 s52, s59
    s_waitcnt lgkmcnt(4)
    v_mfma_f32_16x16x32_bf16 v[176:179], a[24:27], a[192:195], v[176:179]
    ds_read_b64_tr_b16 a[8:9], v1 offset:2048
    buffer_load_dwordx4 v20, s[20:23], s57 offen  lds
    v_mfma_f32_16x16x32_bf16 v[176:179], a[28:31], a[208:211], v[176:179]
    v_mfma_f32_16x16x32_bf16 v[180:183], a[28:31], a[212:215], v[180:183]
    ds_read_b64_tr_b16 a[10:11], v1 offset:2560
    v_mfma_f32_16x16x32_bf16 v[180:183], a[24:27], a[196:199], v[180:183]
    v_mfma_f32_16x16x32_bf16 v[184:187], a[24:27], a[200:203], v[184:187]
    ds_read_b64_tr_b16 a[12:13], v1 offset:10240
    v_mfma_f32_16x16x32_bf16 v[184:187], a[28:31], a[216:219], v[184:187]
    v_mfma_f32_16x16x32_bf16 v[188:191], a[28:31], a[220:223], v[188:191]
    ds_read_b64_tr_b16 a[14:15], v1 offset:10752
    v_mfma_f32_16x16x32_bf16 v[188:191], a[24:27], a[204:207], v[188:191]
    s_waitcnt lgkmcnt(4)
    v_mfma_f32_16x16x32_bf16 v[64:67], a[0:3], a[224:227], v[64:67]
    v_add_u32 v2, 65536, v2
    ds_read_b64_tr_b16 a[16:17], v2 offset:0
    buffer_load_dword v22, v13, s[24:27], s74 offen sc1
    v_mfma_f32_16x16x32_bf16 v[64:67], a[4:7], a[240:243], v[64:67]
    s_mul_i32 s56, s88, 589824
    s_add_u32 s56, s56, s53
    s_add_u32 m0, s46, 65536
    v_mfma_f32_16x16x32_bf16 v[68:71], a[4:7], a[244:247], v[68:71]
    ds_read_b64_tr_b16 a[18:19], v2 offset:512
    v_mfma_f32_16x16x32_bf16 v[68:71], a[0:3], a[228:231], v[68:71]
    v_mfma_f32_16x16x32_bf16 v[72:75], a[0:3], a[232:235], v[72:75]
    ds_read_b64_tr_b16 a[20:21], v2 offset:8192
    v_mfma_f32_16x16x32_bf16 v[72:75], a[4:7], a[248:251], v[72:75]
    v_mfma_f32_16x16x32_bf16 v[76:79], a[4:7], a[252:255], v[76:79]
    ds_read_b64_tr_b16 a[22:23], v2 offset:8704
    v_mfma_f32_16x16x32_bf16 v[76:79], a[0:3], a[236:239], v[76:79]
    s_waitcnt lgkmcnt(4)
    v_mfma_f32_16x16x32_bf16 v[80:83], a[8:11], a[224:227], v[80:83]
    ds_read_b64_tr_b16 a[24:25], v2 offset:2048
    buffer_load_dwordx4 v21, s[64:67], s56 offen  lds
    v_mfma_f32_16x16x32_bf16 v[80:83], a[12:15], a[240:243], v[80:83]
    v_mfma_f32_16x16x32_bf16 v[84:87], a[12:15], a[244:247], v[84:87]
    ds_read_b64_tr_b16 a[26:27], v2 offset:2560
    v_mfma_f32_16x16x32_bf16 v[84:87], a[8:11], a[228:231], v[84:87]
    s_mul_i32 s57, s88, 221184
    s_add_u32 s57, s57, s54
    s_add_u32 m0, s46, 66560
    v_mfma_f32_16x16x32_bf16 v[88:91], a[8:11], a[232:235], v[88:91]
    ds_read_b64_tr_b16 a[28:29], v2 offset:10240
    v_mfma_f32_16x16x32_bf16 v[88:91], a[12:15], a[248:251], v[88:91]
    v_mfma_f32_16x16x32_bf16 v[92:95], a[12:15], a[252:255], v[92:95]
    ds_read_b64_tr_b16 a[30:31], v2 offset:10752
    v_mfma_f32_16x16x32_bf16 v[92:95], a[8:11], a[236:239], v[92:95]
    s_waitcnt lgkmcnt(4)
    v_mfma_f32_16x16x32_bf16 v[96:99], a[16:19], a[224:227], v[96:99]
    v_add_u32 v3, 65536, v3
    ds_read_b64_tr_b16 a[0:1], v3 offset:0
    v_mfma_f32_16x16x32_bf16 v[96:99], a[20:23], a[240:243], v[96:99]
    v_mfma_f32_16x16x32_bf16 v[100:103], a[20:23], a[244:247], v[100:103]
    ds_read_b64_tr_b16 a[2:3], v3 offset:512
    v_mfma_f32_16x16x32_bf16 v[100:103], a[16:19], a[228:231], v[100:103]
    v_and_b32 v28, 31, v0
    v_lshlrev_b32 v28, 7, v28
    v_bfe_u32 v29, v0, 5, 1
    v_lshl_add_u32 v28, v29, 13, v28
    v_and_b32 v29, 63, v0
    v_subrev_u32 v29, 8, v29
    v_cmp_gt_u32 vcc, 8, v29
    s_nop 1
    v_cndmask_b32 v28, -16, v28, vcc
    buffer_load_dword v12, v28, s[24:27], s58 offen sc1
    v_mfma_f32_16x16x32_bf16 v[104:107], a[16:19], a[232:235], v[104:107]
    ds_read_b64_tr_b16 a[4:5], v3 offset:8192
    buffer_load_dwordx4 v19, s[20:23], s57 offen  lds
    v_mfma_f32_16x16x32_bf16 v[104:107], a[20:23], a[248:251], v[104:107]
    v_mfma_f32_16x16x32_bf16 v[108:111], a[20:23], a[252:255], v[108:111]
    ds_read_b64_tr_b16 a[6:7], v3 offset:8704
    v_mfma_f32_16x16x32_bf16 v[108:111], a[16:19], a[236:239], v[108:111]
    s_add_u32 m0, s46, 67584
    s_waitcnt lgkmcnt(4)
    v_mfma_f32_16x16x32_bf16 v[112:115], a[24:27], a[224:227], v[112:115]
    ds_read_b64_tr_b16 a[8:9], v3 offset:2048
    v_mfma_f32_16x16x32_bf16 v[112:115], a[28:31], a[240:243], v[112:115]
    v_mfma_f32_16x16x32_bf16 v[116:119], a[28:31], a[244:247], v[116:119]
    ds_read_b64_tr_b16 a[10:11], v3 offset:2560
    buffer_load_dwordx4 v20, s[20:23], s57 offen  lds
    v_mfma_f32_16x16x32_bf16 v[116:119], a[24:27], a[228:231], v[116:119]
    v_mfma_f32_16x16x32_bf16 v[120:123], a[24:27], a[232:235], v[120:123]
    ds_read_b64_tr_b16 a[12:13], v3 offset:10240
    v_mfma_f32_16x16x32_bf16 v[120:123], a[28:31], a[248:251], v[120:123]
    s_mul_i32 s56, s89, 589824
    s_add_u32 s56, s56, s53
    s_add_u32 m0, s46, 81920
    v_mfma_f32_16x16x32_bf16 v[124:127], a[28:31], a[252:255], v[124:127]
    ds_read_b64_tr_b16 a[14:15], v3 offset:10752
    v_mfma_f32_16x16x32_bf16 v[124:127], a[24:27], a[236:239], v[124:127]
    s_waitcnt lgkmcnt(4)
    v_mfma_f32_16x16x32_bf16 v[128:131], a[0:3], a[224:227], v[128:131]
    v_add_u32 v4, 65536, v4
    ds_read_b64_tr_b16 a[16:17], v4 offset:0
    v_mul_f32 v80, v64, v80
    v_mfma_f32_16x16x32_bf16 v[128:131], a[4:7], a[240:243], v[128:131]
    v_mul_f32 v81, v65, v81
    v_mul_f32 v82, v66, v82
    v_mfma_f32_16x16x32_bf16 v[132:135], a[4:7], a[244:247], v[132:135]
    ds_read_b64_tr_b16 a[18:19], v4 offset:512
    v_mul_f32 v83, v67, v83
    v_mfma_f32_16x16x32_bf16 v[132:135], a[0:3], a[228:231], v[132:135]
    v_cvt_pk_bf16_f32 v32, v80, v81
    v_cvt_pk_bf16_f32 v33, v82, v83
    v_mfma_f32_16x16x32_bf16 v[136:139], a[0:3], a[232:235], v[136:139]
    ds_read_b64_tr_b16 a[20:21], v4 offset:8192
    v_mul_f32 v84, v68, v84
    v_mfma_f32_16x16x32_bf16 v[136:139], a[4:7], a[248:251], v[136:139]
    v_mul_f32 v85, v69, v85
    v_mul_f32 v86, v70, v86
    v_mfma_f32_16x16x32_bf16 v[140:143], a[4:7], a[252:255], v[140:143]
    ds_read_b64_tr_b16 a[22:23], v4 offset:8704
    buffer_load_dwordx4 v21, s[64:67], s56 offen  lds
    v_mfma_f32_16x16x32_bf16 v[140:143], a[0:3], a[236:239], v[140:143]
    v_mul_f32 v87, v71, v87
    s_waitcnt lgkmcnt(4)
    v_mfma_f32_16x16x32_bf16 v[144:147], a[8:11], a[224:227], v[144:147]
    ds_read_b64_tr_b16 a[24:25], v4 offset:2048
    v_cvt_pk_bf16_f32 v36, v84, v85
    v_cvt_pk_bf16_f32 v37, v86, v87
    v_mul_f32 v88, v72, v88
    v_mfma_f32_16x16x32_bf16 v[144:147], a[12:15], a[240:243], v[144:147]
    s_mul_i32 s57, s89, 221184
    s_add_u32 s57, s57, s54
    s_add_u32 m0, s46, 82944
    v_mul_f32 v89, v73, v89
    v_mfma_f32_16x16x32_bf16 v[148:151], a[12:15], a[244:247], v[148:151]
    ds_read_b64_tr_b16 a[26:27], v4 offset:2560
    v_mul_f32 v90, v74, v90
    v_mul_f32 v91, v75, v91
    v_mfma_f32_16x16x32_bf16 v[148:151], a[8:11], a[228:231], v[148:151]
    v_cvt_pk_bf16_f32 v40, v88, v89
    v_cvt_pk_bf16_f32 v41, v90, v91
    v_mfma_f32_16x16x32_bf16 v[152:155], a[8:11], a[232:235], v[152:155]
    ds_read_b64_tr_b16 a[28:29], v4 offset:10240
    v_mul_f32 v92, v76, v92
    v_mfma_f32_16x16x32_bf16 v[152:155], a[12:15], a[248:251], v[152:155]
    v_mul_f32 v93, v77, v93
    v_mul_f32 v94, v78, v94
    v_mfma_f32_16x16x32_bf16 v[156:159], a[12:15], a[252:255], v[156:159]
    ds_read_b64_tr_b16 a[30:31], v4 offset:10752
    v_mul_f32 v95, v79, v95
    v_cvt_pk_bf16_f32 v44, v92, v93
    v_cvt_pk_bf16_f32 v45, v94, v95
    v_mfma_f32_16x16x32_bf16 v[156:159], a[8:11], a[236:239], v[156:159]
    s_waitcnt vmcnt(21)
    s_barrier
    s_waitcnt lgkmcnt(4)
    v_mfma_f32_16x16x32_bf16 v[160:163], a[16:19], a[224:227], v[160:163]
    v_subrev_u32 v1, 131072, v1
    ds_read_b64_tr_b16 a[0:1], v1 offset:1024
    v_mul_f32 v112, v96, v112
    v_mul_f32 v113, v97, v113
    v_mfma_f32_16x16x32_bf16 v[160:163], a[20:23], a[240:243], v[160:163]
    v_mul_f32 v114, v98, v114
    v_mul_f32 v115, v99, v115
    v_cvt_pk_bf16_f32 v34, v112, v113
    v_mfma_f32_16x16x32_bf16 v[164:167], a[20:23], a[244:247], v[164:167]
    ds_read_b64_tr_b16 a[2:3], v1 offset:1536
    buffer_load_dwordx4 v19, s[20:23], s57 offen  lds
    v_cvt_pk_bf16_f32 v35, v114, v115
    v_mfma_f32_16x16x32_bf16 v[164:167], a[16:19], a[228:231], v[164:167]
    v_mul_f32 v116, v100, v116
    v_mul_f32 v117, v101, v117
    v_and_b32 v28, 31, v0
    v_lshlrev_b32 v28, 7, v28
    v_bfe_u32 v29, v0, 5, 1
    v_lshl_add_u32 v28, v29, 13, v28
    v_and_b32 v29, 63, v0
    v_subrev_u32 v29, 16, v29
    v_cmp_gt_u32 vcc, 8, v29
    s_nop 1
    v_cndmask_b32 v28, -16, v28, vcc
    buffer_load_dword v12, v28, s[24:27], s58 offen sc1
    v_mfma_f32_16x16x32_bf16 v[168:171], a[16:19], a[232:235], v[168:171]
    ds_read_b64_tr_b16 a[4:5], v1 offset:9216
    v_mul_f32 v118, v102, v118
    v_mfma_f32_16x16x32_bf16 v[168:171], a[20:23], a[248:251], v[168:171]
    s_add_u32 m0, s46, 83968
    v_mul_f32 v119, v103, v119
    v_cvt_pk_bf16_f32 v38, v116, v117
    v_mfma_f32_16x16x32_bf16 v[172:175], a[20:23], a[252:255], v[172:175]
    ds_read_b64_tr_b16 a[6:7], v1 offset:9728
    v_cvt_pk_bf16_f32 v39, v118, v119
    v_permlane32_swap_b32 v32, v34
    v_mfma_f32_16x16x32_bf16 v[172:175], a[16:19], a[236:239], v[172:175]
    v_permlane32_swap_b32 v33, v35
    v_mul_f32 v120, v104, v120
    s_waitcnt lgkmcnt(4)
    v_mfma_f32_16x16x32_bf16 v[176:179], a[24:27], a[224:227], v[176:179]
    v_subrev_u32 v2, 131072, v2
    ds_read_b64_tr_b16 a[8:9], v2 offset:1024
    buffer_load_dwordx4 v20, s[20:23], s57 offen  lds
    v_mul_f32 v121, v105, v121
    v_mfma_f32_16x16x32_bf16 v[176:179], a[28:31], a[240:243], v[176:179]
    v_mul_f32 v122, v106, v122
    v_mul_f32 v123, v107, v123
    v_mfma_f32_16x16x32_bf16 v[180:183], a[28:31], a[244:247], v[180:183]
    ds_read_b64_tr_b16 a[10:11], v2 offset:1536
    v_cvt_pk_bf16_f32 v42, v120, v121
    v_cvt_pk_bf16_f32 v43, v122, v123
    v_mfma_f32_16x16x32_bf16 v[180:183], a[24:27], a[228:231], v[180:183]
    v_permlane32_swap_b32 v36, v38
    v_permlane32_swap_b32 v37, v39
    v_mfma_f32_16x16x32_bf16 v[184:187], a[24:27], a[232:235], v[184:187]
    ds_read_b64_tr_b16 a[12:13], v2 offset:9216
    v_mul_f32 v124, v108, v124
    v_mul_f32 v125, v109, v125
    v_mfma_f32_16x16x32_bf16 v[184:187], a[28:31], a[248:251], v[184:187]
    v_mul_f32 v126, v110, v126
    v_mul_f32 v127, v111, v127
    v_mfma_f32_16x16x32_bf16 v[188:191], a[28:31], a[252:255], v[188:191]
    ds_read_b64_tr_b16 a[14:15], v2 offset:9728
    v_cvt_pk_bf16_f32 v46, v124, v125
    v_mfma_f32_16x16x32_bf16 v[188:191], a[24:27], a[236:239], v[188:191]
    v_cvt_pk_bf16_f32 v47, v126, v127
    v_permlane32_swap_b32 v40, v42
    v_permlane32_swap_b32 v41, v43
    s_nop 0
    v_permlane32_swap_b32 v44, v46
    v_permlane32_swap_b32 v45, v47
    s_cmp_ge_u32 s5, 27
    s_cbranch_scc1 L_mk_n
    s_cmp_ge_u32 s5, 18
    s_cbranch_scc1 L_mk_v
    s_waitcnt lgkmcnt(4)
    v_mfma_f32_16x16x32_bf16 v[64:67], a[0:3], v[192:195], 0
    v_subrev_u32 v3, 131072, v3
    ds_read_b64_tr_b16 a[16:17], v3 offset:1024
    v_mul_f32 v144, v128, v144
    s_mul_i32 s56, s90, 589824
    s_add_u32 s56, s56, s53
    s_add_u32 m0, s46, 98304
    v_mfma_f32_16x16x32_bf16 v[64:67], a[4:7], v[208:211], v[64:67]
    v_mul_f32 v145, v129, v145
    v_mul_f32 v146, v130, v146
    s_add_u32 s47, s58, 131072
    buffer_store_dwordx4 v[32:35], v16, s[24:27], s47 offen offset:0 sc1
    v_mfma_f32_16x16x32_bf16 v[68:71], a[4:7], v[212:215], 0
    ds_read_b64_tr_b16 a[18:19], v3 offset:1536
    v_mul_f32 v147, v131, v147
    v_mfma_f32_16x16x32_bf16 v[68:71], a[0:3], v[196:199], v[68:71]
    v_cvt_pk_bf16_f32 v48, v144, v145
    v_cvt_pk_bf16_f32 v49, v146, v147
    v_mfma_f32_16x16x32_bf16 v[72:75], a[0:3], v[200:203], 0
    ds_read_b64_tr_b16 a[20:21], v3 offset:9216
    v_mul_f32 v148, v132, v148
    v_mfma_f32_16x16x32_bf16 v[72:75], a[4:7], v[216:219], v[72:75]
    v_mul_f32 v149, v133, v149
    v_mul_f32 v150, v134, v150
    v_mfma_f32_16x16x32_bf16 v[76:79], a[4:7], v[220:223], 0
    ds_read_b64_tr_b16 a[22:23], v3 offset:9728
    v_mul_f32 v151, v135, v151
    v_mfma_f32_16x16x32_bf16 v[76:79], a[0:3], v[204:207], v[76:79]
    v_cvt_pk_bf16_f32 v52, v148, v149
    s_waitcnt lgkmcnt(4)
    v_mfma_f32_16x16x32_bf16 v[80:83], a[8:11], v[192:195], 0
    v_subrev_u32 v4, 131072, v4
    ds_read_b64_tr_b16 a[24:25], v4 offset:1024
    v_cvt_pk_bf16_f32 v53, v150, v151
    v_mfma_f32_16x16x32_bf16 v[80:83], a[12:15], v[208:211], v[80:83]
    v_mul_f32 v152, v136, v152
    v_mul_f32 v153, v137, v153
    v_mfma_f32_16x16x32_bf16 v[84:87], a[12:15], v[212:215], 0
    ds_read_b64_tr_b16 a[26:27], v4 offset:1536
    v_mul_f32 v154, v138, v154
    v_mul_f32 v155, v139, v155
    v_mfma_f32_16x16x32_bf16 v[84:87], a[8:11], v[196:199], v[84:87]
    v_cvt_pk_bf16_f32 v56, v152, v153
    v_cvt_pk_bf16_f32 v57, v154, v155
    v_mfma_f32_16x16x32_bf16 v[88:91], a[8:11], v[200:203], 0
    ds_read_b64_tr_b16 a[28:29], v4 offset:9216
    v_mul_f32 v156, v140, v156
    v_mul_f32 v157, v141, v157
    v_mfma_f32_16x16x32_bf16 v[88:91], a[12:15], v[216:219], v[88:91]
    v_mul_f32 v158, v142, v158
    v_mul_f32 v159, v143, v159
    buffer_load_dwordx4 v21, s[64:67], s56 offen  lds
    v_mfma_f32_16x16x32_bf16 v[92:95], a[12:15], v[220:223], 0
    ds_read_b64_tr_b16 a[30:31], v4 offset:9728
    v_cvt_pk_bf16_f32 v60, v156, v157
    s_add_u32 s47, s58, 131072
    buffer_store_dwordx4 v[36:39], v16, s[24:27], s47 offen offset:1024 sc1
    v_mfma_f32_16x16x32_bf16 v[92:95], a[8:11], v[204:207], v[92:95]
    v_cvt_pk_bf16_f32 v61, v158, v159
    v_mul_f32 v176, v160, v176
    s_waitcnt lgkmcnt(4)
    v_mfma_f32_16x16x32_bf16 v[96:99], a[16:19], v[192:195], 0
    ds_read_b64_tr_b16 a[0:1], v5 offset:0
    v_mul_f32 v177, v161, v177
    v_mul_f32 v178, v162, v178
    v_mfma_f32_16x16x32_bf16 v[96:99], a[20:23], v[208:211], v[96:99]
    v_mul_f32 v179, v163, v179
    v_cvt_pk_bf16_f32 v50, v176, v177
    v_and_b32 v28, 31, v0
    v_lshlrev_b32 v28, 7, v28
    v_bfe_u32 v29, v0, 5, 1
    v_lshl_add_u32 v28, v29, 13, v28
    v_and_b32 v29, 63, v0
    v_subrev_u32 v29, 24, v29
    v_cmp_gt_u32 vcc, 8, v29
    s_nop 1
    v_cndmask_b32 v28, -16, v28, vcc
    buffer_load_dword v12, v28, s[24:27], s58 offen sc1
    v_mfma_f32_16x16x32_bf16 v[100:103], a[20:23], v[212:215], 0
    ds_read_b64_tr_b16 a[2:3], v5 offset:512
    v_cvt_pk_bf16_f32 v51, v178, v179
    v_mul_f32 v180, v164, v180
    v_mfma_f32_16x16x32_bf16 v[100:103], a[16:19], v[196:199], v[100:103]
    v_mul_f32 v181, v165, v181
    v_mul_f32 v182, v166, v182
    v_mfma_f32_16x16x32_bf16 v[104:107], a[16:19], v[200:203], 0
    ds_read_b64_tr_b16 a[4:5], v5 offset:4096
    v_mul_f32 v183, v167, v183
    v_mfma_f32_16x16x32_bf16 v[104:107], a[20:23], v[216:219], v[104:107]
    v_cvt_pk_bf16_f32 v54, v180, v181
    v_cvt_pk_bf16_f32 v55, v182, v183
    v_mfma_f32_16x16x32_bf16 v[108:111], a[20:23], v[220:223], 0
    ds_read_b64_tr_b16 a[6:7], v5 offset:4608
    v_permlane32_swap_b32 v48, v50
    v_permlane32_swap_b32 v49, v51
    v_mfma_f32_16x16x32_bf16 v[108:111], a[16:19], v[204:207], v[108:111]
    v_mul_f32 v184, v168, v184
    v_mul_f32 v185, v169, v185
    s_waitcnt lgkmcnt(4)
    v_mfma_f32_16x16x32_bf16 v[112:115], a[24:27], v[192:195], 0
    ds_read_b64_tr_b16 a[8:9], v5 offset:8192
    v_mul_f32 v186, v170, v186
    v_mul_f32 v187, v171, v187
    v_mfma_f32_16x16x32_bf16 v[112:115], a[28:31], v[208:211], v[112:115]
    v_cvt_pk_bf16_f32 v58, v184, v185
    v_cvt_pk_bf16_f32 v59, v186, v187
    v_mfma_f32_16x16x32_bf16 v[116:119], a[28:31], v[212:215], 0
    ds_read_b64_tr_b16 a[10:11], v5 offset:8704
    v_permlane32_swap_b32 v52, v54
    v_mfma_f32_16x16x32_bf16 v[116:119], a[24:27], v[196:199], v[116:119]
    v_permlane32_swap_b32 v53, v55
    v_mul_f32 v188, v172, v188
    v_mfma_f32_16x16x32_bf16 v[120:123], a[24:27], v[200:203], 0
    ds_read_b64_tr_b16 a[12:13], v5 offset:12288
    v_mul_f32 v189, v173, v189
    v_mul_f32 v190, v174, v190
    v_mfma_f32_16x16x32_bf16 v[120:123], a[28:31], v[216:219], v[120:123]
    v_mul_f32 v191, v175, v191
    v_cvt_pk_bf16_f32 v62, v188, v189
    v_mfma_f32_16x16x32_bf16 v[124:127], a[28:31], v[220:223], 0
    ds_read_b64_tr_b16 a[14:15], v5 offset:12800
    v_cvt_pk_bf16_f32 v63, v190, v191
    v_permlane32_swap_b32 v56, v58
    v_permlane32_swap_b32 v57, v59
    s_nop 0
    v_permlane32_swap_b32 v60, v62
    v_permlane32_swap_b32 v61, v63
    v_mfma_f32_16x16x32_bf16 v[124:127], a[24:27], v[204:207], v[124:127]
    s_waitcnt vmcnt(20)
    s_barrier
    s_waitcnt lgkmcnt(4)
    v_mfma_f32_16x16x32_bf16 v[160:163], a[0:3], v[192:195], 0
    ds_read_b64_tr_b16 a[16:17], v1 offset:17408
    s_mul_i32 s57, s90, 221184
    s_add_u32 s57, s57, s54
    s_add_u32 m0, s46, 99328
    v_mfma_f32_16x16x32_bf16 v[160:163], a[4:7], v[208:211], v[160:163]
    buffer_load_dwordx4 v19, s[20:23], s57 offen  lds
    v_mfma_f32_16x16x32_bf16 v[164:167], a[4:7], v[212:215], 0
    ds_read_b64_tr_b16 a[18:19], v1 offset:17920
    v_mfma_f32_16x16x32_bf16 v[164:167], a[0:3], v[196:199], v[164:167]
    s_add_u32 m0, s46, 100352
    v_mfma_f32_16x16x32_bf16 v[168:171], a[0:3], v[200:203], 0
    ds_read_b64_tr_b16 a[20:21], v1 offset:25600
    v_mfma_f32_16x16x32_bf16 v[168:171], a[4:7], v[216:219], v[168:171]
    s_add_u32 s47, s58, 131072
    buffer_store_dwordx4 v[40:43], v16, s[24:27], s47 offen offset:2048 sc1
    v_mfma_f32_16x16x32_bf16 v[172:175], a[4:7], v[220:223], 0
    ds_read_b64_tr_b16 a[22:23], v1 offset:26112
    v_mfma_f32_16x16x32_bf16 v[172:175], a[0:3], v[204:207], v[172:175]
    buffer_load_dwordx4 v20, s[20:23], s57 offen  lds
    s_waitcnt lgkmcnt(4)
    v_mfma_f32_16x16x32_bf16 v[176:179], a[8:11], v[192:195], 0
    ds_read_b64_tr_b16 a[24:25], v2 offset:17408
    v_mfma_f32_16x16x32_bf16 v[176:179], a[12:15], v[208:211], v[176:179]
    v_and_b32 v28, 31, v0
    v_lshlrev_b32 v28, 7, v28
    v_bfe_u32 v29, v0, 5, 1
    v_lshl_add_u32 v28, v29, 13, v28
    v_and_b32 v29, 63, v0
    v_subrev_u32 v29, 32, v29
    v_cmp_gt_u32 vcc, 8, v29
    s_nop 1
    v_cndmask_b32 v28, -16, v28, vcc
    buffer_load_dword v12, v28, s[24:27], s58 offen sc1
    v_mfma_f32_16x16x32_bf16 v[180:183], a[12:15], v[212:215], 0
    ds_read_b64_tr_b16 a[26:27], v2 offset:17920
    v_mfma_f32_16x16x32_bf16 v[180:183], a[8:11], v[196:199], v[180:183]
    v_mfma_f32_16x16x32_bf16 v[184:187], a[8:11], v[200:203], 0
    ds_read_b64_tr_b16 a[28:29], v2 offset:25600
    v_mfma_f32_16x16x32_bf16 v[184:187], a[12:15], v[216:219], v[184:187]
    v_mfma_f32_16x16x32_bf16 v[188:191], a[12:15], v[220:223], 0
    ds_read_b64_tr_b16 a[30:31], v2 offset:26112
    v_mfma_f32_16x16x32_bf16 v[188:191], a[8:11], v[204:207], v[188:191]
    s_waitcnt lgkmcnt(4)
    v_mfma_f32_16x16x32_bf16 v[64:67], a[16:19], v[224:227], v[64:67]
    ds_read_b64_tr_b16 a[0:1], v3 offset:17408
    v_mfma_f32_16x16x32_bf16 v[64:67], a[20:23], v[240:243], v[64:67]
    s_mul_i32 s56, s91, 589824
    s_add_u32 s56, s56, s53
    s_add_u32 m0, s46, 114688
    v_mfma_f32_16x16x32_bf16 v[68:71], a[20:23], v[244:247], v[68:71]
    ds_read_b64_tr_b16 a[2:3], v3 offset:17920
    v_mfma_f32_16x16x32_bf16 v[68:71], a[16:19], v[228:231], v[68:71]
    s_add_u32 s82, s7, 2
    s_waitcnt vmcnt(16)
    v_subrev_u32 v22, s82, v22
    v_cmp_lt_u32 vcc, 7, v22
    s_cbranch_vccz L_poll3_ok
    s_mov_b32 s83, 0
L_poll3:
    buffer_load_dword v22, v13, s[24:27], s74 offen sc1
    s_add_u32 s83, s83, 1
    s_waitcnt vmcnt(0)
    v_subrev_u32 v22, s82, v22
    v_cmp_lt_u32 vcc, 7, v22
    s_cbranch_vccz L_poll3_ok
    s_cmp_lt_u32 s83, 0x40000
    s_cbranch_scc1 L_poll3
L_poll3_ok:
    v_mfma_f32_16x16x32_bf16 v[72:75], a[16:19], v[232:235], v[72:75]
    ds_read_b64_tr_b16 a[4:5], v3 offset:25600
    v_mfma_f32_16x16x32_bf16 v[72:75], a[20:23], v[248:251], v[72:75]
    s_add_u32 s47, s58, 131072
    buffer_store_dwordx4 v[44:47], v16, s[24:27], s47 offen offset:3072 sc1
    v_mfma_f32_16x16x32_bf16 v[76:79], a[20:23], v[252:255], v[76:79]
    ds_read_b64_tr_b16 a[6:7], v3 offset:26112
    v_mfma_f32_16x16x32_bf16 v[76:79], a[16:19], v[236:239], v[76:79]
    s_waitcnt lgkmcnt(4)
    v_mfma_f32_16x16x32_bf16 v[80:83], a[24:27], v[224:227], v[80:83]
    ds_read_b64_tr_b16 a[8:9], v4 offset:17408
    v_mfma_f32_16x16x32_bf16 v[80:83], a[28:31], v[240:243], v[80:83]
    v_mfma_f32_16x16x32_bf16 v[84:87], a[28:31], v[244:247], v[84:87]
    ds_read_b64_tr_b16 a[10:11], v4 offset:17920
    v_mfma_f32_16x16x32_bf16 v[84:87], a[24:27], v[228:231], v[84:87]
    v_mfma_f32_16x16x32_bf16 v[88:91], a[24:27], v[232:235], v[88:91]
    ds_read_b64_tr_b16 a[12:13], v4 offset:25600
    v_mfma_f32_16x16x32_bf16 v[88:91], a[28:31], v[248:251], v[88:91]
    buffer_load_dwordx4 v21, s[64:67], s56 offen  lds
    v_mfma_f32_16x16x32_bf16 v[92:95], a[28:31], v[252:255], v[92:95]
    ds_read_b64_tr_b16 a[14:15], v4 offset:26112
    v_and_b32 v28, 31, v0
    v_lshlrev_b32 v28, 7, v28
    v_bfe_u32 v29, v0, 5, 1
    v_lshl_add_u32 v28, v29, 13, v28
    v_and_b32 v29, 63, v0
    v_subrev_u32 v29, 40, v29
    v_cmp_gt_u32 vcc, 8, v29
    s_nop 1
    v_cndmask_b32 v28, -16, v28, vcc
    buffer_load_dword v12, v28, s[24:27], s58 offen sc1
    v_mfma_f32_16x16x32_bf16 v[92:95], a[24:27], v[236:239], v[92:95]
    s_waitcnt lgkmcnt(4)
    v_mfma_f32_16x16x32_bf16 v[96:99], a[0:3], v[224:227], v[96:99]
    ds_read_b64_tr_b16 a[16:17], v5 offset:16384
    v_mfma_f32_16x16x32_bf16 v[96:99], a[4:7], v[240:243], v[96:99]
    s_mul_i32 s57, s91, 221184
    s_add_u32 s57, s57, s54
    s_add_u32 m0, s46, 115712
    v_mfma_f32_16x16x32_bf16 v[100:103], a[4:7], v[244:247], v[100:103]
    ds_read_b64_tr_b16 a[18:19], v5 offset:16896
    v_mfma_f32_16x16x32_bf16 v[100:103], a[0:3], v[228:231], v[100:103]
    v_mfma_f32_16x16x32_bf16 v[104:107], a[0:3], v[232:235], v[104:107]
    ds_read_b64_tr_b16 a[20:21], v5 offset:20480
    v_mfma_f32_16x16x32_bf16 v[104:107], a[4:7], v[248:251], v[104:107]
    v_mfma_f32_16x16x32_bf16 v[108:111], a[4:7], v[252:255], v[108:111]
    ds_read_b64_tr_b16 a[22:23], v5 offset:20992
    v_mfma_f32_16x16x32_bf16 v[108:111], a[0:3], v[236:239], v[108:111]
    s_waitcnt lgkmcnt(4)
    v_mfma_f32_16x16x32_bf16 v[112:115], a[8:11], v[224:227], v[112:115]
    ds_read_b64_tr_b16 a[24:25], v5 offset:24576
    v_mfma_f32_16x16x32_bf16 v[112:115], a[12:15], v[240:243], v[112:115]
    s_add_u32 s47, s58, 139264
    buffer_store_dwordx4 v[48:51], v16, s[24:27], s47 offen offset:0 sc1
    v_mfma_f32_16x16x32_bf16 v[116:119], a[12:15], v[244:247], v[116:119]
    ds_read_b64_tr_b16 a[26:27], v5 offset:25088
    v_mfma_f32_16x16x32_bf16 v[116:119], a[8:11], v[228:231], v[116:119]
    v_mfma_f32_16x16x32_bf16 v[120:123], a[8:11], v[232:235], v[120:123]
    ds_read_b64_tr_b16 a[28:29], v5 offset:28672
    v_mfma_f32_16x16x32_bf16 v[120:123], a[12:15], v[248:251], v[120:123]
    v_mfma_f32_16x16x32_bf16 v[124:127], a[12:15], v[252:255], v[124:127]
    ds_read_b64_tr_b16 a[30:31], v5 offset:29184
    buffer_load_dwordx4 v19, s[20:23], s57 offen  lds
    v_mfma_f32_16x16x32_bf16 v[124:127], a[8:11], v[236:239], v[124:127]
    s_waitcnt vmcnt(26)
    s_barrier
    s_waitcnt lgkmcnt(4)
    v_mfma_f32_16x16x32_bf16 v[160:163], a[16:19], v[224:227], v[160:163]
    ds_read_b64_tr_b16 a[0:1], v1 offset:33792
    v_mfma_f32_16x16x32_bf16 v[160:163], a[20:23], v[240:243], v[160:163]
    v_mfma_f32_16x16x32_bf16 v[164:167], a[20:23], v[244:247], v[164:167]
    ds_read_b64_tr_b16 a[2:3], v1 offset:34304
    v_mfma_f32_16x16x32_bf16 v[164:167], a[16:19], v[228:231], v[164:167]
    s_add_u32 m0, s46, 116736
    v_mfma_f32_16x16x32_bf16 v[168:171], a[16:19], v[232:235], v[168:171]
    ds_read_b64_tr_b16 a[4:5], v1 offset:41984
    v_mfma_f32_16x16x32_bf16 v[168:171], a[20:23], v[248:251], v[168:171]
    v_mfma_f32_16x16x32_bf16 v[172:175], a[20:23], v[252:255], v[172:175]
    ds_read_b64_tr_b16 a[6:7], v1 offset:42496
    v_mfma_f32_16x16x32_bf16 v[172:175], a[16:19], v[236:239], v[172:175]
    buffer_load_dwordx4 v20, s[20:23], s57 offen  lds
    s_waitcnt lgkmcnt(4)
    v_mfma_f32_16x16x32_bf16 v[176:179], a[24:27], v[224:227], v[176:179]
    ds_read_b64_tr_b16 a[8:9], v2 offset:33792
    v_mfma_f32_16x16x32_bf16 v[176:179], a[28:31], v[240:243], v[176:179]
    v_and_b32 v28, 31, v0
    v_lshlrev_b32 v28, 7, v28
    v_bfe_u32 v29, v0, 5, 1
    v_lshl_add_u32 v28, v29, 13, v28
    v_and_b32 v29, 63, v0
    v_subrev_u32 v29, 48, v29
    v_cmp_gt_u32 vcc, 8, v29
    s_nop 1
    v_cndmask_b32 v28, -16, v28, vcc
    buffer_load_dword v12, v28, s[24:27], s58 offen sc1
    v_mfma_f32_16x16x32_bf16 v[180:183], a[28:31], v[244:247], v[180:183]
    ds_read_b64_tr_b16 a[10:11], v2 offset:34304
    v_mfma_f32_16x16x32_bf16 v[180:183], a[24:27], v[228:231], v[180:183]
    v_mfma_f32_16x16x32_bf16 v[184:187], a[24:27], v[232:235], v[184:187]
    ds_read_b64_tr_b16 a[12:13], v2 offset:41984
    v_mfma_f32_16x16x32_bf16 v[184:187], a[28:31], v[248:251], v[184:187]
    v_mfma_f32_16x16x32_bf16 v[188:191], a[28:31], v[252:255], v[188:191]
    ds_read_b64_tr_b16 a[14:15], v2 offset:42496
    v_mfma_f32_16x16x32_bf16 v[188:191], a[24:27], v[236:239], v[188:191]
    s_waitcnt lgkmcnt(4)
    v_mfma_f32_16x16x32_bf16 v[64:67], a[0:3], a[32:35], v[64:67]
    ds_read_b64_tr_b16 a[16:17], v3 offset:33792
    v_mfma_f32_16x16x32_bf16 v[64:67], a[4:7], a[48:51], v[64:67]
    s_mul_i32 s56, s92, 589824
    s_add_u32 s56, s56, s53
    s_add_u32 m0, s46, 131072
    v_mfma_f32_16x16x32_bf16 v[68:71], a[4:7], a[52:55], v[68:71]
    ds_read_b64_tr_b16 a[18:19], v3 offset:34304
    v_mfma_f32_16x16x32_bf16 v[68:71], a[0:3], a[36:39], v[68:71]
    s_add_u32 s47, s58, 139264
    buffer_store_dwordx4 v[52:55], v16, s[24:27], s47 offen offset:1024 sc1
    v_mfma_f32_16x16x32_bf16 v[72:75], a[0:3], a[40:43], v[72:75]
    ds_read_b64_tr_b16 a[20:21], v3 offset:41984
    v_mfma_f32_16x16x32_bf16 v[72:75], a[4:7], a[56:59], v[72:75]
    v_mfma_f32_16x16x32_bf16 v[76:79], a[4:7], a[60:63], v[76:79]
    ds_read_b64_tr_b16 a[22:23], v3 offset:42496
    v_mfma_f32_16x16x32_bf16 v[76:79], a[0:3], a[44:47], v[76:79]
    s_waitcnt lgkmcnt(4)
    v_mfma_f32_16x16x32_bf16 v[80:83], a[8:11], a[32:35], v[80:83]
    ds_read_b64_tr_b16 a[24:25], v4 offset:33792
    buffer_load_dwordx4 v21, s[64:67], s56 offen  lds
    v_mfma_f32_16x16x32_bf16 v[80:83], a[12:15], a[48:51], v[80:83]
    v_mfma_f32_16x16x32_bf16 v[84:87], a[12:15], a[52:55], v[84:87]
    ds_read_b64_tr_b16 a[26:27], v4 offset:34304
    v_mfma_f32_16x16x32_bf16 v[84:87], a[8:11], a[36:39], v[84:87]
    s_mul_i32 s57, s92, 221184
    s_add_u32 s57, s57, s54
    s_add_u32 m0, s46, 132096
    v_mfma_f32_16x16x32_bf16 v[88:91], a[8:11], a[40:43], v[88:91]
    ds_read_b64_tr_b16 a[28:29], v4 offset:41984
    v_mfma_f32_16x16x32_bf16 v[88:91], a[12:15], a[56:59], v[88:91]
    v_mfma_f32_16x16x32_bf16 v[92:95], a[12:15], a[60:63], v[92:95]
    ds_read_b64_tr_b16 a[30:31], v4 offset:42496
    v_and_b32 v28, 31, v0
    v_lshlrev_b32 v28, 7, v28
    v_bfe_u32 v29, v0, 5, 1
    v_lshl_add_u32 v28, v29, 13, v28
    v_and_b32 v29, 63, v0
    v_subrev_u32 v29, 56, v29
    v_cmp_gt_u32 vcc, 8, v29
    s_nop 1
    v_cndmask_b32 v28, -16, v28, vcc
    buffer_load_dword v12, v28, s[24:27], s58 offen sc1
    v_mfma_f32_16x16x32_bf16 v[92:95], a[8:11], a[44:47], v[92:95]
    s_waitcnt lgkmcnt(4)
    v_mfma_f32_16x16x32_bf16 v[96:99], a[16:19], a[32:35], v[96:99]
    ds_read_b64_tr_b16 a[0:1], v5 offset:32768
    v_mfma_f32_16x16x32_bf16 v[96:99], a[20:23], a[48:51], v[96:99]
    s_add_u32 s47, s58, 139264
    buffer_store_dwordx4 v[56:59], v16, s[24:27], s47 offen offset:2048 sc1
    v_mfma_f32_16x16x32_bf16 v[100:103], a[20:23], a[52:55], v[100:103]
    ds_read_b64_tr_b16 a[2:3], v5 offset:33280
    v_mfma_f32_16x16x32_bf16 v[100:103], a[16:19], a[36:39], v[100:103]
    buffer_load_dwordx4 v19, s[20:23], s57 offen  lds
    v_mfma_f32_16x16x32_bf16 v[104:107], a[16:19], a[40:43], v[104:107]
    ds_read_b64_tr_b16 a[4:5], v5 offset:36864
    v_mfma_f32_16x16x32_bf16 v[104:107], a[20:23], a[56:59], v[104:107]
    v_mfma_f32_16x16x32_bf16 v[108:111], a[20:23], a[60:63], v[108:111]
    ds_read_b64_tr_b16 a[6:7], v5 offset:37376
    s_add_u32 m0, s46, 133120
    v_mfma_f32_16x16x32_bf16 v[108:111], a[16:19], a[44:47], v[108:111]
    s_waitcnt lgkmcnt(4)
    v_mfma_f32_16x16x32_bf16 v[112:115], a[24:27], a[32:35], v[112:115]
    ds_read_b64_tr_b16 a[8:9], v5 offset:40960
    v_mfma_f32_16x16x32_bf16 v[112:115], a[28:31], a[48:51], v[112:115]
    buffer_load_dwordx4 v20, s[20:23], s57 offen  lds
    v_mfma_f32_16x16x32_bf16 v[116:119], a[28:31], a[52:55], v[116:119]
    ds_read_b64_tr_b16 a[10:11], v5 offset:41472
    v_mfma_f32_16x16x32_bf16 v[116:119], a[24:27], a[36:39], v[116:119]
    v_mfma_f32_16x16x32_bf16 v[120:123], a[24:27], a[40:43], v[120:123]
    ds_read_b64_tr_b16 a[12:13], v5 offset:45056
    v_mfma_f32_16x16x32_bf16 v[120:123], a[28:31], a[56:59], v[120:123]
    s_add_u32 s47, s58, 139264
    buffer_store_dwordx4 v[60:63], v16, s[24:27], s47 offen offset:3072 sc1
    v_mfma_f32_16x16x32_bf16 v[124:127], a[28:31], a[60:63], v[124:127]
    ds_read_b64_tr_b16 a[14:15], v5 offset:45568
    v_mfma_f32_16x16x32_bf16 v[124:127], a[24:27], a[44:47], v[124:127]
    s_waitcnt vmcnt(31)
    s_barrier
    s_waitcnt lgkmcnt(4)
    v_mfma_f32_16x16x32_bf16 v[160:163], a[0:3], a[32:35], v[160:163]
    ds_read_b64_tr_b16 a[16:17], v1 offset:50176
    v_mfma_f32_16x16x32_bf16 v[160:163], a[4:7], a[48:51], v[160:163]
    v_mfma_f32_16x16x32_bf16 v[164:167], a[4:7], a[52:55], v[164:167]
    ds_read_b64_tr_b16 a[18:19], v1 offset:50688
    v_mfma_f32_16x16x32_bf16 v[164:167], a[0:3], a[36:39], v[164:167]
    v_mfma_f32_16x16x32_bf16 v[168:171], a[0:3], a[40:43], v[168:171]
    ds_read_b64_tr_b16 a[20:21], v1 offset:58368
    v_mfma_f32_16x16x32_bf16 v[168:171], a[4:7], a[56:59], v[168:171]
    v_mfma_f32_16x16x32_bf16 v[172:175], a[4:7], a[60:63], v[172:175]
    ds_read_b64_tr_b16 a[22:23], v1 offset:58880
    v_mfma_f32_16x16x32_bf16 v[172:175], a[0:3], a[44:47], v[172:175]
    s_waitcnt lgkmcnt(4)
    v_mfma_f32_16x16x32_bf16 v[176:179], a[8:11], a[32:35], v[176:179]
    ds_read_b64_tr_b16 a[24:25], v2 offset:50176
    v_mfma_f32_16x16x32_bf16 v[176:179], a[12:15], a[48:51], v[176:179]
    v_mfma_f32_16x16x32_bf16 v[180:183], a[12:15], a[52:55], v[180:183]
    ds_read_b64_tr_b16 a[26:27], v2 offset:50688
    v_mfma_f32_16x16x32_bf16 v[180:183], a[8:11], a[36:39], v[180:183]
    v_mfma_f32_16x16x32_bf16 v[184:187], a[8:11], a[40:43], v[184:187]
    ds_read_b64_tr_b16 a[28:29], v2 offset:58368
    v_mfma_f32_16x16x32_bf16 v[184:187], a[12:15], a[56:59], v[184:187]
    v_mfma_f32_16x16x32_bf16 v[188:191], a[12:15], a[60:63], v[188:191]
    ds_read_b64_tr_b16 a[30:31], v2 offset:58880
    v_mfma_f32_16x16x32_bf16 v[188:191], a[8:11], a[44:47], v[188:191]
    s_waitcnt lgkmcnt(4)
    v_mfma_f32_16x16x32_bf16 v[64:67], a[16:19], a[64:67], v[64:67]
    ds_read_b64_tr_b16 a[0:1], v3 offset:50176
    s_and_b32 s4, s2, 1
    v_mfma_f32_16x16x32_bf16 v[64:67], a[20:23], a[80:83], v[64:67]
    s_lshl_b32 s75, s16, 15
    s_add_u32 s75, s75, s49
    v_mfma_f32_16x16x32_bf16 v[68:71], a[20:23], a[84:87], v[68:71]
    ds_read_b64_tr_b16 a[2:3], v3 offset:50688
    s_lshl_b32 s4, s4, 3
    v_mfma_f32_16x16x32_bf16 v[68:71], a[16:19], a[68:71], v[68:71]
    s_bfe_u32 s62, s2, 0x30003
    v_mfma_f32_16x16x32_bf16 v[72:75], a[16:19], a[72:75], v[72:75]
    ds_read_b64_tr_b16 a[4:5], v3 offset:58368
    buffer_load_dwordx4 v[192:195], v16, s[24:27], s75 offen offset:0 sc1
    v_mfma_f32_16x16x32_bf16 v[72:75], a[20:23], a[88:91], v[72:75]
    s_add_u32 s4, s4, s62
    v_mfma_f32_16x16x32_bf16 v[76:79], a[20:23], a[92:95], v[76:79]
    ds_read_b64_tr_b16 a[6:7], v3 offset:58880
    buffer_load_dwordx4 v[196:199], v16, s[24:27], s75 offen offset:2048 sc1
    v_mfma_f32_16x16x32_bf16 v[76:79], a[16:19], a[76:79], v[76:79]
    s_bfe_u32 s12, s2, 0x20001
    s_waitcnt lgkmcnt(4)
    v_mfma_f32_16x16x32_bf16 v[80:83], a[24:27], a[64:67], v[80:83]
    ds_read_b64_tr_b16 a[8:9], v4 offset:50176
    s_add_u32 s75, s75, 8192
    v_mfma_f32_16x16x32_bf16 v[80:83], a[28:31], a[80:83], v[80:83]
    s_lshr_b32 s13, s2, 6
    v_mfma_f32_16x16x32_bf16 v[84:87], a[28:31], a[84:87], v[84:87]
    ds_read_b64_tr_b16 a[10:11], v4 offset:50688
    s_mul_i32 s48, s12, 36
    v_mfma_f32_16x16x32_bf16 v[84:87], a[24:27], a[68:71], v[84:87]
    buffer_load_dwordx4 v[200:203], v16, s[24:27], s75 offen offset:0 sc1
    v_mfma_f32_16x16x32_bf16 v[88:91], a[24:27], a[72:75], v[88:91]
    ds_read_b64_tr_b16 a[12:13], v4 offset:58368
    s_add_u32 s48, s48, s3
    v_mfma_f32_16x16x32_bf16 v[88:91], a[28:31], a[88:91], v[88:91]
    buffer_load_dwordx4 v[204:207], v16, s[24:27], s75 offen offset:2048 sc1
    v_mfma_f32_16x16x32_bf16 v[92:95], a[28:31], a[92:95], v[92:95]
    ds_read_b64_tr_b16 a[14:15], v4 offset:58880
    s_mul_i32 s48, s48, 36864
    v_mfma_f32_16x16x32_bf16 v[92:95], a[24:27], a[76:79], v[92:95]
    s_add_u32 s75, s75, 8192
    s_waitcnt lgkmcnt(4)
    v_mfma_f32_16x16x32_bf16 v[96:99], a[0:3], a[64:67], v[96:99]
    ds_read_b64_tr_b16 a[16:17], v5 offset:49152
    s_mul_i32 s62, s13, 288
    v_mfma_f32_16x16x32_bf16 v[96:99], a[4:7], a[80:83], v[96:99]
    buffer_load_dwordx4 v[208:211], v16, s[24:27], s75 offen offset:0 sc1
    s_and_b32 s62, s62, 0xffffffc0
    v_mfma_f32_16x16x32_bf16 v[100:103], a[4:7], a[84:87], v[100:103]
    ds_read_b64_tr_b16 a[18:19], v5 offset:49664
    v_mfma_f32_16x16x32_bf16 v[100:103], a[0:3], a[68:71], v[100:103]
    buffer_load_dwordx4 v[212:215], v16, s[24:27], s75 offen offset:2048 sc1
    s_add_u32 s48, s48, s62
    v_mfma_f32_16x16x32_bf16 v[104:107], a[0:3], a[72:75], v[104:107]
    ds_read_b64_tr_b16 a[20:21], v5 offset:53248
    v_mfma_f32_16x16x32_bf16 v[104:107], a[4:7], a[88:91], v[104:107]
    s_mul_i32 s50, s3, 10240
    v_mfma_f32_16x16x32_bf16 v[108:111], a[4:7], a[92:95], v[108:111]
    ds_read_b64_tr_b16 a[22:23], v5 offset:53760
    s_add_u32 s75, s75, 8192
    v_mfma_f32_16x16x32_bf16 v[108:111], a[0:3], a[76:79], v[108:111]
    s_lshl_b32 s53, s4, 2
    s_waitcnt lgkmcnt(4)
    v_mfma_f32_16x16x32_bf16 v[112:115], a[8:11], a[64:67], v[112:115]
    ds_read_b64_tr_b16 a[24:25], v5 offset:57344
    buffer_load_dwordx4 v[216:219], v16, s[24:27], s75 offen offset:0 sc1
    v_mfma_f32_16x16x32_bf16 v[112:115], a[12:15], a[80:83], v[112:115]
    s_add_u32 s53, s53, s13
    v_mfma_f32_16x16x32_bf16 v[116:119], a[12:15], a[84:87], v[116:119]
    ds_read_b64_tr_b16 a[26:27], v5 offset:57856
    buffer_load_dwordx4 v[220:223], v16, s[24:27], s75 offen offset:2048 sc1
    v_mfma_f32_16x16x32_bf16 v[116:119], a[8:11], a[68:71], v[116:119]
    s_lshl_b32 s53, s53, 2
    v_mfma_f32_16x16x32_bf16 v[120:123], a[8:11], a[72:75], v[120:123]
    ds_read_b64_tr_b16 a[28:29], v5 offset:61440
    s_add_u32 s59, s53, s12
    v_mfma_f32_16x16x32_bf16 v[120:123], a[12:15], a[88:91], v[120:123]
    s_lshl_b32 s75, s17, 15
    s_add_u32 s75, s75, s49
    v_mfma_f32_16x16x32_bf16 v[124:127], a[12:15], a[92:95], v[124:127]
    ds_read_b64_tr_b16 a[30:31], v5 offset:61952
    s_add_u32 s53, s53, s3
    v_mfma_f32_16x16x32_bf16 v[124:127], a[8:11], a[76:79], v[124:127]
    s_waitcnt vmcnt(34)
    s_barrier
    s_waitcnt lgkmcnt(4)
    v_mfma_f32_16x16x32_bf16 v[160:163], a[16:19], a[64:67], v[160:163]
    v_add_u32 v1, 65536, v1
    ds_read_b64_tr_b16 a[0:1], v1 offset:1024
    s_lshl_b32 s53, s53, 2
    v_mfma_f32_16x16x32_bf16 v[160:163], a[20:23], a[80:83], v[160:163]
    buffer_load_dwordx4 v[224:227], v16, s[24:27], s75 offen offset:0 sc1
    v_mfma_f32_16x16x32_bf16 v[164:167], a[20:23], a[84:87], v[164:167]
    ds_read_b64_tr_b16 a[2:3], v1 offset:1536
    s_add_u32 s53, s53, s12
    v_mfma_f32_16x16x32_bf16 v[164:167], a[16:19], a[68:71], v[164:167]
    buffer_load_dwordx4 v[228:231], v16, s[24:27], s75 offen offset:2048 sc1
    s_mul_i32 s53, s53, 9216
    v_mfma_f32_16x16x32_bf16 v[168:171], a[16:19], a[72:75], v[168:171]
    ds_read_b64_tr_b16 a[4:5], v1 offset:9216
    v_mfma_f32_16x16x32_bf16 v[168:171], a[20:23], a[88:91], v[168:171]
    s_add_u32 s75, s75, 8192
    s_add_u32 s53, s53, 30408704
    v_mfma_f32_16x16x32_bf16 v[172:175], a[20:23], a[92:95], v[172:175]
    ds_read_b64_tr_b16 a[6:7], v1 offset:9728
    v_mfma_f32_16x16x32_bf16 v[172:175], a[16:19], a[76:79], v[172:175]
    buffer_load_dwordx4 v[232:235], v16, s[24:27], s75 offen offset:0 sc1
    s_waitcnt lgkmcnt(4)
    v_mfma_f32_16x16x32_bf16 v[176:179], a[24:27], a[64:67], v[176:179]
    v_add_u32 v2, 65536, v2
    ds_read_b64_tr_b16 a[8:9], v2 offset:1024
    s_mul_i32 s59, s59, 36864
    v_mfma_f32_16x16x32_bf16 v[176:179], a[28:31], a[80:83], v[176:179]
    buffer_load_dwordx4 v[236:239], v16, s[24:27], s75 offen offset:2048 sc1
    s_mul_i32 s62, s3, 9216
    v_mfma_f32_16x16x32_bf16 v[180:183], a[28:31], a[84:87], v[180:183]
    ds_read_b64_tr_b16 a[10:11], v2 offset:1536
    v_mfma_f32_16x16x32_bf16 v[180:183], a[24:27], a[68:71], v[180:183]
    v_mfma_f32_16x16x32_bf16 v[184:187], a[24:27], a[72:75], v[184:187]
    ds_read_b64_tr_b16 a[12:13], v2 offset:9216
    v_mfma_f32_16x16x32_bf16 v[184:187], a[28:31], a[88:91], v[184:187]
    v_mfma_f32_16x16x32_bf16 v[188:191], a[28:31], a[92:95], v[188:191]
    ds_read_b64_tr_b16 a[14:15], v2 offset:9728
    v_mfma_f32_16x16x32_bf16 v[188:191], a[24:27], a[76:79], v[188:191]
    s_waitcnt lgkmcnt(4)
    v_mfma_f32_16x16x32_bf16 v[64:67], a[0:3], a[96:99], v[64:67]
    v_add_u32 v3, 65536, v3
    ds_read_b64_tr_b16 a[16:17], v3 offset:1024
    s_add_u32 s59, s59, s62
    v_mfma_f32_16x16x32_bf16 v[64:67], a[4:7], a[112:115], v[64:67]
    s_add_u32 s56, s62, 40960
    s_mul_i32 s51, s16, 147456
    s_add_u32 s51, s51, s48
    v_mfma_f32_16x16x32_bf16 v[68:71], a[4:7], a[116:119], v[68:71]
    ds_read_b64_tr_b16 a[18:19], v3 offset:1536
    s_add_u32 s59, s59, 30408704
    v_mfma_f32_16x16x32_bf16 v[68:71], a[0:3], a[100:103], v[68:71]
    s_mul_i32 s54, s13, 9
    v_mfma_f32_16x16x32_bf16 v[72:75], a[0:3], a[104:107], v[72:75]
    ds_read_b64_tr_b16 a[20:21], v3 offset:9216
    s_mul_i32 s62, s3, 3
    v_mfma_f32_16x16x32_bf16 v[72:75], a[4:7], a[120:123], v[72:75]
    s_add_u32 s54, s54, s62
    s_add_u32 m0, s50, 0
    v_mfma_f32_16x16x32_bf16 v[76:79], a[4:7], a[124:127], v[76:79]
    ds_read_b64_tr_b16 a[22:23], v3 offset:9728
    s_mul_i32 s54, s54, 18432
    v_mfma_f32_16x16x32_bf16 v[76:79], a[0:3], a[108:111], v[76:79]
    s_add_u32 s54, s54, 47185920
    s_waitcnt lgkmcnt(4)
    v_mfma_f32_16x16x32_bf16 v[80:83], a[8:11], a[96:99], v[80:83]
    v_add_u32 v4, 65536, v4
    ds_read_b64_tr_b16 a[24:25], v4 offset:1024
    buffer_load_dwordx4 v6, s[32:35], s51 offen offset:0  lds
    v_mfma_f32_16x16x32_bf16 v[80:83], a[12:15], a[112:115], v[80:83]
    s_cmp_eq_u32 s3, s12
    s_cselect_b32 s53, 1073741824, s53
    s_cselect_b32 s59, 1073741824, s59
    s_cselect_b32 s44, s56, 0x30000
    s_cselect_b32 s56, 0x30000, s56
    v_mfma_f32_16x16x32_bf16 v[84:87], a[12:15], a[116:119], v[84:87]
    ds_read_b64_tr_b16 a[26:27], v4 offset:1536
    buffer_load_dwordx4 v7, s[32:35], s51 offen offset:1024  lds
    v_mfma_f32_16x16x32_bf16 v[84:87], a[8:11], a[100:103], v[84:87]
    v_mfma_f32_16x16x32_bf16 v[88:91], a[8:11], a[104:107], v[88:91]
    ds_read_b64_tr_b16 a[28:29], v4 offset:9216
    buffer_load_dwordx4 v8, s[32:35], s51 offen offset:2048  lds
    v_mfma_f32_16x16x32_bf16 v[88:91], a[12:15], a[120:123], v[88:91]
    s_lshl_b32 s55, s4, 2
    v_mfma_f32_16x16x32_bf16 v[92:95], a[12:15], a[124:127], v[92:95]
    ds_read_b64_tr_b16 a[30:31], v4 offset:9728
    s_and_b32 s62, s12, 2
    v_mfma_f32_16x16x32_bf16 v[92:95], a[8:11], a[108:111], v[92:95]
    s_add_u32 s55, s55, s62
    s_waitcnt lgkmcnt(4)
    v_mfma_f32_16x16x32_bf16 v[96:99], a[16:19], a[96:99], v[96:99]
    v_add_u32 v5, 65536, v5
    ds_read_b64_tr_b16 a[0:1], v5 offset:0
    s_mul_i32 s60, s55, 36864
    v_mfma_f32_16x16x32_bf16 v[96:99], a[20:23], a[112:115], v[96:99]
    s_mul_i32 s62, s13, 288
    buffer_load_dwordx4 v9, s[32:35], s51 offen offset:3072  lds
    v_mfma_f32_16x16x32_bf16 v[100:103], a[20:23], a[116:119], v[100:103]
    ds_read_b64_tr_b16 a[2:3], v5 offset:512
    s_add_u32 s60, s60, s62
    v_mfma_f32_16x16x32_bf16 v[100:103], a[16:19], a[100:103], v[100:103]
    s_mul_i32 s62, s3, 96
    s_add_u32 m0, s50, 4096
    v_mfma_f32_16x16x32_bf16 v[104:107], a[16:19], a[104:107], v[104:107]
    ds_read_b64_tr_b16 a[4:5], v5 offset:4096
    s_add_u32 s60, s60, s62
    v_mfma_f32_16x16x32_bf16 v[104:107], a[20:23], a[120:123], v[104:107]
    buffer_load_dwordx4 v10, s[32:35], s51 offen offset:0  lds
    v_mfma_f32_16x16x32_bf16 v[108:111], a[20:23], a[124:127], v[108:111]
    ds_read_b64_tr_b16 a[6:7], v5 offset:4608
    s_and_b32 s13, s12, 1
    v_mfma_f32_16x16x32_bf16 v[108:111], a[16:19], a[108:111], v[108:111]
    s_mul_i32 s62, s13, 18432
    s_waitcnt lgkmcnt(4)
    v_mfma_f32_16x16x32_bf16 v[112:115], a[24:27], a[96:99], v[112:115]
    ds_read_b64_tr_b16 a[8:9], v5 offset:8192
    s_add_u32 s60, s60, s62
    v_mfma_f32_16x16x32_bf16 v[112:115], a[28:31], a[112:115], v[112:115]
    s_cmp_ge_u32 s3, 3
    s_cselect_b32 s54, 1073741824, s54
    s_cselect_b32 s60, 1073741824, s60
    v_mfma_f32_16x16x32_bf16 v[116:119], a[28:31], a[116:119], v[116:119]
    ds_read_b64_tr_b16 a[10:11], v5 offset:8704
    s_add_u32 s51, s51, 9216
    v_mfma_f32_16x16x32_bf16 v[116:119], a[24:27], a[100:103], v[116:119]
    s_add_u32 m0, s50, 5120
    v_mfma_f32_16x16x32_bf16 v[120:123], a[24:27], a[104:107], v[120:123]
    ds_read_b64_tr_b16 a[12:13], v5 offset:12288
    s_add_u32 s61, s60, 36864
    v_mfma_f32_16x16x32_bf16 v[120:123], a[28:31], a[120:123], v[120:123]
    s_lshr_b32 s57, s55, 3
    buffer_load_dwordx4 v6, s[32:35], s51 offen offset:0  lds
    v_mfma_f32_16x16x32_bf16 v[124:127], a[28:31], a[124:127], v[124:127]
    ds_read_b64_tr_b16 a[14:15], v5 offset:12800
    s_lshl_b32 s57, s57, 16
    v_mfma_f32_16x16x32_bf16 v[124:127], a[24:27], a[108:111], v[124:127]
    s_waitcnt vmcnt(18)
    s_barrier
    v_mov_b32 v29, s7
    v_add_u32 v29, 3, v29
    buffer_store_dword v29, v30, s[24:27], s6 offen sc1
    s_waitcnt lgkmcnt(4)
    v_mfma_f32_16x16x32_bf16 v[160:163], a[0:3], a[96:99], v[160:163]
    ds_read_b64_tr_b16 a[16:17], v1 offset:17408
    s_bfe_u32 s62, s55, 0x20001
    v_mfma_f32_16x16x32_bf16 v[160:163], a[4:7], a[112:115], v[160:163]
    s_lshl_b32 s62, s62, 7
    s_add_u32 s57, s57, s62
    v_mfma_f32_16x16x32_bf16 v[164:167], a[4:7], a[116:119], v[164:167]
    ds_read_b64_tr_b16 a[18:19], v1 offset:17920
    s_add_u32 s57, s57, 54526976
    v_mfma_f32_16x16x32_bf16 v[164:167], a[0:3], a[100:103], v[164:167]
    s_mul_i32 s55, s55, 36864
    buffer_load_dwordx4 v7, s[32:35], s51 offen offset:1024  lds
    v_mfma_f32_16x16x32_bf16 v[168:171], a[0:3], a[104:107], v[168:171]
    ds_read_b64_tr_b16 a[20:21], v1 offset:25600
    s_add_u32 s55, s55, 27262976
    v_mfma_f32_16x16x32_bf16 v[168:171], a[4:7], a[120:123], v[168:171]
    s_lshl_b32 s62, s3, 10
    buffer_load_dwordx4 v8, s[32:35], s51 offen offset:2048  lds
    buffer_load_dwordx4 v9, s[32:35], s51 offen offset:3072  lds
    v_mfma_f32_16x16x32_bf16 v[172:175], a[4:7], a[124:127], v[172:175]
    ds_read_b64_tr_b16 a[22:23], v1 offset:26112
    s_add_u32 s4, s55, s62
    v_mfma_f32_16x16x32_bf16 v[172:175], a[0:3], a[108:111], v[172:175]
    s_lshl_b32 s62, s13, 6
    s_waitcnt lgkmcnt(4)
    v_mfma_f32_16x16x32_bf16 v[176:179], a[8:11], a[96:99], v[176:179]
    ds_read_b64_tr_b16 a[24:25], v2 offset:17408
    s_add_u32 s4, s4, s62
    v_mfma_f32_16x16x32_bf16 v[176:179], a[12:15], a[112:115], v[176:179]
    s_add_u32 s4, s4, 32768
    s_add_u32 m0, s50, 9216
    v_mfma_f32_16x16x32_bf16 v[180:183], a[12:15], a[116:119], v[180:183]
    ds_read_b64_tr_b16 a[26:27], v2 offset:17920
    s_lshl_b32 s62, s3, 13
    v_mfma_f32_16x16x32_bf16 v[180:183], a[8:11], a[100:103], v[180:183]
    buffer_load_dwordx4 v10, s[32:35], s51 offen offset:0  lds
    v_mfma_f32_16x16x32_bf16 v[184:187], a[8:11], a[104:107], v[184:187]
    ds_read_b64_tr_b16 a[28:29], v2 offset:25600
    v_mfma_f32_16x16x32_bf16 v[184:187], a[12:15], a[120:123], v[184:187]
    v_mfma_f32_16x16x32_bf16 v[188:191], a[12:15], a[124:127], v[188:191]
    ds_read_b64_tr_b16 a[30:31], v2 offset:26112
    v_mfma_f32_16x16x32_bf16 v[188:191], a[8:11], a[108:111], v[188:191]
    s_waitcnt lgkmcnt(4)
    v_mfma_f32_16x16x32_bf16 v[64:67], a[16:19], a[128:131], v[64:67]
    ds_read_b64_tr_b16 a[0:1], v3 offset:17408
    s_add_u32 s75, s75, 8192
    v_mfma_f32_16x16x32_bf16 v[64:67], a[20:23], a[144:147], v[64:67]
    s_getpc_b64 s[76:77]
L_rw4:
    s_mov_b32 s78, L_mk_end-L_rw4
    s_mov_b32 s79, 0x00020000
    s_lshr_b32 s73, s2, 3
    s_mul_i32 s73, s73, 1536
    v_lshlrev_b32 v28, 7, v0
    v_cmp_gt_u32 vcc, 1536, v28
    s_nop 1
    v_cndmask_b32 v28, -16, v28, vcc
    buffer_load_dword v12, v28, s[76:79], s73 offen
    v_mfma_f32_16x16x32_bf16 v[68:71], a[20:23], a[148:151], v[68:71]
    ds_read_b64_tr_b16 a[2:3], v3 offset:17920
    buffer_load_dwordx4 v[240:243], v16, s[24:27], s75 offen offset:0 sc1
    v_mfma_f32_16x16x32_bf16 v[68:71], a[16:19], a[132:135], v[68:71]
    v_mfma_f32_16x16x32_bf16 v[72:75], a[16:19], a[136:139], v[72:75]
    ds_read_b64_tr_b16 a[4:5], v3 offset:25600
    buffer_load_dwordx4 v[244:247], v16, s[24:27], s75 offen offset:2048 sc1
    v_mfma_f32_16x16x32_bf16 v[72:75], a[20:23], a[152:155], v[72:75]
    v_mfma_f32_16x16x32_bf16 v[76:79], a[20:23], a[156:159], v[76:79]
    ds_read_b64_tr_b16 a[6:7], v3 offset:26112
    s_add_u32 s75, s75, 8192
    v_mfma_f32_16x16x32_bf16 v[76:79], a[16:19], a[140:143], v[76:79]
    s_waitcnt lgkmcnt(4)
    v_mfma_f32_16x16x32_bf16 v[80:83], a[24:27], a[128:131], v[80:83]
    ds_read_b64_tr_b16 a[8:9], v4 offset:17408
    v_mfma_f32_16x16x32_bf16 v[80:83], a[28:31], a[144:147], v[80:83]
    buffer_load_dwordx4 v[248:251], v16, s[24:27], s75 offen offset:0 sc1
    v_mfma_f32_16x16x32_bf16 v[84:87], a[28:31], a[148:151], v[84:87]
    ds_read_b64_tr_b16 a[10:11], v4 offset:17920
    v_mfma_f32_16x16x32_bf16 v[84:87], a[24:27], a[132:135], v[84:87]
    buffer_load_dwordx4 v[252:255], v16, s[24:27], s75 offen offset:2048 sc1
    v_mfma_f32_16x16x32_bf16 v[88:91], a[24:27], a[136:139], v[88:91]
    ds_read_b64_tr_b16 a[12:13], v4 offset:25600
    v_mfma_f32_16x16x32_bf16 v[88:91], a[28:31], a[152:155], v[88:91]
    s_lshl_b32 s75, s18, 15
    s_add_u32 s75, s75, s49
    v_mfma_f32_16x16x32_bf16 v[92:95], a[28:31], a[156:159], v[92:95]
    ds_read_b64_tr_b16 a[14:15], v4 offset:26112
    v_add_u32 v17, 61440, v11
    v_mfma_f32_16x16x32_bf16 v[92:95], a[24:27], a[140:143], v[92:95]
    v_add_u32 v18, 122880, v11
    s_waitcnt lgkmcnt(4)
    v_mfma_f32_16x16x32_bf16 v[96:99], a[0:3], a[128:131], v[96:99]
    ds_read_b64_tr_b16 a[16:17], v5 offset:16384
    v_mfma_f32_16x16x32_bf16 v[96:99], a[4:7], a[144:147], v[96:99]
    v_add_u32 v21, 61440, v14
    v_mfma_f32_16x16x32_bf16 v[100:103], a[4:7], a[148:151], v[100:103]
    ds_read_b64_tr_b16 a[18:19], v5 offset:16896
    buffer_load_dwordx4 a[64:67], v16, s[24:27], s75 offen offset:0 sc1
    v_mfma_f32_16x16x32_bf16 v[100:103], a[0:3], a[132:135], v[100:103]
    v_add_u32 v19, 122880, v14
    v_mfma_f32_16x16x32_bf16 v[104:107], a[0:3], a[136:139], v[104:107]
    ds_read_b64_tr_b16 a[20:21], v5 offset:20480
    buffer_load_dwordx4 a[68:71], v16, s[24:27], s75 offen offset:2048 sc1
    v_mfma_f32_16x16x32_bf16 v[104:107], a[4:7], a[152:155], v[104:107]
    v_add_u32 v20, 1024, v25
    s_mov_b32 exec_lo, 0
    v_mov_b32 v20, 73728
    s_mov_b32 exec_lo, -1
    v_mfma_f32_16x16x32_bf16 v[108:111], a[4:7], a[156:159], v[108:111]
    ds_read_b64_tr_b16 a[22:23], v5 offset:20992
    v_mfma_f32_16x16x32_bf16 v[108:111], a[0:3], a[140:143], v[108:111]
    s_add_u32 s75, s75, 8192
    s_waitcnt lgkmcnt(4)
    v_mfma_f32_16x16x32_bf16 v[112:115], a[8:11], a[128:131], v[112:115]
    ds_read_b64_tr_b16 a[24:25], v5 offset:24576
    v_mfma_f32_16x16x32_bf16 v[112:115], a[12:15], a[144:147], v[112:115]
    buffer_load_dwordx4 a[72:75], v16, s[24:27], s75 offen offset:0 sc1
    v_mfma_f32_16x16x32_bf16 v[116:119], a[12:15], a[148:151], v[116:119]
    ds_read_b64_tr_b16 a[26:27], v5 offset:25088
    v_mfma_f32_16x16x32_bf16 v[116:119], a[8:11], a[132:135], v[116:119]
    buffer_load_dwordx4 a[76:79], v16, s[24:27], s75 offen offset:2048 sc1
    v_mfma_f32_16x16x32_bf16 v[120:123], a[8:11], a[136:139], v[120:123]
    ds_read_b64_tr_b16 a[28:29], v5 offset:28672
    v_mfma_f32_16x16x32_bf16 v[120:123], a[12:15], a[152:155], v[120:123]
    s_add_u32 s20, s24, 18874368
    s_addc_u32 s21, s25, 0
    v_mfma_f32_16x16x32_bf16 v[124:127], a[12:15], a[156:159], v[124:127]
    ds_read_b64_tr_b16 a[30:31], v5 offset:29184
    s_add_u32 s75, s75, 8192
    v_mfma_f32_16x16x32_bf16 v[124:127], a[8:11], a[140:143], v[124:127]
    s_waitcnt vmcnt(47)
    s_barrier
    s_waitcnt lgkmcnt(4)
    v_mfma_f32_16x16x32_bf16 v[160:163], a[16:19], a[128:131], v[160:163]
    ds_read_b64_tr_b16 a[0:1], v1 offset:33792
    s_mov_b32 s22, 4726784
    v_mfma_f32_16x16x32_bf16 v[160:163], a[20:23], a[144:147], v[160:163]
    s_mov_b32 s23, 0x00020000
    buffer_load_dwordx4 a[80:83], v16, s[24:27], s75 offen offset:0 sc1
    v_mfma_f32_16x16x32_bf16 v[164:167], a[20:23], a[148:151], v[164:167]
    ds_read_b64_tr_b16 a[2:3], v1 offset:34304
    buffer_load_dwordx4 a[84:87], v16, s[24:27], s75 offen offset:2048 sc1
    v_mfma_f32_16x16x32_bf16 v[164:167], a[16:19], a[132:135], v[164:167]
    s_add_u32 s28, s24, 24117248
    s_addc_u32 s29, s25, 0
    v_mfma_f32_16x16x32_bf16 v[168:171], a[16:19], a[136:139], v[168:171]
    ds_read_b64_tr_b16 a[4:5], v1 offset:41984
    v_mfma_f32_16x16x32_bf16 v[168:171], a[20:23], a[152:155], v[168:171]
    s_add_u32 s75, s75, 8192
    v_mfma_f32_16x16x32_bf16 v[172:175], a[20:23], a[156:159], v[172:175]
    ds_read_b64_tr_b16 a[6:7], v1 offset:42496
    v_mfma_f32_16x16x32_bf16 v[172:175], a[16:19], a[140:143], v[172:175]
    s_mov_b32 s30, 2392064
    s_waitcnt lgkmcnt(4)
    v_mfma_f32_16x16x32_bf16 v[176:179], a[24:27], a[128:131], v[176:179]
    ds_read_b64_tr_b16 a[8:9], v2 offset:33792
    buffer_load_dwordx4 a[88:91], v16, s[24:27], s75 offen offset:0 sc1
    v_mfma_f32_16x16x32_bf16 v[176:179], a[28:31], a[144:147], v[176:179]
    s_mov_b32 s31, 0x00020000
    buffer_load_dwordx4 a[92:95], v16, s[24:27], s75 offen offset:2048 sc1
    v_mfma_f32_16x16x32_bf16 v[180:183], a[28:31], a[148:151], v[180:183]
    ds_read_b64_tr_b16 a[10:11], v2 offset:34304
    v_mfma_f32_16x16x32_bf16 v[180:183], a[24:27], a[132:135], v[180:183]
    v_mfma_f32_16x16x32_bf16 v[184:187], a[24:27], a[136:139], v[184:187]
    ds_read_b64_tr_b16 a[12:13], v2 offset:41984
    v_mfma_f32_16x16x32_bf16 v[184:187], a[28:31], a[152:155], v[184:187]
    v_mfma_f32_16x16x32_bf16 v[188:191], a[28:31], a[156:159], v[188:191]
    ds_read_b64_tr_b16 a[14:15], v2 offset:42496
    v_mfma_f32_16x16x32_bf16 v[188:191], a[24:27], a[140:143], v[188:191]
    s_waitcnt lgkmcnt(4)
    v_mfma_f32_16x16x32_bf16 v[64:67], a[0:3], a[160:163], v[64:67]
    ds_read_b64_tr_b16 a[16:17], v3 offset:33792
    s_add_u32 s55, s55, s62
    v_mfma_f32_16x16x32_bf16 v[64:67], a[4:7], a[176:179], v[64:67]
    s_lshl_b32 s62, s13, 8
    v_mfma_f32_16x16x32_bf16 v[68:71], a[4:7], a[180:183], v[68:71]
    ds_read_b64_tr_b16 a[18:19], v3 offset:34304
    v_mfma_f32_16x16x32_bf16 v[68:71], a[0:3], a[164:167], v[68:71]
    s_add_u32 s55, s55, s62
    v_mfma_f32_16x16x32_bf16 v[72:75], a[0:3], a[168:171], v[72:75]
    ds_read_b64_tr_b16 a[20:21], v3 offset:41984
    s_lshl_b32 s80, s3, 1
    v_mfma_f32_16x16x32_bf16 v[72:75], a[4:7], a[184:187], v[72:75]
    s_mul_i32 s51, s17, 147456
    s_add_u32 s51, s51, s48
    v_mfma_f32_16x16x32_bf16 v[76:79], a[4:7], a[188:191], v[76:79]
    ds_read_b64_tr_b16 a[22:23], v3 offset:42496
    s_add_u32 s80, s80, 9
    v_mfma_f32_16x16x32_bf16 v[76:79], a[0:3], a[172:175], v[76:79]
    s_sub_u32 s80, s80, s84
    s_waitcnt lgkmcnt(4)
    v_mfma_f32_16x16x32_bf16 v[80:83], a[8:11], a[160:163], v[80:83]
    ds_read_b64_tr_b16 a[24:25], v4 offset:33792
    s_add_u32 m0, s50, 40960
    v_mfma_f32_16x16x32_bf16 v[80:83], a[12:15], a[176:179], v[80:83]
    s_add_u32 s81, s80, 1
    buffer_load_dwordx4 v6, s[32:35], s51 offen offset:0  lds
    v_mfma_f32_16x16x32_bf16 v[84:87], a[12:15], a[180:183], v[84:87]
    ds_read_b64_tr_b16 a[26:27], v4 offset:34304
    buffer_load_dwordx4 v7, s[32:35], s51 offen offset:1024  lds
    v_mfma_f32_16x16x32_bf16 v[84:87], a[8:11], a[164:167], v[84:87]
    s_sub_u32 s14, 17, s84
    v_mfma_f32_16x16x32_bf16 v[88:91], a[8:11], a[168:171], v[88:91]
    ds_read_b64_tr_b16 a[28:29], v4 offset:41984
    buffer_load_dwordx4 v8, s[32:35], s51 offen offset:2048  lds
    v_mfma_f32_16x16x32_bf16 v[88:91], a[12:15], a[184:187], v[88:91]
    s_sub_u32 s62, s80, 9
    s_cselect_b32 s80, s80, s62
    v_mfma_f32_16x16x32_bf16 v[92:95], a[12:15], a[188:191], v[92:95]
    ds_read_b64_tr_b16 a[30:31], v4 offset:42496
    v_mfma_f32_16x16x32_bf16 v[92:95], a[8:11], a[172:175], v[92:95]
    s_lshl_b32 s80, s80, 12
    s_waitcnt lgkmcnt(4)
    v_mfma_f32_16x16x32_bf16 v[96:99], a[16:19], a[160:163], v[96:99]
    ds_read_b64_tr_b16 a[0:1], v5 offset:32768
    buffer_load_dwordx4 v9, s[32:35], s51 offen offset:3072  lds
    v_mfma_f32_16x16x32_bf16 v[96:99], a[20:23], a[176:179], v[96:99]
    s_sub_u32 s62, s81, 9
    s_cselect_b32 s81, s81, s62
    v_mfma_f32_16x16x32_bf16 v[100:103], a[20:23], a[180:183], v[100:103]
    ds_read_b64_tr_b16 a[2:3], v5 offset:33280
    s_add_u32 m0, s50, 45056
    v_mfma_f32_16x16x32_bf16 v[100:103], a[16:19], a[164:167], v[100:103]
    v_mfma_f32_16x16x32_bf16 v[104:107], a[16:19], a[168:171], v[104:107]
    ds_read_b64_tr_b16 a[4:5], v5 offset:36864
    s_lshl_b32 s81, s81, 12
    v_mfma_f32_16x16x32_bf16 v[104:107], a[20:23], a[184:187], v[104:107]
    buffer_load_dwordx4 v10, s[32:35], s51 offen offset:0  lds
    v_mfma_f32_16x16x32_bf16 v[108:111], a[20:23], a[188:191], v[108:111]
    ds_read_b64_tr_b16 a[6:7], v5 offset:37376
    v_mfma_f32_16x16x32_bf16 v[108:111], a[16:19], a[172:175], v[108:111]
    s_add_u32 s51, s51, 9216
    s_waitcnt lgkmcnt(4)
    v_mfma_f32_16x16x32_bf16 v[112:115], a[24:27], a[160:163], v[112:115]
    ds_read_b64_tr_b16 a[8:9], v5 offset:40960
    v_mfma_f32_16x16x32_bf16 v[112:115], a[28:31], a[176:179], v[112:115]
    s_sub_u32 s62, s14, 9
    s_cselect_b32 s14, s14, s62
    v_mfma_f32_16x16x32_bf16 v[116:119], a[28:31], a[180:183], v[116:119]
    ds_read_b64_tr_b16 a[10:11], v5 offset:41472
    s_lshl_b32 s14, s14, 12
    v_mfma_f32_16x16x32_bf16 v[116:119], a[24:27], a[164:167], v[116:119]
    s_lshr_b32 s62, s3, 1
    s_add_u32 m0, s50, 46080
    v_mfma_f32_16x16x32_bf16 v[120:123], a[24:27], a[168:171], v[120:123]
    ds_read_b64_tr_b16 a[12:13], v5 offset:45056
    s_lshl_b32 s62, s62, 11
    v_mfma_f32_16x16x32_bf16 v[120:123], a[28:31], a[184:187], v[120:123]
    s_add_u32 s14, s14, s62
    buffer_load_dwordx4 v6, s[32:35], s51 offen offset:0  lds
    v_mfma_f32_16x16x32_bf16 v[124:127], a[28:31], a[188:191], v[124:127]
    ds_read_b64_tr_b16 a[14:15], v5 offset:45568
    v_mfma_f32_16x16x32_bf16 v[124:127], a[24:27], a[172:175], v[124:127]
    s_waitcnt vmcnt(50)
    s_barrier
    s_waitcnt lgkmcnt(4)
    v_mfma_f32_16x16x32_bf16 v[160:163], a[0:3], a[160:163], v[160:163]
    ds_read_b64_tr_b16 a[16:17], v1 offset:50176
    s_and_b32 s62, s3, 1
    v_mfma_f32_16x16x32_bf16 v[160:163], a[4:7], a[176:179], v[160:163]
    s_lshl_b32 s62, s62, 9
    buffer_load_dwordx4 v7, s[32:35], s51 offen offset:1024  lds
    v_mfma_f32_16x16x32_bf16 v[164:167], a[4:7], a[180:183], v[164:167]
    ds_read_b64_tr_b16 a[18:19], v1 offset:50688
    s_add_u32 s14, s14, s62
    v_mfma_f32_16x16x32_bf16 v[164:167], a[0:3], a[164:167], v[164:167]
    buffer_load_dwordx4 v8, s[32:35], s51 offen offset:2048  lds
    buffer_load_dword v22, v13, s[24:27], s74 offen sc1
    v_mfma_f32_16x16x32_bf16 v[168:171], a[0:3], a[168:171], v[168:171]
    ds_read_b64_tr_b16 a[20:21], v1 offset:58368
    s_and_b32 s15, s2, 0xf9
    v_mfma_f32_16x16x32_bf16 v[168:171], a[4:7], a[184:187], v[168:171]
    s_lshl_b32 s15, s15, 11
    buffer_load_dwordx4 v9, s[32:35], s51 offen offset:3072  lds
    v_mfma_f32_16x16x32_bf16 v[172:175], a[4:7], a[188:191], v[172:175]
    ds_read_b64_tr_b16 a[22:23], v1 offset:58880
    s_add_u32 m0, s50, 50176
    v_mfma_f32_16x16x32_bf16 v[172:175], a[0:3], a[172:175], v[172:175]
    s_lshl_b32 s62, s12, 7
    s_waitcnt lgkmcnt(4)
    v_mfma_f32_16x16x32_bf16 v[176:179], a[8:11], a[160:163], v[176:179]
    ds_read_b64_tr_b16 a[24:25], v2 offset:50176
    s_add_u32 s15, s15, s62
    v_mfma_f32_16x16x32_bf16 v[176:179], a[12:15], a[176:179], v[176:179]
    buffer_load_dwordx4 v10, s[32:35], s51 offen offset:0  lds
    v_mfma_f32_16x16x32_bf16 v[180:183], a[12:15], a[180:183], v[180:183]
    ds_read_b64_tr_b16 a[26:27], v2 offset:50688
    s_add_u32 s15, s15, 54526464
    v_mfma_f32_16x16x32_bf16 v[180:183], a[8:11], a[164:167], v[180:183]
    v_mfma_f32_16x16x32_bf16 v[184:187], a[8:11], a[168:171], v[184:187]
    ds_read_b64_tr_b16 a[28:29], v2 offset:58368
    v_mfma_f32_16x16x32_bf16 v[184:187], a[12:15], a[184:187], v[184:187]
    v_mfma_f32_16x16x32_bf16 v[188:191], a[12:15], a[188:191], v[188:191]
    ds_read_b64_tr_b16 a[30:31], v2 offset:58880
    v_mfma_f32_16x16x32_bf16 v[188:191], a[8:11], a[172:175], v[188:191]
    s_waitcnt lgkmcnt(4)
    v_mfma_f32_16x16x32_bf16 v[64:67], a[16:19], a[192:195], v[64:67]
    ds_read_b64_tr_b16 a[0:1], v3 offset:50176
    s_and_b32 s93, s2, 7
    v_mfma_f32_16x16x32_bf16 v[64:67], a[20:23], a[208:211], v[64:67]
    s_lshl_b32 s93, s93, 2
    s_lshl_b32 s75, s19, 15
    s_add_u32 s75, s75, s49
    v_mfma_f32_16x16x32_bf16 v[68:71], a[20:23], a[212:215], v[68:71]
    ds_read_b64_tr_b16 a[2:3], v3 offset:50688
    v_mfma_f32_16x16x32_bf16 v[68:71], a[16:19], a[196:199], v[68:71]
    s_bfe_u32 s62, s2, 0x20003
    v_mfma_f32_16x16x32_bf16 v[72:75], a[16:19], a[200:203], v[72:75]
    ds_read_b64_tr_b16 a[4:5], v3 offset:58368
    v_mfma_f32_16x16x32_bf16 v[72:75], a[20:23], a[216:219], v[72:75]
    s_add_u32 s93, s93, s62
    v_mfma_f32_16x16x32_bf16 v[76:79], a[20:23], a[220:223], v[76:79]
    ds_read_b64_tr_b16 a[6:7], v3 offset:58880
    v_mfma_f32_16x16x32_bf16 v[76:79], a[16:19], a[204:207], v[76:79]
    s_lshr_b32 s94, s2, 5
    s_waitcnt lgkmcnt(4)
    v_mfma_f32_16x16x32_bf16 v[80:83], a[24:27], a[192:195], v[80:83]
    ds_read_b64_tr_b16 a[8:9], v4 offset:50176
    buffer_load_dwordx4 a[96:99], v16, s[24:27], s75 offen offset:0 sc1
    v_mfma_f32_16x16x32_bf16 v[80:83], a[28:31], a[208:211], v[80:83]
    s_lshl_b32 s94, s94, 2
    v_mfma_f32_16x16x32_bf16 v[84:87], a[28:31], a[212:215], v[84:87]
    ds_read_b64_tr_b16 a[10:11], v4 offset:50688
    v_mfma_f32_16x16x32_bf16 v[84:87], a[24:27], a[196:199], v[84:87]
    s_add_u32 s94, s94, s3
    v_mfma_f32_16x16x32_bf16 v[88:91], a[24:27], a[200:203], v[88:91]
    ds_read_b64_tr_b16 a[12:13], v4 offset:58368
    v_mfma_f32_16x16x32_bf16 v[88:91], a[28:31], a[216:219], v[88:91]
    s_lshl_b32 s94, s94, 1
    buffer_load_dwordx4 a[100:103], v16, s[24:27], s75 offen offset:2048 sc1
    v_mfma_f32_16x16x32_bf16 v[92:95], a[28:31], a[220:223], v[92:95]
    ds_read_b64_tr_b16 a[14:15], v4 offset:58880
    s_mul_i32 s96, s93, 9
    v_mfma_f32_16x16x32_bf16 v[92:95], a[24:27], a[204:207], v[92:95]
    s_waitcnt lgkmcnt(4)
    v_mfma_f32_16x16x32_bf16 v[96:99], a[0:3], a[192:195], v[96:99]
    ds_read_b64_tr_b16 a[16:17], v5 offset:49152
    s_and_b32 s96, s96, 3
    v_mfma_f32_16x16x32_bf16 v[96:99], a[4:7], a[208:211], v[96:99]
    s_add_u32 s75, s75, 8192
    v_mfma_f32_16x16x32_bf16 v[100:103], a[4:7], a[212:215], v[100:103]
    ds_read_b64_tr_b16 a[18:19], v5 offset:49664
    s_mul_i32 s97, s94, 73856
    v_mfma_f32_16x16x32_bf16 v[100:103], a[0:3], a[196:199], v[100:103]
    v_mfma_f32_16x16x32_bf16 v[104:107], a[0:3], a[200:203], v[104:107]
    ds_read_b64_tr_b16 a[20:21], v5 offset:53248
    s_add_u32 s98, s97, -664704
    v_mfma_f32_16x16x32_bf16 v[104:107], a[4:7], a[216:219], v[104:107]
    v_mfma_f32_16x16x32_bf16 v[108:111], a[4:7], a[220:223], v[108:111]
    ds_read_b64_tr_b16 a[22:23], v5 offset:53760
    s_add_u32 s97, s97, 18837504
    v_mfma_f32_16x16x32_bf16 v[108:111], a[0:3], a[204:207], v[108:111]
    buffer_load_dwordx4 a[104:107], v16, s[24:27], s75 offen offset:0 sc1
    s_waitcnt lgkmcnt(4)
    v_mfma_f32_16x16x32_bf16 v[112:115], a[8:11], a[192:195], v[112:115]
    ds_read_b64_tr_b16 a[24:25], v5 offset:57344
    s_sub_u32 s5, s94, 9
    v_mfma_f32_16x16x32_bf16 v[112:115], a[12:15], a[208:211], v[112:115]
    v_mfma_f32_16x16x32_bf16 v[116:119], a[12:15], a[212:215], v[116:119]
    ds_read_b64_tr_b16 a[26:27], v5 offset:57856
    s_mul_i32 s5, s5, 37376
    v_mfma_f32_16x16x32_bf16 v[116:119], a[8:11], a[196:199], v[116:119]
    buffer_load_dwordx4 a[108:111], v16, s[24:27], s75 offen offset:2048 sc1
    v_mfma_f32_16x16x32_bf16 v[120:123], a[8:11], a[200:203], v[120:123]
    ds_read_b64_tr_b16 a[28:29], v5 offset:61440
    v_mfma_f32_16x16x32_bf16 v[120:123], a[12:15], a[216:219], v[120:123]
    v_mfma_f32_16x16x32_bf16 v[124:127], a[12:15], a[220:223], v[124:127]
    ds_read_b64_tr_b16 a[30:31], v5 offset:61952
    s_add_u32 s75, s75, 8192
    v_mfma_f32_16x16x32_bf16 v[124:127], a[8:11], a[204:207], v[124:127]
    s_add_u32 s82, s7, 3
    s_waitcnt vmcnt(6)
    v_subrev_u32 v22, s82, v22
    v_cmp_lt_u32 vcc, 7, v22
    s_cbranch_vccz L_poll5_ok
    s_mov_b32 s83, 0
L_poll5:
    buffer_load_dword v22, v13, s[24:27], s74 offen sc1
    s_add_u32 s83, s83, 1
    s_waitcnt vmcnt(0)
    v_subrev_u32 v22, s82, v22
    v_cmp_lt_u32 vcc, 7, v22
    s_cbranch_vccz L_poll5_ok
    s_cmp_lt_u32 s83, 0x40000
    s_cbranch_scc1 L_poll5
L_poll5_ok:
    s_waitcnt vmcnt(52)
    s_barrier
    s_waitcnt lgkmcnt(4)
    v_mfma_f32_16x16x32_bf16 v[160:163], a[16:19], a[192:195], v[160:163]
    v_add_u32 v1, 65536, v1
    ds_read_b64_tr_b16 a[0:1], v1 offset:1024
    v_mfma_f32_16x16x32_bf16 v[160:163], a[20:23], a[208:211], v[160:163]
    v_mfma_f32_16x16x32_bf16 v[164:167], a[20:23], a[212:215], v[164:167]
    ds_read_b64_tr_b16 a[2:3], v1 offset:1536
    v_mfma_f32_16x16x32_bf16 v[164:167], a[16:19], a[196:199], v[164:167]
    buffer_load_dwordx4 a[112:115], v16, s[24:27], s75 offen offset:0 sc1
    v_mfma_f32_16x16x32_bf16 v[168:171], a[16:19], a[200:203], v[168:171]
    ds_read_b64_tr_b16 a[4:5], v1 offset:9216
    v_mfma_f32_16x16x32_bf16 v[168:171], a[20:23], a[216:219], v[168:171]
    v_mfma_f32_16x16x32_bf16 v[172:175], a[20:23], a[220:223], v[172:175]
    ds_read_b64_tr_b16 a[6:7], v1 offset:9728
    v_mfma_f32_16x16x32_bf16 v[172:175], a[16:19], a[204:207], v[172:175]
    buffer_load_dwordx4 a[116:119], v16, s[24:27], s75 offen offset:2048 sc1
    s_waitcnt lgkmcnt(4)
    v_mfma_f32_16x16x32_bf16 v[176:179], a[24:27], a[192:195], v[176:179]
    v_add_u32 v2, 65536, v2
    ds_read_b64_tr_b16 a[8:9], v2 offset:1024
    v_mfma_f32_16x16x32_bf16 v[176:179], a[28:31], a[208:211], v[176:179]
    v_mfma_f32_16x16x32_bf16 v[180:183], a[28:31], a[212:215], v[180:183]
    ds_read_b64_tr_b16 a[10:11], v2 offset:1536
    v_mfma_f32_16x16x32_bf16 v[180:183], a[24:27], a[196:199], v[180:183]
    v_mfma_f32_16x16x32_bf16 v[184:187], a[24:27], a[200:203], v[184:187]
    ds_read_b64_tr_b16 a[12:13], v2 offset:9216
    v_mfma_f32_16x16x32_bf16 v[184:187], a[28:31], a[216:219], v[184:187]
    v_mfma_f32_16x16x32_bf16 v[188:191], a[28:31], a[220:223], v[188:191]
    ds_read_b64_tr_b16 a[14:15], v2 offset:9728
    v_mfma_f32_16x16x32_bf16 v[188:191], a[24:27], a[204:207], v[188:191]
    s_waitcnt lgkmcnt(4)
    v_mfma_f32_16x16x32_bf16 v[64:67], a[0:3], a[224:227], v[64:67]
    v_add_u32 v3, 65536, v3
    ds_read_b64_tr_b16 a[16:17], v3 offset:1024
    s_add_u32 s75, s75, 8192
    v_mfma_f32_16x16x32_bf16 v[64:67], a[4:7], a[240:243], v[64:67]
    v_mfma_f32_16x16x32_bf16 v[68:71], a[4:7], a[244:247], v[68:71]
    ds_read_b64_tr_b16 a[18:19], v3 offset:1536
    buffer_load_dwordx4 a[120:123], v16, s[24:27], s75 offen offset:0 sc1
    v_mfma_f32_16x16x32_bf16 v[68:71], a[0:3], a[228:231], v[68:71]
    v_mfma_f32_16x16x32_bf16 v[72:75], a[0:3], a[232:235], v[72:75]
    ds_read_b64_tr_b16 a[20:21], v3 offset:9216
    v_mfma_f32_16x16x32_bf16 v[72:75], a[4:7], a[248:251], v[72:75]
    buffer_load_dwordx4 a[124:127], v16, s[24:27], s75 offen offset:2048 sc1
    v_mfma_f32_16x16x32_bf16 v[76:79], a[4:7], a[252:255], v[76:79]
    ds_read_b64_tr_b16 a[22:23], v3 offset:9728
    v_mfma_f32_16x16x32_bf16 v[76:79], a[0:3], a[236:239], v[76:79]
    s_waitcnt lgkmcnt(4)
    v_mfma_f32_16x16x32_bf16 v[80:83], a[8:11], a[224:227], v[80:83]
    v_add_u32 v4, 65536, v4
    ds_read_b64_tr_b16 a[24:25], v4 offset:1024
    v_mfma_f32_16x16x32_bf16 v[80:83], a[12:15], a[240:243], v[80:83]
    s_lshl_b32 s75, s16, 15
    s_add_u32 s75, s75, s49
    s_add_u32 s75, s75, 131072
    v_mfma_f32_16x16x32_bf16 v[84:87], a[12:15], a[244:247], v[84:87]
    ds_read_b64_tr_b16 a[26:27], v4 offset:1536
    v_mfma_f32_16x16x32_bf16 v[84:87], a[8:11], a[228:231], v[84:87]
    v_mfma_f32_16x16x32_bf16 v[88:91], a[8:11], a[232:235], v[88:91]
    ds_read_b64_tr_b16 a[28:29], v4 offset:9216
    v_mfma_f32_16x16x32_bf16 v[88:91], a[12:15], a[248:251], v[88:91]
    v_mfma_f32_16x16x32_bf16 v[92:95], a[12:15], a[252:255], v[92:95]
    ds_read_b64_tr_b16 a[30:31], v4 offset:9728
    v_mfma_f32_16x16x32_bf16 v[92:95], a[8:11], a[236:239], v[92:95]
    buffer_load_dwordx4 a[128:131], v16, s[24:27], s75 offen offset:0 sc1
    s_waitcnt lgkmcnt(4)
    v_mfma_f32_16x16x32_bf16 v[96:99], a[16:19], a[224:227], v[96:99]
    v_add_u32 v5, 65536, v5
    ds_read_b64_tr_b16 a[0:1], v5 offset:0
    v_mfma_f32_16x16x32_bf16 v[96:99], a[20:23], a[240:243], v[96:99]
    v_mfma_f32_16x16x32_bf16 v[100:103], a[20:23], a[244:247], v[100:103]
    ds_read_b64_tr_b16 a[2:3], v5 offset:512
    buffer_load_dwordx4 a[132:135], v16, s[24:27], s75 offen offset:2048 sc1
    v_mfma_f32_16x16x32_bf16 v[100:103], a[16:19], a[228:231], v[100:103]
    s_mov_b32 s83, s52
    v_mul_f32 v64, s83, v64
    v_mfma_f32_16x16x32_bf16 v[104:107], a[16:19], a[232:235], v[104:107]
    ds_read_b64_tr_b16 a[4:5], v5 offset:4096
    v_mul_f32 v65, s83, v65
    s_add_u32 s75, s75, 8192
    v_mfma_f32_16x16x32_bf16 v[104:107], a[20:23], a[248:251], v[104:107]
    v_mul_f32 v66, s83, v66
    v_mul_f32 v67, s83, v67
    v_mfma_f32_16x16x32_bf16 v[108:111], a[20:23], a[252:255], v[108:111]
    ds_read_b64_tr_b16 a[6:7], v5 offset:4608
    v_mul_f32 v80, s83, v80
    v_mfma_f32_16x16x32_bf16 v[108:111], a[16:19], a[236:239], v[108:111]
    v_mul_f32 v81, s83, v81
    v_mul_f32 v82, s83, v82
    s_waitcnt lgkmcnt(4)
    v_mfma_f32_16x16x32_bf16 v[112:115], a[24:27], a[224:227], v[112:115]
    ds_read_b64_tr_b16 a[8:9], v5 offset:8192
    v_mul_f32 v83, s83, v83
    v_cvt_pk_bf16_f32 v32, v64, v65
    v_mfma_f32_16x16x32_bf16 v[112:115], a[28:31], a[240:243], v[112:115]
    v_cvt_pk_bf16_f32 v33, v66, v67
    v_cvt_pk_bf16_f32 v34, v80, v81
    v_cvt_pk_bf16_f32 v35, v82, v83
    v_mfma_f32_16x16x32_bf16 v[116:119], a[28:31], a[244:247], v[116:119]
    ds_read_b64_tr_b16 a[10:11], v5 offset:8704
    v_mul_f32 v68, s83, v68
    v_mul_f32 v69, s83, v69
    v_mul_f32 v70, s83, v70
    v_mfma_f32_16x16x32_bf16 v[116:119], a[24:27], a[228:231], v[116:119]
    v_mul_f32 v71, s83, v71
    v_mul_f32 v84, s83, v84
    buffer_load_dwordx4 a[136:139], v16, s[24:27], s75 offen offset:0 sc1
    buffer_load_dwordx4 a[140:143], v16, s[24:27], s75 offen offset:2048 sc1
    v_mfma_f32_16x16x32_bf16 v[120:123], a[24:27], a[232:235], v[120:123]
    ds_read_b64_tr_b16 a[12:13], v5 offset:12288
    v_mul_f32 v85, s83, v85
    v_mul_f32 v86, s83, v86
    v_mul_f32 v87, s83, v87
    v_mfma_f32_16x16x32_bf16 v[120:123], a[28:31], a[248:251], v[120:123]
    v_cvt_pk_bf16_f32 v36, v68, v69
    v_cvt_pk_bf16_f32 v37, v70, v71
    v_cvt_pk_bf16_f32 v38, v84, v85
    s_add_u32 s75, s75, 8192
    v_mfma_f32_16x16x32_bf16 v[124:127], a[28:31], a[252:255], v[124:127]
    ds_read_b64_tr_b16 a[14:15], v5 offset:12800
    v_cvt_pk_bf16_f32 v39, v86, v87
    v_permlane16_swap_b32 v32, v34
    v_permlane16_swap_b32 v33, v35
    v_mfma_f32_16x16x32_bf16 v[124:127], a[24:27], a[236:239], v[124:127]
    v_permlane16_swap_b32 v36, v38
    v_permlane16_swap_b32 v37, v39
    buffer_load_dwordx4 a[144:147], v16, s[24:27], s75 offen offset:0 sc1
    s_waitcnt lgkmcnt(4)
    v_mfma_f32_16x16x32_bf16 v[160:163], a[0:3], a[224:227], v[160:163]
    v_mul_f32 v72, s83, v72
    v_mul_f32 v73, s83, v73
    v_mul_f32 v74, s83, v74
    v_mfma_f32_16x16x32_bf16 v[160:163], a[4:7], a[240:243], v[160:163]
    v_mul_f32 v75, s83, v75
    v_mul_f32 v88, s83, v88
    v_mul_f32 v89, s83, v89
    buffer_load_dwordx4 a[148:151], v16, s[24:27], s75 offen offset:2048 sc1
    v_mfma_f32_16x16x32_bf16 v[164:167], a[4:7], a[244:247], v[164:167]
    v_mul_f32 v90, s83, v90
    v_mul_f32 v91, s83, v91
    v_mfma_f32_16x16x32_bf16 v[164:167], a[0:3], a[228:231], v[164:167]
    v_cvt_pk_bf16_f32 v40, v72, v73
    v_cvt_pk_bf16_f32 v41, v74, v75
    v_cvt_pk_bf16_f32 v42, v88, v89
    v_mfma_f32_16x16x32_bf16 v[168:171], a[0:3], a[232:235], v[168:171]
    v_cvt_pk_bf16_f32 v43, v90, v91
    v_mul_f32 v76, s83, v76
    v_mul_f32 v77, s83, v77
    v_mfma_f32_16x16x32_bf16 v[168:171], a[4:7], a[248:251], v[168:171]
    v_mul_f32 v78, s83, v78
    v_mul_f32 v79, s83, v79
    v_mul_f32 v92, s83, v92
    v_mfma_f32_16x16x32_bf16 v[172:175], a[4:7], a[252:255], v[172:175]
    v_mul_f32 v93, s83, v93
    v_mul_f32 v94, s83, v94
    v_mfma_f32_16x16x32_bf16 v[172:175], a[0:3], a[236:239], v[172:175]
    v_mul_f32 v95, s83, v95
    v_cvt_pk_bf16_f32 v44, v76, v77
    v_cvt_pk_bf16_f32 v45, v78, v79
    v_cvt_pk_bf16_f32 v46, v92, v93
    v_cvt_pk_bf16_f32 v47, v94, v95
    v_permlane16_swap_b32 v40, v42
    v_permlane16_swap_b32 v41, v43
    v_permlane16_swap_b32 v44, v46
    v_permlane16_swap_b32 v45, v47
    s_waitcnt lgkmcnt(0)
    v_mfma_f32_16x16x32_bf16 v[176:179], a[8:11], a[224:227], v[176:179]
    v_mul_f32 v96, s83, v96
    s_add_u32 s75, s75, 8192
    v_mfma_f32_16x16x32_bf16 v[176:179], a[12:15], a[240:243], v[176:179]
    v_mul_f32 v97, s83, v97
    v_mul_f32 v98, s83, v98
    buffer_load_dwordx4 a[152:155], v16, s[24:27], s75 offen offset:0 sc1
    v_mfma_f32_16x16x32_bf16 v[180:183], a[12:15], a[244:247], v[180:183]
    v_mul_f32 v99, s83, v99
    buffer_load_dwordx4 a[156:159], v16, s[24:27], s75 offen offset:2048 sc1
    v_mfma_f32_16x16x32_bf16 v[180:183], a[8:11], a[228:231], v[180:183]
    v_mul_f32 v112, s83, v112
    v_mul_f32 v113, s83, v113
    v_mfma_f32_16x16x32_bf16 v[184:187], a[8:11], a[232:235], v[184:187]
    v_mul_f32 v114, s83, v114
    v_mfma_f32_16x16x32_bf16 v[184:187], a[12:15], a[248:251], v[184:187]
    v_mul_f32 v115, s83, v115
    v_cvt_pk_bf16_f32 v48, v96, v97
    v_mfma_f32_16x16x32_bf16 v[188:191], a[12:15], a[252:255], v[188:191]
    v_cvt_pk_bf16_f32 v49, v98, v99
    v_mfma_f32_16x16x32_bf16 v[188:191], a[8:11], a[236:239], v[188:191]
    v_cvt_pk_bf16_f32 v50, v112, v113
    v_cvt_pk_bf16_f32 v51, v114, v115
    v_mul_f32 v100, s83, v100
    v_mul_f32 v101, s83, v101
    v_mul_f32 v102, s83, v102
    v_mul_f32 v103, s83, v103
    v_mul_f32 v116, s83, v116
    v_mul_f32 v117, s83, v117
    v_mul_f32 v118, s83, v118
    v_mul_f32 v119, s83, v119
    v_cvt_pk_bf16_f32 v52, v100, v101
    v_cvt_pk_bf16_f32 v53, v102, v103
    v_cvt_pk_bf16_f32 v54, v116, v117
    v_cvt_pk_bf16_f32 v55, v118, v119
    v_permlane16_swap_b32 v48, v50
    v_permlane16_swap_b32 v49, v51
    v_permlane16_swap_b32 v52, v54
    v_permlane16_swap_b32 v53, v55
    v_mul_f32 v104, s83, v104
    v_mul_f32 v105, s83, v105
    v_mul_f32 v106, s83, v106
    v_mul_f32 v107, s83, v107
    v_mul_f32 v120, s83, v120
    v_mul_f32 v121, s83, v121
    v_mul_f32 v122, s83, v122
    v_mul_f32 v123, s83, v123
    v_cvt_pk_bf16_f32 v56, v104, v105
    v_cvt_pk_bf16_f32 v57, v106, v107
    v_cvt_pk_bf16_f32 v58, v120, v121
    v_cvt_pk_bf16_f32 v59, v122, v123
    v_mul_f32 v108, s83, v108
    v_mul_f32 v109, s83, v109
    v_mul_f32 v110, s83, v110
    v_mul_f32 v111, s83, v111
    v_mul_f32 v124, s83, v124
    v_mul_f32 v125, s83, v125
    v_mul_f32 v126, s83, v126
    v_mul_f32 v127, s83, v127
    v_cvt_pk_bf16_f32 v60, v108, v109
    v_cvt_pk_bf16_f32 v61, v110, v111
    v_cvt_pk_bf16_f32 v62, v124, v125
    v_cvt_pk_bf16_f32 v63, v126, v127
    v_permlane16_swap_b32 v56, v58
    v_permlane16_swap_b32 v57, v59
    v_permlane16_swap_b32 v60, v62
    v_permlane16_swap_b32 v61, v63
    s_branch L_mk_m
L_mk_v:
    s_waitcnt lgkmcnt(4)
    v_mfma_f32_16x16x32_bf16 v[64:67], v[192:195], a[0:3], 0
    v_subrev_u32 v3, 131072, v3
    ds_read_b64_tr_b16 a[16:17], v3 offset:1024
    v_mul_f32 v144, v128, v144
    s_mul_i32 s56, s90, 589824
    s_add_u32 s56, s56, s53
    s_add_u32 m0, s46, 98304
    v_mfma_f32_16x16x32_bf16 v[64:67], v[208:211], a[4:7], v[64:67]
    v_mul_f32 v145, v129, v145
    v_mul_f32 v146, v130, v146
    s_add_u32 s47, s58, 131072
    buffer_store_dwordx4 v[32:35], v16, s[24:27], s47 offen offset:0 sc1
    v_mfma_f32_16x16x32_bf16 v[68:71], v[212:215], a[4:7], 0
    ds_read_b64_tr_b16 a[18:19], v3 offset:1536
    v_mul_f32 v147, v131, v147
    v_mfma_f32_16x16x32_bf16 v[68:71], v[196:199], a[0:3], v[68:71]
    v_cvt_pk_bf16_f32 v48, v144, v145
    v_cvt_pk_bf16_f32 v49, v146, v147
    v_mfma_f32_16x16x32_bf16 v[72:75], v[200:203], a[0:3], 0
    ds_read_b64_tr_b16 a[20:21], v3 offset:9216
    v_mul_f32 v148, v132, v148
    v_mfma_f32_16x16x32_bf16 v[72:75], v[216:219], a[4:7], v[72:75]
    v_mul_f32 v149, v133, v149
    v_mul_f32 v150, v134, v150
    v_mfma_f32_16x16x32_bf16 v[76:79], v[220:223], a[4:7], 0
    ds_read_b64_tr_b16 a[22:23], v3 offset:9728
    v_mul_f32 v151, v135, v151
    v_mfma_f32_16x16x32_bf16 v[76:79], v[204:207], a[0:3], v[76:79]
    v_cvt_pk_bf16_f32 v52, v148, v149
    s_waitcnt lgkmcnt(4)
    v_mfma_f32_16x16x32_bf16 v[80:83], v[192:195], a[8:11], 0
    v_subrev_u32 v4, 131072, v4
    ds_read_b64_tr_b16 a[24:25], v4 offset:1024
    v_cvt_pk_bf16_f32 v53, v150, v151
    v_mfma_f32_16x16x32_bf16 v[80:83], v[208:211], a[12:15], v[80:83]
    v_mul_f32 v152, v136, v152
    v_mul_f32 v153, v137, v153
    v_mfma_f32_16x16x32_bf16 v[84:87], v[212:215], a[12:15], 0
    ds_read_b64_tr_b16 a[26:27], v4 offset:1536
    v_mul_f32 v154, v138, v154
    v_mul_f32 v155, v139, v155
    v_mfma_f32_16x16x32_bf16 v[84:87], v[196:199], a[8:11], v[84:87]
    v_cvt_pk_bf16_f32 v56, v152, v153
    v_cvt_pk_bf16_f32 v57, v154, v155
    v_mfma_f32_16x16x32_bf16 v[88:91], v[200:203], a[8:11], 0
    ds_read_b64_tr_b16 a[28:29], v4 offset:9216
    v_mul_f32 v156, v140, v156
    v_mul_f32 v157, v141, v157
    v_mfma_f32_16x16x32_bf16 v[88:91], v[216:219], a[12:15], v[88:91]
    v_mul_f32 v158, v142, v158
    v_mul_f32 v159, v143, v159
    buffer_load_dwordx4 v21, s[64:67], s56 offen  lds
    v_mfma_f32_16x16x32_bf16 v[92:95], v[220:223], a[12:15], 0
    ds_read_b64_tr_b16 a[30:31], v4 offset:9728
    v_cvt_pk_bf16_f32 v60, v156, v157
    s_add_u32 s47, s58, 131072
    buffer_store_dwordx4 v[36:39], v16, s[24:27], s47 offen offset:1024 sc1
    v_mfma_f32_16x16x32_bf16 v[92:95], v[204:207], a[8:11], v[92:95]
    v_cvt_pk_bf16_f32 v61, v158, v159
    v_mul_f32 v176, v160, v176
    s_waitcnt lgkmcnt(4)
    v_mfma_f32_16x16x32_bf16 v[96:99], v[192:195], a[16:19], 0
    ds_read_b64_tr_b16 a[0:1], v5 offset:0
    v_mul_f32 v177, v161, v177
    v_mul_f32 v178, v162, v178
    v_mfma_f32_16x16x32_bf16 v[96:99], v[208:211], a[20:23], v[96:99]
    v_mul_f32 v179, v163, v179
    v_cvt_pk_bf16_f32 v50, v176, v177
    v_and_b32 v28, 31, v0
    v_lshlrev_b32 v28, 7, v28
    v_bfe_u32 v29, v0, 5, 1
    v_lshl_add_u32 v28, v29, 13, v28
    v_and_b32 v29, 63, v0
    v_subrev_u32 v29, 24, v29
    v_cmp_gt_u32 vcc, 8, v29
    s_nop 1
    v_cndmask_b32 v28, -16, v28, vcc
    buffer_load_dword v12, v28, s[24:27], s58 offen sc1
    v_mfma_f32_16x16x32_bf16 v[100:103], v[212:215], a[20:23], 0
    ds_read_b64_tr_b16 a[2:3], v5 offset:512
    v_cvt_pk_bf16_f32 v51, v178, v179
    v_mul_f32 v180, v164, v180
    v_mfma_f32_16x16x32_bf16 v[100:103], v[196:199], a[16:19], v[100:103]
    v_mul_f32 v181, v165, v181
    v_mul_f32 v182, v166, v182
    v_mfma_f32_16x16x32_bf16 v[104:107], v[200:203], a[16:19], 0
    ds_read_b64_tr_b16 a[4:5], v5 offset:4096
    v_mul_f32 v183, v167, v183
    v_mfma_f32_16x16x32_bf16 v[104:107], v[216:219], a[20:23], v[104:107]
    v_cvt_pk_bf16_f32 v54, v180, v181
    v_cvt_pk_bf16_f32 v55, v182, v183
    v_mfma_f32_16x16x32_bf16 v[108:111], v[220:223], a[20:23], 0
    ds_read_b64_tr_b16 a[6:7], v5 offset:4608
    v_permlane32_swap_b32 v48, v50
    v_permlane32_swap_b32 v49, v51
    v_mfma_f32_16x16x32_bf16 v[108:111], v[204:207], a[16:19], v[108:111]
    v_mul_f32 v184, v168, v184
    v_mul_f32 v185, v169, v185
    s_waitcnt lgkmcnt(4)
    v_mfma_f32_16x16x32_bf16 v[112:115], v[192:195], a[24:27], 0
    ds_read_b64_tr_b16 a[8:9], v5 offset:8192
    v_mul_f32 v186, v170, v186
    v_mul_f32 v187, v171, v187
    v_mfma_f32_16x16x32_bf16 v[112:115], v[208:211], a[28:31], v[112:115]
    v_cvt_pk_bf16_f32 v58, v184, v185
    v_cvt_pk_bf16_f32 v59, v186, v187
    v_mfma_f32_16x16x32_bf16 v[116:119], v[212:215], a[28:31], 0
    ds_read_b64_tr_b16 a[10:11], v5 offset:8704
    v_permlane32_swap_b32 v52, v54
    v_mfma_f32_16x16x32_bf16 v[116:119], v[196:199], a[24:27], v[116:119]
    v_permlane32_swap_b32 v53, v55
    v_mul_f32 v188, v172, v188
    v_mfma_f32_16x16x32_bf16 v[120:123], v[200:203], a[24:27], 0
    ds_read_b64_tr_b16 a[12:13], v5 offset:12288
    v_mul_f32 v189, v173, v189
    v_mul_f32 v190, v174, v190
    v_mfma_f32_16x16x32_bf16 v[120:123], v[216:219], a[28:31], v[120:123]
    v_mul_f32 v191, v175, v191
    v_cvt_pk_bf16_f32 v62, v188, v189
    v_mfma_f32_16x16x32_bf16 v[124:127], v[220:223], a[28:31], 0
    ds_read_b64_tr_b16 a[14:15], v5 offset:12800
    v_cvt_pk_bf16_f32 v63, v190, v191
    v_permlane32_swap_b32 v56, v58
    v_permlane32_swap_b32 v57, v59
    s_nop 0
    v_permlane32_swap_b32 v60, v62
    v_permlane32_swap_b32 v61, v63
    v_mfma_f32_16x16x32_bf16 v[124:127], v[204:207], a[24:27], v[124:127]
    s_waitcnt vmcnt(20)
    s_barrier
    s_waitcnt lgkmcnt(4)
    v_mfma_f32_16x16x32_bf16 v[160:163], a[0:3], v[192:195], 0
    ds_read_b64_tr_b16 a[16:17], v1 offset:17408
    s_mul_i32 s57, s90, 221184
    s_add_u32 s57, s57, s54
    s_add_u32 m0, s46, 99328
    v_mfma_f32_16x16x32_bf16 v[160:163], a[4:7], v[208:211], v[160:163]
    buffer_load_dwordx4 v19, s[20:23], s57 offen  lds
    v_mfma_f32_16x16x32_bf16 v[164:167], a[4:7], v[212:215], 0
    ds_read_b64_tr_b16 a[18:19], v1 offset:17920
    v_mfma_f32_16x16x32_bf16 v[164:167], a[0:3], v[196:199], v[164:167]
    s_add_u32 m0, s46, 100352
    v_mfma_f32_16x16x32_bf16 v[168:171], a[0:3], v[200:203], 0
    ds_read_b64_tr_b16 a[20:21], v1 offset:25600
    v_mfma_f32_16x16x32_bf16 v[168:171], a[4:7], v[216:219], v[168:171]
    s_add_u32 s47, s58, 131072
    buffer_store_dwordx4 v[40:43], v16, s[24:27], s47 offen offset:2048 sc1
    v_mfma_f32_16x16x32_bf16 v[172:175], a[4:7], v[220:223], 0
    ds_read_b64_tr_b16 a[22:23], v1 offset:26112
    v_mfma_f32_16x16x32_bf16 v[172:175], a[0:3], v[204:207], v[172:175]
    buffer_load_dwordx4 v20, s[20:23], s57 offen  lds
    s_waitcnt lgkmcnt(4)
    v_mfma_f32_16x16x32_bf16 v[176:179], a[8:11], v[192:195], 0
    ds_read_b64_tr_b16 a[24:25], v2 offset:17408
    v_mfma_f32_16x16x32_bf16 v[176:179], a[12:15], v[208:211], v[176:179]
    v_and_b32 v28, 31, v0
    v_lshlrev_b32 v28, 7, v28
    v_bfe_u32 v29, v0, 5, 1
    v_lshl_add_u32 v28, v29, 13, v28
    v_and_b32 v29, 63, v0
    v_subrev_u32 v29, 32, v29
    v_cmp_gt_u32 vcc, 8, v29
    s_nop 1
    v_cndmask_b32 v28, -16, v28, vcc
    buffer_load_dword v12, v28, s[24:27], s58 offen sc1
    v_mfma_f32_16x16x32_bf16 v[180:183], a[12:15], v[212:215], 0
    ds_read_b64_tr_b16 a[26:27], v2 offset:17920
    v_mfma_f32_16x16x32_bf16 v[180:183], a[8:11], v[196:199], v[180:183]
    v_mfma_f32_16x16x32_bf16 v[184:187], a[8:11], v[200:203], 0
    ds_read_b64_tr_b16 a[28:29], v2 offset:25600
    v_mfma_f32_16x16x32_bf16 v[184:187], a[12:15], v[216:219], v[184:187]
    v_mfma_f32_16x16x32_bf16 v[188:191], a[12:15], v[220:223], 0
    ds_read_b64_tr_b16 a[30:31], v2 offset:26112
    v_mfma_f32_16x16x32_bf16 v[188:191], a[8:11], v[204:207], v[188:191]
    s_waitcnt lgkmcnt(4)
    v_mfma_f32_16x16x32_bf16 v[64:67], v[224:227], a[16:19], v[64:67]
    ds_read_b64_tr_b16 a[0:1], v3 offset:17408
    v_mfma_f32_16x16x32_bf16 v[64:67], v[240:243], a[20:23], v[64:67]
    s_mul_i32 s56, s91, 589824
    s_add_u32 s56, s56, s53
    s_add_u32 m0, s46, 114688
    v_mfma_f32_16x16x32_bf16 v[68:71], v[244:247], a[20:23], v[68:71]
    ds_read_b64_tr_b16 a[2:3], v3 offset:17920
    v_mfma_f32_16x16x32_bf16 v[68:71], v[228:231], a[16:19], v[68:71]
    s_add_u32 s82, s7, 2
    s_waitcnt vmcnt(16)
    v_subrev_u32 v22, s82, v22
    v_cmp_lt_u32 vcc, 7, v22
    s_cbranch_vccz L_poll6_ok
    s_mov_b32 s83, 0
L_poll6:
    buffer_load_dword v22, v13, s[24:27], s74 offen sc1
    s_add_u32 s83, s83, 1
    s_waitcnt vmcnt(0)
    v_subrev_u32 v22, s82, v22
    v_cmp_lt_u32 vcc, 7, v22
    s_cbranch_vccz L_poll6_ok
    s_cmp_lt_u32 s83, 0x40000
    s_cbranch_scc1 L_poll6
L_poll6_ok:
    v_mfma_f32_16x16x32_bf16 v[72:75], v[232:235], a[16:19], v[72:75]
    ds_read_b64_tr_b16 a[4:5], v3 offset:25600
    v_mfma_f32_16x16x32_bf16 v[72:75], v[248:251], a[20:23], v[72:75]
    s_add_u32 s47, s58, 131072
    buffer_store_dwordx4 v[44:47], v16, s[24:27], s47 offen offset:3072 sc1
    v_mfma_f32_16x16x32_bf16 v[76:79], v[252:255], a[20:23], v[76:79]
    ds_read_b64_tr_b16 a[6:7], v3 offset:26112
    v_mfma_f32_16x16x32_bf16 v[76:79], v[236:239], a[16:19], v[76:79]
    s_waitcnt lgkmcnt(4)
    v_mfma_f32_16x16x32_bf16 v[80:83], v[224:227], a[24:27], v[80:83]
    ds_read_b64_tr_b16 a[8:9], v4 offset:17408
    v_mfma_f32_16x16x32_bf16 v[80:83], v[240:243], a[28:31], v[80:83]
    v_mfma_f32_16x16x32_bf16 v[84:87], v[244:247], a[28:31], v[84:87]
    ds_read_b64_tr_b16 a[10:11], v4 offset:17920
    v_mfma_f32_16x16x32_bf16 v[84:87], v[228:231], a[24:27], v[84:87]
    v_mfma_f32_16x16x32_bf16 v[88:91], v[232:235], a[24:27], v[88:91]
    ds_read_b64_tr_b16 a[12:13], v4 offset:25600
    v_mfma_f32_16x16x32_bf16 v[88:91], v[248:251], a[28:31], v[88:91]
    buffer_load_dwordx4 v21, s[64:67], s56 offen  lds
    v_mfma_f32_16x16x32_bf16 v[92:95], v[252:255], a[28:31], v[92:95]
    ds_read_b64_tr_b16 a[14:15], v4 offset:26112
    v_and_b32 v28, 31, v0
    v_lshlrev_b32 v28, 7, v28
    v_bfe_u32 v29, v0, 5, 1
    v_lshl_add_u32 v28, v29, 13, v28
    v_and_b32 v29, 63, v0
    v_subrev_u32 v29, 40, v29
    v_cmp_gt_u32 vcc, 8, v29
    s_nop 1
    v_cndmask_b32 v28, -16, v28, vcc
    buffer_load_dword v12, v28, s[24:27], s58 offen sc1
    v_mfma_f32_16x16x32_bf16 v[92:95], v[236:239], a[24:27], v[92:95]
    s_waitcnt lgkmcnt(4)
    v_mfma_f32_16x16x32_bf16 v[96:99], v[224:227], a[0:3], v[96:99]
    ds_read_b64_tr_b16 a[16:17], v5 offset:16384
    v_mfma_f32_16x16x32_bf16 v[96:99], v[240:243], a[4:7], v[96:99]
    s_mul_i32 s57, s91, 221184
    s_add_u32 s57, s57, s54
    s_add_u32 m0, s46, 115712
    v_mfma_f32_16x16x32_bf16 v[100:103], v[244:247], a[4:7], v[100:103]
    ds_read_b64_tr_b16 a[18:19], v5 offset:16896
    v_mfma_f32_16x16x32_bf16 v[100:103], v[228:231], a[0:3], v[100:103]
    v_mfma_f32_16x16x32_bf16 v[104:107], v[232:235], a[0:3], v[104:107]
    ds_read_b64_tr_b16 a[20:21], v5 offset:20480
    v_mfma_f32_16x16x32_bf16 v[104:107], v[248:251], a[4:7], v[104:107]
    v_mfma_f32_16x16x32_bf16 v[108:111], v[252:255], a[4:7], v[108:111]
    ds_read_b64_tr_b16 a[22:23], v5 offset:20992
    v_mfma_f32_16x16x32_bf16 v[108:111], v[236:239], a[0:3], v[108:111]
    s_waitcnt lgkmcnt(4)
    v_mfma_f32_16x16x32_bf16 v[112:115], v[224:227], a[8:11], v[112:115]
    ds_read_b64_tr_b16 a[24:25], v5 offset:24576
    v_mfma_f32_16x16x32_bf16 v[112:115], v[240:243], a[12:15], v[112:115]
    s_add_u32 s47, s58, 139264
    buffer_store_dwordx4 v[48:51], v16, s[24:27], s47 offen offset:0 sc1
    v_mfma_f32_16x16x32_bf16 v[116:119], v[244:247], a[12:15], v[116:119]
    ds_read_b64_tr_b16 a[26:27], v5 offset:25088
    v_mfma_f32_16x16x32_bf16 v[116:119], v[228:231], a[8:11], v[116:119]
    v_mfma_f32_16x16x32_bf16 v[120:123], v[232:235], a[8:11], v[120:123]
    ds_read_b64_tr_b16 a[28:29], v5 offset:28672
    v_mfma_f32_16x16x32_bf16 v[120:123], v[248:251], a[12:15], v[120:123]
    v_mfma_f32_16x16x32_bf16 v[124:127], v[252:255], a[12:15], v[124:127]
    ds_read_b64_tr_b16 a[30:31], v5 offset:29184
    buffer_load_dwordx4 v19, s[20:23], s57 offen  lds
    v_mfma_f32_16x16x32_bf16 v[124:127], v[236:239], a[8:11], v[124:127]
    s_waitcnt vmcnt(26)
    s_barrier
    s_waitcnt lgkmcnt(4)
    v_mfma_f32_16x16x32_bf16 v[160:163], a[16:19], v[224:227], v[160:163]
    ds_read_b64_tr_b16 a[0:1], v1 offset:33792
    v_mfma_f32_16x16x32_bf16 v[160:163], a[20:23], v[240:243], v[160:163]
    v_mfma_f32_16x16x32_bf16 v[164:167], a[20:23], v[244:247], v[164:167]
    ds_read_b64_tr_b16 a[2:3], v1 offset:34304
    v_mfma_f32_16x16x32_bf16 v[164:167], a[16:19], v[228:231], v[164:167]
    s_add_u32 m0, s46, 116736
    v_mfma_f32_16x16x32_bf16 v[168:171], a[16:19], v[232:235], v[168:171]
    ds_read_b64_tr_b16 a[4:5], v1 offset:41984
    v_mfma_f32_16x16x32_bf16 v[168:171], a[20:23], v[248:251], v[168:171]
    v_mfma_f32_16x16x32_bf16 v[172:175], a[20:23], v[252:255], v[172:175]
    ds_read_b64_tr_b16 a[6:7], v1 offset:42496
    v_mfma_f32_16x16x32_bf16 v[172:175], a[16:19], v[236:239], v[172:175]
    buffer_load_dwordx4 v20, s[20:23], s57 offen  lds
    s_waitcnt lgkmcnt(4)
    v_mfma_f32_16x16x32_bf16 v[176:179], a[24:27], v[224:227], v[176:179]
    ds_read_b64_tr_b16 a[8:9], v2 offset:33792
    v_mfma_f32_16x16x32_bf16 v[176:179], a[28:31], v[240:243], v[176:179]
    v_and_b32 v28, 31, v0
    v_lshlrev_b32 v28, 7, v28
    v_bfe_u32 v29, v0, 5, 1
    v_lshl_add_u32 v28, v29, 13, v28
    v_and_b32 v29, 63, v0
    v_subrev_u32 v29, 48, v29
    v_cmp_gt_u32 vcc, 8, v29
    s_nop 1
    v_cndmask_b32 v28, -16, v28, vcc
    buffer_load_dword v12, v28, s[24:27], s58 offen sc1
    v_mfma_f32_16x16x32_bf16 v[180:183], a[28:31], v[244:247], v[180:183]
    ds_read_b64_tr_b16 a[10:11], v2 offset:34304
    v_mfma_f32_16x16x32_bf16 v[180:183], a[24:27], v[228:231], v[180:183]
    v_mfma_f32_16x16x32_bf16 v[184:187], a[24:27], v[232:235], v[184:187]
    ds_read_b64_tr_b16 a[12:13], v2 offset:41984
    v_mfma_f32_16x16x32_bf16 v[184:187], a[28:31], v[248:251], v[184:187]
    v_mfma_f32_16x16x32_bf16 v[188:191], a[28:31], v[252:255], v[188:191]
    ds_read_b64_tr_b16 a[14:15], v2 offset:42496
    v_mfma_f32_16x16x32_bf16 v[188:191], a[24:27], v[236:239], v[188:191]
    s_waitcnt lgkmcnt(4)
    v_mfma_f32_16x16x32_bf16 v[64:67], a[32:35], a[0:3], v[64:67]
    ds_read_b64_tr_b16 a[16:17], v3 offset:33792
    v_mfma_f32_16x16x32_bf16 v[64:67], a[48:51], a[4:7], v[64:67]
    s_mul_i32 s56, s92, 589824
    s_add_u32 s56, s56, s53
    s_add_u32 m0, s46, 131072
    v_mfma_f32_16x16x32_bf16 v[68:71], a[52:55], a[4:7], v[68:71]
    ds_read_b64_tr_b16 a[18:19], v3 offset:34304
    v_mfma_f32_16x16x32_bf16 v[68:71], a[36:39], a[0:3], v[68:71]
    s_add_u32 s47, s58, 139264
    buffer_store_dwordx4 v[52:55], v16, s[24:27], s47 offen offset:1024 sc1
    v_mfma_f32_16x16x32_bf16 v[72:75], a[40:43], a[0:3], v[72:75]
    ds_read_b64_tr_b16 a[20:21], v3 offset:41984
    v_mfma_f32_16x16x32_bf16 v[72:75], a[56:59], a[4:7], v[72:75]
    v_mfma_f32_16x16x32_bf16 v[76:79], a[60:63], a[4:7], v[76:79]
    ds_read_b64_tr_b16 a[22:23], v3 offset:42496
    v_mfma_f32_16x16x32_bf16 v[76:79], a[44:47], a[0:3], v[76:79]
    s_waitcnt lgkmcnt(4)
    v_mfma_f32_16x16x32_bf16 v[80:83], a[32:35], a[8:11], v[80:83]
    ds_read_b64_tr_b16 a[24:25], v4 offset:33792
    buffer_load_dwordx4 v21, s[64:67], s56 offen  lds
    v_mfma_f32_16x16x32_bf16 v[80:83], a[48:51], a[12:15], v[80:83]
    v_mfma_f32_16x16x32_bf16 v[84:87], a[52:55], a[12:15], v[84:87]
    ds_read_b64_tr_b16 a[26:27], v4 offset:34304
    v_mfma_f32_16x16x32_bf16 v[84:87], a[36:39], a[8:11], v[84:87]
    s_mul_i32 s57, s92, 221184
    s_add_u32 s57, s57, s54
    s_add_u32 m0, s46, 132096
    v_mfma_f32_16x16x32_bf16 v[88:91], a[40:43], a[8:11], v[88:91]
    ds_read_b64_tr_b16 a[28:29], v4 offset:41984
    v_mfma_f32_16x16x32_bf16 v[88:91], a[56:59], a[12:15], v[88:91]
    v_mfma_f32_16x16x32_bf16 v[92:95], a[60:63], a[12:15], v[92:95]
    ds_read_b64_tr_b16 a[30:31], v4 offset:42496
    v_and_b32 v28, 31, v0
    v_lshlrev_b32 v28, 7, v28
    v_bfe_u32 v29, v0, 5, 1
    v_lshl_add_u32 v28, v29, 13, v28
    v_and_b32 v29, 63, v0
    v_subrev_u32 v29, 56, v29
    v_cmp_gt_u32 vcc, 8, v29
    s_nop 1
    v_cndmask_b32 v28, -16, v28, vcc
    buffer_load_dword v12, v28, s[24:27], s58 offen sc1
    v_mfma_f32_16x16x32_bf16 v[92:95], a[44:47], a[8:11], v[92:95]
    s_waitcnt lgkmcnt(4)
    v_mfma_f32_16x16x32_bf16 v[96:99], a[32:35], a[16:19], v[96:99]
    ds_read_b64_tr_b16 a[0:1], v5 offset:32768
    v_mfma_f32_16x16x32_bf16 v[96:99], a[48:51], a[20:23], v[96:99]
    s_add_u32 s47, s58, 139264
    buffer_store_dwordx4 v[56:59], v16, s[24:27], s47 offen offset:2048 sc1
    v_mfma_f32_16x16x32_bf16 v[100:103], a[52:55], a[20:23], v[100:103]
    ds_read_b64_tr_b16 a[2:3], v5 offset:33280
    v_mfma_f32_16x16x32_bf16 v[100:103], a[36:39], a[16:19], v[100:103]
    buffer_load_dwordx4 v19, s[20:23], s57 offen  lds
    v_mfma_f32_16x16x32_bf16 v[104:107], a[40:43], a[16:19], v[104:107]
    ds_read_b64_tr_b16 a[4:5], v5 offset:36864
    v_mfma_f32_16x16x32_bf16 v[104:107], a[56:59], a[20:23], v[104:107]
    v_mfma_f32_16x16x32_bf16 v[108:111], a[60:63], a[20:23], v[108:111]
    ds_read_b64_tr_b16 a[6:7], v5 offset:37376
    s_add_u32 m0, s46, 133120
    v_mfma_f32_16x16x32_bf16 v[108:111], a[44:47], a[16:19], v[108:111]
    s_waitcnt lgkmcnt(4)
    v_mfma_f32_16x16x32_bf16 v[112:115], a[32:35], a[24:27], v[112:115]
    ds_read_b64_tr_b16 a[8:9], v5 offset:40960
    v_mfma_f32_16x16x32_bf16 v[112:115], a[48:51], a[28:31], v[112:115]
    buffer_load_dwordx4 v20, s[20:23], s57 offen  lds
    v_mfma_f32_16x16x32_bf16 v[116:119], a[52:55], a[28:31], v[116:119]
    ds_read_b64_tr_b16 a[10:11], v5 offset:41472
    v_mfma_f32_16x16x32_bf16 v[116:119], a[36:39], a[24:27], v[116:119]
    v_mfma_f32_16x16x32_bf16 v[120:123], a[40:43], a[24:27], v[120:123]
    ds_read_b64_tr_b16 a[12:13], v5 offset:45056
    v_mfma_f32_16x16x32_bf16 v[120:123], a[56:59], a[28:31], v[120:123]
    s_add_u32 s47, s58, 139264
    buffer_store_dwordx4 v[60:63], v16, s[24:27], s47 offen offset:3072 sc1
    v_mfma_f32_16x16x32_bf16 v[124:127], a[60:63], a[28:31], v[124:127]
    ds_read_b64_tr_b16 a[14:15], v5 offset:45568
    v_mfma_f32_16x16x32_bf16 v[124:127], a[44:47], a[24:27], v[124:127]
    s_waitcnt vmcnt(31)
    s_barrier
    s_waitcnt lgkmcnt(4)
    v_mfma_f32_16x16x32_bf16 v[160:163], a[0:3], a[32:35], v[160:163]
    ds_read_b64_tr_b16 a[16:17], v1 offset:50176
    v_mfma_f32_16x16x32_bf16 v[160:163], a[4:7], a[48:51], v[160:163]
    v_mfma_f32_16x16x32_bf16 v[164:167], a[4:7], a[52:55], v[164:167]
    ds_read_b64_tr_b16 a[18:19], v1 offset:50688
    v_mfma_f32_16x16x32_bf16 v[164:167], a[0:3], a[36:39], v[164:167]
    v_mfma_f32_16x16x32_bf16 v[168:171], a[0:3], a[40:43], v[168:171]
    ds_read_b64_tr_b16 a[20:21], v1 offset:58368
    v_mfma_f32_16x16x32_bf16 v[168:171], a[4:7], a[56:59], v[168:171]
    v_mfma_f32_16x16x32_bf16 v[172:175], a[4:7], a[60:63], v[172:175]
    ds_read_b64_tr_b16 a[22:23], v1 offset:58880
    v_mfma_f32_16x16x32_bf16 v[172:175], a[0:3], a[44:47], v[172:175]
    s_waitcnt lgkmcnt(4)
    v_mfma_f32_16x16x32_bf16 v[176:179], a[8:11], a[32:35], v[176:179]
    ds_read_b64_tr_b16 a[24:25], v2 offset:50176
    v_mfma_f32_16x16x32_bf16 v[176:179], a[12:15], a[48:51], v[176:179]
    v_mfma_f32_16x16x32_bf16 v[180:183], a[12:15], a[52:55], v[180:183]
    ds_read_b64_tr_b16 a[26:27], v2 offset:50688
    v_mfma_f32_16x16x32_bf16 v[180:183], a[8:11], a[36:39], v[180:183]
    v_mfma_f32_16x16x32_bf16 v[184:187], a[8:11], a[40:43], v[184:187]
    ds_read_b64_tr_b16 a[28:29], v2 offset:58368
    v_mfma_f32_16x16x32_bf16 v[184:187], a[12:15], a[56:59], v[184:187]
    v_mfma_f32_16x16x32_bf16 v[188:191], a[12:15], a[60:63], v[188:191]
    ds_read_b64_tr_b16 a[30:31], v2 offset:58880
    v_mfma_f32_16x16x32_bf16 v[188:191], a[8:11], a[44:47], v[188:191]
    s_waitcnt lgkmcnt(4)
    v_mfma_f32_16x16x32_bf16 v[64:67], a[64:67], a[16:19], v[64:67]
    ds_read_b64_tr_b16 a[0:1], v3 offset:50176
    s_and_b32 s4, s2, 1
    v_mfma_f32_16x16x32_bf16 v[64:67], a[80:83], a[20:23], v[64:67]
    s_lshl_b32 s75, s16, 15
    s_add_u32 s75, s75, s49
    v_mfma_f32_16x16x32_bf16 v[68:71], a[84:87], a[20:23], v[68:71]
    ds_read_b64_tr_b16 a[2:3], v3 offset:50688
    s_lshl_b32 s4, s4, 3
    v_mfma_f32_16x16x32_bf16 v[68:71], a[68:71], a[16:19], v[68:71]
    s_bfe_u32 s62, s2, 0x30003
    v_mfma_f32_16x16x32_bf16 v[72:75], a[72:75], a[16:19], v[72:75]
    ds_read_b64_tr_b16 a[4:5], v3 offset:58368
    buffer_load_dwordx4 v[192:195], v16, s[24:27], s75 offen offset:0 sc1
    v_mfma_f32_16x16x32_bf16 v[72:75], a[88:91], a[20:23], v[72:75]
    s_add_u32 s4, s4, s62
    v_mfma_f32_16x16x32_bf16 v[76:79], a[92:95], a[20:23], v[76:79]
    ds_read_b64_tr_b16 a[6:7], v3 offset:58880
    buffer_load_dwordx4 v[196:199], v16, s[24:27], s75 offen offset:2048 sc1
    v_mfma_f32_16x16x32_bf16 v[76:79], a[76:79], a[16:19], v[76:79]
    s_bfe_u32 s12, s2, 0x20001
    s_waitcnt lgkmcnt(4)
    v_mfma_f32_16x16x32_bf16 v[80:83], a[64:67], a[24:27], v[80:83]
    ds_read_b64_tr_b16 a[8:9], v4 offset:50176
    s_add_u32 s75, s75, 8192
    v_mfma_f32_16x16x32_bf16 v[80:83], a[80:83], a[28:31], v[80:83]
    s_lshr_b32 s13, s2, 6
    v_mfma_f32_16x16x32_bf16 v[84:87], a[84:87], a[28:31], v[84:87]
    ds_read_b64_tr_b16 a[10:11], v4 offset:50688
    s_mul_i32 s48, s12, 36
    v_mfma_f32_16x16x32_bf16 v[84:87], a[68:71], a[24:27], v[84:87]
    buffer_load_dwordx4 v[200:203], v16, s[24:27], s75 offen offset:0 sc1
    v_mfma_f32_16x16x32_bf16 v[88:91], a[72:75], a[24:27], v[88:91]
    ds_read_b64_tr_b16 a[12:13], v4 offset:58368
    s_add_u32 s48, s48, s3
    v_mfma_f32_16x16x32_bf16 v[88:91], a[88:91], a[28:31], v[88:91]
    buffer_load_dwordx4 v[204:207], v16, s[24:27], s75 offen offset:2048 sc1
    v_mfma_f32_16x16x32_bf16 v[92:95], a[92:95], a[28:31], v[92:95]
    ds_read_b64_tr_b16 a[14:15], v4 offset:58880
    s_mul_i32 s48, s48, 36864
    v_mfma_f32_16x16x32_bf16 v[92:95], a[76:79], a[24:27], v[92:95]
    s_add_u32 s75, s75, 8192
    s_waitcnt lgkmcnt(4)
    v_mfma_f32_16x16x32_bf16 v[96:99], a[64:67], a[0:3], v[96:99]
    ds_read_b64_tr_b16 a[16:17], v5 offset:49152
    s_mul_i32 s62, s13, 288
    v_mfma_f32_16x16x32_bf16 v[96:99], a[80:83], a[4:7], v[96:99]
    buffer_load_dwordx4 v[208:211], v16, s[24:27], s75 offen offset:0 sc1
    s_and_b32 s62, s62, 0xffffffc0
    v_mfma_f32_16x16x32_bf16 v[100:103], a[84:87], a[4:7], v[100:103]
    ds_read_b64_tr_b16 a[18:19], v5 offset:49664
    v_mfma_f32_16x16x32_bf16 v[100:103], a[68:71], a[0:3], v[100:103]
    buffer_load_dwordx4 v[212:215], v16, s[24:27], s75 offen offset:2048 sc1
    s_add_u32 s48, s48, s62
    v_mfma_f32_16x16x32_bf16 v[104:107], a[72:75], a[0:3], v[104:107]
    ds_read_b64_tr_b16 a[20:21], v5 offset:53248
    v_mfma_f32_16x16x32_bf16 v[104:107], a[88:91], a[4:7], v[104:107]
    s_mul_i32 s50, s3, 10240
    v_mfma_f32_16x16x32_bf16 v[108:111], a[92:95], a[4:7], v[108:111]
    ds_read_b64_tr_b16 a[22:23], v5 offset:53760
    s_add_u32 s75, s75, 8192
    v_mfma_f32_16x16x32_bf16 v[108:111], a[76:79], a[0:3], v[108:111]
    s_lshl_b32 s53, s4, 2
    s_waitcnt lgkmcnt(4)
    v_mfma_f32_16x16x32_bf16 v[112:115], a[64:67], a[8:11], v[112:115]
    ds_read_b64_tr_b16 a[24:25], v5 offset:57344
    buffer_load_dwordx4 v[216:219], v16, s[24:27], s75 offen offset:0 sc1
    v_mfma_f32_16x16x32_bf16 v[112:115], a[80:83], a[12:15], v[112:115]
    s_add_u32 s53, s53, s13
    v_mfma_f32_16x16x32_bf16 v[116:119], a[84:87], a[12:15], v[116:119]
    ds_read_b64_tr_b16 a[26:27], v5 offset:57856
    buffer_load_dwordx4 v[220:223], v16, s[24:27], s75 offen offset:2048 sc1
    v_mfma_f32_16x16x32_bf16 v[116:119], a[68:71], a[8:11], v[116:119]
    s_lshl_b32 s53, s53, 2
    v_mfma_f32_16x16x32_bf16 v[120:123], a[72:75], a[8:11], v[120:123]
    ds_read_b64_tr_b16 a[28:29], v5 offset:61440
    s_add_u32 s59, s53, s12
    v_mfma_f32_16x16x32_bf16 v[120:123], a[88:91], a[12:15], v[120:123]
    s_lshl_b32 s75, s17, 15
    s_add_u32 s75, s75, s49
    v_mfma_f32_16x16x32_bf16 v[124:127], a[92:95], a[12:15], v[124:127]
    ds_read_b64_tr_b16 a[30:31], v5 offset:61952
    s_add_u32 s53, s53, s3
    v_mfma_f32_16x16x32_bf16 v[124:127], a[76:79], a[8:11], v[124:127]
    s_waitcnt vmcnt(34)
    s_barrier
    s_waitcnt lgkmcnt(4)
    v_mfma_f32_16x16x32_bf16 v[160:163], a[16:19], a[64:67], v[160:163]
    v_add_u32 v1, 65536, v1
    ds_read_b64_tr_b16 a[0:1], v1 offset:1024
    s_lshl_b32 s53, s53, 2
    v_mfma_f32_16x16x32_bf16 v[160:163], a[20:23], a[80:83], v[160:163]
    buffer_load_dwordx4 v[224:227], v16, s[24:27], s75 offen offset:0 sc1
    v_mfma_f32_16x16x32_bf16 v[164:167], a[20:23], a[84:87], v[164:167]
    ds_read_b64_tr_b16 a[2:3], v1 offset:1536
    s_add_u32 s53, s53, s12
    v_mfma_f32_16x16x32_bf16 v[164:167], a[16:19], a[68:71], v[164:167]
    buffer_load_dwordx4 v[228:231], v16, s[24:27], s75 offen offset:2048 sc1
    s_mul_i32 s53, s53, 9216
    v_mfma_f32_16x16x32_bf16 v[168:171], a[16:19], a[72:75], v[168:171]
    ds_read_b64_tr_b16 a[4:5], v1 offset:9216
    v_mfma_f32_16x16x32_bf16 v[168:171], a[20:23], a[88:91], v[168:171]
    s_add_u32 s75, s75, 8192
    s_add_u32 s53, s53, 30408704
    v_mfma_f32_16x16x32_bf16 v[172:175], a[20:23], a[92:95], v[172:175]
    ds_read_b64_tr_b16 a[6:7], v1 offset:9728
    v_mfma_f32_16x16x32_bf16 v[172:175], a[16:19], a[76:79], v[172:175]
    buffer_load_dwordx4 v[232:235], v16, s[24:27], s75 offen offset:0 sc1
    s_waitcnt lgkmcnt(4)
    v_mfma_f32_16x16x32_bf16 v[176:179], a[24:27], a[64:67], v[176:179]
    v_add_u32 v2, 65536, v2
    ds_read_b64_tr_b16 a[8:9], v2 offset:1024
    s_mul_i32 s59, s59, 36864
    v_mfma_f32_16x16x32_bf16 v[176:179], a[28:31], a[80:83], v[176:179]
    buffer_load_dwordx4 v[236:239], v16, s[24:27], s75 offen offset:2048 sc1
    s_mul_i32 s62, s3, 9216
    v_mfma_f32_16x16x32_bf16 v[180:183], a[28:31], a[84:87], v[180:183]
    ds_read_b64_tr_b16 a[10:11], v2 offset:1536
    v_mfma_f32_16x16x32_bf16 v[180:183], a[24:27], a[68:71], v[180:183]
    v_mfma_f32_16x16x32_bf16 v[184:187], a[24:27], a[72:75], v[184:187]
    ds_read_b64_tr_b16 a[12:13], v2 offset:9216
    v_mfma_f32_16x16x32_bf16 v[184:187], a[28:31], a[88:91], v[184:187]
    v_mfma_f32_16x16x32_bf16 v[188:191], a[28:31], a[92:95], v[188:191]
    ds_read_b64_tr_b16 a[14:15], v2 offset:9728
    v_mfma_f32_16x16x32_bf16 v[188:191], a[24:27], a[76:79], v[188:191]
    s_waitcnt lgkmcnt(4)
    v_mfma_f32_16x16x32_bf16 v[64:67], a[96:99], a[0:3], v[64:67]
    v_add_u32 v3, 65536, v3
    ds_read_b64_tr_b16 a[16:17], v3 offset:1024
    s_add_u32 s59, s59, s62
    v_mfma_f32_16x16x32_bf16 v[64:67], a[112:115], a[4:7], v[64:67]
    s_add_u32 s56, s62, 40960
    s_mul_i32 s51, s16, 147456
    s_add_u32 s51, s51, s48
    v_mfma_f32_16x16x32_bf16 v[68:71], a[116:119], a[4:7], v[68:71]
    ds_read_b64_tr_b16 a[18:19], v3 offset:1536
    s_add_u32 s59, s59, 30408704
    v_mfma_f32_16x16x32_bf16 v[68:71], a[100:103], a[0:3], v[68:71]
    s_mul_i32 s54, s13, 9
    v_mfma_f32_16x16x32_bf16 v[72:75], a[104:107], a[0:3], v[72:75]
    ds_read_b64_tr_b16 a[20:21], v3 offset:9216
    s_mul_i32 s62, s3, 3
    v_mfma_f32_16x16x32_bf16 v[72:75], a[120:123], a[4:7], v[72:75]
    s_add_u32 s54, s54, s62
    s_add_u32 m0, s50, 0
    v_mfma_f32_16x16x32_bf16 v[76:79], a[124:127], a[4:7], v[76:79]
    ds_read_b64_tr_b16 a[22:23], v3 offset:9728
    s_mul_i32 s54, s54, 18432
    v_mfma_f32_16x16x32_bf16 v[76:79], a[108:111], a[0:3], v[76:79]
    s_add_u32 s54, s54, 47185920
    s_waitcnt lgkmcnt(4)
    v_mfma_f32_16x16x32_bf16 v[80:83], a[96:99], a[8:11], v[80:83]
    v_add_u32 v4, 65536, v4
    ds_read_b64_tr_b16 a[24:25], v4 offset:1024
    buffer_load_dwordx4 v6, s[32:35], s51 offen offset:0  lds
    v_mfma_f32_16x16x32_bf16 v[80:83], a[112:115], a[12:15], v[80:83]
    s_cmp_eq_u32 s3, s12
    s_cselect_b32 s53, 1073741824, s53
    s_cselect_b32 s59, 1073741824, s59
    s_cselect_b32 s44, s56, 0x30000
    s_cselect_b32 s56, 0x30000, s56
    v_mfma_f32_16x16x32_bf16 v[84:87], a[116:119], a[12:15], v[84:87]
    ds_read_b64_tr_b16 a[26:27], v4 offset:1536
    buffer_load_dwordx4 v7, s[32:35], s51 offen offset:1024  lds
    v_mfma_f32_16x16x32_bf16 v[84:87], a[100:103], a[8:11], v[84:87]
    v_mfma_f32_16x16x32_bf16 v[88:91], a[104:107], a[8:11], v[88:91]
    ds_read_b64_tr_b16 a[28:29], v4 offset:9216
    buffer_load_dwordx4 v8, s[32:35], s51 offen offset:2048  lds
    v_mfma_f32_16x16x32_bf16 v[88:91], a[120:123], a[12:15], v[88:91]
    s_lshl_b32 s55, s4, 2
    v_mfma_f32_16x16x32_bf16 v[92:95], a[124:127], a[12:15], v[92:95]
    ds_read_b64_tr_b16 a[30:31], v4 offset:9728
    s_and_b32 s62, s12, 2
    v_mfma_f32_16x16x32_bf16 v[92:95], a[108:111], a[8:11], v[92:95]
    s_add_u32 s55, s55, s62
    s_waitcnt lgkmcnt(4)
    v_mfma_f32_16x16x32_bf16 v[96:99], a[96:99], a[16:19], v[96:99]
    v_add_u32 v5, 65536, v5
    ds_read_b64_tr_b16 a[0:1], v5 offset:0
    s_mul_i32 s60, s55, 36864
    v_mfma_f32_16x16x32_bf16 v[96:99], a[112:115], a[20:23], v[96:99]
    s_mul_i32 s62, s13, 288
    buffer_load_dwordx4 v9, s[32:35], s51 offen offset:3072  lds
    v_mfma_f32_16x16x32_bf16 v[100:103], a[116:119], a[20:23], v[100:103]
    ds_read_b64_tr_b16 a[2:3], v5 offset:512
    s_add_u32 s60, s60, s62
    v_mfma_f32_16x16x32_bf16 v[100:103], a[100:103], a[16:19], v[100:103]
    s_mul_i32 s62, s3, 96
    s_add_u32 m0, s50, 4096
    v_mfma_f32_16x16x32_bf16 v[104:107], a[104:107], a[16:19], v[104:107]
    ds_read_b64_tr_b16 a[4:5], v5 offset:4096
    s_add_u32 s60, s60, s62
    v_mfma_f32_16x16x32_bf16 v[104:107], a[120:123], a[20:23], v[104:107]
    buffer_load_dwordx4 v10, s[32:35], s51 offen offset:0  lds
    v_mfma_f32_16x16x32_bf16 v[108:111], a[124:127], a[20:23], v[108:111]
    ds_read_b64_tr_b16 a[6:7], v5 offset:4608
    s_and_b32 s13, s12, 1
    v_mfma_f32_16x16x32_bf16 v[108:111], a[108:111], a[16:19], v[108:111]
    s_mul_i32 s62, s13, 18432
    s_waitcnt lgkmcnt(4)
    v_mfma_f32_16x16x32_bf16 v[112:115], a[96:99], a[24:27], v[112:115]
    ds_read_b64_tr_b16 a[8:9], v5 offset:8192
    s_add_u32 s60, s60, s62
    v_mfma_f32_16x16x32_bf16 v[112:115], a[112:115], a[28:31], v[112:115]
    s_cmp_ge_u32 s3, 3
    s_cselect_b32 s54, 1073741824, s54
    s_cselect_b32 s60, 1073741824, s60
    v_mfma_f32_16x16x32_bf16 v[116:119], a[116:119], a[28:31], v[116:119]
    ds_read_b64_tr_b16 a[10:11], v5 offset:8704
    s_add_u32 s51, s51, 9216
    v_mfma_f32_16x16x32_bf16 v[116:119], a[100:103], a[24:27], v[116:119]
    s_add_u32 m0, s50, 5120
    v_mfma_f32_16x16x32_bf16 v[120:123], a[104:107], a[24:27], v[120:123]
    ds_read_b64_tr_b16 a[12:13], v5 offset:12288
    s_add_u32 s61, s60, 36864
    v_mfma_f32_16x16x32_bf16 v[120:123], a[120:123], a[28:31], v[120:123]
    s_lshr_b32 s57, s55, 3
    buffer_load_dwordx4 v6, s[32:35], s51 offen offset:0  lds
    v_mfma_f32_16x16x32_bf16 v[124:127], a[124:127], a[28:31], v[124:127]
    ds_read_b64_tr_b16 a[14:15], v5 offset:12800
    s_lshl_b32 s57, s57, 16
    v_mfma_f32_16x16x32_bf16 v[124:127], a[108:111], a[24:27], v[124:127]
    s_waitcnt vmcnt(18)
    s_barrier
    v_mov_b32 v29, s7
    v_add_u32 v29, 3, v29
    buffer_store_dword v29, v30, s[24:27], s6 offen sc1
    s_waitcnt lgkmcnt(4)
    v_mfma_f32_16x16x32_bf16 v[160:163], a[0:3], a[96:99], v[160:163]
    ds_read_b64_tr_b16 a[16:17], v1 offset:17408
    s_bfe_u32 s62, s55, 0x20001
    v_mfma_f32_16x16x32_bf16 v[160:163], a[4:7], a[112:115], v[160:163]
    s_lshl_b32 s62, s62, 7
    s_add_u32 s57, s57, s62
    v_mfma_f32_16x16x32_bf16 v[164:167], a[4:7], a[116:119], v[164:167]
    ds_read_b64_tr_b16 a[18:19], v1 offset:17920
    s_add_u32 s57, s57, 54526976
    v_mfma_f32_16x16x32_bf16 v[164:167], a[0:3], a[100:103], v[164:167]
    s_mul_i32 s55, s55, 36864
    buffer_load_dwordx4 v7, s[32:35], s51 offen offset:1024  lds
    v_mfma_f32_16x16x32_bf16 v[168:171], a[0:3], a[104:107], v[168:171]
    ds_read_b64_tr_b16 a[20:21], v1 offset:25600
    s_add_u32 s55, s55, 27262976
    v_mfma_f32_16x16x32_bf16 v[168:171], a[4:7], a[120:123], v[168:171]
    s_lshl_b32 s62, s3, 10
    buffer_load_dwordx4 v8, s[32:35], s51 offen offset:2048  lds
    buffer_load_dwordx4 v9, s[32:35], s51 offen offset:3072  lds
    v_mfma_f32_16x16x32_bf16 v[172:175], a[4:7], a[124:127], v[172:175]
    ds_read_b64_tr_b16 a[22:23], v1 offset:26112
    s_add_u32 s4, s55, s62
    v_mfma_f32_16x16x32_bf16 v[172:175], a[0:3], a[108:111], v[172:175]
    s_lshl_b32 s62, s13, 6
    s_waitcnt lgkmcnt(4)
    v_mfma_f32_16x16x32_bf16 v[176:179], a[8:11], a[96:99], v[176:179]
    ds_read_b64_tr_b16 a[24:25], v2 offset:17408
    s_add_u32 s4, s4, s62
    v_mfma_f32_16x16x32_bf16 v[176:179], a[12:15], a[112:115], v[176:179]
    s_add_u32 s4, s4, 32768
    s_add_u32 m0, s50, 9216
    v_mfma_f32_16x16x32_bf16 v[180:183], a[12:15], a[116:119], v[180:183]
    ds_read_b64_tr_b16 a[26:27], v2 offset:17920
    s_lshl_b32 s62, s3, 13
    v_mfma_f32_16x16x32_bf16 v[180:183], a[8:11], a[100:103], v[180:183]
    buffer_load_dwordx4 v10, s[32:35], s51 offen offset:0  lds
    v_mfma_f32_16x16x32_bf16 v[184:187], a[8:11], a[104:107], v[184:187]
    ds_read_b64_tr_b16 a[28:29], v2 offset:25600
    v_mfma_f32_16x16x32_bf16 v[184:187], a[12:15], a[120:123], v[184:187]
    v_mfma_f32_16x16x32_bf16 v[188:191], a[12:15], a[124:127], v[188:191]
    ds_read_b64_tr_b16 a[30:31], v2 offset:26112
    v_mfma_f32_16x16x32_bf16 v[188:191], a[8:11], a[108:111], v[188:191]
    s_waitcnt lgkmcnt(4)
    v_mfma_f32_16x16x32_bf16 v[64:67], a[128:131], a[16:19], v[64:67]
    ds_read_b64_tr_b16 a[0:1], v3 offset:17408
    s_add_u32 s75, s75, 8192
    v_mfma_f32_16x16x32_bf16 v[64:67], a[144:147], a[20:23], v[64:67]
    s_getpc_b64 s[76:77]
L_rw7:
    s_mov_b32 s78, L_mk_end-L_rw7
    s_mov_b32 s79, 0x00020000
    s_lshr_b32 s73, s2, 3
    s_mul_i32 s73, s73, 1536
    v_lshlrev_b32 v28, 7, v0
    v_cmp_gt_u32 vcc, 1536, v28
    s_nop 1
    v_cndmask_b32 v28, -16, v28, vcc
    buffer_load_dword v12, v28, s[76:79], s73 offen
    v_mfma_f32_16x16x32_bf16 v[68:71], a[148:151], a[20:23], v[68:71]
    ds_read_b64_tr_b16 a[2:3], v3 offset:17920
    buffer_load_dwordx4 v[240:243], v16, s[24:27], s75 offen offset:0 sc1
    v_mfma_f32_16x16x32_bf16 v[68:71], a[132:135], a[16:19], v[68:71]
    v_mfma_f32_16x16x32_bf16 v[72:75], a[136:139], a[16:19], v[72:75]
    ds_read_b64_tr_b16 a[4:5], v3 offset:25600
    buffer_load_dwordx4 v[244:247], v16, s[24:27], s75 offen offset:2048 sc1
    v_mfma_f32_16x16x32_bf16 v[72:75], a[152:155], a[20:23], v[72:75]
    v_mfma_f32_16x16x32_bf16 v[76:79], a[156:159], a[20:23], v[76:79]
    ds_read_b64_tr_b16 a[6:7], v3 offset:26112
    s_add_u32 s75, s75, 8192
    v_mfma_f32_16x16x32_bf16 v[76:79], a[140:143], a[16:19], v[76:79]
    s_waitcnt lgkmcnt(4)
    v_mfma_f32_16x16x32_bf16 v[80:83], a[128:131], a[24:27], v[80:83]
    ds_read_b64_tr_b16 a[8:9], v4 offset:17408
    v_mfma_f32_16x16x32_bf16 v[80:83], a[144:147], a[28:31], v[80:83]
    buffer_load_dwordx4 v[248:251], v16, s[24:27], s75 offen offset:0 sc1
    v_mfma_f32_16x16x32_bf16 v[84:87], a[148:151], a[28:31], v[84:87]
    ds_read_b64_tr_b16 a[10:11], v4 offset:17920
    v_mfma_f32_16x16x32_bf16 v[84:87], a[132:135], a[24:27], v[84:87]
    buffer_load_dwordx4 v[252:255], v16, s[24:27], s75 offen offset:2048 sc1
    v_mfma_f32_16x16x32_bf16 v[88:91], a[136:139], a[24:27], v[88:91]
    ds_read_b64_tr_b16 a[12:13], v4 offset:25600
    v_mfma_f32_16x16x32_bf16 v[88:91], a[152:155], a[28:31], v[88:91]
    s_lshl_b32 s75, s18, 15
    s_add_u32 s75, s75, s49
    v_mfma_f32_16x16x32_bf16 v[92:95], a[156:159], a[28:31], v[92:95]
    ds_read_b64_tr_b16 a[14:15], v4 offset:26112
    v_add_u32 v17, 61440, v11
    v_mfma_f32_16x16x32_bf16 v[92:95], a[140:143], a[24:27], v[92:95]
    v_add_u32 v18, 122880, v11
    s_waitcnt lgkmcnt(4)
    v_mfma_f32_16x16x32_bf16 v[96:99], a[128:131], a[0:3], v[96:99]
    ds_read_b64_tr_b16 a[16:17], v5 offset:16384
    v_mfma_f32_16x16x32_bf16 v[96:99], a[144:147], a[4:7], v[96:99]
    v_add_u32 v21, 61440, v14
    v_mfma_f32_16x16x32_bf16 v[100:103], a[148:151], a[4:7], v[100:103]
    ds_read_b64_tr_b16 a[18:19], v5 offset:16896
    buffer_load_dwordx4 a[64:67], v16, s[24:27], s75 offen offset:0 sc1
    v_mfma_f32_16x16x32_bf16 v[100:103], a[132:135], a[0:3], v[100:103]
    v_add_u32 v19, 122880, v14
    v_mfma_f32_16x16x32_bf16 v[104:107], a[136:139], a[0:3], v[104:107]
    ds_read_b64_tr_b16 a[20:21], v5 offset:20480
    buffer_load_dwordx4 a[68:71], v16, s[24:27], s75 offen offset:2048 sc1
    v_mfma_f32_16x16x32_bf16 v[104:107], a[152:155], a[4:7], v[104:107]
    v_add_u32 v20, 1024, v25
    s_mov_b32 exec_lo, 0
    v_mov_b32 v20, 73728
    s_mov_b32 exec_lo, -1
    v_mfma_f32_16x16x32_bf16 v[108:111], a[156:159], a[4:7], v[108:111]
    ds_read_b64_tr_b16 a[22:23], v5 offset:20992
    v_mfma_f32_16x16x32_bf16 v[108:111], a[140:143], a[0:3], v[108:111]
    s_add_u32 s75, s75, 8192
    s_waitcnt lgkmcnt(4)
    v_mfma_f32_16x16x32_bf16 v[112:115], a[128:131], a[8:11], v[112:115]
    ds_read_b64_tr_b16 a[24:25], v5 offset:24576
    v_mfma_f32_16x16x32_bf16 v[112:115], a[144:147], a[12:15], v[112:115]
    buffer_load_dwordx4 a[72:75], v16, s[24:27], s75 offen offset:0 sc1
    v_mfma_f32_16x16x32_bf16 v[116:119], a[148:151], a[12:15], v[116:119]
    ds_read_b64_tr_b16 a[26:27], v5 offset:25088
    v_mfma_f32_16x16x32_bf16 v[116:119], a[132:135], a[8:11], v[116:119]
    buffer_load_dwordx4 a[76:79], v16, s[24:27], s75 offen offset:2048 sc1
    v_mfma_f32_16x16x32_bf16 v[120:123], a[136:139], a[8:11], v[120:123]
    ds_read_b64_tr_b16 a[28:29], v5 offset:28672
    v_mfma_f32_16x16x32_bf16 v[120:123], a[152:155], a[12:15], v[120:123]
    s_add_u32 s20, s24, 18874368
    s_addc_u32 s21, s25, 0
    v_mfma_f32_16x16x32_bf16 v[124:127], a[156:159], a[12:15], v[124:127]
    ds_read_b64_tr_b16 a[30:31], v5 offset:29184
    s_add_u32 s75, s75, 8192
    v_mfma_f32_16x16x32_bf16 v[124:127], a[140:143], a[8:11], v[124:127]
    s_waitcnt vmcnt(47)
    s_barrier
    s_waitcnt lgkmcnt(4)
    v_mfma_f32_16x16x32_bf16 v[160:163], a[16:19], a[128:131], v[160:163]
    ds_read_b64_tr_b16 a[0:1], v1 offset:33792
    s_mov_b32 s22, 4726784
    v_mfma_f32_16x16x32_bf16 v[160:163], a[20:23], a[144:147], v[160:163]
    s_mov_b32 s23, 0x00020000
    buffer_load_dwordx4 a[80:83], v16, s[24:27], s75 offen offset:0 sc1
    v_mfma_f32_16x16x32_bf16 v[164:167], a[20:23], a[148:151], v[164:167]
    ds_read_b64_tr_b16 a[2:3], v1 offset:34304
    buffer_load_dwordx4 a[84:87], v16, s[24:27], s75 offen offset:2048 sc1
    v_mfma_f32_16x16x32_bf16 v[164:167], a[16:19], a[132:135], v[164:167]
    s_add_u32 s28, s24, 24117248
    s_addc_u32 s29, s25, 0
    v_mfma_f32_16x16x32_bf16 v[168:171], a[16:19], a[136:139], v[168:171]
    ds_read_b64_tr_b16 a[4:5], v1 offset:41984
    v_mfma_f32_16x16x32_bf16 v[168:171], a[20:23], a[152:155], v[168:171]
    s_add_u32 s75, s75, 8192
    v_mfma_f32_16x16x32_bf16 v[172:175], a[20:23], a[156:159], v[172:175]
    ds_read_b64_tr_b16 a[6:7], v1 offset:42496
    v_mfma_f32_16x16x32_bf16 v[172:175], a[16:19], a[140:143], v[172:175]
    s_mov_b32 s30, 2392064
    s_waitcnt lgkmcnt(4)
    v_mfma_f32_16x16x32_bf16 v[176:179], a[24:27], a[128:131], v[176:179]
    ds_read_b64_tr_b16 a[8:9], v2 offset:33792
    buffer_load_dwordx4 a[88:91], v16, s[24:27], s75 offen offset:0 sc1
    v_mfma_f32_16x16x32_bf16 v[176:179], a[28:31], a[144:147], v[176:179]
    s_mov_b32 s31, 0x00020000
    buffer_load_dwordx4 a[92:95], v16, s[24:27], s75 offen offset:2048 sc1
    v_mfma_f32_16x16x32_bf16 v[180:183], a[28:31], a[148:151], v[180:183]
    ds_read_b64_tr_b16 a[10:11], v2 offset:34304
    v_mfma_f32_16x16x32_bf16 v[180:183], a[24:27], a[132:135], v[180:183]
    v_mfma_f32_16x16x32_bf16 v[184:187], a[24:27], a[136:139], v[184:187]
    ds_read_b64_tr_b16 a[12:13], v2 offset:41984
    v_mfma_f32_16x16x32_bf16 v[184:187], a[28:31], a[152:155], v[184:187]
    v_mfma_f32_16x16x32_bf16 v[188:191], a[28:31], a[156:159], v[188:191]
    ds_read_b64_tr_b16 a[14:15], v2 offset:42496
    v_mfma_f32_16x16x32_bf16 v[188:191], a[24:27], a[140:143], v[188:191]
    s_waitcnt lgkmcnt(4)
    v_mfma_f32_16x16x32_bf16 v[64:67], a[160:163], a[0:3], v[64:67]
    ds_read_b64_tr_b16 a[16:17], v3 offset:33792
    s_add_u32 s55, s55, s62
    v_mfma_f32_16x16x32_bf16 v[64:67], a[176:179], a[4:7], v[64:67]
    s_lshl_b32 s62, s13, 8
    v_mfma_f32_16x16x32_bf16 v[68:71], a[180:183], a[4:7], v[68:71]
    ds_read_b64_tr_b16 a[18:19], v3 offset:34304
    v_mfma_f32_16x16x32_bf16 v[68:71], a[164:167], a[0:3], v[68:71]
    s_add_u32 s55, s55, s62
    v_mfma_f32_16x16x32_bf16 v[72:75], a[168:171], a[0:3], v[72:75]
    ds_read_b64_tr_b16 a[20:21], v3 offset:41984
    s_lshl_b32 s80, s3, 1
    v_mfma_f32_16x16x32_bf16 v[72:75], a[184:187], a[4:7], v[72:75]
    s_mul_i32 s51, s17, 147456
    s_add_u32 s51, s51, s48
    v_mfma_f32_16x16x32_bf16 v[76:79], a[188:191], a[4:7], v[76:79]
    ds_read_b64_tr_b16 a[22:23], v3 offset:42496
    s_add_u32 s80, s80, 9
    v_mfma_f32_16x16x32_bf16 v[76:79], a[172:175], a[0:3], v[76:79]
    s_sub_u32 s80, s80, s84
    s_waitcnt lgkmcnt(4)
    v_mfma_f32_16x16x32_bf16 v[80:83], a[160:163], a[8:11], v[80:83]
    ds_read_b64_tr_b16 a[24:25], v4 offset:33792
    s_add_u32 m0, s50, 40960
    v_mfma_f32_16x16x32_bf16 v[80:83], a[176:179], a[12:15], v[80:83]
    s_add_u32 s81, s80, 1
    buffer_load_dwordx4 v6, s[32:35], s51 offen offset:0  lds
    v_mfma_f32_16x16x32_bf16 v[84:87], a[180:183], a[12:15], v[84:87]
    ds_read_b64_tr_b16 a[26:27], v4 offset:34304
    buffer_load_dwordx4 v7, s[32:35], s51 offen offset:1024  lds
    v_mfma_f32_16x16x32_bf16 v[84:87], a[164:167], a[8:11], v[84:87]
    s_sub_u32 s14, 17, s84
    v_mfma_f32_16x16x32_bf16 v[88:91], a[168:171], a[8:11], v[88:91]
    ds_read_b64_tr_b16 a[28:29], v4 offset:41984
    buffer_load_dwordx4 v8, s[32:35], s51 offen offset:2048  lds
    v_mfma_f32_16x16x32_bf16 v[88:91], a[184:187], a[12:15], v[88:91]
    s_sub_u32 s62, s80, 9
    s_cselect_b32 s80, s80, s62
    v_mfma_f32_16x16x32_bf16 v[92:95], a[188:191], a[12:15], v[92:95]
    ds_read_b64_tr_b16 a[30:31], v4 offset:42496
    v_mfma_f32_16x16x32_bf16 v[92:95], a[172:175], a[8:11], v[92:95]
    s_lshl_b32 s80, s80, 12
    s_waitcnt lgkmcnt(4)
    v_mfma_f32_16x16x32_bf16 v[96:99], a[160:163], a[16:19], v[96:99]
    ds_read_b64_tr_b16 a[0:1], v5 offset:32768
    buffer_load_dwordx4 v9, s[32:35], s51 offen offset:3072  lds
    v_mfma_f32_16x16x32_bf16 v[96:99], a[176:179], a[20:23], v[96:99]
    s_sub_u32 s62, s81, 9
    s_cselect_b32 s81, s81, s62
    v_mfma_f32_16x16x32_bf16 v[100:103], a[180:183], a[20:23], v[100:103]
    ds_read_b64_tr_b16 a[2:3], v5 offset:33280
    s_add_u32 m0, s50, 45056
    v_mfma_f32_16x16x32_bf16 v[100:103], a[164:167], a[16:19], v[100:103]
    v_mfma_f32_16x16x32_bf16 v[104:107], a[168:171], a[16:19], v[104:107]
    ds_read_b64_tr_b16 a[4:5], v5 offset:36864
    s_lshl_b32 s81, s81, 12
    v_mfma_f32_16x16x32_bf16 v[104:107], a[184:187], a[20:23], v[104:107]
    buffer_load_dwordx4 v10, s[32:35], s51 offen offset:0  lds
    v_mfma_f32_16x16x32_bf16 v[108:111], a[188:191], a[20:23], v[108:111]
    ds_read_b64_tr_b16 a[6:7], v5 offset:37376
    v_mfma_f32_16x16x32_bf16 v[108:111], a[172:175], a[16:19], v[108:111]
    s_add_u32 s51, s51, 9216
    s_waitcnt lgkmcnt(4)
    v_mfma_f32_16x16x32_bf16 v[112:115], a[160:163], a[24:27], v[112:115]
    ds_read_b64_tr_b16 a[8:9], v5 offset:40960
    v_mfma_f32_16x16x32_bf16 v[112:115], a[176:179], a[28:31], v[112:115]
    s_sub_u32 s62, s14, 9
    s_cselect_b32 s14, s14, s62
    v_mfma_f32_16x16x32_bf16 v[116:119], a[180:183], a[28:31], v[116:119]
    ds_read_b64_tr_b16 a[10:11], v5 offset:41472
    s_lshl_b32 s14, s14, 12
    v_mfma_f32_16x16x32_bf16 v[116:119], a[164:167], a[24:27], v[116:119]
    s_lshr_b32 s62, s3, 1
    s_add_u32 m0, s50, 46080
    v_mfma_f32_16x16x32_bf16 v[120:123], a[168:171], a[24:27], v[120:123]
    ds_read_b64_tr_b16 a[12:13], v5 offset:45056
    s_lshl_b32 s62, s62, 11
    v_mfma_f32_16x16x32_bf16 v[120:123], a[184:187], a[28:31], v[120:123]
    s_add_u32 s14, s14, s62
    buffer_load_dwordx4 v6, s[32:35], s51 offen offset:0  lds
    v_mfma_f32_16x16x32_bf16 v[124:127], a[188:191], a[28:31], v[124:127]
    ds_read_b64_tr_b16 a[14:15], v5 offset:45568
    v_mfma_f32_16x16x32_bf16 v[124:127], a[172:175], a[24:27], v[124:127]
    s_waitcnt vmcnt(50)
    s_barrier
    s_waitcnt lgkmcnt(4)
    v_mfma_f32_16x16x32_bf16 v[160:163], a[0:3], a[160:163], v[160:163]
    ds_read_b64_tr_b16 a[16:17], v1 offset:50176
    s_and_b32 s62, s3, 1
    v_mfma_f32_16x16x32_bf16 v[160:163], a[4:7], a[176:179], v[160:163]
    s_lshl_b32 s62, s62, 9
    buffer_load_dwordx4 v7, s[32:35], s51 offen offset:1024  lds
    v_mfma_f32_16x16x32_bf16 v[164:167], a[4:7], a[180:183], v[164:167]
    ds_read_b64_tr_b16 a[18:19], v1 offset:50688
    s_add_u32 s14, s14, s62
    v_mfma_f32_16x16x32_bf16 v[164:167], a[0:3], a[164:167], v[164:167]
    buffer_load_dwordx4 v8, s[32:35], s51 offen offset:2048  lds
    buffer_load_dword v22, v13, s[24:27], s74 offen sc1
    v_mfma_f32_16x16x32_bf16 v[168:171], a[0:3], a[168:171], v[168:171]
    ds_read_b64_tr_b16 a[20:21], v1 offset:58368
    s_and_b32 s15, s2, 0xf9
    v_mfma_f32_16x16x32_bf16 v[168:171], a[4:7], a[184:187], v[168:171]
    s_lshl_b32 s15, s15, 11
    buffer_load_dwordx4 v9, s[32:35], s51 offen offset:3072  lds
    v_mfma_f32_16x16x32_bf16 v[172:175], a[4:7], a[188:191], v[172:175]
    ds_read_b64_tr_b16 a[22:23], v1 offset:58880
    s_add_u32 m0, s50, 50176
    v_mfma_f32_16x16x32_bf16 v[172:175], a[0:3], a[172:175], v[172:175]
    s_lshl_b32 s62, s12, 7
    s_waitcnt lgkmcnt(4)
    v_mfma_f32_16x16x32_bf16 v[176:179], a[8:11], a[160:163], v[176:179]
    ds_read_b64_tr_b16 a[24:25], v2 offset:50176
    s_add_u32 s15, s15, s62
    v_mfma_f32_16x16x32_bf16 v[176:179], a[12:15], a[176:179], v[176:179]
    buffer_load_dwordx4 v10, s[32:35], s51 offen offset:0  lds
    v_mfma_f32_16x16x32_bf16 v[180:183], a[12:15], a[180:183], v[180:183]
    ds_read_b64_tr_b16 a[26:27], v2 offset:50688
    s_add_u32 s15, s15, 54526464
    v_mfma_f32_16x16x32_bf16 v[180:183], a[8:11], a[164:167], v[180:183]
    v_mfma_f32_16x16x32_bf16 v[184:187], a[8:11], a[168:171], v[184:187]
    ds_read_b64_tr_b16 a[28:29], v2 offset:58368
    v_mfma_f32_16x16x32_bf16 v[184:187], a[12:15], a[184:187], v[184:187]
    v_mfma_f32_16x16x32_bf16 v[188:191], a[12:15], a[188:191], v[188:191]
    ds_read_b64_tr_b16 a[30:31], v2 offset:58880
    v_mfma_f32_16x16x32_bf16 v[188:191], a[8:11], a[172:175], v[188:191]
    s_waitcnt lgkmcnt(4)
    v_mfma_f32_16x16x32_bf16 v[64:67], a[192:195], a[16:19], v[64:67]
    ds_read_b64_tr_b16 a[0:1], v3 offset:50176
    s_and_b32 s93, s2, 7
    v_mfma_f32_16x16x32_bf16 v[64:67], a[208:211], a[20:23], v[64:67]
    s_lshl_b32 s93, s93, 2
    s_lshl_b32 s75, s19, 15
    s_add_u32 s75, s75, s49
    v_mfma_f32_16x16x32_bf16 v[68:71], a[212:215], a[20:23], v[68:71]
    ds_read_b64_tr_b16 a[2:3], v3 offset:50688
    v_mfma_f32_16x16x32_bf16 v[68:71], a[196:199], a[16:19], v[68:71]
    s_bfe_u32 s62, s2, 0x20003
    v_mfma_f32_16x16x32_bf16 v[72:75], a[200:203], a[16:19], v[72:75]
    ds_read_b64_tr_b16 a[4:5], v3 offset:58368
    v_mfma_f32_16x16x32_bf16 v[72:75], a[216:219], a[20:23], v[72:75]
    s_add_u32 s93, s93, s62
    v_mfma_f32_16x16x32_bf16 v[76:79], a[220:223], a[20:23], v[76:79]
    ds_read_b64_tr_b16 a[6:7], v3 offset:58880
    v_mfma_f32_16x16x32_bf16 v[76:79], a[204:207], a[16:19], v[76:79]
    s_lshr_b32 s94, s2, 5
    s_waitcnt lgkmcnt(4)
    v_mfma_f32_16x16x32_bf16 v[80:83], a[192:195], a[24:27], v[80:83]
    ds_read_b64_tr_b16 a[8:9], v4 offset:50176
    buffer_load_dwordx4 a[96:99], v16, s[24:27], s75 offen offset:0 sc1
    v_mfma_f32_16x16x32_bf16 v[80:83], a[208:211], a[28:31], v[80:83]
    s_lshl_b32 s94, s94, 2
    v_mfma_f32_16x16x32_bf16 v[84:87], a[212:215], a[28:31], v[84:87]
    ds_read_b64_tr_b16 a[10:11], v4 offset:50688
    v_mfma_f32_16x16x32_bf16 v[84:87], a[196:199], a[24:27], v[84:87]
    s_add_u32 s94, s94, s3
    v_mfma_f32_16x16x32_bf16 v[88:91], a[200:203], a[24:27], v[88:91]
    ds_read_b64_tr_b16 a[12:13], v4 offset:58368
    v_mfma_f32_16x16x32_bf16 v[88:91], a[216:219], a[28:31], v[88:91]
    s_lshl_b32 s94, s94, 1
    buffer_load_dwordx4 a[100:103], v16, s[24:27], s75 offen offset:2048 sc1
    v_mfma_f32_16x16x32_bf16 v[92:95], a[220:223], a[28:31], v[92:95]
    ds_read_b64_tr_b16 a[14:15], v4 offset:58880
    s_mul_i32 s96, s93, 9
    v_mfma_f32_16x16x32_bf16 v[92:95], a[204:207], a[24:27], v[92:95]
    s_waitcnt lgkmcnt(4)
    v_mfma_f32_16x16x32_bf16 v[96:99], a[192:195], a[0:3], v[96:99]
    ds_read_b64_tr_b16 a[16:17], v5 offset:49152
    s_and_b32 s96, s96, 3
    v_mfma_f32_16x16x32_bf16 v[96:99], a[208:211], a[4:7], v[96:99]
    s_add_u32 s75, s75, 8192
    v_mfma_f32_16x16x32_bf16 v[100:103], a[212:215], a[4:7], v[100:103]
    ds_read_b64_tr_b16 a[18:19], v5 offset:49664
    s_mul_i32 s97, s94, 73856
    v_mfma_f32_16x16x32_bf16 v[100:103], a[196:199], a[0:3], v[100:103]
    v_mfma_f32_16x16x32_bf16 v[104:107], a[200:203], a[0:3], v[104:107]
    ds_read_b64_tr_b16 a[20:21], v5 offset:53248
    s_add_u32 s98, s97, -664704
    v_mfma_f32_16x16x32_bf16 v[104:107], a[216:219], a[4:7], v[104:107]
    v_mfma_f32_16x16x32_bf16 v[108:111], a[220:223], a[4:7], v[108:111]
    ds_read_b64_tr_b16 a[22:23], v5 offset:53760
    s_add_u32 s97, s97, 18837504
    v_mfma_f32_16x16x32_bf16 v[108:111], a[204:207], a[0:3], v[108:111]
    buffer_load_dwordx4 a[104:107], v16, s[24:27], s75 offen offset:0 sc1
    s_waitcnt lgkmcnt(4)
    v_mfma_f32_16x16x32_bf16 v[112:115], a[192:195], a[8:11], v[112:115]
    ds_read_b64_tr_b16 a[24:25], v5 offset:57344
    s_sub_u32 s5, s94, 9
    v_mfma_f32_16x16x32_bf16 v[112:115], a[208:211], a[12:15], v[112:115]
    v_mfma_f32_16x16x32_bf16 v[116:119], a[212:215], a[12:15], v[116:119]
    ds_read_b64_tr_b16 a[26:27], v5 offset:57856
    s_mul_i32 s5, s5, 37376
    v_mfma_f32_16x16x32_bf16 v[116:119], a[196:199], a[8:11], v[116:119]
    buffer_load_dwordx4 a[108:111], v16, s[24:27], s75 offen offset:2048 sc1
    v_mfma_f32_16x16x32_bf16 v[120:123], a[200:203], a[8:11], v[120:123]
    ds_read_b64_tr_b16 a[28:29], v5 offset:61440
    v_mfma_f32_16x16x32_bf16 v[120:123], a[216:219], a[12:15], v[120:123]
    v_mfma_f32_16x16x32_bf16 v[124:127], a[220:223], a[12:15], v[124:127]
    ds_read_b64_tr_b16 a[30:31], v5 offset:61952
    s_add_u32 s75, s75, 8192
    v_mfma_f32_16x16x32_bf16 v[124:127], a[204:207], a[8:11], v[124:127]
    s_add_u32 s82, s7, 3
    s_waitcnt vmcnt(6)
    v_subrev_u32 v22, s82, v22
    v_cmp_lt_u32 vcc, 7, v22
    s_cbranch_vccz L_poll8_ok
    s_mov_b32 s83, 0
L_poll8:
    buffer_load_dword v22, v13, s[24:27], s74 offen sc1
    s_add_u32 s83, s83, 1
    s_waitcnt vmcnt(0)
    v_subrev_u32 v22, s82, v22
    v_cmp_lt_u32 vcc, 7, v22
    s_cbranch_vccz L_poll8_ok
    s_cmp_lt_u32 s83, 0x40000
    s_cbranch_scc1 L_poll8
L_poll8_ok:
    s_waitcnt vmcnt(52)
    s_barrier
    s_waitcnt lgkmcnt(4)
    v_mfma_f32_16x16x32_bf16 v[160:163], a[16:19], a[192:195], v[160:163]
    v_add_u32 v1, 65536, v1
    ds_read_b64_tr_b16 a[0:1], v1 offset:1024
    v_mfma_f32_16x16x32_bf16 v[160:163], a[20:23], a[208:211], v[160:163]
    v_mfma_f32_16x16x32_bf16 v[164:167], a[20:23], a[212:215], v[164:167]
    ds_read_b64_tr_b16 a[2:3], v1 offset:1536
    v_mfma_f32_16x16x32_bf16 v[164:167], a[16:19], a[196:199], v[164:167]
    buffer_load_dwordx4 a[112:115], v16, s[24:27], s75 offen offset:0 sc1
    v_mfma_f32_16x16x32_bf16 v[168:171], a[16:19], a[200:203], v[168:171]
    ds_read_b64_tr_b16 a[4:5], v1 offset:9216
    v_mfma_f32_16x16x32_bf16 v[168:171], a[20:23], a[216:219], v[168:171]
    v_mfma_f32_16x16x32_bf16 v[172:175], a[20:23], a[220:223], v[172:175]
    ds_read_b64_tr_b16 a[6:7], v1 offset:9728
    v_mfma_f32_16x16x32_bf16 v[172:175], a[16:19], a[204:207], v[172:175]
    buffer_load_dwordx4 a[116:119], v16, s[24:27], s75 offen offset:2048 sc1
    s_waitcnt lgkmcnt(4)
    v_mfma_f32_16x16x32_bf16 v[176:179], a[24:27], a[192:195], v[176:179]
    v_add_u32 v2, 65536, v2
    ds_read_b64_tr_b16 a[8:9], v2 offset:1024
    v_mfma_f32_16x16x32_bf16 v[176:179], a[28:31], a[208:211], v[176:179]
    v_mfma_f32_16x16x32_bf16 v[180:183], a[28:31], a[212:215], v[180:183]
    ds_read_b64_tr_b16 a[10:11], v2 offset:1536
    v_mfma_f32_16x16x32_bf16 v[180:183], a[24:27], a[196:199], v[180:183]
    v_mfma_f32_16x16x32_bf16 v[184:187], a[24:27], a[200:203], v[184:187]
    ds_read_b64_tr_b16 a[12:13], v2 offset:9216
    v_mfma_f32_16x16x32_bf16 v[184:187], a[28:31], a[216:219], v[184:187]
    v_mfma_f32_16x16x32_bf16 v[188:191], a[28:31], a[220:223], v[188:191]
    ds_read_b64_tr_b16 a[14:15], v2 offset:9728
    v_mfma_f32_16x16x32_bf16 v[188:191], a[24:27], a[204:207], v[188:191]
    s_waitcnt lgkmcnt(4)
    v_mfma_f32_16x16x32_bf16 v[64:67], a[224:227], a[0:3], v[64:67]
    v_add_u32 v3, 65536, v3
    ds_read_b64_tr_b16 a[16:17], v3 offset:1024
    s_add_u32 s75, s75, 8192
    v_mfma_f32_16x16x32_bf16 v[64:67], a[240:243], a[4:7], v[64:67]
    v_mfma_f32_16x16x32_bf16 v[68:71], a[244:247], a[4:7], v[68:71]
    ds_read_b64_tr_b16 a[18:19], v3 offset:1536
    buffer_load_dwordx4 a[120:123], v16, s[24:27], s75 offen offset:0 sc1
    v_mfma_f32_16x16x32_bf16 v[68:71], a[228:231], a[0:3], v[68:71]
    v_mfma_f32_16x16x32_bf16 v[72:75], a[232:235], a[0:3], v[72:75]
    ds_read_b64_tr_b16 a[20:21], v3 offset:9216
    v_mfma_f32_16x16x32_bf16 v[72:75], a[248:251], a[4:7], v[72:75]
    buffer_load_dwordx4 a[124:127], v16, s[24:27], s75 offen offset:2048 sc1
    v_mfma_f32_16x16x32_bf16 v[76:79], a[252:255], a[4:7], v[76:79]
    ds_read_b64_tr_b16 a[22:23], v3 offset:9728
    v_mfma_f32_16x16x32_bf16 v[76:79], a[236:239], a[0:3], v[76:79]
    s_waitcnt lgkmcnt(4)
    v_mfma_f32_16x16x32_bf16 v[80:83], a[224:227], a[8:11], v[80:83]
    v_add_u32 v4, 65536, v4
    ds_read_b64_tr_b16 a[24:25], v4 offset:1024
    v_mfma_f32_16x16x32_bf16 v[80:83], a[240:243], a[12:15], v[80:83]
    s_lshl_b32 s75, s16, 15
    s_add_u32 s75, s75, s49
    s_add_u32 s75, s75, 131072
    v_mfma_f32_16x16x32_bf16 v[84:87], a[244:247], a[12:15], v[84:87]
    ds_read_b64_tr_b16 a[26:27], v4 offset:1536
    v_mfma_f32_16x16x32_bf16 v[84:87], a[228:231], a[8:11], v[84:87]
    v_mfma_f32_16x16x32_bf16 v[88:91], a[232:235], a[8:11], v[88:91]
    ds_read_b64_tr_b16 a[28:29], v4 offset:9216
    v_mfma_f32_16x16x32_bf16 v[88:91], a[248:251], a[12:15], v[88:91]
    v_mfma_f32_16x16x32_bf16 v[92:95], a[252:255], a[12:15], v[92:95]
    ds_read_b64_tr_b16 a[30:31], v4 offset:9728
    v_mfma_f32_16x16x32_bf16 v[92:95], a[236:239], a[8:11], v[92:95]
    buffer_load_dwordx4 a[128:131], v16, s[24:27], s75 offen offset:0 sc1
    s_waitcnt lgkmcnt(4)
    v_mfma_f32_16x16x32_bf16 v[96:99], a[224:227], a[16:19], v[96:99]
    v_add_u32 v5, 65536, v5
    ds_read_b64_tr_b16 a[0:1], v5 offset:0
    v_mfma_f32_16x16x32_bf16 v[96:99], a[240:243], a[20:23], v[96:99]
    v_mfma_f32_16x16x32_bf16 v[100:103], a[244:247], a[20:23], v[100:103]
    ds_read_b64_tr_b16 a[2:3], v5 offset:512
    buffer_load_dwordx4 a[132:135], v16, s[24:27], s75 offen offset:2048 sc1
    v_mfma_f32_16x16x32_bf16 v[100:103], a[228:231], a[16:19], v[100:103]
    s_mov_b32 s83, s52
    v_cvt_pk_bf16_f32 v32, v64, v65
    v_mfma_f32_16x16x32_bf16 v[104:107], a[232:235], a[16:19], v[104:107]
    ds_read_b64_tr_b16 a[4:5], v5 offset:4096
    v_cvt_pk_bf16_f32 v33, v66, v67
    v_mfma_f32_16x16x32_bf16 v[104:107], a[248:251], a[20:23], v[104:107]
    v_cvt_pk_bf16_f32 v34, v80, v81
    s_add_u32 s75, s75, 8192
    v_mfma_f32_16x16x32_bf16 v[108:111], a[252:255], a[20:23], v[108:111]
    ds_read_b64_tr_b16 a[6:7], v5 offset:4608
    v_cvt_pk_bf16_f32 v35, v82, v83
    v_mfma_f32_16x16x32_bf16 v[108:111], a[236:239], a[16:19], v[108:111]
    v_cvt_pk_bf16_f32 v36, v68, v69
    s_waitcnt lgkmcnt(4)
    v_mfma_f32_16x16x32_bf16 v[112:115], a[224:227], a[24:27], v[112:115]
    ds_read_b64_tr_b16 a[8:9], v5 offset:8192
    v_cvt_pk_bf16_f32 v37, v70, v71
    v_mfma_f32_16x16x32_bf16 v[112:115], a[240:243], a[28:31], v[112:115]
    v_cvt_pk_bf16_f32 v38, v84, v85
    v_cvt_pk_bf16_f32 v39, v86, v87
    v_mfma_f32_16x16x32_bf16 v[116:119], a[244:247], a[28:31], v[116:119]
    ds_read_b64_tr_b16 a[10:11], v5 offset:8704
    v_permlane32_swap_b32 v32, v34
    v_mfma_f32_16x16x32_bf16 v[116:119], a[228:231], a[24:27], v[116:119]
    v_permlane32_swap_b32 v33, v35
    buffer_load_dwordx4 a[136:139], v16, s[24:27], s75 offen offset:0 sc1
    buffer_load_dwordx4 a[140:143], v16, s[24:27], s75 offen offset:2048 sc1
    v_mfma_f32_16x16x32_bf16 v[120:123], a[232:235], a[24:27], v[120:123]
    ds_read_b64_tr_b16 a[12:13], v5 offset:12288
    v_permlane32_swap_b32 v36, v38
    v_mfma_f32_16x16x32_bf16 v[120:123], a[248:251], a[28:31], v[120:123]
    v_permlane32_swap_b32 v37, v39
    v_cvt_pk_bf16_f32 v40, v72, v73
    v_mfma_f32_16x16x32_bf16 v[124:127], a[252:255], a[28:31], v[124:127]
    ds_read_b64_tr_b16 a[14:15], v5 offset:12800
    v_cvt_pk_bf16_f32 v41, v74, v75
    v_mfma_f32_16x16x32_bf16 v[124:127], a[236:239], a[24:27], v[124:127]
    v_cvt_pk_bf16_f32 v42, v88, v89
    s_waitcnt lgkmcnt(4)
    v_mfma_f32_16x16x32_bf16 v[160:163], a[0:3], a[224:227], v[160:163]
    v_cvt_pk_bf16_f32 v43, v90, v91
    v_mfma_f32_16x16x32_bf16 v[160:163], a[4:7], a[240:243], v[160:163]
    v_cvt_pk_bf16_f32 v44, v76, v77
    s_add_u32 s75, s75, 8192
    buffer_load_dwordx4 a[144:147], v16, s[24:27], s75 offen offset:0 sc1
    v_mfma_f32_16x16x32_bf16 v[164:167], a[4:7], a[244:247], v[164:167]
    v_cvt_pk_bf16_f32 v45, v78, v79
    v_mfma_f32_16x16x32_bf16 v[164:167], a[0:3], a[228:231], v[164:167]
    v_cvt_pk_bf16_f32 v46, v92, v93
    v_cvt_pk_bf16_f32 v47, v94, v95
    v_mfma_f32_16x16x32_bf16 v[168:171], a[0:3], a[232:235], v[168:171]
    v_permlane32_swap_b32 v40, v42
    v_mfma_f32_16x16x32_bf16 v[168:171], a[4:7], a[248:251], v[168:171]
    v_permlane32_swap_b32 v41, v43
    buffer_load_dwordx4 a[148:151], v16, s[24:27], s75 offen offset:2048 sc1
    s_add_u32 s75, s75, 8192
    v_mfma_f32_16x16x32_bf16 v[172:175], a[4:7], a[252:255], v[172:175]
    v_permlane32_swap_b32 v44, v46
    buffer_load_dwordx4 a[152:155], v16, s[24:27], s75 offen offset:0 sc1
    v_mfma_f32_16x16x32_bf16 v[172:175], a[0:3], a[236:239], v[172:175]
    v_permlane32_swap_b32 v45, v47
    s_waitcnt lgkmcnt(0)
    v_mfma_f32_16x16x32_bf16 v[176:179], a[8:11], a[224:227], v[176:179]
    v_cvt_pk_bf16_f32 v48, v96, v97
    v_mfma_f32_16x16x32_bf16 v[176:179], a[12:15], a[240:243], v[176:179]
    v_cvt_pk_bf16_f32 v49, v98, v99
    v_cvt_pk_bf16_f32 v50, v112, v113
    buffer_load_dwordx4 a[156:159], v16, s[24:27], s75 offen offset:2048 sc1
    v_mfma_f32_16x16x32_bf16 v[180:183], a[12:15], a[244:247], v[180:183]
    v_cvt_pk_bf16_f32 v51, v114, v115
    v_mfma_f32_16x16x32_bf16 v[180:183], a[8:11], a[228:231], v[180:183]
    v_cvt_pk_bf16_f32 v52, v100, v101
    v_cvt_pk_bf16_f32 v53, v102, v103
    v_mfma_f32_16x16x32_bf16 v[184:187], a[8:11], a[232:235], v[184:187]
    v_cvt_pk_bf16_f32 v54, v116, v117
    v_mfma_f32_16x16x32_bf16 v[184:187], a[12:15], a[248:251], v[184:187]
    v_cvt_pk_bf16_f32 v55, v118, v119
    v_permlane32_swap_b32 v48, v50
    v_mfma_f32_16x16x32_bf16 v[188:191], a[12:15], a[252:255], v[188:191]
    v_permlane32_swap_b32 v49, v51
    v_mfma_f32_16x16x32_bf16 v[188:191], a[8:11], a[236:239], v[188:191]
    v_permlane32_swap_b32 v52, v54
    v_permlane32_swap_b32 v53, v55
    v_cvt_pk_bf16_f32 v56, v104, v105
    v_cvt_pk_bf16_f32 v57, v106, v107
    v_cvt_pk_bf16_f32 v58, v120, v121
    v_cvt_pk_bf16_f32 v59, v122, v123
    v_cvt_pk_bf16_f32 v60, v108, v109
    v_cvt_pk_bf16_f32 v61, v110, v111
    v_cvt_pk_bf16_f32 v62, v124, v125
    v_cvt_pk_bf16_f32 v63, v126, v127
    v_permlane32_swap_b32 v56, v58
    v_permlane32_swap_b32 v57, v59
    v_permlane32_swap_b32 v60, v62
    v_permlane32_swap_b32 v61, v63
    s_branch L_mk_m
L_mk_n:
    v_mul_f32 v144, v128, v144
    v_mul_f32 v145, v129, v145
    v_mul_f32 v146, v130, v146
    v_mul_f32 v147, v131, v147
    v_cvt_pk_bf16_f32 v48, v144, v145
    v_cvt_pk_bf16_f32 v49, v146, v147
    v_mul_f32 v148, v132, v148
    v_mul_f32 v149, v133, v149
    v_mul_f32 v150, v134, v150
    v_mul_f32 v151, v135, v151
    v_cvt_pk_bf16_f32 v52, v148, v149
    v_cvt_pk_bf16_f32 v53, v150, v151
    v_mul_f32 v152, v136, v152
    v_mul_f32 v153, v137, v153
    v_mul_f32 v154, v138, v154
    v_mul_f32 v155, v139, v155
    v_cvt_pk_bf16_f32 v56, v152, v153
    v_cvt_pk_bf16_f32 v57, v154, v155
    v_mul_f32 v156, v140, v156
    v_mul_f32 v157, v141, v157
    v_mul_f32 v158, v142, v158
    v_mul_f32 v159, v143, v159
    v_cvt_pk_bf16_f32 v60, v156, v157
    v_cvt_pk_bf16_f32 v61, v158, v159
    v_mul_f32 v176, v160, v176
    v_mul_f32 v177, v161, v177
    v_mul_f32 v178, v162, v178
    v_mul_f32 v179, v163, v179
    v_cvt_pk_bf16_f32 v50, v176, v177
    v_cvt_pk_bf16_f32 v51, v178, v179
    v_mul_f32 v180, v164, v180
    v_mul_f32 v181, v165, v181
    v_mul_f32 v182, v166, v182
    v_mul_f32 v183, v167, v183
    v_cvt_pk_bf16_f32 v54, v180, v181
    v_cvt_pk_bf16_f32 v55, v182, v183
    v_permlane32_swap_b32 v48, v50
    v_permlane32_swap_b32 v49, v51
    v_mul_f32 v184, v168, v184
    v_mul_f32 v185, v169, v185
    v_mul_f32 v186, v170, v186
    v_mul_f32 v187, v171, v187
    v_cvt_pk_bf16_f32 v58, v184, v185
    v_cvt_pk_bf16_f32 v59, v186, v187
    v_permlane32_swap_b32 v52, v54
    v_permlane32_swap_b32 v53, v55
    v_mul_f32 v188, v172, v188
    v_mul_f32 v189, v173, v189
    v_mul_f32 v190, v174, v190
    v_mul_f32 v191, v175, v191
    v_cvt_pk_bf16_f32 v62, v188, v189
    v_cvt_pk_bf16_f32 v63, v190, v191
    v_permlane32_swap_b32 v56, v58
    v_permlane32_swap_b32 v57, v59
    s_nop 0
    v_permlane32_swap_b32 v60, v62
    v_permlane32_swap_b32 v61, v63
    s_sub_u32 s93, s5, 27
    s_lshl_b32 s93, s93, 3
    s_add_u32 s93, s93, s4
    s_lshl_b32 s93, s93, 2
    s_add_u32 s93, s93, s3
    s_add_u32 s93, s93, 0
    s_mul_i32 s94, s93, 7282
    s_lshr_b32 s94, s94, 16
    s_mul_i32 s95, s94, 9
    s_sub_u32 s95, s93, s95
    v_bfe_u32 v64, v0, 3, 3
    v_lshrrev_b32 v65, 1, v64
    v_mul_u32_u24 v65, 18, v65
    v_and_b32 v66, 1, v64
    v_add_u32 v65, v65, v66
    s_cmp_ge_u32 s94, 16
    s_cselect_b64 vcc, -1, 0
    v_and_b32 v66, 2, v64
    v_cndmask_b32 v65, v64, v65, vcc
    v_mul_u32_u24 v65, 1152, v65
    v_and_b32 v67, 7, v0
    v_xor_b32 v66, v66, v67
    v_lshlrev_b32 v66, 4, v66
    v_add_u32 v64, v65, v66
    v_xor_b32 v66, 64, v66
    v_add_u32 v65, v65, v66
    s_mul_i32 s96, s94, 41472
    s_mul_i32 s97, s94, 331776
    s_sub_u32 s97, s97, 5289984
    s_cmp_ge_u32 s94, 16
    s_cselect_b32 s96, s97, s96
    s_lshl_b32 s97, s95, 7
    s_add_u32 s96, s96, s97
    s_cmp_ge_u32 s94, 16
    s_mov_b32 s97, 0
    s_cselect_b32 s97, 0, s97
    s_add_u32 s97, s97, s96
    s_add_u32 m0, s46, 147456
    s_nop 0
    buffer_load_dwordx4 v64, s[28:31], s97 offen lds
    s_cmp_ge_u32 s94, 16
    s_mov_b32 s97, 9216
    s_cselect_b32 s97, 82944, s97
    s_add_u32 s97, s97, s96
    s_add_u32 m0, s46, 148480
    s_nop 0
    buffer_load_dwordx4 v65, s[28:31], s97 offen lds
    s_cmp_ge_u32 s94, 16
    s_mov_b32 s97, 20736
    s_cselect_b32 s97, 165888, s97
    s_add_u32 s97, s97, s96
    s_add_u32 m0, s46, 149504
    s_nop 0
    buffer_load_dwordx4 v64, s[28:31], s97 offen lds
    s_cmp_ge_u32 s94, 16
    s_mov_b32 s97, 29952
    s_cselect_b32 s97, 248832, s97
    s_add_u32 s97, s97, s96
    s_add_u32 m0, s46, 150528
    s_nop 0
    buffer_load_dwordx4 v65, s[28:31], s97 offen lds
    s_waitcnt vmcnt(20)
    s_barrier
    ds_read_b64_tr_b16 a[0:1], v5 offset:0
    ds_read_b64_tr_b16 a[2:3], v5 offset:512
    ds_read_b64_tr_b16 a[4:5], v5 offset:4096
    ds_read_b64_tr_b16 a[6:7], v5 offset:4608
    ds_read_b64_tr_b16 a[8:9], v5 offset:8192
    ds_read_b64_tr_b16 a[10:11], v5 offset:8704
    ds_read_b64_tr_b16 a[12:13], v5 offset:12288
    ds_read_b64_tr_b16 a[14:15], v5 offset:12800
    s_waitcnt lgkmcnt(4)
    v_mfma_f32_16x16x32_bf16 v[160:163], a[0:3], v[192:195], 0
    ds_read_b64_tr_b16 a[16:17], v5 offset:16384
    v_mfma_f32_16x16x32_bf16 v[160:163], a[4:7], v[208:211], v[160:163]
    s_mul_i32 s56, s90, 589824
    s_add_u32 s56, s56, s53
    s_add_u32 m0, s46, 98304
    v_mfma_f32_16x16x32_bf16 v[164:167], a[4:7], v[212:215], 0
    ds_read_b64_tr_b16 a[18:19], v5 offset:16896
    v_mfma_f32_16x16x32_bf16 v[164:167], a[0:3], v[196:199], v[164:167]
    s_add_u32 s47, s58, 131072
    buffer_store_dwordx4 v[32:35], v16, s[24:27], s47 offen offset:0 sc1
    v_mfma_f32_16x16x32_bf16 v[168:171], a[0:3], v[200:203], 0
    ds_read_b64_tr_b16 a[20:21], v5 offset:20480
    buffer_load_dwordx4 v21, s[64:67], s56 offen  lds
    v_and_b32 v28, 31, v0
    v_lshlrev_b32 v28, 7, v28
    v_bfe_u32 v29, v0, 5, 1
    v_lshl_add_u32 v28, v29, 13, v28
    v_and_b32 v29, 63, v0
    v_subrev_u32 v29, 24, v29
    v_cmp_gt_u32 vcc, 8, v29
    s_nop 1
    v_cndmask_b32 v28, -16, v28, vcc
    buffer_load_dword v12, v28, s[24:27], s58 offen sc1
    v_mfma_f32_16x16x32_bf16 v[168:171], a[4:7], v[216:219], v[168:171]
    s_mul_i32 s57, s90, 221184
    s_add_u32 s57, s57, s54
    s_add_u32 m0, s46, 99328
    v_mfma_f32_16x16x32_bf16 v[172:175], a[4:7], v[220:223], 0
    ds_read_b64_tr_b16 a[22:23], v5 offset:20992
    s_add_u32 s47, s58, 131072
    buffer_store_dwordx4 v[36:39], v16, s[24:27], s47 offen offset:1024 sc1
    v_mfma_f32_16x16x32_bf16 v[172:175], a[0:3], v[204:207], v[172:175]
    s_waitcnt lgkmcnt(4)
    v_mfma_f32_16x16x32_bf16 v[176:179], a[8:11], v[192:195], 0
    ds_read_b64_tr_b16 a[24:25], v5 offset:24576
    v_mfma_f32_16x16x32_bf16 v[176:179], a[12:15], v[208:211], v[176:179]
    buffer_load_dwordx4 v19, s[20:23], s57 offen  lds
    v_mfma_f32_16x16x32_bf16 v[180:183], a[12:15], v[212:215], 0
    ds_read_b64_tr_b16 a[26:27], v5 offset:25088
    v_mfma_f32_16x16x32_bf16 v[180:183], a[8:11], v[196:199], v[180:183]
    s_add_u32 m0, s46, 100352
    v_mfma_f32_16x16x32_bf16 v[184:187], a[8:11], v[200:203], 0
    ds_read_b64_tr_b16 a[28:29], v5 offset:28672
    buffer_load_dwordx4 v20, s[20:23], s57 offen  lds
    v_and_b32 v28, 31, v0
    v_lshlrev_b32 v28, 7, v28
    v_bfe_u32 v29, v0, 5, 1
    v_lshl_add_u32 v28, v29, 13, v28
    v_and_b32 v29, 63, v0
    v_subrev_u32 v29, 32, v29
    v_cmp_gt_u32 vcc, 8, v29
    s_nop 1
    v_cndmask_b32 v28, -16, v28, vcc
    buffer_load_dword v12, v28, s[24:27], s58 offen sc1
    v_mfma_f32_16x16x32_bf16 v[184:187], a[12:15], v[216:219], v[184:187]
    s_add_u32 s47, s58, 131072
    buffer_store_dwordx4 v[40:43], v16, s[24:27], s47 offen offset:2048 sc1
    v_mfma_f32_16x16x32_bf16 v[188:191], a[12:15], v[220:223], 0
    ds_read_b64_tr_b16 a[30:31], v5 offset:29184
    v_mfma_f32_16x16x32_bf16 v[188:191], a[8:11], v[204:207], v[188:191]
    s_waitcnt vmcnt(25)
    s_barrier
    s_waitcnt lgkmcnt(4)
    v_mfma_f32_16x16x32_bf16 v[160:163], a[16:19], v[224:227], v[160:163]
    ds_read_b64_tr_b16 a[0:1], v5 offset:32768
    s_add_u32 s82, s7, 2
    s_waitcnt vmcnt(20)
    v_subrev_u32 v22, s82, v22
    v_cmp_lt_u32 vcc, 7, v22
    s_cbranch_vccz L_poll9_ok
    s_mov_b32 s83, 0
L_poll9:
    buffer_load_dword v22, v13, s[24:27], s74 offen sc1
    s_add_u32 s83, s83, 1
    s_waitcnt vmcnt(0)
    v_subrev_u32 v22, s82, v22
    v_cmp_lt_u32 vcc, 7, v22
    s_cbranch_vccz L_poll9_ok
    s_cmp_lt_u32 s83, 0x40000
    s_cbranch_scc1 L_poll9
L_poll9_ok:
    v_mfma_f32_16x16x32_bf16 v[160:163], a[20:23], v[240:243], v[160:163]
    s_mul_i32 s63, s4, 32768
    s_bfe_u32 s82, s2, 0x20001
    s_mul_i32 s82, s82, 1327104
    s_add_u32 s63, s63, s82
    s_add_u32 s63, s63, 1064960
    s_cmp_eq_u32 s5, 27
    s_cselect_b32 s63, 1073741824, s63
    v_mfma_f32_16x16x32_bf16 v[164:167], a[20:23], v[244:247], v[164:167]
    ds_read_b64_tr_b16 a[2:3], v5 offset:33280
    s_add_u32 s47, s58, 131072
    buffer_store_dwordx4 v[44:47], v16, s[24:27], s47 offen offset:3072 sc1
    v_mfma_f32_16x16x32_bf16 v[164:167], a[16:19], v[228:231], v[164:167]
    s_mul_i32 s56, s91, 589824
    s_add_u32 s56, s56, s53
    s_add_u32 m0, s46, 114688
    v_mfma_f32_16x16x32_bf16 v[168:171], a[16:19], v[232:235], v[168:171]
    ds_read_b64_tr_b16 a[4:5], v5 offset:36864
    buffer_load_dwordx4 v21, s[64:67], s56 offen  lds
    v_and_b32 v28, 31, v0
    v_lshlrev_b32 v28, 7, v28
    v_bfe_u32 v29, v0, 5, 1
    v_lshl_add_u32 v28, v29, 13, v28
    v_and_b32 v29, 63, v0
    v_subrev_u32 v29, 40, v29
    v_cmp_gt_u32 vcc, 8, v29
    s_nop 1
    v_cndmask_b32 v28, -16, v28, vcc
    buffer_load_dword v12, v28, s[24:27], s58 offen sc1
    v_mfma_f32_16x16x32_bf16 v[168:171], a[20:23], v[248:251], v[168:171]
    s_mul_i32 s57, s91, 221184
    s_add_u32 s57, s57, s54
    s_add_u32 m0, s46, 115712
    v_mfma_f32_16x16x32_bf16 v[172:175], a[20:23], v[252:255], v[172:175]
    ds_read_b64_tr_b16 a[6:7], v5 offset:37376
    v_mfma_f32_16x16x32_bf16 v[172:175], a[16:19], v[236:239], v[172:175]
    s_waitcnt lgkmcnt(4)
    v_mfma_f32_16x16x32_bf16 v[176:179], a[24:27], v[224:227], v[176:179]
    ds_read_b64_tr_b16 a[8:9], v5 offset:40960
    v_mfma_f32_16x16x32_bf16 v[176:179], a[28:31], v[240:243], v[176:179]
    buffer_load_dwordx4 v19, s[20:23], s57 offen  lds
    v_mfma_f32_16x16x32_bf16 v[180:183], a[28:31], v[244:247], v[180:183]
    ds_read_b64_tr_b16 a[10:11], v5 offset:41472
    v_mfma_f32_16x16x32_bf16 v[180:183], a[24:27], v[228:231], v[180:183]
    s_add_u32 m0, s46, 116736
    v_mfma_f32_16x16x32_bf16 v[184:187], a[24:27], v[232:235], v[184:187]
    ds_read_b64_tr_b16 a[12:13], v5 offset:45056
    buffer_load_dwordx4 v20, s[20:23], s57 offen  lds
    v_and_b32 v28, 31, v0
    v_lshlrev_b32 v28, 7, v28
    v_bfe_u32 v29, v0, 5, 1
    v_lshl_add_u32 v28, v29, 13, v28
    v_and_b32 v29, 63, v0
    v_subrev_u32 v29, 48, v29
    v_cmp_gt_u32 vcc, 8, v29
    s_nop 1
    v_cndmask_b32 v28, -16, v28, vcc
    buffer_load_dword v12, v28, s[24:27], s58 offen sc1
    v_mfma_f32_16x16x32_bf16 v[184:187], a[28:31], v[248:251], v[184:187]
    s_add_u32 s47, s58, 139264
    buffer_store_dwordx4 v[48:51], v16, s[24:27], s47 offen offset:0 sc1
    v_mfma_f32_16x16x32_bf16 v[188:191], a[28:31], v[252:255], v[188:191]
    ds_read_b64_tr_b16 a[14:15], v5 offset:45568
    v_mfma_f32_16x16x32_bf16 v[188:191], a[24:27], v[236:239], v[188:191]
    s_waitcnt vmcnt(28)
    s_barrier
    s_waitcnt lgkmcnt(4)
    v_mfma_f32_16x16x32_bf16 v[160:163], a[0:3], a[32:35], v[160:163]
    ds_read_b64_tr_b16 a[16:17], v5 offset:49152
    v_mfma_f32_16x16x32_bf16 v[160:163], a[4:7], a[48:51], v[160:163]
    s_mul_i32 s56, s92, 589824
    s_add_u32 s56, s56, s53
    s_add_u32 m0, s46, 131072
    v_mfma_f32_16x16x32_bf16 v[164:167], a[4:7], a[52:55], v[164:167]
    ds_read_b64_tr_b16 a[18:19], v5 offset:49664
    buffer_load_dwordx4 v21, s[64:67], s56 offen  lds
    v_mfma_f32_16x16x32_bf16 v[164:167], a[0:3], a[36:39], v[164:167]
    s_mul_i32 s57, s92, 221184
    s_add_u32 s57, s57, s54
    s_add_u32 m0, s46, 132096
    v_mfma_f32_16x16x32_bf16 v[168:171], a[0:3], a[40:43], v[168:171]
    ds_read_b64_tr_b16 a[20:21], v5 offset:53248
    v_and_b32 v28, 31, v0
    v_lshlrev_b32 v28, 7, v28
    v_bfe_u32 v29, v0, 5, 1
    v_lshl_add_u32 v28, v29, 13, v28
    v_and_b32 v29, 63, v0
    v_subrev_u32 v29, 56, v29
    v_cmp_gt_u32 vcc, 8, v29
    s_nop 1
    v_cndmask_b32 v28, -16, v28, vcc
    buffer_load_dword v12, v28, s[24:27], s58 offen sc1
    v_mfma_f32_16x16x32_bf16 v[168:171], a[4:7], a[56:59], v[168:171]
    s_add_u32 s47, s58, 139264
    buffer_store_dwordx4 v[52:55], v16, s[24:27], s47 offen offset:1024 sc1
    v_mfma_f32_16x16x32_bf16 v[172:175], a[4:7], a[60:63], v[172:175]
    ds_read_b64_tr_b16 a[22:23], v5 offset:53760
    buffer_load_dwordx4 v19, s[20:23], s57 offen  lds
    v_mfma_f32_16x16x32_bf16 v[172:175], a[0:3], a[44:47], v[172:175]
    s_add_u32 m0, s46, 133120
    s_waitcnt lgkmcnt(4)
    v_mfma_f32_16x16x32_bf16 v[176:179], a[8:11], a[32:35], v[176:179]
    ds_read_b64_tr_b16 a[24:25], v5 offset:57344
    buffer_load_dwordx4 v20, s[20:23], s57 offen  lds
    v_mfma_f32_16x16x32_bf16 v[176:179], a[12:15], a[48:51], v[176:179]
    s_add_u32 s47, s58, 139264
    buffer_store_dwordx4 v[56:59], v16, s[24:27], s47 offen offset:2048 sc1
    v_mfma_f32_16x16x32_bf16 v[180:183], a[12:15], a[52:55], v[180:183]
    ds_read_b64_tr_b16 a[26:27], v5 offset:57856
    v_mfma_f32_16x16x32_bf16 v[180:183], a[8:11], a[36:39], v[180:183]
    s_add_u32 s47, s58, 139264
    buffer_store_dwordx4 v[60:63], v16, s[24:27], s47 offen offset:3072 sc1
    v_mfma_f32_16x16x32_bf16 v[184:187], a[8:11], a[40:43], v[184:187]
    ds_read_b64_tr_b16 a[28:29], v5 offset:61440
    v_mfma_f32_16x16x32_bf16 v[184:187], a[12:15], a[56:59], v[184:187]
    v_mfma_f32_16x16x32_bf16 v[188:191], a[12:15], a[60:63], v[188:191]
    ds_read_b64_tr_b16 a[30:31], v5 offset:61952
    v_mfma_f32_16x16x32_bf16 v[188:191], a[8:11], a[44:47], v[188:191]
    s_waitcnt vmcnt(30)
    s_barrier
    v_bfe_u32 v64, v0, 4, 1
    v_mul_u32_u24 v64, 1088, v64
    v_bfe_u32 v65, v0, 2, 2
    v_lshl_add_u32 v64, v65, 7, v64
    v_lshrrev_b32 v65, 1, v65
    v_lshl_add_u32 v64, v65, 5, v64
    v_and_b32 v65, 3, v0
    v_lshl_add_u32 v64, v65, 3, v64
    v_bfe_u32 v65, v0, 5, 3
    v_lshl_add_u32 v64, v65, 11, v64
    v_add_u32 v64, 147456, v64
    v_xor_b32 v65, 32, v64
    v_xor_b32 v66, 64, v64
    v_xor_b32 v67, 96, v64
    s_waitcnt vmcnt(22)
    ds_read_b64_tr_b16 v[68:69], v64 offset:0
    ds_read_b64_tr_b16 v[70:71], v64 offset:512
    ds_read_b64_tr_b16 v[72:73], v65 offset:0
    ds_read_b64_tr_b16 v[74:75], v65 offset:512
    ds_read_b64_tr_b16 v[76:77], v66 offset:0
    ds_read_b64_tr_b16 v[78:79], v66 offset:512
    ds_read_b64_tr_b16 v[80:81], v67 offset:0
    ds_read_b64_tr_b16 v[82:83], v67 offset:512
    s_mul_i32 s94, s94, 3
    s_waitcnt lgkmcnt(0)
    s_lshl_b32 s96, s95, 2
    s_add_u32 s96, s96, 0
    s_mul_i32 s97, s96, 43
    s_lshr_b32 s97, s97, 7
    s_mul_i32 s97, s97, 51
    s_add_u32 s96, s96, s97
    s_add_u32 s96, s96, s94
    s_lshl_b32 s96, s96, 10
    s_add_u32 s96, s96, 47185920
    buffer_store_dwordx4 v[68:71], v16, s[24:27], s96 offen sc1
    s_lshl_b32 s96, s95, 2
    s_add_u32 s96, s96, 1
    s_mul_i32 s97, s96, 43
    s_lshr_b32 s97, s97, 7
    s_mul_i32 s97, s97, 51
    s_add_u32 s96, s96, s97
    s_add_u32 s96, s96, s94
    s_lshl_b32 s96, s96, 10
    s_add_u32 s96, s96, 47185920
    buffer_store_dwordx4 v[72:75], v16, s[24:27], s96 offen sc1
    s_lshl_b32 s96, s95, 2
    s_add_u32 s96, s96, 2
    s_mul_i32 s97, s96, 43
    s_lshr_b32 s97, s97, 7
    s_mul_i32 s97, s97, 51
    s_add_u32 s96, s96, s97
    s_add_u32 s96, s96, s94
    s_lshl_b32 s96, s96, 10
    s_add_u32 s96, s96, 47185920
    buffer_store_dwordx4 v[76:79], v16, s[24:27], s96 offen sc1
    s_lshl_b32 s96, s95, 2
    s_add_u32 s96, s96, 3
    s_mul_i32 s97, s96, 43
    s_lshr_b32 s97, s97, 7
    s_mul_i32 s97, s97, 51
    s_add_u32 s96, s96, s97
    s_add_u32 s96, s96, s94
    s_lshl_b32 s96, s96, 10
    s_add_u32 s96, s96, 47185920
    buffer_store_dwordx4 v[80:83], v16, s[24:27], s96 offen sc1
    s_cmp_ge_u32 s93, 2
    s_cbranch_scc1 L_nx
    s_sub_u32 s93, s5, 27
    s_lshl_b32 s93, s93, 3
    s_add_u32 s93, s93, s4
    s_lshl_b32 s93, s93, 2
    s_add_u32 s93, s93, s3
    s_add_u32 s93, s93, 160
    s_mul_i32 s94, s93, 7282
    s_lshr_b32 s94, s94, 16
    s_mul_i32 s95, s94, 9
    s_sub_u32 s95, s93, s95
    v_bfe_u32 v64, v0, 3, 3
    v_lshrrev_b32 v65, 1, v64
    v_mul_u32_u24 v65, 18, v65
    v_and_b32 v66, 1, v64
    v_add_u32 v65, v65, v66
    s_cmp_ge_u32 s94, 16
    s_cselect_b64 vcc, -1, 0
    v_and_b32 v66, 2, v64
    v_cndmask_b32 v65, v64, v65, vcc
    v_mul_u32_u24 v65, 1152, v65
    v_and_b32 v67, 7, v0
    v_xor_b32 v66, v66, v67
    v_lshlrev_b32 v66, 4, v66
    v_add_u32 v64, v65, v66
    v_xor_b32 v66, 64, v66
    v_add_u32 v65, v65, v66
    s_mul_i32 s96, s94, 41472
    s_mul_i32 s97, s94, 331776
    s_sub_u32 s97, s97, 5289984
    s_cmp_ge_u32 s94, 16
    s_cselect_b32 s96, s97, s96
    s_lshl_b32 s97, s95, 7
    s_add_u32 s96, s96, s97
    s_cmp_ge_u32 s94, 16
    s_mov_b32 s97, 0
    s_cselect_b32 s97, 0, s97
    s_add_u32 s97, s97, s96
    s_add_u32 m0, s46, 147456
    s_nop 0
    buffer_load_dwordx4 v64, s[28:31], s97 offen lds
    s_cmp_ge_u32 s94, 16
    s_mov_b32 s97, 9216
    s_cselect_b32 s97, 82944, s97
    s_add_u32 s97, s97, s96
    s_add_u32 m0, s46, 148480
    s_nop 0
    buffer_load_dwordx4 v65, s[28:31], s97 offen lds
    s_cmp_ge_u32 s94, 16
    s_mov_b32 s97, 20736
    s_cselect_b32 s97, 165888, s97
    s_add_u32 s97, s97, s96
    s_add_u32 m0, s46, 149504
    s_nop 0
    buffer_load_dwordx4 v64, s[28:31], s97 offen lds
    s_cmp_ge_u32 s94, 16
    s_mov_b32 s97, 29952
    s_cselect_b32 s97, 248832, s97
    s_add_u32 s97, s97, s96
    s_add_u32 m0, s46, 150528
    s_nop 0
    buffer_load_dwordx4 v65, s[28:31], s97 offen lds
    v_bfe_u32 v64, v0, 4, 1
    v_mul_u32_u24 v64, 1088, v64
    v_bfe_u32 v65, v0, 2, 2
    v_lshl_add_u32 v64, v65, 7, v64
    v_lshrrev_b32 v65, 1, v65
    v_lshl_add_u32 v64, v65, 5, v64
    v_and_b32 v65, 3, v0
    v_lshl_add_u32 v64, v65, 3, v64
    v_bfe_u32 v65, v0, 5, 3
    v_lshl_add_u32 v64, v65, 11, v64
    v_add_u32 v64, 147456, v64
    v_xor_b32 v65, 32, v64
    v_xor_b32 v66, 64, v64
    v_xor_b32 v67, 96, v64
    s_waitcnt vmcnt(0)
    ds_read_b64_tr_b16 v[68:69], v64 offset:0
    ds_read_b64_tr_b16 v[70:71], v64 offset:512
    ds_read_b64_tr_b16 v[72:73], v65 offset:0
    ds_read_b64_tr_b16 v[74:75], v65 offset:512
    ds_read_b64_tr_b16 v[76:77], v66 offset:0
    ds_read_b64_tr_b16 v[78:79], v66 offset:512
    ds_read_b64_tr_b16 v[80:81], v67 offset:0
    ds_read_b64_tr_b16 v[82:83], v67 offset:512
    s_mul_i32 s94, s94, 3
    s_waitcnt lgkmcnt(0)
    s_lshl_b32 s96, s95, 2
    s_add_u32 s96, s96, 0
    s_mul_i32 s97, s96, 43
    s_lshr_b32 s97, s97, 7
    s_mul_i32 s97, s97, 51
    s_add_u32 s96, s96, s97
    s_add_u32 s96, s96, s94
    s_lshl_b32 s96, s96, 10
    s_add_u32 s96, s96, 47185920
    buffer_store_dwordx4 v[68:71], v16, s[24:27], s96 offen sc1
    s_lshl_b32 s96, s95, 2
    s_add_u32 s96, s96, 1
    s_mul_i32 s97, s96, 43
    s_lshr_b32 s97, s97, 7
    s_mul_i32 s97, s97, 51
    s_add_u32 s96, s96, s97
    s_add_u32 s96, s96, s94
    s_lshl_b32 s96, s96, 10
    s_add_u32 s96, s96, 47185920
    buffer_store_dwordx4 v[72:75], v16, s[24:27], s96 offen sc1
    s_lshl_b32 s96, s95, 2
    s_add_u32 s96, s96, 2
    s_mul_i32 s97, s96, 43
    s_lshr_b32 s97, s97, 7
    s_mul_i32 s97, s97, 51
    s_add_u32 s96, s96, s97
    s_add_u32 s96, s96, s94
    s_lshl_b32 s96, s96, 10
    s_add_u32 s96, s96, 47185920
    buffer_store_dwordx4 v[76:79], v16, s[24:27], s96 offen sc1
    s_lshl_b32 s96, s95, 2
    s_add_u32 s96, s96, 3
    s_mul_i32 s97, s96, 43
    s_lshr_b32 s97, s97, 7
    s_mul_i32 s97, s97, 51
    s_add_u32 s96, s96, s97
    s_add_u32 s96, s96, s94
    s_lshl_b32 s96, s96, 10
    s_add_u32 s96, s96, 47185920
    buffer_store_dwordx4 v[80:83], v16, s[24:27], s96 offen sc1
    s_waitcnt vmcnt(0)
L_nx:
    s_waitcnt lgkmcnt(12)
    v_mfma_f32_16x16x32_bf16 v[160:163], a[16:19], a[64:67], v[160:163]
    v_add_u32 v5, 65536, v5
    ds_read_b64_tr_b16 a[0:1], v5 offset:0
    s_and_b32 s4, s2, 1
    s_lshl_b32 s4, s4, 3
    v_mfma_f32_16x16x32_bf16 v[160:163], a[20:23], a[80:83], v[160:163]
    s_lshl_b32 s75, s16, 15
    s_add_u32 s75, s75, s49
    s_bfe_u32 s62, s2, 0x30003
    v_mfma_f32_16x16x32_bf16 v[164:167], a[20:23], a[84:87], v[164:167]
    ds_read_b64_tr_b16 a[2:3], v5 offset:512
    buffer_load_dwordx4 v[192:195], v16, s[24:27], s75 offen offset:0 sc1
    s_add_u32 s4, s4, s62
    v_mfma_f32_16x16x32_bf16 v[164:167], a[16:19], a[68:71], v[164:167]
    buffer_load_dwordx4 v[196:199], v16, s[24:27], s75 offen offset:2048 sc1
    s_add_u32 s75, s75, 8192
    s_bfe_u32 s12, s2, 0x20001
    v_mfma_f32_16x16x32_bf16 v[168:171], a[16:19], a[72:75], v[168:171]
    ds_read_b64_tr_b16 a[4:5], v5 offset:4096
    buffer_load_dwordx4 v[200:203], v16, s[24:27], s75 offen offset:0 sc1
    s_lshr_b32 s13, s2, 6
    v_mfma_f32_16x16x32_bf16 v[168:171], a[20:23], a[88:91], v[168:171]
    buffer_load_dwordx4 v[204:207], v16, s[24:27], s75 offen offset:2048 sc1
    s_add_u32 s75, s75, 8192
    s_mul_i32 s48, s12, 36
    v_mfma_f32_16x16x32_bf16 v[172:175], a[20:23], a[92:95], v[172:175]
    ds_read_b64_tr_b16 a[6:7], v5 offset:4608
    buffer_load_dwordx4 v[208:211], v16, s[24:27], s75 offen offset:0 sc1
    s_add_u32 s48, s48, s3
    v_mfma_f32_16x16x32_bf16 v[172:175], a[16:19], a[76:79], v[172:175]
    buffer_load_dwordx4 v[212:215], v16, s[24:27], s75 offen offset:2048 sc1
    s_mul_i32 s48, s48, 36864
    s_mul_i32 s62, s13, 288
    s_waitcnt lgkmcnt(12)
    v_mfma_f32_16x16x32_bf16 v[176:179], a[24:27], a[64:67], v[176:179]
    ds_read_b64_tr_b16 a[8:9], v5 offset:8192
    s_add_u32 s75, s75, 8192
    s_and_b32 s62, s62, 0xffffffc0
    v_mfma_f32_16x16x32_bf16 v[176:179], a[28:31], a[80:83], v[176:179]
    buffer_load_dwordx4 v[216:219], v16, s[24:27], s75 offen offset:0 sc1
    buffer_load_dwordx4 v[220:223], v16, s[24:27], s75 offen offset:2048 sc1
    s_add_u32 s48, s48, s62
    s_mul_i32 s50, s3, 10240
    v_mfma_f32_16x16x32_bf16 v[180:183], a[28:31], a[84:87], v[180:183]
    ds_read_b64_tr_b16 a[10:11], v5 offset:8704
    s_lshl_b32 s53, s4, 2
    s_add_u32 s53, s53, s13
    v_mfma_f32_16x16x32_bf16 v[180:183], a[24:27], a[68:71], v[180:183]
    s_lshl_b32 s75, s17, 15
    s_add_u32 s75, s75, s49
    s_lshl_b32 s53, s53, 2
    s_add_u32 s59, s53, s12
    v_mfma_f32_16x16x32_bf16 v[184:187], a[24:27], a[72:75], v[184:187]
    ds_read_b64_tr_b16 a[12:13], v5 offset:12288
    buffer_load_dwordx4 v[224:227], v16, s[24:27], s75 offen offset:0 sc1
    s_add_u32 s53, s53, s3
    s_lshl_b32 s53, s53, 2
    s_add_u32 s53, s53, s12
    v_mfma_f32_16x16x32_bf16 v[184:187], a[28:31], a[88:91], v[184:187]
    buffer_load_dwordx4 v[228:231], v16, s[24:27], s75 offen offset:2048 sc1
    s_add_u32 s75, s75, 8192
    buffer_load_dwordx4 v[232:235], v16, s[24:27], s75 offen offset:0 sc1
    buffer_load_dwordx4 v[236:239], v16, s[24:27], s75 offen offset:2048 sc1
    s_mul_i32 s53, s53, 9216
    s_add_u32 s53, s53, 30408704
    s_mul_i32 s59, s59, 36864
    s_mul_i32 s62, s3, 9216
    v_mfma_f32_16x16x32_bf16 v[188:191], a[28:31], a[92:95], v[188:191]
    ds_read_b64_tr_b16 a[14:15], v5 offset:12800
    v_mfma_f32_16x16x32_bf16 v[188:191], a[24:27], a[76:79], v[188:191]
    s_waitcnt vmcnt(16)
    s_barrier
    v_mov_b32 v29, s7
    v_add_u32 v29, 3, v29
    buffer_store_dword v29, v30, s[24:27], s6 offen sc1
    s_waitcnt lgkmcnt(4)
    v_mfma_f32_16x16x32_bf16 v[160:163], a[0:3], a[96:99], v[160:163]
    ds_read_b64_tr_b16 a[16:17], v5 offset:16384
    v_lshlrev_b32 v28, 7, v0
    v_cmp_gt_u32 vcc, 256, v0
    s_add_u32 s73, s63, 0
    s_nop 0
    v_cndmask_b32 v28, -16, v28, vcc
    buffer_load_dword v12, v28, s[32:35], s73 offen
    v_mfma_f32_16x16x32_bf16 v[160:163], a[4:7], a[112:115], v[160:163]
    s_add_u32 s59, s59, s62
    s_add_u32 s56, s62, 40960
    s_mul_i32 s51, s16, 147456
    s_add_u32 s51, s51, s48
    v_mfma_f32_16x16x32_bf16 v[164:167], a[4:7], a[116:119], v[164:167]
    ds_read_b64_tr_b16 a[18:19], v5 offset:16896
    s_add_u32 s59, s59, 30408704
    s_add_u32 m0, s50, 0
    v_mfma_f32_16x16x32_bf16 v[164:167], a[0:3], a[100:103], v[164:167]
    s_mul_i32 s54, s13, 9
    s_mul_i32 s62, s3, 3
    buffer_load_dwordx4 v6, s[32:35], s51 offen offset:0  lds
    v_mfma_f32_16x16x32_bf16 v[168:171], a[0:3], a[104:107], v[168:171]
    ds_read_b64_tr_b16 a[20:21], v5 offset:20480
    s_add_u32 s54, s54, s62
    s_mul_i32 s54, s54, 18432
    s_add_u32 s54, s54, 47185920
    v_mfma_f32_16x16x32_bf16 v[168:171], a[4:7], a[120:123], v[168:171]
    s_cmp_eq_u32 s3, s12
    s_cselect_b32 s53, 1073741824, s53
    s_cselect_b32 s59, 1073741824, s59
    s_cselect_b32 s44, s56, 0x30000
    s_cselect_b32 s56, 0x30000, s56
    v_mfma_f32_16x16x32_bf16 v[172:175], a[4:7], a[124:127], v[172:175]
    ds_read_b64_tr_b16 a[22:23], v5 offset:20992
    s_lshl_b32 s55, s4, 2
    buffer_load_dwordx4 v7, s[32:35], s51 offen offset:1024  lds
    buffer_load_dwordx4 v8, s[32:35], s51 offen offset:2048  lds
    buffer_load_dwordx4 v9, s[32:35], s51 offen offset:3072  lds
    v_mfma_f32_16x16x32_bf16 v[172:175], a[0:3], a[108:111], v[172:175]
    s_and_b32 s62, s12, 2
    s_add_u32 s55, s55, s62
    s_mul_i32 s60, s55, 36864
    s_add_u32 m0, s50, 4096
    s_waitcnt lgkmcnt(4)
    v_mfma_f32_16x16x32_bf16 v[176:179], a[8:11], a[96:99], v[176:179]
    ds_read_b64_tr_b16 a[24:25], v5 offset:24576
    s_mul_i32 s62, s13, 288
    s_add_u32 s60, s60, s62
    s_mul_i32 s62, s3, 96
    v_mfma_f32_16x16x32_bf16 v[176:179], a[12:15], a[112:115], v[176:179]
    s_add_u32 s60, s60, s62
    s_and_b32 s13, s12, 1
    s_mul_i32 s62, s13, 18432
    buffer_load_dwordx4 v10, s[32:35], s51 offen offset:0  lds
    v_mfma_f32_16x16x32_bf16 v[180:183], a[12:15], a[116:119], v[180:183]
    ds_read_b64_tr_b16 a[26:27], v5 offset:25088
    s_add_u32 s60, s60, s62
    s_add_u32 s51, s51, 9216
    s_add_u32 m0, s50, 5120
    s_nop 0
    buffer_load_dwordx4 v6, s[32:35], s51 offen offset:0  lds
    v_mfma_f32_16x16x32_bf16 v[180:183], a[8:11], a[100:103], v[180:183]
    s_cmp_ge_u32 s3, 3
    s_cselect_b32 s54, 1073741824, s54
    s_cselect_b32 s60, 1073741824, s60
    s_add_u32 s61, s60, 36864
    s_lshr_b32 s57, s55, 3
    v_mfma_f32_16x16x32_bf16 v[184:187], a[8:11], a[104:107], v[184:187]
    ds_read_b64_tr_b16 a[28:29], v5 offset:28672
    s_lshl_b32 s57, s57, 16
    s_bfe_u32 s62, s55, 0x20001
    s_lshl_b32 s62, s62, 7
    buffer_load_dwordx4 v7, s[32:35], s51 offen offset:1024  lds
    buffer_load_dwordx4 v8, s[32:35], s51 offen offset:2048  lds
    buffer_load_dwordx4 v9, s[32:35], s51 offen offset:3072  lds
    s_add_u32 m0, s50, 9216
    v_mfma_f32_16x16x32_bf16 v[184:187], a[12:15], a[120:123], v[184:187]
    s_add_u32 s57, s57, s62
    s_add_u32 s57, s57, 54526976
    s_mul_i32 s55, s55, 36864
    s_add_u32 s55, s55, 27262976
    s_lshl_b32 s62, s3, 10
    s_add_u32 s4, s55, s62
    s_lshl_b32 s62, s13, 6
    s_add_u32 s4, s4, s62
    s_add_u32 s4, s4, 32768
    s_lshl_b32 s62, s3, 13
    buffer_load_dwordx4 v10, s[32:35], s51 offen offset:0  lds
    v_mfma_f32_16x16x32_bf16 v[188:191], a[12:15], a[124:127], v[188:191]
    ds_read_b64_tr_b16 a[30:31], v5 offset:29184
    v_mfma_f32_16x16x32_bf16 v[188:191], a[8:11], a[108:111], v[188:191]
    s_waitcnt vmcnt(44)
    s_barrier
    s_waitcnt lgkmcnt(4)
    v_mfma_f32_16x16x32_bf16 v[160:163], a[16:19], a[128:131], v[160:163]
    ds_read_b64_tr_b16 a[0:1], v5 offset:32768
    s_add_u32 s75, s75, 8192
    s_getpc_b64 s[76:77]
L_rw10:
    s_mov_b32 s78, L_mk_end-L_rw10
    s_mov_b32 s79, 0x00020000
    s_lshr_b32 s73, s2, 3
    s_mul_i32 s73, s73, 1536
    v_lshlrev_b32 v28, 7, v0
    v_cmp_gt_u32 vcc, 1536, v28
    s_nop 1
    v_cndmask_b32 v28, -16, v28, vcc
    buffer_load_dword v12, v28, s[76:79], s73 offen
    v_mfma_f32_16x16x32_bf16 v[160:163], a[20:23], a[144:147], v[160:163]
    buffer_load_dwordx4 v[240:243], v16, s[24:27], s75 offen offset:0 sc1
    buffer_load_dwordx4 v[244:247], v16, s[24:27], s75 offen offset:2048 sc1
    v_mfma_f32_16x16x32_bf16 v[164:167], a[20:23], a[148:151], v[164:167]
    ds_read_b64_tr_b16 a[2:3], v5 offset:33280
    s_add_u32 s75, s75, 8192
    v_mfma_f32_16x16x32_bf16 v[164:167], a[16:19], a[132:135], v[164:167]
    buffer_load_dwordx4 v[248:251], v16, s[24:27], s75 offen offset:0 sc1
    buffer_load_dwordx4 v[252:255], v16, s[24:27], s75 offen offset:2048 sc1
    v_mfma_f32_16x16x32_bf16 v[168:171], a[16:19], a[136:139], v[168:171]
    ds_read_b64_tr_b16 a[4:5], v5 offset:36864
    v_add_u32 v17, 61440, v11
    v_mfma_f32_16x16x32_bf16 v[168:171], a[20:23], a[152:155], v[168:171]
    v_add_u32 v18, 122880, v11
    v_add_u32 v21, 61440, v14
    v_mfma_f32_16x16x32_bf16 v[172:175], a[20:23], a[156:159], v[172:175]
    ds_read_b64_tr_b16 a[6:7], v5 offset:37376
    v_add_u32 v19, 122880, v14
    v_mfma_f32_16x16x32_bf16 v[172:175], a[16:19], a[140:143], v[172:175]
    s_lshl_b32 s75, s18, 15
    s_add_u32 s75, s75, s49
    s_waitcnt lgkmcnt(4)
    v_mfma_f32_16x16x32_bf16 v[176:179], a[24:27], a[128:131], v[176:179]
    ds_read_b64_tr_b16 a[8:9], v5 offset:40960
    buffer_load_dwordx4 a[64:67], v16, s[24:27], s75 offen offset:0 sc1
    buffer_load_dwordx4 a[68:71], v16, s[24:27], s75 offen offset:2048 sc1
    v_mfma_f32_16x16x32_bf16 v[176:179], a[28:31], a[144:147], v[176:179]
    v_add_u32 v20, 1024, v25
    s_mov_b32 exec_lo, 0
    v_mov_b32 v20, 73728
    s_mov_b32 exec_lo, -1
    v_mfma_f32_16x16x32_bf16 v[180:183], a[28:31], a[148:151], v[180:183]
    ds_read_b64_tr_b16 a[10:11], v5 offset:41472
    s_add_u32 s75, s75, 8192
    buffer_load_dwordx4 a[72:75], v16, s[24:27], s75 offen offset:0 sc1
    v_mfma_f32_16x16x32_bf16 v[180:183], a[24:27], a[132:135], v[180:183]
    s_add_u32 s20, s24, 18874368
    s_addc_u32 s21, s25, 0
    buffer_load_dwordx4 a[76:79], v16, s[24:27], s75 offen offset:2048 sc1
    v_mfma_f32_16x16x32_bf16 v[184:187], a[24:27], a[136:139], v[184:187]
    ds_read_b64_tr_b16 a[12:13], v5 offset:45056
    s_mov_b32 s22, 4726784
    s_add_u32 s75, s75, 8192
    buffer_load_dwordx4 a[80:83], v16, s[24:27], s75 offen offset:0 sc1
    buffer_load_dwordx4 a[84:87], v16, s[24:27], s75 offen offset:2048 sc1
    s_add_u32 s75, s75, 8192
    v_mfma_f32_16x16x32_bf16 v[184:187], a[28:31], a[152:155], v[184:187]
    s_mov_b32 s23, 0x00020000
    s_add_u32 s28, s24, 24117248
    s_addc_u32 s29, s25, 0
    s_mov_b32 s30, 2392064
    s_mov_b32 s31, 0x00020000
    buffer_load_dwordx4 a[88:91], v16, s[24:27], s75 offen offset:0 sc1
    buffer_load_dwordx4 a[92:95], v16, s[24:27], s75 offen offset:2048 sc1
    v_mfma_f32_16x16x32_bf16 v[188:191], a[28:31], a[156:159], v[188:191]
    ds_read_b64_tr_b16 a[14:15], v5 offset:45568
    v_mfma_f32_16x16x32_bf16 v[188:191], a[24:27], a[140:143], v[188:191]
    s_waitcnt vmcnt(50)
    s_barrier
    s_waitcnt lgkmcnt(4)
    v_mfma_f32_16x16x32_bf16 v[160:163], a[0:3], a[160:163], v[160:163]
    ds_read_b64_tr_b16 a[16:17], v5 offset:49152
    s_add_u32 s55, s55, s62
    s_mul_i32 s51, s17, 147456
    s_add_u32 s51, s51, s48
    v_mfma_f32_16x16x32_bf16 v[160:163], a[4:7], a[176:179], v[160:163]
    s_lshl_b32 s62, s13, 8
    s_add_u32 s55, s55, s62
    s_add_u32 m0, s50, 40960
    v_mfma_f32_16x16x32_bf16 v[164:167], a[4:7], a[180:183], v[164:167]
    ds_read_b64_tr_b16 a[18:19], v5 offset:49664
    s_lshl_b32 s80, s3, 1
    buffer_load_dwordx4 v6, s[32:35], s51 offen offset:0  lds
    v_mfma_f32_16x16x32_bf16 v[164:167], a[0:3], a[164:167], v[164:167]
    s_add_u32 s80, s80, 9
    s_sub_u32 s80, s80, s84
    buffer_load_dwordx4 v7, s[32:35], s51 offen offset:1024  lds
    v_mfma_f32_16x16x32_bf16 v[168:171], a[0:3], a[168:171], v[168:171]
    ds_read_b64_tr_b16 a[20:21], v5 offset:53248
    s_add_u32 s81, s80, 1
    buffer_load_dwordx4 v8, s[32:35], s51 offen offset:2048  lds
    v_mfma_f32_16x16x32_bf16 v[168:171], a[4:7], a[184:187], v[168:171]
    s_sub_u32 s14, 17, s84
    s_sub_u32 s62, s80, 9
    s_cselect_b32 s80, s80, s62
    v_mfma_f32_16x16x32_bf16 v[172:175], a[4:7], a[188:191], v[172:175]
    ds_read_b64_tr_b16 a[22:23], v5 offset:53760
    s_lshl_b32 s80, s80, 12
    buffer_load_dwordx4 v9, s[32:35], s51 offen offset:3072  lds
    v_mfma_f32_16x16x32_bf16 v[172:175], a[0:3], a[172:175], v[172:175]
    s_sub_u32 s62, s81, 9
    s_cselect_b32 s81, s81, s62
    s_waitcnt lgkmcnt(4)
    v_mfma_f32_16x16x32_bf16 v[176:179], a[8:11], a[160:163], v[176:179]
    ds_read_b64_tr_b16 a[24:25], v5 offset:57344
    s_lshl_b32 s81, s81, 12
    s_add_u32 m0, s50, 45056
    v_mfma_f32_16x16x32_bf16 v[176:179], a[12:15], a[176:179], v[176:179]
    s_sub_u32 s62, s14, 9
    s_cselect_b32 s14, s14, s62
    buffer_load_dwordx4 v10, s[32:35], s51 offen offset:0  lds
    v_mfma_f32_16x16x32_bf16 v[180:183], a[12:15], a[180:183], v[180:183]
    ds_read_b64_tr_b16 a[26:27], v5 offset:57856
    s_lshl_b32 s14, s14, 12
    s_add_u32 s51, s51, 9216
    v_mfma_f32_16x16x32_bf16 v[180:183], a[8:11], a[164:167], v[180:183]
    s_lshr_b32 s62, s3, 1
    s_lshl_b32 s62, s62, 11
    s_add_u32 m0, s50, 46080
    s_nop 0
    buffer_load_dwordx4 v6, s[32:35], s51 offen offset:0  lds
    buffer_load_dword v22, v13, s[24:27], s74 offen sc1
    v_mfma_f32_16x16x32_bf16 v[184:187], a[8:11], a[168:171], v[184:187]
    ds_read_b64_tr_b16 a[28:29], v5 offset:61440
    s_add_u32 s14, s14, s62
    s_and_b32 s62, s3, 1
    buffer_load_dwordx4 v7, s[32:35], s51 offen offset:1024  lds
    buffer_load_dwordx4 v8, s[32:35], s51 offen offset:2048  lds
    buffer_load_dwordx4 v9, s[32:35], s51 offen offset:3072  lds
    s_add_u32 m0, s50, 50176
    v_mfma_f32_16x16x32_bf16 v[184:187], a[12:15], a[184:187], v[184:187]
    s_lshl_b32 s62, s62, 9
    s_add_u32 s14, s14, s62
    s_and_b32 s15, s2, 0xf9
    s_lshl_b32 s15, s15, 11
    s_lshl_b32 s62, s12, 7
    s_add_u32 s15, s15, s62
    s_add_u32 s15, s15, 54526464
    buffer_load_dwordx4 v10, s[32:35], s51 offen offset:0  lds
    v_mfma_f32_16x16x32_bf16 v[188:191], a[12:15], a[188:191], v[188:191]
    ds_read_b64_tr_b16 a[30:31], v5 offset:61952
    v_mfma_f32_16x16x32_bf16 v[188:191], a[8:11], a[172:175], v[188:191]
    s_waitcnt vmcnt(48)
    s_barrier
    v_mov_b32 v28, 1
    v_lshlrev_b32 v29, 8, v0
    buffer_atomic_add v28, v29, s[36:39], 0 offen sc1
    s_waitcnt lgkmcnt(4)
    v_mfma_f32_16x16x32_bf16 v[160:163], a[16:19], a[192:195], v[160:163]
    v_add_u32 v5, 65536, v5
    ds_read_b64_tr_b16 a[0:1], v5 offset:0
    s_and_b32 s93, s2, 7
    s_lshl_b32 s75, s19, 15
    s_add_u32 s75, s75, s49
    v_mfma_f32_16x16x32_bf16 v[160:163], a[20:23], a[208:211], v[160:163]
    s_lshl_b32 s93, s93, 2
    s_bfe_u32 s62, s2, 0x20003
    v_mfma_f32_16x16x32_bf16 v[164:167], a[20:23], a[212:215], v[164:167]
    ds_read_b64_tr_b16 a[2:3], v5 offset:512
    s_add_u32 s93, s93, s62
    buffer_load_dwordx4 a[96:99], v16, s[24:27], s75 offen offset:0 sc1
    v_mfma_f32_16x16x32_bf16 v[164:167], a[16:19], a[196:199], v[164:167]
    s_lshr_b32 s94, s2, 5
    s_lshl_b32 s94, s94, 2
    v_mfma_f32_16x16x32_bf16 v[168:171], a[16:19], a[200:203], v[168:171]
    ds_read_b64_tr_b16 a[4:5], v5 offset:4096
    s_add_u32 s94, s94, s3
    buffer_load_dwordx4 a[100:103], v16, s[24:27], s75 offen offset:2048 sc1
    v_mfma_f32_16x16x32_bf16 v[168:171], a[20:23], a[216:219], v[168:171]
    s_lshl_b32 s94, s94, 1
    s_mul_i32 s96, s93, 9
    v_mfma_f32_16x16x32_bf16 v[172:175], a[20:23], a[220:223], v[172:175]
    ds_read_b64_tr_b16 a[6:7], v5 offset:4608
    s_and_b32 s96, s96, 3
    v_mfma_f32_16x16x32_bf16 v[172:175], a[16:19], a[204:207], v[172:175]
    s_mul_i32 s97, s94, 73856
    s_waitcnt lgkmcnt(4)
    v_mfma_f32_16x16x32_bf16 v[176:179], a[24:27], a[192:195], v[176:179]
    ds_read_b64_tr_b16 a[8:9], v5 offset:8192
    s_add_u32 s98, s97, -664704
    s_add_u32 s97, s97, 18837504
    s_sub_u32 s5, s94, 9
    s_mul_i32 s5, s5, 37376
    v_mfma_f32_16x16x32_bf16 v[176:179], a[28:31], a[208:211], v[176:179]
    s_add_u32 s75, s75, 8192
    buffer_load_dwordx4 a[104:107], v16, s[24:27], s75 offen offset:0 sc1
    v_mfma_f32_16x16x32_bf16 v[180:183], a[28:31], a[212:215], v[180:183]
    ds_read_b64_tr_b16 a[10:11], v5 offset:8704
    buffer_load_dwordx4 a[108:111], v16, s[24:27], s75 offen offset:2048 sc1
    v_mfma_f32_16x16x32_bf16 v[180:183], a[24:27], a[196:199], v[180:183]
    s_add_u32 s75, s75, 8192
    buffer_load_dwordx4 a[112:115], v16, s[24:27], s75 offen offset:0 sc1
    v_mfma_f32_16x16x32_bf16 v[184:187], a[24:27], a[200:203], v[184:187]
    ds_read_b64_tr_b16 a[12:13], v5 offset:12288
    buffer_load_dwordx4 a[116:119], v16, s[24:27], s75 offen offset:2048 sc1
    v_mfma_f32_16x16x32_bf16 v[184:187], a[28:31], a[216:219], v[184:187]
    v_mfma_f32_16x16x32_bf16 v[188:191], a[28:31], a[220:223], v[188:191]
    ds_read_b64_tr_b16 a[14:15], v5 offset:12800
    v_mfma_f32_16x16x32_bf16 v[188:191], a[24:27], a[204:207], v[188:191]
    s_add_u32 s82, s7, 3
    s_waitcnt vmcnt(11)
    v_subrev_u32 v22, s82, v22
    v_cmp_lt_u32 vcc, 7, v22
    s_cbranch_vccz L_poll11_ok
    s_mov_b32 s83, 0
L_poll11:
    buffer_load_dword v22, v13, s[24:27], s74 offen sc1
    s_add_u32 s83, s83, 1
    s_waitcnt vmcnt(0)
    v_subrev_u32 v22, s82, v22
    v_cmp_lt_u32 vcc, 7, v22
    s_cbranch_vccz L_poll11_ok
    s_cmp_lt_u32 s83, 0x40000
    s_cbranch_scc1 L_poll11
L_poll11_ok:
    s_barrier
    s_waitcnt lgkmcnt(4)
    v_mfma_f32_16x16x32_bf16 v[160:163], a[0:3], a[224:227], v[160:163]
    s_add_u32 s75, s75, 8192
    v_mfma_f32_16x16x32_bf16 v[160:163], a[4:7], a[240:243], v[160:163]
    buffer_load_dwordx4 a[120:123], v16, s[24:27], s75 offen offset:0 sc1
    buffer_load_dwordx4 a[124:127], v16, s[24:27], s75 offen offset:2048 sc1
    v_mfma_f32_16x16x32_bf16 v[164:167], a[4:7], a[244:247], v[164:167]
    v_mfma_f32_16x16x32_bf16 v[164:167], a[0:3], a[228:231], v[164:167]
    s_lshl_b32 s75, s16, 15
    s_add_u32 s75, s75, s49
    s_add_u32 s75, s75, 131072
    v_mfma_f32_16x16x32_bf16 v[168:171], a[0:3], a[232:235], v[168:171]
    buffer_load_dwordx4 a[128:131], v16, s[24:27], s75 offen offset:0 sc1
    v_mfma_f32_16x16x32_bf16 v[168:171], a[4:7], a[248:251], v[168:171]
    buffer_load_dwordx4 a[132:135], v16, s[24:27], s75 offen offset:2048 sc1
    v_mfma_f32_16x16x32_bf16 v[172:175], a[4:7], a[252:255], v[172:175]
    s_add_u32 s75, s75, 8192
    v_mfma_f32_16x16x32_bf16 v[172:175], a[0:3], a[236:239], v[172:175]
    buffer_load_dwordx4 a[136:139], v16, s[24:27], s75 offen offset:0 sc1
    s_waitcnt lgkmcnt(0)
    v_mfma_f32_16x16x32_bf16 v[176:179], a[8:11], a[224:227], v[176:179]
    buffer_load_dwordx4 a[140:143], v16, s[24:27], s75 offen offset:2048 sc1
    v_mfma_f32_16x16x32_bf16 v[176:179], a[12:15], a[240:243], v[176:179]
    s_add_u32 s75, s75, 8192
    buffer_load_dwordx4 a[144:147], v16, s[24:27], s75 offen offset:0 sc1
    v_mfma_f32_16x16x32_bf16 v[180:183], a[12:15], a[244:247], v[180:183]
    buffer_load_dwordx4 a[148:151], v16, s[24:27], s75 offen offset:2048 sc1
    v_mfma_f32_16x16x32_bf16 v[180:183], a[8:11], a[228:231], v[180:183]
    s_add_u32 s75, s75, 8192
    v_mfma_f32_16x16x32_bf16 v[184:187], a[8:11], a[232:235], v[184:187]
    buffer_load_dwordx4 a[152:155], v16, s[24:27], s75 offen offset:0 sc1
    v_mfma_f32_16x16x32_bf16 v[184:187], a[12:15], a[248:251], v[184:187]
    buffer_load_dwordx4 a[156:159], v16, s[24:27], s75 offen offset:2048 sc1
    v_mfma_f32_16x16x32_bf16 v[188:191], a[12:15], a[252:255], v[188:191]
    v_mfma_f32_16x16x32_bf16 v[188:191], a[8:11], a[236:239], v[188:191]
L_mk_m:
    s_nop 7
    s_waitcnt vmcnt(38)
    s_barrier
    ds_read_b64_tr_b16 a[0:1], v11 offset:0
    ds_read_b64_tr_b16 a[2:3], v11 offset:5120
    ds_read_b64_tr_b16 a[4:5], v11 offset:10240
    ds_read_b64_tr_b16 a[6:7], v11 offset:15360
    ds_read_b64_tr_b16 a[8:9], v14 offset:32
    ds_read_b64_tr_b16 a[10:11], v14 offset:5152
    ds_read_b64_tr_b16 a[12:13], v14 offset:10272
    ds_read_b64_tr_b16 a[14:15], v14 offset:15392
    ds_read_b64_tr_b16 a[16:17], v11 offset:64
    ds_read_b64_tr_b16 a[18:19], v11 offset:5184
    ds_read_b64_tr_b16 a[20:21], v11 offset:10304
    ds_read_b64_tr_b16 a[22:23], v11 offset:15424
    ds_read_b64_tr_b16 a[24:25], v14 offset:96
    ds_read_b64_tr_b16 a[26:27], v14 offset:5216
    s_waitcnt vmcnt(56)
    s_waitcnt lgkmcnt(6)
    v_mfma_f32_16x16x32_bf16 v[128:131], a[0:3], v[192:195], 0
    ds_read_b64_tr_b16 a[28:29], v14 offset:10336
    v_mfma_f32_16x16x32_bf16 v[128:131], a[4:7], v[200:203], v[128:131]
    ds_read_b64_tr_b16 a[30:31], v14 offset:15456
    v_mfma_f32_16x16x32_bf16 v[132:135], a[4:7], v[204:207], 0
    ds_read_b64_tr_b16 a[32:33], v11 offset:128
    v_mul_f32 v160, v160, v176
    buffer_store_dwordx4 v[32:35], v23, s[24:27], s68 offen sc1
    v_mfma_f32_16x16x32_bf16 v[132:135], a[0:3], v[196:199], v[132:135]
    ds_read_b64_tr_b16 a[34:35], v11 offset:5248
    v_mul_f32 v161, v161, v177
    v_mfma_f32_16x16x32_bf16 v[136:139], a[8:11], v[192:195], 0
    ds_read_b64_tr_b16 a[36:37], v11 offset:10368
    v_mul_f32 v162, v162, v178
    v_mfma_f32_16x16x32_bf16 v[136:139], a[12:15], v[200:203], v[136:139]
    ds_read_b64_tr_b16 a[38:39], v11 offset:15488
    v_mul_f32 v163, v163, v179
    v_mfma_f32_16x16x32_bf16 v[140:143], a[12:15], v[204:207], 0
    ds_read_b64_tr_b16 a[40:41], v14 offset:160
    v_mfma_f32_16x16x32_bf16 v[140:143], a[8:11], v[196:199], v[140:143]
    ds_read_b64_tr_b16 a[42:43], v14 offset:5280
    s_waitcnt lgkmcnt(6)
    v_mfma_f32_16x16x32_bf16 v[144:147], a[16:19], v[192:195], 0
    ds_read_b64_tr_b16 a[44:45], v14 offset:10400
    v_cvt_pk_bf16_f32 v176, v160, v161
    v_mfma_f32_16x16x32_bf16 v[144:147], a[20:23], v[200:203], v[144:147]
    ds_read_b64_tr_b16 a[46:47], v14 offset:15520
    v_cvt_pk_bf16_f32 v177, v162, v163
    v_mfma_f32_16x16x32_bf16 v[148:151], a[20:23], v[204:207], 0
    ds_read_b64_tr_b16 a[48:49], v11 offset:192
    v_mul_f32 v164, v164, v180
    v_mfma_f32_16x16x32_bf16 v[148:151], a[16:19], v[196:199], v[148:151]
    ds_read_b64_tr_b16 a[50:51], v11 offset:5312
    v_mul_f32 v165, v165, v181
    v_mfma_f32_16x16x32_bf16 v[152:155], a[24:27], v[192:195], 0
    ds_read_b64_tr_b16 a[52:53], v11 offset:10432
    v_mul_f32 v166, v166, v182
    v_mfma_f32_16x16x32_bf16 v[152:155], a[28:31], v[200:203], v[152:155]
    ds_read_b64_tr_b16 a[54:55], v11 offset:15552
    v_mul_f32 v167, v167, v183
    v_mfma_f32_16x16x32_bf16 v[156:159], a[28:31], v[204:207], 0
    ds_read_b64_tr_b16 a[56:57], v14 offset:224
    v_cvt_pk_bf16_f32 v178, v164, v165
    v_mfma_f32_16x16x32_bf16 v[156:159], a[24:27], v[196:199], v[156:159]
    ds_read_b64_tr_b16 a[58:59], v14 offset:5344
    s_waitcnt lgkmcnt(6)
    v_mfma_f32_16x16x32_bf16 v[64:67], a[32:35], v[192:195], 0
    ds_read_b64_tr_b16 a[60:61], v14 offset:10464
    v_cvt_pk_bf16_f32 v179, v166, v167
    v_mfma_f32_16x16x32_bf16 v[64:67], a[36:39], v[200:203], v[64:67]
    ds_read_b64_tr_b16 a[62:63], v14 offset:15584
    v_mul_f32 v168, v168, v184
    v_mfma_f32_16x16x32_bf16 v[68:71], a[36:39], v[204:207], 0
    ds_read_b64_tr_b16 a[0:1], v11 offset:256
    v_mul_f32 v169, v169, v185
    v_mfma_f32_16x16x32_bf16 v[68:71], a[32:35], v[196:199], v[68:71]
    ds_read_b64_tr_b16 a[2:3], v11 offset:5376
    v_mul_f32 v170, v170, v186
    v_mfma_f32_16x16x32_bf16 v[72:75], a[40:43], v[192:195], 0
    ds_read_b64_tr_b16 a[4:5], v11 offset:10496
    s_mul_i32 s51, s18, 147456
    s_add_u32 s51, s51, s48
    s_add_u32 m0, s50, 81920
    s_nop 0
    buffer_load_dwordx4 v6, s[32:35], s51 offen offset:0  lds
    v_mfma_f32_16x16x32_bf16 v[72:75], a[44:47], v[200:203], v[72:75]
    ds_read_b64_tr_b16 a[6:7], v11 offset:15616
    v_mul_f32 v171, v171, v187
    buffer_load_dwordx4 v7, s[32:35], s51 offen offset:1024  lds
    v_mfma_f32_16x16x32_bf16 v[76:79], a[44:47], v[204:207], 0
    ds_read_b64_tr_b16 a[8:9], v11 offset:20480
    v_cvt_pk_bf16_f32 v184, v168, v169
    v_mfma_f32_16x16x32_bf16 v[76:79], a[40:43], v[196:199], v[76:79]
    ds_read_b64_tr_b16 a[10:11], v11 offset:25600
    buffer_store_dwordx4 v[36:39], v24, s[24:27], s68 offen sc1
    s_waitcnt lgkmcnt(6)
    v_mfma_f32_16x16x32_bf16 v[80:83], a[48:51], v[192:195], 0
    ds_read_b64_tr_b16 a[12:13], v11 offset:30720
    v_cvt_pk_bf16_f32 v185, v170, v171
    v_mfma_f32_16x16x32_bf16 v[80:83], a[52:55], v[200:203], v[80:83]
    ds_read_b64_tr_b16 a[14:15], v11 offset:35840
    v_mul_f32 v172, v172, v188
    buffer_load_dwordx4 v8, s[32:35], s51 offen offset:2048  lds
    v_mfma_f32_16x16x32_bf16 v[84:87], a[52:55], v[204:207], 0
    ds_read_b64_tr_b16 a[16:17], v14 offset:20512
    v_mul_f32 v173, v173, v189
    v_mfma_f32_16x16x32_bf16 v[84:87], a[48:51], v[196:199], v[84:87]
    ds_read_b64_tr_b16 a[18:19], v14 offset:25632
    v_mul_f32 v174, v174, v190
    v_mfma_f32_16x16x32_bf16 v[88:91], a[56:59], v[192:195], 0
    ds_read_b64_tr_b16 a[20:21], v14 offset:30752
    v_mul_f32 v175, v175, v191
    v_mfma_f32_16x16x32_bf16 v[88:91], a[60:63], v[200:203], v[88:91]
    ds_read_b64_tr_b16 a[22:23], v14 offset:35872
    v_cvt_pk_bf16_f32 v186, v172, v173
    v_mfma_f32_16x16x32_bf16 v[92:95], a[60:63], v[204:207], 0
    ds_read_b64_tr_b16 a[24:25], v11 offset:20544
    buffer_load_dwordx4 v9, s[32:35], s51 offen offset:3072  lds
    v_mfma_f32_16x16x32_bf16 v[92:95], a[56:59], v[196:199], v[92:95]
    ds_read_b64_tr_b16 a[26:27], v11 offset:25664
    s_waitcnt lgkmcnt(6)
    v_mfma_f32_16x16x32_bf16 v[96:99], a[0:3], v[192:195], 0
    ds_read_b64_tr_b16 a[28:29], v11 offset:30784
    v_cvt_pk_bf16_f32 v187, v174, v175
    v_mfma_f32_16x16x32_bf16 v[96:99], a[4:7], v[200:203], v[96:99]
    ds_read_b64_tr_b16 a[30:31], v11 offset:35904
    v_lshrrev_b32 v4, 9, v16
    v_mfma_f32_16x16x32_bf16 v[100:103], a[4:7], v[204:207], 0
    ds_read_b64_tr_b16 a[32:33], v14 offset:20576
    v_lshl_add_u32 v4, v4, 9, v16
    s_add_u32 m0, s50, 86016
    v_mfma_f32_16x16x32_bf16 v[100:103], a[0:3], v[196:199], v[100:103]
    ds_read_b64_tr_b16 a[34:35], v14 offset:25696
    v_permlane32_swap_b32 v176, v178
    s_waitcnt vmcnt(58)
    v_mfma_f32_16x16x32_bf16 v[128:131], a[8:11], v[208:211], v[128:131]
    ds_read_b64_tr_b16 a[36:37], v14 offset:30816
    v_permlane32_swap_b32 v177, v179
    v_mfma_f32_16x16x32_bf16 v[128:131], a[12:15], v[216:219], v[128:131]
    ds_read_b64_tr_b16 a[38:39], v14 offset:35936
    v_permlane32_swap_b32 v184, v186
    buffer_load_dwordx4 v10, s[32:35], s51 offen offset:0  lds
    v_mfma_f32_16x16x32_bf16 v[132:135], a[12:15], v[220:223], v[132:135]
    ds_read_b64_tr_b16 a[40:41], v11 offset:20608
    v_permlane32_swap_b32 v185, v187
    v_mfma_f32_16x16x32_bf16 v[132:135], a[8:11], v[212:215], v[132:135]
    ds_read_b64_tr_b16 a[42:43], v11 offset:25728
    s_waitcnt lgkmcnt(6)
    v_mfma_f32_16x16x32_bf16 v[136:139], a[16:19], v[208:211], v[136:139]
    ds_read_b64_tr_b16 a[44:45], v11 offset:30848
    s_add_u32 s51, s51, 9216
    v_mfma_f32_16x16x32_bf16 v[136:139], a[20:23], v[216:219], v[136:139]
    ds_read_b64_tr_b16 a[46:47], v11 offset:35968
    s_add_u32 m0, s50, 87040
    v_mfma_f32_16x16x32_bf16 v[140:143], a[20:23], v[220:223], v[140:143]
    ds_read_b64_tr_b16 a[48:49], v14 offset:20640
    buffer_load_dwordx4 v6, s[32:35], s51 offen offset:0  lds
    v_mfma_f32_16x16x32_bf16 v[140:143], a[16:19], v[212:215], v[140:143]
    ds_read_b64_tr_b16 a[50:51], v14 offset:25760
    buffer_load_dwordx4 v7, s[32:35], s51 offen offset:1024  lds
    v_mfma_f32_16x16x32_bf16 v[144:147], a[24:27], v[208:211], v[144:147]
    ds_read_b64_tr_b16 a[52:53], v14 offset:30880
    buffer_store_dwordx4 v[176:179], v4, s[24:27], s72 offen offset:0 sc1
    v_mfma_f32_16x16x32_bf16 v[144:147], a[28:31], v[216:219], v[144:147]
    ds_read_b64_tr_b16 a[54:55], v14 offset:36000
    v_mfma_f32_16x16x32_bf16 v[148:151], a[28:31], v[220:223], v[148:151]
    ds_read_b64_tr_b16 a[56:57], v11 offset:20672
    v_mfma_f32_16x16x32_bf16 v[148:151], a[24:27], v[212:215], v[148:151]
    ds_read_b64_tr_b16 a[58:59], v11 offset:25792
    s_waitcnt lgkmcnt(6)
    v_mfma_f32_16x16x32_bf16 v[152:155], a[32:35], v[208:211], v[152:155]
    ds_read_b64_tr_b16 a[60:61], v11 offset:30912
    buffer_load_dwordx4 v8, s[32:35], s51 offen offset:2048  lds
    v_mfma_f32_16x16x32_bf16 v[152:155], a[36:39], v[216:219], v[152:155]
    ds_read_b64_tr_b16 a[62:63], v11 offset:36032
    v_mfma_f32_16x16x32_bf16 v[156:159], a[36:39], v[220:223], v[156:159]
    ds_read_b64_tr_b16 a[0:1], v14 offset:20704
    v_mfma_f32_16x16x32_bf16 v[156:159], a[32:35], v[212:215], v[156:159]
    ds_read_b64_tr_b16 a[2:3], v14 offset:25824
    v_mfma_f32_16x16x32_bf16 v[64:67], a[40:43], v[208:211], v[64:67]
    ds_read_b64_tr_b16 a[4:5], v14 offset:30944
    buffer_load_dwordx4 v9, s[32:35], s51 offen offset:3072  lds
    v_mfma_f32_16x16x32_bf16 v[64:67], a[44:47], v[216:219], v[64:67]
    ds_read_b64_tr_b16 a[6:7], v14 offset:36064
    v_mfma_f32_16x16x32_bf16 v[68:71], a[44:47], v[220:223], v[68:71]
    ds_read_b64_tr_b16 a[8:9], v11 offset:20736
    v_mfma_f32_16x16x32_bf16 v[68:71], a[40:43], v[212:215], v[68:71]
    ds_read_b64_tr_b16 a[10:11], v11 offset:25856
    s_waitcnt lgkmcnt(6)
    v_mfma_f32_16x16x32_bf16 v[72:75], a[48:51], v[208:211], v[72:75]
    ds_read_b64_tr_b16 a[12:13], v11 offset:30976
    v_mfma_f32_16x16x32_bf16 v[72:75], a[52:55], v[216:219], v[72:75]
    s_waitcnt vmcnt(28)
    s_barrier
    ds_read_b64_tr_b16 a[14:15], v11 offset:36096
    v_mfma_f32_16x16x32_bf16 v[76:79], a[52:55], v[220:223], v[76:79]
    ds_read_b64_tr_b16 a[16:17], v11 offset:40960
    s_add_u32 m0, s50, 91136
    v_mfma_f32_16x16x32_bf16 v[76:79], a[48:51], v[212:215], v[76:79]
    ds_read_b64_tr_b16 a[18:19], v11 offset:46080
    v_mfma_f32_16x16x32_bf16 v[80:83], a[56:59], v[208:211], v[80:83]
    ds_read_b64_tr_b16 a[20:21], v11 offset:51200
    buffer_load_dwordx4 v10, s[32:35], s51 offen offset:0  lds
    v_mfma_f32_16x16x32_bf16 v[80:83], a[60:63], v[216:219], v[80:83]
    ds_read_b64_tr_b16 a[22:23], v11 offset:56320
    v_mfma_f32_16x16x32_bf16 v[84:87], a[60:63], v[220:223], v[84:87]
    ds_read_b64_tr_b16 a[24:25], v14 offset:40992
    s_mul_i32 s51, s19, 147456
    s_add_u32 s51, s51, s48
    v_mfma_f32_16x16x32_bf16 v[84:87], a[56:59], v[212:215], v[84:87]
    ds_read_b64_tr_b16 a[26:27], v14 offset:46112
    s_waitcnt lgkmcnt(6)
    v_mfma_f32_16x16x32_bf16 v[88:91], a[0:3], v[208:211], v[88:91]
    ds_read_b64_tr_b16 a[28:29], v14 offset:51232
    s_add_u32 m0, s50, 122880
    v_mfma_f32_16x16x32_bf16 v[88:91], a[4:7], v[216:219], v[88:91]
    ds_read_b64_tr_b16 a[30:31], v14 offset:56352
    buffer_store_dwordx4 v[184:187], v4, s[24:27], s72 offen offset:2048 sc1
    v_mfma_f32_16x16x32_bf16 v[92:95], a[4:7], v[220:223], v[92:95]
    ds_read_b64_tr_b16 a[32:33], v11 offset:41024
    buffer_load_dwordx4 v6, s[32:35], s51 offen offset:0  lds
    v_mfma_f32_16x16x32_bf16 v[92:95], a[0:3], v[212:215], v[92:95]
    ds_read_b64_tr_b16 a[34:35], v11 offset:46144
    buffer_load_dwordx4 v7, s[32:35], s51 offen offset:1024  lds
    v_mfma_f32_16x16x32_bf16 v[96:99], a[8:11], v[208:211], v[96:99]
    ds_read_b64_tr_b16 a[36:37], v11 offset:51264
    v_mfma_f32_16x16x32_bf16 v[96:99], a[12:15], v[216:219], v[96:99]
    ds_read_b64_tr_b16 a[38:39], v11 offset:56384
    v_mfma_f32_16x16x32_bf16 v[100:103], a[12:15], v[220:223], v[100:103]
    ds_read_b64_tr_b16 a[40:41], v14 offset:41056
    v_mfma_f32_16x16x32_bf16 v[100:103], a[8:11], v[212:215], v[100:103]
    ds_read_b64_tr_b16 a[42:43], v14 offset:46176
    s_waitcnt vmcnt(63)
    s_waitcnt lgkmcnt(6)
    v_mfma_f32_16x16x32_bf16 v[128:131], a[16:19], v[224:227], v[128:131]
    ds_read_b64_tr_b16 a[44:45], v14 offset:51296
    buffer_load_dwordx4 v8, s[32:35], s51 offen offset:2048  lds
    v_mfma_f32_16x16x32_bf16 v[128:131], a[20:23], v[232:235], v[128:131]
    ds_read_b64_tr_b16 a[46:47], v14 offset:56416
    v_mfma_f32_16x16x32_bf16 v[132:135], a[20:23], v[236:239], v[132:135]
    ds_read_b64_tr_b16 a[48:49], v11 offset:41088
    v_mfma_f32_16x16x32_bf16 v[132:135], a[16:19], v[228:231], v[132:135]
    ds_read_b64_tr_b16 a[50:51], v11 offset:46208
    buffer_load_dwordx4 v9, s[32:35], s51 offen offset:3072  lds
    v_mfma_f32_16x16x32_bf16 v[136:139], a[24:27], v[224:227], v[136:139]
    ds_read_b64_tr_b16 a[52:53], v11 offset:51328
    v_mfma_f32_16x16x32_bf16 v[136:139], a[28:31], v[232:235], v[136:139]
    ds_read_b64_tr_b16 a[54:55], v11 offset:56448
    v_mfma_f32_16x16x32_bf16 v[140:143], a[28:31], v[236:239], v[140:143]
    ds_read_b64_tr_b16 a[56:57], v14 offset:41120
    v_mfma_f32_16x16x32_bf16 v[140:143], a[24:27], v[228:231], v[140:143]
    ds_read_b64_tr_b16 a[58:59], v14 offset:46240
    s_waitcnt lgkmcnt(6)
    v_mfma_f32_16x16x32_bf16 v[144:147], a[32:35], v[224:227], v[144:147]
    ds_read_b64_tr_b16 a[60:61], v14 offset:51360
    s_add_u32 m0, s50, 126976
    v_mfma_f32_16x16x32_bf16 v[144:147], a[36:39], v[232:235], v[144:147]
    ds_read_b64_tr_b16 a[62:63], v14 offset:56480
    v_mfma_f32_16x16x32_bf16 v[148:151], a[36:39], v[236:239], v[148:151]
    ds_read_b64_tr_b16 a[0:1], v11 offset:41152
    buffer_load_dwordx4 v10, s[32:35], s51 offen offset:0  lds
    v_mfma_f32_16x16x32_bf16 v[148:151], a[32:35], v[228:231], v[148:151]
    ds_read_b64_tr_b16 a[2:3], v11 offset:46272
    v_mfma_f32_16x16x32_bf16 v[152:155], a[40:43], v[224:227], v[152:155]
    ds_read_b64_tr_b16 a[4:5], v11 offset:51392
    s_add_u32 s51, s51, 9216
    v_mfma_f32_16x16x32_bf16 v[152:155], a[44:47], v[232:235], v[152:155]
    ds_read_b64_tr_b16 a[6:7], v11 offset:56512
    v_mfma_f32_16x16x32_bf16 v[156:159], a[44:47], v[236:239], v[156:159]
    ds_read_b64_tr_b16 a[8:9], v14 offset:41184
    buffer_store_dwordx4 v[40:43], v23, s[24:27], s69 offen sc1
    v_mfma_f32_16x16x32_bf16 v[156:159], a[40:43], v[228:231], v[156:159]
    ds_read_b64_tr_b16 a[10:11], v14 offset:46304
    s_waitcnt lgkmcnt(6)
    v_mfma_f32_16x16x32_bf16 v[64:67], a[48:51], v[224:227], v[64:67]
    ds_read_b64_tr_b16 a[12:13], v14 offset:51424
    s_add_u32 m0, s50, 128000
    v_mfma_f32_16x16x32_bf16 v[64:67], a[52:55], v[232:235], v[64:67]
    ds_read_b64_tr_b16 a[14:15], v14 offset:56544
    buffer_load_dwordx4 v6, s[32:35], s51 offen offset:0  lds
    v_mfma_f32_16x16x32_bf16 v[68:71], a[52:55], v[236:239], v[68:71]
    ds_read_b64_tr_b16 a[16:17], v11 offset:41216
    buffer_load_dwordx4 v7, s[32:35], s51 offen offset:1024  lds
    v_mfma_f32_16x16x32_bf16 v[68:71], a[48:51], v[228:231], v[68:71]
    ds_read_b64_tr_b16 a[18:19], v11 offset:46336
    v_mfma_f32_16x16x32_bf16 v[72:75], a[56:59], v[224:227], v[72:75]
    ds_read_b64_tr_b16 a[20:21], v11 offset:51456
    v_mfma_f32_16x16x32_bf16 v[72:75], a[60:63], v[232:235], v[72:75]
    ds_read_b64_tr_b16 a[22:23], v11 offset:56576
    v_mfma_f32_16x16x32_bf16 v[76:79], a[60:63], v[236:239], v[76:79]
    ds_read_b64_tr_b16 a[24:25], v17 offset:0
    buffer_load_dwordx4 v8, s[32:35], s51 offen offset:2048  lds
    v_mfma_f32_16x16x32_bf16 v[76:79], a[56:59], v[228:231], v[76:79]
    ds_read_b64_tr_b16 a[26:27], v17 offset:5120
    s_waitcnt lgkmcnt(6)
    v_mfma_f32_16x16x32_bf16 v[80:83], a[0:3], v[224:227], v[80:83]
    ds_read_b64_tr_b16 a[28:29], v17 offset:10240
    v_mfma_f32_16x16x32_bf16 v[80:83], a[4:7], v[232:235], v[80:83]
    ds_read_b64_tr_b16 a[30:31], v17 offset:15360
    v_mfma_f32_16x16x32_bf16 v[84:87], a[4:7], v[236:239], v[84:87]
    ds_read_b64_tr_b16 a[32:33], v21 offset:32
    buffer_load_dwordx4 v9, s[32:35], s51 offen offset:3072  lds
    v_mfma_f32_16x16x32_bf16 v[84:87], a[0:3], v[228:231], v[84:87]
    ds_read_b64_tr_b16 a[34:35], v21 offset:5152
    v_mfma_f32_16x16x32_bf16 v[88:91], a[8:11], v[224:227], v[88:91]
    ds_read_b64_tr_b16 a[36:37], v21 offset:10272
    v_mfma_f32_16x16x32_bf16 v[88:91], a[12:15], v[232:235], v[88:91]
    ds_read_b64_tr_b16 a[38:39], v21 offset:15392
    v_mfma_f32_16x16x32_bf16 v[92:95], a[12:15], v[236:239], v[92:95]
    ds_read_b64_tr_b16 a[40:41], v17 offset:64
    v_mfma_f32_16x16x32_bf16 v[92:95], a[8:11], v[228:231], v[92:95]
    ds_read_b64_tr_b16 a[42:43], v17 offset:5184
    s_waitcnt lgkmcnt(6)
    v_mfma_f32_16x16x32_bf16 v[96:99], a[16:19], v[224:227], v[96:99]
    ds_read_b64_tr_b16 a[44:45], v17 offset:10304
    s_add_u32 m0, s50, 132096
    v_mfma_f32_16x16x32_bf16 v[96:99], a[20:23], v[232:235], v[96:99]
    ds_read_b64_tr_b16 a[46:47], v17 offset:15424
    buffer_load_dwordx4 v10, s[32:35], s51 offen offset:0  lds
    v_mfma_f32_16x16x32_bf16 v[100:103], a[20:23], v[236:239], v[100:103]
    ds_read_b64_tr_b16 a[48:49], v21 offset:96
    v_mfma_f32_16x16x32_bf16 v[100:103], a[16:19], v[228:231], v[100:103]
    ds_read_b64_tr_b16 a[50:51], v21 offset:5216
    buffer_store_dwordx4 v[44:47], v24, s[24:27], s69 offen sc1
    s_waitcnt vmcnt(60)
    v_mfma_f32_16x16x32_bf16 v[128:131], a[24:27], v[240:243], v[128:131]
    ds_read_b64_tr_b16 a[52:53], v21 offset:10336
    s_lshl_b32 s75, s17, 15
    s_add_u32 s75, s75, s49
    s_add_u32 s75, s75, 131072
    v_mfma_f32_16x16x32_bf16 v[128:131], a[28:31], v[248:251], v[128:131]
    ds_read_b64_tr_b16 a[54:55], v21 offset:15456
    v_mfma_f32_16x16x32_bf16 v[132:135], a[28:31], v[252:255], v[132:135]
    ds_read_b64_tr_b16 a[56:57], v17 offset:128
    v_mfma_f32_16x16x32_bf16 v[132:135], a[24:27], v[244:247], v[132:135]
    ds_read_b64_tr_b16 a[58:59], v17 offset:5248
    s_waitcnt lgkmcnt(6)
    v_mfma_f32_16x16x32_bf16 v[136:139], a[32:35], v[240:243], v[136:139]
    ds_read_b64_tr_b16 a[60:61], v17 offset:10368
    buffer_load_dwordx4 a[160:163], v16, s[24:27], s75 offen offset:0 sc1
    v_mfma_f32_16x16x32_bf16 v[136:139], a[36:39], v[248:251], v[136:139]
    ds_read_b64_tr_b16 a[62:63], v17 offset:15488
    buffer_load_dwordx4 a[164:167], v16, s[24:27], s75 offen offset:2048 sc1
    v_mfma_f32_16x16x32_bf16 v[140:143], a[36:39], v[252:255], v[140:143]
    ds_read_b64_tr_b16 a[0:1], v21 offset:160
    v_mfma_f32_16x16x32_bf16 v[140:143], a[32:35], v[244:247], v[140:143]
    ds_read_b64_tr_b16 a[2:3], v21 offset:5280
    v_mfma_f32_16x16x32_bf16 v[144:147], a[40:43], v[240:243], v[144:147]
    ds_read_b64_tr_b16 a[4:5], v21 offset:10400
    v_mfma_f32_16x16x32_bf16 v[144:147], a[44:47], v[248:251], v[144:147]
    ds_read_b64_tr_b16 a[6:7], v21 offset:15520
    s_add_u32 s75, s75, 8192
    v_mfma_f32_16x16x32_bf16 v[148:151], a[44:47], v[252:255], v[148:151]
    ds_read_b64_tr_b16 a[8:9], v17 offset:192
    v_mfma_f32_16x16x32_bf16 v[148:151], a[40:43], v[244:247], v[148:151]
    ds_read_b64_tr_b16 a[10:11], v17 offset:5312
    s_waitcnt lgkmcnt(6)
    v_mfma_f32_16x16x32_bf16 v[152:155], a[48:51], v[240:243], v[152:155]
    ds_read_b64_tr_b16 a[12:13], v17 offset:10432
    buffer_load_dwordx4 a[168:171], v16, s[24:27], s75 offen offset:0 sc1
    v_mfma_f32_16x16x32_bf16 v[152:155], a[52:55], v[248:251], v[152:155]
    ds_read_b64_tr_b16 a[14:15], v17 offset:15552
    buffer_load_dwordx4 a[172:175], v16, s[24:27], s75 offen offset:2048 sc1
    v_mfma_f32_16x16x32_bf16 v[156:159], a[52:55], v[252:255], v[156:159]
    ds_read_b64_tr_b16 a[16:17], v21 offset:224
    v_mfma_f32_16x16x32_bf16 v[156:159], a[48:51], v[244:247], v[156:159]
    ds_read_b64_tr_b16 a[18:19], v21 offset:5344
    v_mfma_f32_16x16x32_bf16 v[64:67], a[56:59], v[240:243], v[64:67]
    ds_read_b64_tr_b16 a[20:21], v21 offset:10464
    v_mfma_f32_16x16x32_bf16 v[64:67], a[60:63], v[248:251], v[64:67]
    ds_read_b64_tr_b16 a[22:23], v21 offset:15584
    v_mfma_f32_16x16x32_bf16 v[68:71], a[60:63], v[252:255], v[68:71]
    ds_read_b64_tr_b16 a[24:25], v17 offset:256
    s_add_u32 s75, s75, 8192
    v_mfma_f32_16x16x32_bf16 v[68:71], a[56:59], v[244:247], v[68:71]
    ds_read_b64_tr_b16 a[26:27], v17 offset:5376
    s_waitcnt lgkmcnt(6)
    v_mfma_f32_16x16x32_bf16 v[72:75], a[0:3], v[240:243], v[72:75]
    ds_read_b64_tr_b16 a[28:29], v17 offset:10496
    buffer_store_dwordx4 v[48:51], v23, s[24:27], s70 offen sc1
    v_mfma_f32_16x16x32_bf16 v[72:75], a[4:7], v[248:251], v[72:75]
    s_waitcnt vmcnt(18)
    s_barrier
    ds_read_b64_tr_b16 a[30:31], v17 offset:15616
    v_mfma_f32_16x16x32_bf16 v[76:79], a[4:7], v[252:255], v[76:79]
    ds_read_b64_tr_b16 a[32:33], v17 offset:20480
    buffer_load_dwordx4 a[176:179], v16, s[24:27], s75 offen offset:0 sc1
    v_mfma_f32_16x16x32_bf16 v[76:79], a[0:3], v[244:247], v[76:79]
    ds_read_b64_tr_b16 a[34:35], v17 offset:25600
    s_add_u32 s48, s48, 589824
    v_mfma_f32_16x16x32_bf16 v[80:83], a[8:11], v[240:243], v[80:83]
    ds_read_b64_tr_b16 a[36:37], v17 offset:30720
    s_mul_i32 s51, s16, 147456
    s_add_u32 s51, s51, s48
    v_mfma_f32_16x16x32_bf16 v[80:83], a[12:15], v[248:251], v[80:83]
    ds_read_b64_tr_b16 a[38:39], v17 offset:35840
    s_add_u32 m0, s50, 0
    v_mfma_f32_16x16x32_bf16 v[84:87], a[12:15], v[252:255], v[84:87]
    ds_read_b64_tr_b16 a[40:41], v21 offset:20512
    buffer_load_dwordx4 v6, s[32:35], s51 offen offset:0  lds
    v_mfma_f32_16x16x32_bf16 v[84:87], a[8:11], v[244:247], v[84:87]
    ds_read_b64_tr_b16 a[42:43], v21 offset:25632
    s_waitcnt lgkmcnt(6)
    v_mfma_f32_16x16x32_bf16 v[88:91], a[16:19], v[240:243], v[88:91]
    ds_read_b64_tr_b16 a[44:45], v21 offset:30752
    buffer_load_dwordx4 v7, s[32:35], s51 offen offset:1024  lds
    v_mfma_f32_16x16x32_bf16 v[88:91], a[20:23], v[248:251], v[88:91]
    ds_read_b64_tr_b16 a[46:47], v21 offset:35872
    v_mfma_f32_16x16x32_bf16 v[92:95], a[20:23], v[252:255], v[92:95]
    ds_read_b64_tr_b16 a[48:49], v17 offset:20544
    v_mfma_f32_16x16x32_bf16 v[92:95], a[16:19], v[244:247], v[92:95]
    ds_read_b64_tr_b16 a[50:51], v17 offset:25664
    v_mfma_f32_16x16x32_bf16 v[96:99], a[24:27], v[240:243], v[96:99]
    ds_read_b64_tr_b16 a[52:53], v17 offset:30784
    buffer_load_dwordx4 v8, s[32:35], s51 offen offset:2048  lds
    v_mfma_f32_16x16x32_bf16 v[96:99], a[28:31], v[248:251], v[96:99]
    ds_read_b64_tr_b16 a[54:55], v17 offset:35904
    v_mfma_f32_16x16x32_bf16 v[100:103], a[28:31], v[252:255], v[100:103]
    ds_read_b64_tr_b16 a[56:57], v21 offset:20576
    v_mfma_f32_16x16x32_bf16 v[100:103], a[24:27], v[244:247], v[100:103]
    ds_read_b64_tr_b16 a[58:59], v21 offset:25696
    s_waitcnt vmcnt(63)
    s_waitcnt lgkmcnt(6)
    v_mfma_f32_16x16x32_bf16 v[128:131], a[32:35], a[64:67], v[128:131]
    ds_read_b64_tr_b16 a[60:61], v21 offset:30816
    buffer_load_dwordx4 v9, s[32:35], s51 offen offset:3072  lds
    v_mfma_f32_16x16x32_bf16 v[128:131], a[36:39], a[72:75], v[128:131]
    ds_read_b64_tr_b16 a[62:63], v21 offset:35936
    v_mfma_f32_16x16x32_bf16 v[132:135], a[36:39], a[76:79], v[132:135]
    ds_read_b64_tr_b16 a[0:1], v17 offset:20608
    v_mfma_f32_16x16x32_bf16 v[132:135], a[32:35], a[68:71], v[132:135]
    ds_read_b64_tr_b16 a[2:3], v17 offset:25728
    v_mfma_f32_16x16x32_bf16 v[136:139], a[40:43], a[64:67], v[136:139]
    ds_read_b64_tr_b16 a[4:5], v17 offset:30848
    v_mfma_f32_16x16x32_bf16 v[136:139], a[44:47], a[72:75], v[136:139]
    ds_read_b64_tr_b16 a[6:7], v17 offset:35968
    buffer_store_dwordx4 v[52:55], v24, s[24:27], s70 offen sc1
    v_mfma_f32_16x16x32_bf16 v[140:143], a[44:47], a[76:79], v[140:143]
    ds_read_b64_tr_b16 a[8:9], v21 offset:20640
    s_add_u32 m0, s50, 4096
    v_mfma_f32_16x16x32_bf16 v[140:143], a[40:43], a[68:71], v[140:143]
    ds_read_b64_tr_b16 a[10:11], v21 offset:25760
    s_waitcnt lgkmcnt(6)
    v_mfma_f32_16x16x32_bf16 v[144:147], a[48:51], a[64:67], v[144:147]
    ds_read_b64_tr_b16 a[12:13], v21 offset:30880
    buffer_load_dwordx4 v10, s[32:35], s51 offen offset:0  lds
    v_mfma_f32_16x16x32_bf16 v[144:147], a[52:55], a[72:75], v[144:147]
    ds_read_b64_tr_b16 a[14:15], v21 offset:36000
    s_add_u32 s51, s51, 9216
    v_mfma_f32_16x16x32_bf16 v[148:151], a[52:55], a[76:79], v[148:151]
    ds_read_b64_tr_b16 a[16:17], v17 offset:20672
    v_mfma_f32_16x16x32_bf16 v[148:151], a[48:51], a[68:71], v[148:151]
    ds_read_b64_tr_b16 a[18:19], v17 offset:25792
    s_add_u32 m0, s50, 5120
    v_mfma_f32_16x16x32_bf16 v[152:155], a[56:59], a[64:67], v[152:155]
    ds_read_b64_tr_b16 a[20:21], v17 offset:30912
    v_mfma_f32_16x16x32_bf16 v[152:155], a[60:63], a[72:75], v[152:155]
    ds_read_b64_tr_b16 a[22:23], v17 offset:36032
    buffer_load_dwordx4 v6, s[32:35], s51 offen offset:0  lds
    v_mfma_f32_16x16x32_bf16 v[156:159], a[60:63], a[76:79], v[156:159]
    ds_read_b64_tr_b16 a[24:25], v21 offset:20704
    buffer_load_dwordx4 v7, s[32:35], s51 offen offset:1024  lds
    v_mfma_f32_16x16x32_bf16 v[156:159], a[56:59], a[68:71], v[156:159]
    ds_read_b64_tr_b16 a[26:27], v21 offset:25824
    s_waitcnt lgkmcnt(6)
    v_mfma_f32_16x16x32_bf16 v[64:67], a[0:3], a[64:67], v[64:67]
    ds_read_b64_tr_b16 a[28:29], v21 offset:30944
    v_mfma_f32_16x16x32_bf16 v[64:67], a[4:7], a[72:75], v[64:67]
    ds_read_b64_tr_b16 a[30:31], v21 offset:36064
    v_mfma_f32_16x16x32_bf16 v[68:71], a[4:7], a[76:79], v[68:71]
    ds_read_b64_tr_b16 a[32:33], v17 offset:20736
    v_mfma_f32_16x16x32_bf16 v[68:71], a[0:3], a[68:71], v[68:71]
    ds_read_b64_tr_b16 a[34:35], v17 offset:25856
    buffer_load_dwordx4 v8, s[32:35], s51 offen offset:2048  lds
    v_mfma_f32_16x16x32_bf16 v[72:75], a[8:11], a[64:67], v[72:75]
    ds_read_b64_tr_b16 a[36:37], v17 offset:30976
    v_mfma_f32_16x16x32_bf16 v[72:75], a[12:15], a[72:75], v[72:75]
    ds_read_b64_tr_b16 a[38:39], v17 offset:36096
    v_mfma_f32_16x16x32_bf16 v[76:79], a[12:15], a[76:79], v[76:79]
    ds_read_b64_tr_b16 a[40:41], v17 offset:40960
    v_mfma_f32_16x16x32_bf16 v[76:79], a[8:11], a[68:71], v[76:79]
    ds_read_b64_tr_b16 a[42:43], v17 offset:46080
    s_waitcnt lgkmcnt(6)
    v_mfma_f32_16x16x32_bf16 v[80:83], a[16:19], a[64:67], v[80:83]
    ds_read_b64_tr_b16 a[44:45], v17 offset:51200
    buffer_load_dwordx4 v9, s[32:35], s51 offen offset:3072  lds
    v_mfma_f32_16x16x32_bf16 v[80:83], a[20:23], a[72:75], v[80:83]
    ds_read_b64_tr_b16 a[46:47], v17 offset:56320
    v_mfma_f32_16x16x32_bf16 v[84:87], a[20:23], a[76:79], v[84:87]
    ds_read_b64_tr_b16 a[48:49], v21 offset:40992
    buffer_store_dwordx4 v[56:59], v23, s[24:27], s71 offen sc1
    v_mfma_f32_16x16x32_bf16 v[84:87], a[16:19], a[68:71], v[84:87]
    ds_read_b64_tr_b16 a[50:51], v21 offset:46112
    v_mfma_f32_16x16x32_bf16 v[88:91], a[24:27], a[64:67], v[88:91]
    ds_read_b64_tr_b16 a[52:53], v21 offset:51232
    s_add_u32 m0, s50, 9216
    v_mfma_f32_16x16x32_bf16 v[88:91], a[28:31], a[72:75], v[88:91]
    ds_read_b64_tr_b16 a[54:55], v21 offset:56352
    v_mfma_f32_16x16x32_bf16 v[92:95], a[28:31], a[76:79], v[92:95]
    ds_read_b64_tr_b16 a[56:57], v17 offset:41024
    buffer_load_dwordx4 v10, s[32:35], s51 offen offset:0  lds
    v_mfma_f32_16x16x32_bf16 v[92:95], a[24:27], a[68:71], v[92:95]
    ds_read_b64_tr_b16 a[58:59], v17 offset:46144
    s_waitcnt lgkmcnt(6)
    v_mfma_f32_16x16x32_bf16 v[96:99], a[32:35], a[64:67], v[96:99]
    ds_read_b64_tr_b16 a[60:61], v17 offset:51264
    buffer_load_dwordx4 a[180:183], v16, s[24:27], s75 offen offset:2048 sc1
    v_mfma_f32_16x16x32_bf16 v[96:99], a[36:39], a[72:75], v[96:99]
    ds_read_b64_tr_b16 a[62:63], v17 offset:56384
    v_mfma_f32_16x16x32_bf16 v[100:103], a[36:39], a[76:79], v[100:103]
    ds_read_b64_tr_b16 a[0:1], v21 offset:41056
    v_mfma_f32_16x16x32_bf16 v[100:103], a[32:35], a[68:71], v[100:103]
    ds_read_b64_tr_b16 a[2:3], v21 offset:46176
    s_waitcnt vmcnt(63)
    v_mfma_f32_16x16x32_bf16 v[128:131], a[40:43], a[80:83], v[128:131]
    ds_read_b64_tr_b16 a[4:5], v21 offset:51296
    v_mfma_f32_16x16x32_bf16 v[128:131], a[44:47], a[88:91], v[128:131]
    ds_read_b64_tr_b16 a[6:7], v21 offset:56416
    s_add_u32 s75, s75, 8192
    v_mfma_f32_16x16x32_bf16 v[132:135], a[44:47], a[92:95], v[132:135]
    ds_read_b64_tr_b16 a[8:9], v17 offset:41088
    v_mfma_f32_16x16x32_bf16 v[132:135], a[40:43], a[84:87], v[132:135]
    ds_read_b64_tr_b16 a[10:11], v17 offset:46208
    s_waitcnt lgkmcnt(6)
    v_mfma_f32_16x16x32_bf16 v[136:139], a[48:51], a[80:83], v[136:139]
    ds_read_b64_tr_b16 a[12:13], v17 offset:51328
    buffer_load_dwordx4 a[184:187], v16, s[24:27], s75 offen offset:0 sc1
    v_mfma_f32_16x16x32_bf16 v[136:139], a[52:55], a[88:91], v[136:139]
    ds_read_b64_tr_b16 a[14:15], v17 offset:56448
    v_mfma_f32_16x16x32_bf16 v[140:143], a[52:55], a[92:95], v[140:143]
    ds_read_b64_tr_b16 a[16:17], v21 offset:41120
    buffer_load_dwordx4 a[188:191], v16, s[24:27], s75 offen offset:2048 sc1
    v_mfma_f32_16x16x32_bf16 v[140:143], a[48:51], a[84:87], v[140:143]
    ds_read_b64_tr_b16 a[18:19], v21 offset:46240
    v_mfma_f32_16x16x32_bf16 v[144:147], a[56:59], a[80:83], v[144:147]
    ds_read_b64_tr_b16 a[20:21], v21 offset:51360
    v_mfma_f32_16x16x32_bf16 v[144:147], a[60:63], a[88:91], v[144:147]
    ds_read_b64_tr_b16 a[22:23], v21 offset:56480
    v_mfma_f32_16x16x32_bf16 v[148:151], a[60:63], a[92:95], v[148:151]
    ds_read_b64_tr_b16 a[24:25], v17 offset:41152
    s_lshl_b32 s75, s18, 15
    s_add_u32 s75, s75, s49
    s_add_u32 s75, s75, 131072
    v_mfma_f32_16x16x32_bf16 v[148:151], a[56:59], a[84:87], v[148:151]
    ds_read_b64_tr_b16 a[26:27], v17 offset:46272
    s_waitcnt lgkmcnt(6)
    v_mfma_f32_16x16x32_bf16 v[152:155], a[0:3], a[80:83], v[152:155]
    ds_read_b64_tr_b16 a[28:29], v17 offset:51392
    buffer_store_dwordx4 v[60:63], v24, s[24:27], s71 offen sc1
    v_mfma_f32_16x16x32_bf16 v[152:155], a[4:7], a[88:91], v[152:155]
    ds_read_b64_tr_b16 a[30:31], v17 offset:56512
    v_mfma_f32_16x16x32_bf16 v[156:159], a[4:7], a[92:95], v[156:159]
    ds_read_b64_tr_b16 a[32:33], v21 offset:41184
    buffer_load_dwordx4 a[192:195], v16, s[24:27], s75 offen offset:0 sc1
    v_mfma_f32_16x16x32_bf16 v[156:159], a[0:3], a[84:87], v[156:159]
    ds_read_b64_tr_b16 a[34:35], v21 offset:46304
    buffer_load_dwordx4 a[196:199], v16, s[24:27], s75 offen offset:2048 sc1
    v_mfma_f32_16x16x32_bf16 v[64:67], a[8:11], a[80:83], v[64:67]
    ds_read_b64_tr_b16 a[36:37], v21 offset:51424
    v_mfma_f32_16x16x32_bf16 v[64:67], a[12:15], a[88:91], v[64:67]
    ds_read_b64_tr_b16 a[38:39], v21 offset:56544
    v_mfma_f32_16x16x32_bf16 v[68:71], a[12:15], a[92:95], v[68:71]
    ds_read_b64_tr_b16 a[40:41], v17 offset:41216
    v_mfma_f32_16x16x32_bf16 v[68:71], a[8:11], a[84:87], v[68:71]
    ds_read_b64_tr_b16 a[42:43], v17 offset:46336
    s_waitcnt lgkmcnt(6)
    v_mfma_f32_16x16x32_bf16 v[72:75], a[16:19], a[80:83], v[72:75]
    ds_read_b64_tr_b16 a[44:45], v17 offset:51456
    s_add_u32 s75, s75, 8192
    v_mfma_f32_16x16x32_bf16 v[72:75], a[20:23], a[88:91], v[72:75]
    s_waitcnt vmcnt(25)
    s_barrier
    ds_read_b64_tr_b16 a[46:47], v17 offset:56576
    v_mfma_f32_16x16x32_bf16 v[76:79], a[20:23], a[92:95], v[76:79]
    ds_read_b64_tr_b16 a[48:49], v18 offset:0
    buffer_load_dwordx4 a[200:203], v16, s[24:27], s75 offen offset:0 sc1
    v_mfma_f32_16x16x32_bf16 v[76:79], a[16:19], a[84:87], v[76:79]
    ds_read_b64_tr_b16 a[50:51], v18 offset:5120
    v_mfma_f32_16x16x32_bf16 v[80:83], a[24:27], a[80:83], v[80:83]
    ds_read_b64_tr_b16 a[52:53], v18 offset:10240
    s_mul_i32 s51, s17, 147456
    s_add_u32 s51, s51, s48
    v_mfma_f32_16x16x32_bf16 v[80:83], a[28:31], a[88:91], v[80:83]
    ds_read_b64_tr_b16 a[54:55], v18 offset:15360
    v_mfma_f32_16x16x32_bf16 v[84:87], a[28:31], a[92:95], v[84:87]
    ds_read_b64_tr_b16 a[56:57], v19 offset:32
    v_mfma_f32_16x16x32_bf16 v[84:87], a[24:27], a[84:87], v[84:87]
    ds_read_b64_tr_b16 a[58:59], v19 offset:5152
    s_waitcnt lgkmcnt(6)
    v_mfma_f32_16x16x32_bf16 v[88:91], a[32:35], a[80:83], v[88:91]
    ds_read_b64_tr_b16 a[60:61], v19 offset:10272
    s_add_u32 m0, s50, 40960
    v_mfma_f32_16x16x32_bf16 v[88:91], a[36:39], a[88:91], v[88:91]
    ds_read_b64_tr_b16 a[62:63], v19 offset:15392
    buffer_load_dwordx4 v6, s[32:35], s51 offen offset:0  lds
    v_mfma_f32_16x16x32_bf16 v[92:95], a[36:39], a[92:95], v[92:95]
    ds_read_b64_tr_b16 a[0:1], v18 offset:64
    buffer_load_dwordx4 v7, s[32:35], s51 offen offset:1024  lds
    v_mfma_f32_16x16x32_bf16 v[92:95], a[32:35], a[84:87], v[92:95]
    ds_read_b64_tr_b16 a[2:3], v18 offset:5184
    v_mfma_f32_16x16x32_bf16 v[96:99], a[40:43], a[80:83], v[96:99]
    ds_read_b64_tr_b16 a[4:5], v18 offset:10304
    v_mfma_f32_16x16x32_bf16 v[96:99], a[44:47], a[88:91], v[96:99]
    ds_read_b64_tr_b16 a[6:7], v18 offset:15424
    buffer_load_dwordx4 v8, s[32:35], s51 offen offset:2048  lds
    v_mfma_f32_16x16x32_bf16 v[100:103], a[44:47], a[92:95], v[100:103]
    ds_read_b64_tr_b16 a[8:9], v19 offset:96
    v_mfma_f32_16x16x32_bf16 v[100:103], a[40:43], a[84:87], v[100:103]
    ds_read_b64_tr_b16 a[10:11], v19 offset:5216
    s_waitcnt vmcnt(63)
    s_waitcnt lgkmcnt(6)
    v_mfma_f32_16x16x32_bf16 v[128:131], a[48:51], a[96:99], v[128:131]
    ds_read_b64_tr_b16 a[12:13], v19 offset:10336
    v_mfma_f32_16x16x32_bf16 v[128:131], a[52:55], a[104:107], v[128:131]
    ds_read_b64_tr_b16 a[14:15], v19 offset:15456
    v_mfma_f32_16x16x32_bf16 v[132:135], a[52:55], a[108:111], v[132:135]
    ds_read_b64_tr_b16 a[16:17], v18 offset:128
    buffer_load_dwordx4 v9, s[32:35], s51 offen offset:3072  lds
    v_mfma_f32_16x16x32_bf16 v[132:135], a[48:51], a[100:103], v[132:135]
    ds_read_b64_tr_b16 a[18:19], v18 offset:5248
    v_mfma_f32_16x16x32_bf16 v[136:139], a[56:59], a[96:99], v[136:139]
    ds_read_b64_tr_b16 a[20:21], v18 offset:10368
    v_mfma_f32_16x16x32_bf16 v[136:139], a[60:63], a[104:107], v[136:139]
    ds_read_b64_tr_b16 a[22:23], v18 offset:15488
    v_mfma_f32_16x16x32_bf16 v[140:143], a[60:63], a[108:111], v[140:143]
    ds_read_b64_tr_b16 a[24:25], v19 offset:160
    s_add_u32 m0, s50, 45056
    v_mfma_f32_16x16x32_bf16 v[140:143], a[56:59], a[100:103], v[140:143]
    ds_read_b64_tr_b16 a[26:27], v19 offset:5280
    s_waitcnt lgkmcnt(6)
    v_mfma_f32_16x16x32_bf16 v[144:147], a[0:3], a[96:99], v[144:147]
    ds_read_b64_tr_b16 a[28:29], v19 offset:10400
    v_mfma_f32_16x16x32_bf16 v[144:147], a[4:7], a[104:107], v[144:147]
    ds_read_b64_tr_b16 a[30:31], v19 offset:15520
    buffer_load_dwordx4 v10, s[32:35], s51 offen offset:0  lds
    v_mfma_f32_16x16x32_bf16 v[148:151], a[4:7], a[108:111], v[148:151]
    ds_read_b64_tr_b16 a[32:33], v18 offset:192
    v_mfma_f32_16x16x32_bf16 v[148:151], a[0:3], a[100:103], v[148:151]
    ds_read_b64_tr_b16 a[34:35], v18 offset:5312
    s_add_u32 s51, s51, 9216
    v_mfma_f32_16x16x32_bf16 v[152:155], a[8:11], a[96:99], v[152:155]
    ds_read_b64_tr_b16 a[36:37], v18 offset:10432
    v_mfma_f32_16x16x32_bf16 v[152:155], a[12:15], a[104:107], v[152:155]
    ds_read_b64_tr_b16 a[38:39], v18 offset:15552
    s_add_u32 m0, s50, 46080
    v_mfma_f32_16x16x32_bf16 v[156:159], a[12:15], a[108:111], v[156:159]
    ds_read_b64_tr_b16 a[40:41], v19 offset:224
    v_mfma_f32_16x16x32_bf16 v[156:159], a[8:11], a[100:103], v[156:159]
    ds_read_b64_tr_b16 a[42:43], v19 offset:5344
    s_waitcnt lgkmcnt(6)
    v_mfma_f32_16x16x32_bf16 v[64:67], a[16:19], a[96:99], v[64:67]
    ds_read_b64_tr_b16 a[44:45], v19 offset:10464
    buffer_load_dwordx4 v6, s[32:35], s51 offen offset:0  lds
    v_mfma_f32_16x16x32_bf16 v[64:67], a[20:23], a[104:107], v[64:67]
    ds_read_b64_tr_b16 a[46:47], v19 offset:15584
    buffer_load_dwordx4 v7, s[32:35], s51 offen offset:1024  lds
    v_mfma_f32_16x16x32_bf16 v[68:71], a[20:23], a[108:111], v[68:71]
    ds_read_b64_tr_b16 a[48:49], v18 offset:256
    v_mfma_f32_16x16x32_bf16 v[68:71], a[16:19], a[100:103], v[68:71]
    ds_read_b64_tr_b16 a[50:51], v18 offset:5376
    v_mfma_f32_16x16x32_bf16 v[72:75], a[24:27], a[96:99], v[72:75]
    ds_read_b64_tr_b16 a[52:53], v18 offset:10496
    buffer_load_dwordx4 v8, s[32:35], s51 offen offset:2048  lds
    v_mfma_f32_16x16x32_bf16 v[72:75], a[28:31], a[104:107], v[72:75]
    ds_read_b64_tr_b16 a[54:55], v18 offset:15616
    v_mfma_f32_16x16x32_bf16 v[76:79], a[28:31], a[108:111], v[76:79]
    ds_read_b64_tr_b16 a[56:57], v18 offset:20480
    v_mfma_f32_16x16x32_bf16 v[76:79], a[24:27], a[100:103], v[76:79]
    ds_read_b64_tr_b16 a[58:59], v18 offset:25600
    s_waitcnt lgkmcnt(6)
    v_mfma_f32_16x16x32_bf16 v[80:83], a[32:35], a[96:99], v[80:83]
    ds_read_b64_tr_b16 a[60:61], v18 offset:30720
    v_mfma_f32_16x16x32_bf16 v[80:83], a[36:39], a[104:107], v[80:83]
    ds_read_b64_tr_b16 a[62:63], v18 offset:35840
    buffer_load_dwordx4 v9, s[32:35], s51 offen offset:3072  lds
    v_mfma_f32_16x16x32_bf16 v[84:87], a[36:39], a[108:111], v[84:87]
    ds_read_b64_tr_b16 a[0:1], v19 offset:20512
    v_mfma_f32_16x16x32_bf16 v[84:87], a[32:35], a[100:103], v[84:87]
    ds_read_b64_tr_b16 a[2:3], v19 offset:25632
    v_mfma_f32_16x16x32_bf16 v[88:91], a[40:43], a[96:99], v[88:91]
    ds_read_b64_tr_b16 a[4:5], v19 offset:30752
    v_mfma_f32_16x16x32_bf16 v[88:91], a[44:47], a[104:107], v[88:91]
    ds_read_b64_tr_b16 a[6:7], v19 offset:35872
    s_add_u32 m0, s50, 50176
    v_mfma_f32_16x16x32_bf16 v[92:95], a[44:47], a[108:111], v[92:95]
    ds_read_b64_tr_b16 a[8:9], v18 offset:20544
    v_mfma_f32_16x16x32_bf16 v[92:95], a[40:43], a[100:103], v[92:95]
    ds_read_b64_tr_b16 a[10:11], v18 offset:25664
    s_waitcnt lgkmcnt(6)
    v_mfma_f32_16x16x32_bf16 v[96:99], a[48:51], a[96:99], v[96:99]
    ds_read_b64_tr_b16 a[12:13], v18 offset:30784
    buffer_load_dwordx4 v10, s[32:35], s51 offen offset:0  lds
    v_mfma_f32_16x16x32_bf16 v[96:99], a[52:55], a[104:107], v[96:99]
    ds_read_b64_tr_b16 a[14:15], v18 offset:35904
    v_mfma_f32_16x16x32_bf16 v[100:103], a[52:55], a[108:111], v[100:103]
    ds_read_b64_tr_b16 a[16:17], v19 offset:20576
    buffer_load_dwordx4 a[204:207], v16, s[24:27], s75 offen offset:2048 sc1
    v_mfma_f32_16x16x32_bf16 v[100:103], a[48:51], a[100:103], v[100:103]
    ds_read_b64_tr_b16 a[18:19], v19 offset:25696
    s_waitcnt vmcnt(63)
    v_mfma_f32_16x16x32_bf16 v[128:131], a[56:59], a[112:115], v[128:131]
    ds_read_b64_tr_b16 a[20:21], v19 offset:30816
    v_mfma_f32_16x16x32_bf16 v[128:131], a[60:63], a[120:123], v[128:131]
    ds_read_b64_tr_b16 a[22:23], v19 offset:35936
    v_mfma_f32_16x16x32_bf16 v[132:135], a[60:63], a[124:127], v[132:135]
    ds_read_b64_tr_b16 a[24:25], v18 offset:20608
    v_mfma_f32_16x16x32_bf16 v[132:135], a[56:59], a[116:119], v[132:135]
    ds_read_b64_tr_b16 a[26:27], v18 offset:25728
    s_waitcnt lgkmcnt(6)
    v_mfma_f32_16x16x32_bf16 v[136:139], a[0:3], a[112:115], v[136:139]
    ds_read_b64_tr_b16 a[28:29], v18 offset:30848
    s_add_u32 s75, s75, 8192
    v_mfma_f32_16x16x32_bf16 v[136:139], a[4:7], a[120:123], v[136:139]
    ds_read_b64_tr_b16 a[30:31], v18 offset:35968
    buffer_load_dwordx4 a[208:211], v16, s[24:27], s75 offen offset:0 sc1
    v_mfma_f32_16x16x32_bf16 v[140:143], a[4:7], a[124:127], v[140:143]
    ds_read_b64_tr_b16 a[32:33], v19 offset:20640
    v_mfma_f32_16x16x32_bf16 v[140:143], a[0:3], a[116:119], v[140:143]
    ds_read_b64_tr_b16 a[34:35], v19 offset:25760
    buffer_load_dwordx4 a[212:215], v16, s[24:27], s75 offen offset:2048 sc1
    v_mfma_f32_16x16x32_bf16 v[144:147], a[8:11], a[112:115], v[144:147]
    ds_read_b64_tr_b16 a[36:37], v19 offset:30880
    v_mfma_f32_16x16x32_bf16 v[144:147], a[12:15], a[120:123], v[144:147]
    ds_read_b64_tr_b16 a[38:39], v19 offset:36000
    v_mfma_f32_16x16x32_bf16 v[148:151], a[12:15], a[124:127], v[148:151]
    ds_read_b64_tr_b16 a[40:41], v18 offset:20672
    v_mfma_f32_16x16x32_bf16 v[148:151], a[8:11], a[116:119], v[148:151]
    ds_read_b64_tr_b16 a[42:43], v18 offset:25792
    s_waitcnt lgkmcnt(6)
    v_mfma_f32_16x16x32_bf16 v[152:155], a[16:19], a[112:115], v[152:155]
    ds_read_b64_tr_b16 a[44:45], v18 offset:30912
    s_add_u32 s75, s75, 8192
    v_mfma_f32_16x16x32_bf16 v[152:155], a[20:23], a[120:123], v[152:155]
    ds_read_b64_tr_b16 a[46:47], v18 offset:36032
    v_mfma_f32_16x16x32_bf16 v[156:159], a[20:23], a[124:127], v[156:159]
    ds_read_b64_tr_b16 a[48:49], v19 offset:20704
    buffer_load_dwordx4 a[216:219], v16, s[24:27], s75 offen offset:0 sc1
    v_mfma_f32_16x16x32_bf16 v[156:159], a[16:19], a[116:119], v[156:159]
    ds_read_b64_tr_b16 a[50:51], v19 offset:25824
    v_mfma_f32_16x16x32_bf16 v[64:67], a[24:27], a[112:115], v[64:67]
    ds_read_b64_tr_b16 a[52:53], v19 offset:30944
    buffer_load_dwordx4 a[220:223], v16, s[24:27], s75 offen offset:2048 sc1
    v_mfma_f32_16x16x32_bf16 v[64:67], a[28:31], a[120:123], v[64:67]
    ds_read_b64_tr_b16 a[54:55], v19 offset:36064
    v_mfma_f32_16x16x32_bf16 v[68:71], a[28:31], a[124:127], v[68:71]
    ds_read_b64_tr_b16 a[56:57], v18 offset:20736
    v_mfma_f32_16x16x32_bf16 v[68:71], a[24:27], a[116:119], v[68:71]
    ds_read_b64_tr_b16 a[58:59], v18 offset:25856
    s_waitcnt lgkmcnt(6)
    v_mfma_f32_16x16x32_bf16 v[72:75], a[32:35], a[112:115], v[72:75]
    ds_read_b64_tr_b16 a[60:61], v18 offset:30976
    v_mfma_f32_16x16x32_bf16 v[72:75], a[36:39], a[120:123], v[72:75]
    s_waitcnt vmcnt(18)
    s_barrier
    v_mov_b32 v29, s7
    v_add_u32 v29, 4, v29
    buffer_store_dword v29, v30, s[24:27], s6 offen sc1
    ds_read_b64_tr_b16 a[62:63], v18 offset:36096
    v_mfma_f32_16x16x32_bf16 v[76:79], a[36:39], a[124:127], v[76:79]
    ds_read_b64_tr_b16 a[0:1], v11 offset:0
    s_lshl_b32 s75, s19, 15
    s_add_u32 s75, s75, s49
    s_add_u32 s75, s75, 131072
    v_mfma_f32_16x16x32_bf16 v[76:79], a[32:35], a[116:119], v[76:79]
    ds_read_b64_tr_b16 a[2:3], v11 offset:5120
    v_mfma_f32_16x16x32_bf16 v[80:83], a[40:43], a[112:115], v[80:83]
    ds_read_b64_tr_b16 a[4:5], v11 offset:10240
    v_mfma_f32_16x16x32_bf16 v[80:83], a[44:47], a[120:123], v[80:83]
    ds_read_b64_tr_b16 a[6:7], v11 offset:15360
    buffer_load_dwordx4 a[224:227], v16, s[24:27], s75 offen offset:0 sc1
    v_mfma_f32_16x16x32_bf16 v[84:87], a[44:47], a[124:127], v[84:87]
    ds_read_b64_tr_b16 a[8:9], v14 offset:32
    s_mul_i32 s51, s18, 147456
    s_add_u32 s51, s51, s48
    v_mfma_f32_16x16x32_bf16 v[84:87], a[40:43], a[116:119], v[84:87]
    ds_read_b64_tr_b16 a[10:11], v14 offset:5152
    s_waitcnt lgkmcnt(6)
    v_mfma_f32_16x16x32_bf16 v[88:91], a[48:51], a[112:115], v[88:91]
    ds_read_b64_tr_b16 a[12:13], v14 offset:10272
    s_add_u32 m0, s50, 81920
    v_mfma_f32_16x16x32_bf16 v[88:91], a[52:55], a[120:123], v[88:91]
    ds_read_b64_tr_b16 a[14:15], v14 offset:15392
    buffer_load_dwordx4 v6, s[32:35], s51 offen offset:0  lds
    v_mfma_f32_16x16x32_bf16 v[92:95], a[52:55], a[124:127], v[92:95]
    ds_read_b64_tr_b16 a[16:17], v11 offset:64
    buffer_load_dwordx4 v7, s[32:35], s51 offen offset:1024  lds
    v_mfma_f32_16x16x32_bf16 v[92:95], a[48:51], a[116:119], v[92:95]
    ds_read_b64_tr_b16 a[18:19], v11 offset:5184
    v_mfma_f32_16x16x32_bf16 v[96:99], a[56:59], a[112:115], v[96:99]
    ds_read_b64_tr_b16 a[20:21], v11 offset:10304
    v_mfma_f32_16x16x32_bf16 v[96:99], a[60:63], a[120:123], v[96:99]
    ds_read_b64_tr_b16 a[22:23], v11 offset:15424
    v_mfma_f32_16x16x32_bf16 v[100:103], a[60:63], a[124:127], v[100:103]
    ds_read_b64_tr_b16 a[24:25], v14 offset:96
    v_mfma_f32_16x16x32_bf16 v[100:103], a[56:59], a[116:119], v[100:103]
    ds_read_b64_tr_b16 a[26:27], v14 offset:5216
    s_waitcnt vmcnt(63)
    s_waitcnt lgkmcnt(6)
    v_mfma_f32_16x16x32_bf16 v[128:131], a[0:3], a[128:131], v[128:131]
    ds_read_b64_tr_b16 a[28:29], v14 offset:10336
    buffer_load_dwordx4 v8, s[32:35], s51 offen offset:2048  lds
    v_mfma_f32_16x16x32_bf16 v[128:131], a[4:7], a[136:139], v[128:131]
    ds_read_b64_tr_b16 a[30:31], v14 offset:15456
    v_mfma_f32_16x16x32_bf16 v[132:135], a[4:7], a[140:143], v[132:135]
    ds_read_b64_tr_b16 a[32:33], v11 offset:128
    v_mfma_f32_16x16x32_bf16 v[132:135], a[0:3], a[132:135], v[132:135]
    ds_read_b64_tr_b16 a[34:35], v11 offset:5248
    buffer_load_dwordx4 v9, s[32:35], s51 offen offset:3072  lds
    v_mfma_f32_16x16x32_bf16 v[136:139], a[8:11], a[128:131], v[136:139]
    ds_read_b64_tr_b16 a[36:37], v11 offset:10368
    v_mfma_f32_16x16x32_bf16 v[136:139], a[12:15], a[136:139], v[136:139]
    ds_read_b64_tr_b16 a[38:39], v11 offset:15488
    v_mfma_f32_16x16x32_bf16 v[140:143], a[12:15], a[140:143], v[140:143]
    ds_read_b64_tr_b16 a[40:41], v14 offset:160
    v_mfma_f32_16x16x32_bf16 v[140:143], a[8:11], a[132:135], v[140:143]
    ds_read_b64_tr_b16 a[42:43], v14 offset:5280
    s_waitcnt lgkmcnt(6)
    v_mfma_f32_16x16x32_bf16 v[144:147], a[16:19], a[128:131], v[144:147]
    ds_read_b64_tr_b16 a[44:45], v14 offset:10400
    s_add_u32 m0, s50, 86016
    v_mfma_f32_16x16x32_bf16 v[144:147], a[20:23], a[136:139], v[144:147]
    ds_read_b64_tr_b16 a[46:47], v14 offset:15520
    v_mfma_f32_16x16x32_bf16 v[148:151], a[20:23], a[140:143], v[148:151]
    ds_read_b64_tr_b16 a[48:49], v11 offset:192
    v_mfma_f32_16x16x32_bf16 v[148:151], a[16:19], a[132:135], v[148:151]
    ds_read_b64_tr_b16 a[50:51], v11 offset:5312
    buffer_load_dwordx4 v10, s[32:35], s51 offen offset:0  lds
    v_mfma_f32_16x16x32_bf16 v[152:155], a[24:27], a[128:131], v[152:155]
    ds_read_b64_tr_b16 a[52:53], v11 offset:10432
    v_mfma_f32_16x16x32_bf16 v[152:155], a[28:31], a[136:139], v[152:155]
    ds_read_b64_tr_b16 a[54:55], v11 offset:15552
    s_add_u32 s51, s51, 9216
    v_mfma_f32_16x16x32_bf16 v[156:159], a[28:31], a[140:143], v[156:159]
    ds_read_b64_tr_b16 a[56:57], v14 offset:224
    s_add_u32 m0, s50, 87040
    v_mfma_f32_16x16x32_bf16 v[156:159], a[24:27], a[132:135], v[156:159]
    ds_read_b64_tr_b16 a[58:59], v14 offset:5344
    s_waitcnt lgkmcnt(6)
    v_mfma_f32_16x16x32_bf16 v[64:67], a[32:35], a[128:131], v[64:67]
    ds_read_b64_tr_b16 a[60:61], v14 offset:10464
    buffer_load_dwordx4 v6, s[32:35], s51 offen offset:0  lds
    v_mfma_f32_16x16x32_bf16 v[64:67], a[36:39], a[136:139], v[64:67]
    ds_read_b64_tr_b16 a[62:63], v14 offset:15584
    buffer_load_dwordx4 v7, s[32:35], s51 offen offset:1024  lds
    v_mfma_f32_16x16x32_bf16 v[68:71], a[36:39], a[140:143], v[68:71]
    ds_read_b64_tr_b16 a[0:1], v11 offset:256
    v_mfma_f32_16x16x32_bf16 v[68:71], a[32:35], a[132:135], v[68:71]
    ds_read_b64_tr_b16 a[2:3], v11 offset:5376
    v_mfma_f32_16x16x32_bf16 v[72:75], a[40:43], a[128:131], v[72:75]
    ds_read_b64_tr_b16 a[4:5], v11 offset:10496
    v_mfma_f32_16x16x32_bf16 v[72:75], a[44:47], a[136:139], v[72:75]
    ds_read_b64_tr_b16 a[6:7], v11 offset:15616
    v_mfma_f32_16x16x32_bf16 v[76:79], a[44:47], a[140:143], v[76:79]
    ds_read_b64_tr_b16 a[8:9], v11 offset:20480
    buffer_load_dwordx4 v8, s[32:35], s51 offen offset:2048  lds
    v_mfma_f32_16x16x32_bf16 v[76:79], a[40:43], a[132:135], v[76:79]
    ds_read_b64_tr_b16 a[10:11], v11 offset:25600
    s_waitcnt lgkmcnt(6)
    v_mfma_f32_16x16x32_bf16 v[80:83], a[48:51], a[128:131], v[80:83]
    ds_read_b64_tr_b16 a[12:13], v11 offset:30720
    v_mfma_f32_16x16x32_bf16 v[80:83], a[52:55], a[136:139], v[80:83]
    ds_read_b64_tr_b16 a[14:15], v11 offset:35840
    v_mfma_f32_16x16x32_bf16 v[84:87], a[52:55], a[140:143], v[84:87]
    ds_read_b64_tr_b16 a[16:17], v14 offset:20512
    v_mfma_f32_16x16x32_bf16 v[84:87], a[48:51], a[132:135], v[84:87]
    ds_read_b64_tr_b16 a[18:19], v14 offset:25632
    buffer_load_dwordx4 v9, s[32:35], s51 offen offset:3072  lds
    v_mfma_f32_16x16x32_bf16 v[88:91], a[56:59], a[128:131], v[88:91]
    ds_read_b64_tr_b16 a[20:21], v14 offset:30752
    v_mfma_f32_16x16x32_bf16 v[88:91], a[60:63], a[136:139], v[88:91]
    ds_read_b64_tr_b16 a[22:23], v14 offset:35872
    v_mfma_f32_16x16x32_bf16 v[92:95], a[60:63], a[140:143], v[92:95]
    ds_read_b64_tr_b16 a[24:25], v11 offset:20544
    v_mfma_f32_16x16x32_bf16 v[92:95], a[56:59], a[132:135], v[92:95]
    ds_read_b64_tr_b16 a[26:27], v11 offset:25664
    s_waitcnt lgkmcnt(6)
    v_mfma_f32_16x16x32_bf16 v[96:99], a[0:3], a[128:131], v[96:99]
    ds_read_b64_tr_b16 a[28:29], v11 offset:30784
    s_add_u32 m0, s50, 91136
    v_mfma_f32_16x16x32_bf16 v[96:99], a[4:7], a[136:139], v[96:99]
    ds_read_b64_tr_b16 a[30:31], v11 offset:35904
    v_mfma_f32_16x16x32_bf16 v[100:103], a[4:7], a[140:143], v[100:103]
    ds_read_b64_tr_b16 a[32:33], v14 offset:20576
    buffer_load_dwordx4 v10, s[32:35], s51 offen offset:0  lds
    v_mfma_f32_16x16x32_bf16 v[100:103], a[0:3], a[132:135], v[100:103]
    ds_read_b64_tr_b16 a[34:35], v14 offset:25696
    s_waitcnt vmcnt(63)
    v_mfma_f32_16x16x32_bf16 v[128:131], a[8:11], a[144:147], v[128:131]
    ds_read_b64_tr_b16 a[36:37], v14 offset:30816
    buffer_load_dwordx4 a[228:231], v16, s[24:27], s75 offen offset:2048 sc1
    v_mfma_f32_16x16x32_bf16 v[128:131], a[12:15], a[152:155], v[128:131]
    ds_read_b64_tr_b16 a[38:39], v14 offset:35936
    v_mfma_f32_16x16x32_bf16 v[132:135], a[12:15], a[156:159], v[132:135]
    ds_read_b64_tr_b16 a[40:41], v11 offset:20608
    v_mfma_f32_16x16x32_bf16 v[132:135], a[8:11], a[148:151], v[132:135]
    ds_read_b64_tr_b16 a[42:43], v11 offset:25728
    s_waitcnt lgkmcnt(6)
    v_mfma_f32_16x16x32_bf16 v[136:139], a[16:19], a[144:147], v[136:139]
    ds_read_b64_tr_b16 a[44:45], v11 offset:30848
    s_add_u32 s75, s75, 8192
    v_mfma_f32_16x16x32_bf16 v[136:139], a[20:23], a[152:155], v[136:139]
    ds_read_b64_tr_b16 a[46:47], v11 offset:35968
    v_mfma_f32_16x16x32_bf16 v[140:143], a[20:23], a[156:159], v[140:143]
    ds_read_b64_tr_b16 a[48:49], v14 offset:20640
    v_mfma_f32_16x16x32_bf16 v[140:143], a[16:19], a[148:151], v[140:143]
    ds_read_b64_tr_b16 a[50:51], v14 offset:25760
    buffer_load_dwordx4 a[232:235], v16, s[24:27], s75 offen offset:0 sc1
    v_mfma_f32_16x16x32_bf16 v[144:147], a[24:27], a[144:147], v[144:147]
    ds_read_b64_tr_b16 a[52:53], v14 offset:30880
    v_mfma_f32_16x16x32_bf16 v[144:147], a[28:31], a[152:155], v[144:147]
    ds_read_b64_tr_b16 a[54:55], v14 offset:36000
    buffer_load_dwordx4 a[236:239], v16, s[24:27], s75 offen offset:2048 sc1
    v_mfma_f32_16x16x32_bf16 v[148:151], a[28:31], a[156:159], v[148:151]
    ds_read_b64_tr_b16 a[56:57], v11 offset:20672
    v_mfma_f32_16x16x32_bf16 v[148:151], a[24:27], a[148:151], v[148:151]
    ds_read_b64_tr_b16 a[58:59], v11 offset:25792
    s_waitcnt lgkmcnt(6)
    v_mfma_f32_16x16x32_bf16 v[152:155], a[32:35], a[144:147], v[152:155]
    ds_read_b64_tr_b16 a[60:61], v11 offset:30912
    v_mfma_f32_16x16x32_bf16 v[152:155], a[36:39], a[152:155], v[152:155]
    ds_read_b64_tr_b16 a[62:63], v11 offset:36032
    v_mfma_f32_16x16x32_bf16 v[156:159], a[36:39], a[156:159], v[156:159]
    ds_read_b64_tr_b16 a[0:1], v14 offset:20704
    s_add_u32 s75, s75, 8192
    v_mfma_f32_16x16x32_bf16 v[156:159], a[32:35], a[148:151], v[156:159]
    ds_read_b64_tr_b16 a[2:3], v14 offset:25824
    v_mfma_f32_16x16x32_bf16 v[64:67], a[40:43], a[144:147], v[64:67]
    ds_read_b64_tr_b16 a[4:5], v14 offset:30944
    buffer_load_dwordx4 a[240:243], v16, s[24:27], s75 offen offset:0 sc1
    v_mfma_f32_16x16x32_bf16 v[64:67], a[44:47], a[152:155], v[64:67]
    ds_read_b64_tr_b16 a[6:7], v14 offset:36064
    s_getpc_b64 s[76:77]
L_rw12:
    s_mov_b32 s78, L_mk_end-L_rw12
    s_mov_b32 s79, 0x00020000
    s_lshr_b32 s82, s2, 3
    s_mul_i32 s82, s82, 768
    v_lshlrev_b32 v28, 7, v0
    v_cmp_gt_u32 vcc, 768, v28
    s_nop 1
    v_cndmask_b32 v28, -16, v28, vcc
    buffer_load_dword v12, v28, s[76:79], s82 offen
    v_mfma_f32_16x16x32_bf16 v[68:71], a[44:47], a[156:159], v[68:71]
    ds_read_b64_tr_b16 a[8:9], v11 offset:20736
    buffer_load_dwordx4 a[244:247], v16, s[24:27], s75 offen offset:2048 sc1
    v_mfma_f32_16x16x32_bf16 v[68:71], a[40:43], a[148:151], v[68:71]
    ds_read_b64_tr_b16 a[10:11], v11 offset:25856
    s_waitcnt lgkmcnt(6)
    v_mfma_f32_16x16x32_bf16 v[72:75], a[48:51], a[144:147], v[72:75]
    ds_read_b64_tr_b16 a[12:13], v11 offset:30976
    v_mfma_f32_16x16x32_bf16 v[72:75], a[52:55], a[152:155], v[72:75]
    s_waitcnt vmcnt(23)
    s_barrier
    ds_read_b64_tr_b16 a[14:15], v11 offset:36096
    v_mfma_f32_16x16x32_bf16 v[76:79], a[52:55], a[156:159], v[76:79]
    ds_read_b64_tr_b16 a[16:17], v11 offset:40960
    v_mfma_f32_16x16x32_bf16 v[76:79], a[48:51], a[148:151], v[76:79]
    ds_read_b64_tr_b16 a[18:19], v11 offset:46080
    s_mul_i32 s51, s19, 147456
    s_add_u32 s51, s51, s48
    v_mfma_f32_16x16x32_bf16 v[80:83], a[56:59], a[144:147], v[80:83]
    ds_read_b64_tr_b16 a[20:21], v11 offset:51200
    v_mfma_f32_16x16x32_bf16 v[80:83], a[60:63], a[152:155], v[80:83]
    ds_read_b64_tr_b16 a[22:23], v11 offset:56320
    s_add_u32 m0, s50, 122880
    v_mfma_f32_16x16x32_bf16 v[84:87], a[60:63], a[156:159], v[84:87]
    ds_read_b64_tr_b16 a[24:25], v14 offset:40992
    buffer_load_dwordx4 v6, s[32:35], s51 offen offset:0  lds
    v_mfma_f32_16x16x32_bf16 v[84:87], a[56:59], a[148:151], v[84:87]
    ds_read_b64_tr_b16 a[26:27], v14 offset:46112
    s_waitcnt lgkmcnt(6)
    v_mfma_f32_16x16x32_bf16 v[88:91], a[0:3], a[144:147], v[88:91]
    ds_read_b64_tr_b16 a[28:29], v14 offset:51232
    buffer_load_dwordx4 v7, s[32:35], s51 offen offset:1024  lds
    v_mfma_f32_16x16x32_bf16 v[88:91], a[4:7], a[152:155], v[88:91]
    ds_read_b64_tr_b16 a[30:31], v14 offset:56352
    v_mfma_f32_16x16x32_bf16 v[92:95], a[4:7], a[156:159], v[92:95]
    ds_read_b64_tr_b16 a[32:33], v11 offset:41024
    v_mfma_f32_16x16x32_bf16 v[92:95], a[0:3], a[148:151], v[92:95]
    ds_read_b64_tr_b16 a[34:35], v11 offset:46144
    v_mfma_f32_16x16x32_bf16 v[96:99], a[8:11], a[144:147], v[96:99]
    ds_read_b64_tr_b16 a[36:37], v11 offset:51264
    buffer_load_dwordx4 v8, s[32:35], s51 offen offset:2048  lds
    v_mfma_f32_16x16x32_bf16 v[96:99], a[12:15], a[152:155], v[96:99]
    ds_read_b64_tr_b16 a[38:39], v11 offset:56384
    v_mfma_f32_16x16x32_bf16 v[100:103], a[12:15], a[156:159], v[100:103]
    ds_read_b64_tr_b16 a[40:41], v14 offset:41056
    v_mfma_f32_16x16x32_bf16 v[100:103], a[8:11], a[148:151], v[100:103]
    ds_read_b64_tr_b16 a[42:43], v14 offset:46176
    s_waitcnt vmcnt(57)
    s_waitcnt lgkmcnt(6)
    v_mfma_f32_16x16x32_bf16 v[128:131], a[16:19], a[160:163], v[128:131]
    ds_read_b64_tr_b16 a[44:45], v14 offset:51296
    v_mfma_f32_16x16x32_bf16 v[128:131], a[20:23], a[168:171], v[128:131]
    ds_read_b64_tr_b16 a[46:47], v14 offset:56416
    buffer_load_dwordx4 v9, s[32:35], s51 offen offset:3072  lds
    v_mfma_f32_16x16x32_bf16 v[132:135], a[20:23], a[172:175], v[132:135]
    ds_read_b64_tr_b16 a[48:49], v11 offset:41088
    v_mfma_f32_16x16x32_bf16 v[132:135], a[16:19], a[164:167], v[132:135]
    ds_read_b64_tr_b16 a[50:51], v11 offset:46208
    v_mfma_f32_16x16x32_bf16 v[136:139], a[24:27], a[160:163], v[136:139]
    ds_read_b64_tr_b16 a[52:53], v11 offset:51328
    v_mfma_f32_16x16x32_bf16 v[136:139], a[28:31], a[168:171], v[136:139]
    ds_read_b64_tr_b16 a[54:55], v11 offset:56448
    s_add_u32 m0, s50, 126976
    v_mfma_f32_16x16x32_bf16 v[140:143], a[28:31], a[172:175], v[140:143]
    ds_read_b64_tr_b16 a[56:57], v14 offset:41120
    v_mfma_f32_16x16x32_bf16 v[140:143], a[24:27], a[164:167], v[140:143]
    ds_read_b64_tr_b16 a[58:59], v14 offset:46240
    s_waitcnt lgkmcnt(6)
    v_mfma_f32_16x16x32_bf16 v[144:147], a[32:35], a[160:163], v[144:147]
    ds_read_b64_tr_b16 a[60:61], v14 offset:51360
    buffer_load_dwordx4 v10, s[32:35], s51 offen offset:0  lds
    v_mfma_f32_16x16x32_bf16 v[144:147], a[36:39], a[168:171], v[144:147]
    ds_read_b64_tr_b16 a[62:63], v14 offset:56480
    v_mfma_f32_16x16x32_bf16 v[148:151], a[36:39], a[172:175], v[148:151]
    ds_read_b64_tr_b16 a[0:1], v11 offset:41152
    s_add_u32 s51, s51, 9216
    v_mfma_f32_16x16x32_bf16 v[148:151], a[32:35], a[164:167], v[148:151]
    ds_read_b64_tr_b16 a[2:3], v11 offset:46272
    s_add_u32 m0, s50, 128000
    v_mfma_f32_16x16x32_bf16 v[152:155], a[40:43], a[160:163], v[152:155]
    ds_read_b64_tr_b16 a[4:5], v11 offset:51392
    v_mfma_f32_16x16x32_bf16 v[152:155], a[44:47], a[168:171], v[152:155]
    ds_read_b64_tr_b16 a[6:7], v11 offset:56512
    buffer_load_dwordx4 v6, s[32:35], s51 offen offset:0  lds
    v_mfma_f32_16x16x32_bf16 v[156:159], a[44:47], a[172:175], v[156:159]
    ds_read_b64_tr_b16 a[8:9], v14 offset:41184
    buffer_load_dwordx4 v7, s[32:35], s51 offen offset:1024  lds
    v_mfma_f32_16x16x32_bf16 v[156:159], a[40:43], a[164:167], v[156:159]
    ds_read_b64_tr_b16 a[10:11], v14 offset:46304
    s_waitcnt lgkmcnt(6)
    v_mfma_f32_16x16x32_bf16 v[64:67], a[48:51], a[160:163], v[64:67]
    ds_read_b64_tr_b16 a[12:13], v14 offset:51424
    v_mfma_f32_16x16x32_bf16 v[64:67], a[52:55], a[168:171], v[64:67]
    ds_read_b64_tr_b16 a[14:15], v14 offset:56544
    v_mfma_f32_16x16x32_bf16 v[68:71], a[52:55], a[172:175], v[68:71]
    ds_read_b64_tr_b16 a[16:17], v11 offset:41216
    buffer_load_dword v22, v13, s[24:27], s74 offen sc1
    v_mfma_f32_16x16x32_bf16 v[68:71], a[48:51], a[164:167], v[68:71]
    ds_read_b64_tr_b16 a[18:19], v11 offset:46336
    buffer_load_dwordx4 v8, s[32:35], s51 offen offset:2048  lds
    v_mfma_f32_16x16x32_bf16 v[72:75], a[56:59], a[160:163], v[72:75]
    ds_read_b64_tr_b16 a[20:21], v11 offset:51456
    v_mfma_f32_16x16x32_bf16 v[72:75], a[60:63], a[168:171], v[72:75]
    ds_read_b64_tr_b16 a[22:23], v11 offset:56576
    v_mfma_f32_16x16x32_bf16 v[76:79], a[60:63], a[172:175], v[76:79]
    ds_read_b64_tr_b16 a[24:25], v17 offset:0
    buffer_load_dword v1, v15, s[24:27], 0 offen sc1
    v_mfma_f32_16x16x32_bf16 v[76:79], a[56:59], a[164:167], v[76:79]
    ds_read_b64_tr_b16 a[26:27], v17 offset:5120
    s_waitcnt lgkmcnt(6)
    v_mfma_f32_16x16x32_bf16 v[80:83], a[0:3], a[160:163], v[80:83]
    ds_read_b64_tr_b16 a[28:29], v17 offset:10240
    buffer_load_dwordx4 v9, s[32:35], s51 offen offset:3072  lds
    v_mfma_f32_16x16x32_bf16 v[80:83], a[4:7], a[168:171], v[80:83]
    ds_read_b64_tr_b16 a[30:31], v17 offset:15360
    v_mfma_f32_16x16x32_bf16 v[84:87], a[4:7], a[172:175], v[84:87]
    ds_read_b64_tr_b16 a[32:33], v21 offset:32
    v_mfma_f32_16x16x32_bf16 v[84:87], a[0:3], a[164:167], v[84:87]
    ds_read_b64_tr_b16 a[34:35], v21 offset:5152
    v_mfma_f32_16x16x32_bf16 v[88:91], a[8:11], a[160:163], v[88:91]
    ds_read_b64_tr_b16 a[36:37], v21 offset:10272
    s_add_u32 m0, s50, 132096
    v_mfma_f32_16x16x32_bf16 v[88:91], a[12:15], a[168:171], v[88:91]
    ds_read_b64_tr_b16 a[38:39], v21 offset:15392
    v_mfma_f32_16x16x32_bf16 v[92:95], a[12:15], a[172:175], v[92:95]
    ds_read_b64_tr_b16 a[40:41], v17 offset:64
    v_mfma_f32_16x16x32_bf16 v[92:95], a[8:11], a[164:167], v[92:95]
    ds_read_b64_tr_b16 a[42:43], v17 offset:5184
    s_waitcnt lgkmcnt(6)
    v_mfma_f32_16x16x32_bf16 v[96:99], a[16:19], a[160:163], v[96:99]
    ds_read_b64_tr_b16 a[44:45], v17 offset:10304
    buffer_load_dwordx4 v10, s[32:35], s51 offen offset:0  lds
    v_mfma_f32_16x16x32_bf16 v[96:99], a[20:23], a[168:171], v[96:99]
    ds_read_b64_tr_b16 a[46:47], v17 offset:15424
    s_add_u32 s75, s75, 8192
    v_mfma_f32_16x16x32_bf16 v[100:103], a[20:23], a[172:175], v[100:103]
    ds_read_b64_tr_b16 a[48:49], v21 offset:96
    v_mfma_f32_16x16x32_bf16 v[100:103], a[16:19], a[164:167], v[100:103]
    ds_read_b64_tr_b16 a[50:51], v21 offset:5216
    buffer_load_dwordx4 a[248:251], v16, s[24:27], s75 offen offset:0 sc1
    s_waitcnt vmcnt(50)
    v_mfma_f32_16x16x32_bf16 v[128:131], a[24:27], a[176:179], v[128:131]
    ds_read_b64_tr_b16 a[52:53], v21 offset:10336
    v_mfma_f32_16x16x32_bf16 v[128:131], a[28:31], a[184:187], v[128:131]
    ds_read_b64_tr_b16 a[54:55], v21 offset:15456
    buffer_load_dwordx4 a[252:255], v16, s[24:27], s75 offen offset:2048 sc1
    v_mfma_f32_16x16x32_bf16 v[132:135], a[28:31], a[188:191], v[132:135]
    ds_read_b64_tr_b16 a[56:57], v17 offset:128
    v_mfma_f32_16x16x32_bf16 v[132:135], a[24:27], a[180:183], v[132:135]
    ds_read_b64_tr_b16 a[58:59], v17 offset:5248
    s_waitcnt lgkmcnt(6)
    v_mfma_f32_16x16x32_bf16 v[136:139], a[32:35], a[176:179], v[136:139]
    ds_read_b64_tr_b16 a[60:61], v17 offset:10368
    v_mfma_f32_16x16x32_bf16 v[136:139], a[36:39], a[184:187], v[136:139]
    ds_read_b64_tr_b16 a[62:63], v17 offset:15488
    v_mfma_f32_16x16x32_bf16 v[140:143], a[36:39], a[188:191], v[140:143]
    ds_read_b64_tr_b16 a[0:1], v21 offset:160
    s_getpc_b64 s[76:77]
L_mt:
    s_add_u32 s76, s76, L_masks-L_mt
    s_addc_u32 s77, s77, 0
    s_mov_b32 s78, 8192
    s_mov_b32 s79, 0x00020000
    s_mov_b32 s73, 4096
    v_mfma_f32_16x16x32_bf16 v[140:143], a[32:35], a[180:183], v[140:143]
    ds_read_b64_tr_b16 a[2:3], v21 offset:5280
    v_mfma_f32_16x16x32_bf16 v[144:147], a[40:43], a[176:179], v[144:147]
    ds_read_b64_tr_b16 a[4:5], v21 offset:10400
    buffer_load_dwordx4 v[208:211], v16, s[76:79], 0 offen offset:0
    v_mfma_f32_16x16x32_bf16 v[144:147], a[44:47], a[184:187], v[144:147]
    ds_read_b64_tr_b16 a[6:7], v21 offset:15520
    buffer_load_dwordx4 v[212:215], v16, s[76:79], 0 offen offset:1024
    v_mfma_f32_16x16x32_bf16 v[148:151], a[44:47], a[188:191], v[148:151]
    ds_read_b64_tr_b16 a[8:9], v17 offset:192
    buffer_load_dwordx4 v[216:219], v16, s[76:79], 0 offen offset:2048
    v_mfma_f32_16x16x32_bf16 v[148:151], a[40:43], a[180:183], v[148:151]
    ds_read_b64_tr_b16 a[10:11], v17 offset:5312
    s_waitcnt lgkmcnt(6)
    v_mfma_f32_16x16x32_bf16 v[152:155], a[48:51], a[176:179], v[152:155]
    ds_read_b64_tr_b16 a[12:13], v17 offset:10432
    s_add_u32 s82, s7, 4
    s_waitcnt vmcnt(9)
    v_subrev_u32 v22, s82, v22
    v_cmp_lt_u32 vcc, 7, v22
    s_cbranch_vccz L_poll13_ok
    s_mov_b32 s83, 0
L_poll13:
    buffer_load_dword v22, v13, s[24:27], s74 offen sc1
    s_add_u32 s83, s83, 1
    s_waitcnt vmcnt(0)
    v_subrev_u32 v22, s82, v22
    v_cmp_lt_u32 vcc, 7, v22
    s_cbranch_vccz L_poll13_ok
    s_cmp_lt_u32 s83, 0x40000
    s_cbranch_scc1 L_poll13
L_poll13_ok:
    v_mfma_f32_16x16x32_bf16 v[152:155], a[52:55], a[184:187], v[152:155]
    ds_read_b64_tr_b16 a[14:15], v17 offset:15552
    buffer_load_dwordx4 v[220:223], v16, s[76:79], 0 offen offset:3072
    v_mfma_f32_16x16x32_bf16 v[156:159], a[52:55], a[188:191], v[156:159]
    ds_read_b64_tr_b16 a[16:17], v21 offset:224
    buffer_load_dwordx4 v[224:227], v16, s[76:79], s73 offen offset:0
    v_mfma_f32_16x16x32_bf16 v[156:159], a[48:51], a[180:183], v[156:159]
    ds_read_b64_tr_b16 a[18:19], v21 offset:5344
    buffer_load_dwordx4 v[228:231], v16, s[76:79], s73 offen offset:1024
    v_mfma_f32_16x16x32_bf16 v[64:67], a[56:59], a[176:179], v[64:67]
    ds_read_b64_tr_b16 a[20:21], v21 offset:10464
    s_add_u32 s82, s7, 4
    s_waitcnt vmcnt(10)
    v_subrev_u32 v1, s82, v1
    v_cmp_lt_u32 vcc, 7, v1
    s_cbranch_vccz L_poll14_ok
    s_mov_b32 s83, 0
L_poll14:
    buffer_load_dword v1, v15, s[24:27], 0 offen sc1
    s_add_u32 s83, s83, 1
    s_waitcnt vmcnt(0)
    v_subrev_u32 v1, s82, v1
    v_cmp_lt_u32 vcc, 7, v1
    s_cbranch_vccz L_poll14_ok
    s_cmp_lt_u32 s83, 0x40000
    s_cbranch_scc1 L_poll14
L_poll14_ok:
    v_mfma_f32_16x16x32_bf16 v[64:67], a[60:63], a[184:187], v[64:67]
    ds_read_b64_tr_b16 a[22:23], v21 offset:15584
    buffer_load_dwordx4 v[232:235], v16, s[76:79], s73 offen offset:2048
    v_mfma_f32_16x16x32_bf16 v[68:71], a[60:63], a[188:191], v[68:71]
    ds_read_b64_tr_b16 a[24:25], v17 offset:256
    v_mfma_f32_16x16x32_bf16 v[68:71], a[56:59], a[180:183], v[68:71]
    ds_read_b64_tr_b16 a[26:27], v17 offset:5376
    s_waitcnt lgkmcnt(6)
    v_mfma_f32_16x16x32_bf16 v[72:75], a[0:3], a[176:179], v[72:75]
    ds_read_b64_tr_b16 a[28:29], v17 offset:10496
    buffer_load_dwordx4 v[236:239], v16, s[76:79], s73 offen offset:3072
    v_mfma_f32_16x16x32_bf16 v[72:75], a[4:7], a[184:187], v[72:75]
    s_waitcnt vmcnt(28)
    s_barrier
    ds_read_b64_tr_b16 a[30:31], v17 offset:15616
    v_mfma_f32_16x16x32_bf16 v[76:79], a[4:7], a[188:191], v[76:79]
    ds_read_b64_tr_b16 a[32:33], v17 offset:20480
    s_add_u32 s48, s48, 589824
    v_mfma_f32_16x16x32_bf16 v[76:79], a[0:3], a[180:183], v[76:79]
    ds_read_b64_tr_b16 a[34:35], v17 offset:25600
    s_mov_b32 s51, s48
    v_mfma_f32_16x16x32_bf16 v[80:83], a[8:11], a[176:179], v[80:83]
    ds_read_b64_tr_b16 a[36:37], v17 offset:30720
    s_add_u32 m0, s50, 0
    v_mfma_f32_16x16x32_bf16 v[80:83], a[12:15], a[184:187], v[80:83]
    ds_read_b64_tr_b16 a[38:39], v17 offset:35840
    buffer_load_dwordx4 v6, s[32:35], s51 offen offset:0  lds
    v_mfma_f32_16x16x32_bf16 v[84:87], a[12:15], a[188:191], v[84:87]
    ds_read_b64_tr_b16 a[40:41], v21 offset:20512
    buffer_load_dwordx4 v7, s[32:35], s51 offen offset:1024  lds
    v_mfma_f32_16x16x32_bf16 v[84:87], a[8:11], a[180:183], v[84:87]
    ds_read_b64_tr_b16 a[42:43], v21 offset:25632
    s_waitcnt lgkmcnt(6)
    v_mfma_f32_16x16x32_bf16 v[88:91], a[16:19], a[176:179], v[88:91]
    ds_read_b64_tr_b16 a[44:45], v21 offset:30752
    v_mfma_f32_16x16x32_bf16 v[88:91], a[20:23], a[184:187], v[88:91]
    ds_read_b64_tr_b16 a[46:47], v21 offset:35872
    v_mfma_f32_16x16x32_bf16 v[92:95], a[20:23], a[188:191], v[92:95]
    ds_read_b64_tr_b16 a[48:49], v17 offset:20544
    v_mfma_f32_16x16x32_bf16 v[92:95], a[16:19], a[180:183], v[92:95]
    ds_read_b64_tr_b16 a[50:51], v17 offset:25664
    buffer_load_dwordx4 v8, s[32:35], s51 offen offset:2048  lds
    v_mfma_f32_16x16x32_bf16 v[96:99], a[24:27], a[176:179], v[96:99]
    ds_read_b64_tr_b16 a[52:53], v17 offset:30784
    v_mfma_f32_16x16x32_bf16 v[96:99], a[28:31], a[184:187], v[96:99]
    ds_read_b64_tr_b16 a[54:55], v17 offset:35904
    v_mfma_f32_16x16x32_bf16 v[100:103], a[28:31], a[188:191], v[100:103]
    ds_read_b64_tr_b16 a[56:57], v21 offset:20576
    v_mfma_f32_16x16x32_bf16 v[100:103], a[24:27], a[180:183], v[100:103]
    ds_read_b64_tr_b16 a[58:59], v21 offset:25696
    s_waitcnt vmcnt(47)
    s_waitcnt lgkmcnt(6)
    v_mfma_f32_16x16x32_bf16 v[128:131], a[32:35], a[192:195], v[128:131]
    ds_read_b64_tr_b16 a[60:61], v21 offset:30816
    buffer_load_dwordx4 v9, s[32:35], s51 offen offset:3072  lds
    v_mfma_f32_16x16x32_bf16 v[128:131], a[36:39], a[200:203], v[128:131]
    ds_read_b64_tr_b16 a[62:63], v21 offset:35936
    v_mfma_f32_16x16x32_bf16 v[132:135], a[36:39], a[204:207], v[132:135]
    ds_read_b64_tr_b16 a[0:1], v17 offset:20608
    v_mfma_f32_16x16x32_bf16 v[132:135], a[32:35], a[196:199], v[132:135]
    ds_read_b64_tr_b16 a[2:3], v17 offset:25728
    v_mfma_f32_16x16x32_bf16 v[136:139], a[40:43], a[192:195], v[136:139]
    ds_read_b64_tr_b16 a[4:5], v17 offset:30848
    s_add_u32 m0, s50, 4096
    v_mfma_f32_16x16x32_bf16 v[136:139], a[44:47], a[200:203], v[136:139]
    ds_read_b64_tr_b16 a[6:7], v17 offset:35968
    v_mfma_f32_16x16x32_bf16 v[140:143], a[44:47], a[204:207], v[140:143]
    ds_read_b64_tr_b16 a[8:9], v21 offset:20640
    v_mfma_f32_16x16x32_bf16 v[140:143], a[40:43], a[196:199], v[140:143]
    ds_read_b64_tr_b16 a[10:11], v21 offset:25760
    s_waitcnt lgkmcnt(6)
    v_mfma_f32_16x16x32_bf16 v[144:147], a[48:51], a[192:195], v[144:147]
    ds_read_b64_tr_b16 a[12:13], v21 offset:30880
    buffer_load_dwordx4 v10, s[32:35], s51 offen offset:0  lds
    v_mfma_f32_16x16x32_bf16 v[144:147], a[52:55], a[200:203], v[144:147]
    ds_read_b64_tr_b16 a[14:15], v21 offset:36000
    s_add_u32 s51, s51, 9216
    v_mfma_f32_16x16x32_bf16 v[148:151], a[52:55], a[204:207], v[148:151]
    ds_read_b64_tr_b16 a[16:17], v17 offset:20672
    s_add_u32 m0, s50, 5120
    v_mfma_f32_16x16x32_bf16 v[148:151], a[48:51], a[196:199], v[148:151]
    ds_read_b64_tr_b16 a[18:19], v17 offset:25792
    v_mfma_f32_16x16x32_bf16 v[152:155], a[56:59], a[192:195], v[152:155]
    ds_read_b64_tr_b16 a[20:21], v17 offset:30912
    buffer_load_dwordx4 v6, s[32:35], s51 offen offset:0  lds
    v_mfma_f32_16x16x32_bf16 v[152:155], a[60:63], a[200:203], v[152:155]
    ds_read_b64_tr_b16 a[22:23], v17 offset:36032
    buffer_load_dwordx4 v7, s[32:35], s51 offen offset:1024  lds
    v_mfma_f32_16x16x32_bf16 v[156:159], a[60:63], a[204:207], v[156:159]
    ds_read_b64_tr_b16 a[24:25], v21 offset:20704
    v_mfma_f32_16x16x32_bf16 v[156:159], a[56:59], a[196:199], v[156:159]
    ds_read_b64_tr_b16 a[26:27], v21 offset:25824
    s_waitcnt lgkmcnt(6)
    v_mfma_f32_16x16x32_bf16 v[64:67], a[0:3], a[192:195], v[64:67]
    ds_read_b64_tr_b16 a[28:29], v21 offset:30944
    v_mfma_f32_16x16x32_bf16 v[64:67], a[4:7], a[200:203], v[64:67]
    ds_read_b64_tr_b16 a[30:31], v21 offset:36064
    v_mfma_f32_16x16x32_bf16 v[68:71], a[4:7], a[204:207], v[68:71]
    ds_read_b64_tr_b16 a[32:33], v17 offset:20736
    buffer_load_dwordx4 v8, s[32:35], s51 offen offset:2048  lds
    v_mfma_f32_16x16x32_bf16 v[68:71], a[0:3], a[196:199], v[68:71]
    ds_read_b64_tr_b16 a[34:35], v17 offset:25856
    v_mfma_f32_16x16x32_bf16 v[72:75], a[8:11], a[192:195], v[72:75]
    ds_read_b64_tr_b16 a[36:37], v17 offset:30976
    v_mfma_f32_16x16x32_bf16 v[72:75], a[12:15], a[200:203], v[72:75]
    ds_read_b64_tr_b16 a[38:39], v17 offset:36096
    v_mfma_f32_16x16x32_bf16 v[76:79], a[12:15], a[204:207], v[76:79]
    ds_read_b64_tr_b16 a[40:41], v17 offset:40960
    buffer_load_dwordx4 v9, s[32:35], s51 offen offset:3072  lds
    v_mfma_f32_16x16x32_bf16 v[76:79], a[8:11], a[196:199], v[76:79]
    ds_read_b64_tr_b16 a[42:43], v17 offset:46080
    s_waitcnt lgkmcnt(6)
    v_mfma_f32_16x16x32_bf16 v[80:83], a[16:19], a[192:195], v[80:83]
    ds_read_b64_tr_b16 a[44:45], v17 offset:51200
    v_mfma_f32_16x16x32_bf16 v[80:83], a[20:23], a[200:203], v[80:83]
    ds_read_b64_tr_b16 a[46:47], v17 offset:56320
    v_mfma_f32_16x16x32_bf16 v[84:87], a[20:23], a[204:207], v[84:87]
    ds_read_b64_tr_b16 a[48:49], v21 offset:40992
    v_mfma_f32_16x16x32_bf16 v[84:87], a[16:19], a[196:199], v[84:87]
    ds_read_b64_tr_b16 a[50:51], v21 offset:46112
    s_add_u32 m0, s50, 9216
    v_mfma_f32_16x16x32_bf16 v[88:91], a[24:27], a[192:195], v[88:91]
    ds_read_b64_tr_b16 a[52:53], v21 offset:51232
    v_mfma_f32_16x16x32_bf16 v[88:91], a[28:31], a[200:203], v[88:91]
    ds_read_b64_tr_b16 a[54:55], v21 offset:56352
    v_mfma_f32_16x16x32_bf16 v[92:95], a[28:31], a[204:207], v[92:95]
    ds_read_b64_tr_b16 a[56:57], v17 offset:41024
    buffer_load_dwordx4 v10, s[32:35], s51 offen offset:0  lds
    v_mfma_f32_16x16x32_bf16 v[92:95], a[24:27], a[196:199], v[92:95]
    ds_read_b64_tr_b16 a[58:59], v17 offset:46144
    s_waitcnt lgkmcnt(6)
    v_mfma_f32_16x16x32_bf16 v[96:99], a[32:35], a[192:195], v[96:99]
    ds_read_b64_tr_b16 a[60:61], v17 offset:51264
    s_add_u32 s75, s49, 262144
    v_mfma_f32_16x16x32_bf16 v[96:99], a[36:39], a[200:203], v[96:99]
    ds_read_b64_tr_b16 a[62:63], v17 offset:56384
    v_mfma_f32_16x16x32_bf16 v[100:103], a[36:39], a[204:207], v[100:103]
    ds_read_b64_tr_b16 a[0:1], v21 offset:41056
    buffer_load_dwordx4 v[160:163], v16, s[24:27], s75 offen offset:0 sc1
    v_mfma_f32_16x16x32_bf16 v[100:103], a[32:35], a[196:199], v[100:103]
    ds_read_b64_tr_b16 a[2:3], v21 offset:46176
    s_waitcnt vmcnt(51)
    v_mfma_f32_16x16x32_bf16 v[128:131], a[40:43], a[208:211], v[128:131]
    ds_read_b64_tr_b16 a[4:5], v21 offset:51296
    buffer_load_dwordx4 v[164:167], v16, s[24:27], s75 offen offset:2048 sc1
    v_mfma_f32_16x16x32_bf16 v[128:131], a[44:47], a[216:219], v[128:131]
    ds_read_b64_tr_b16 a[6:7], v21 offset:56416
    v_mfma_f32_16x16x32_bf16 v[132:135], a[44:47], a[220:223], v[132:135]
    ds_read_b64_tr_b16 a[8:9], v17 offset:41088
    v_mfma_f32_16x16x32_bf16 v[132:135], a[40:43], a[212:215], v[132:135]
    ds_read_b64_tr_b16 a[10:11], v17 offset:46208
    s_waitcnt lgkmcnt(6)
    v_mfma_f32_16x16x32_bf16 v[136:139], a[48:51], a[208:211], v[136:139]
    ds_read_b64_tr_b16 a[12:13], v17 offset:51328
    v_mfma_f32_16x16x32_bf16 v[136:139], a[52:55], a[216:219], v[136:139]
    ds_read_b64_tr_b16 a[14:15], v17 offset:56448
    s_add_u32 s75, s75, 8192
    v_mfma_f32_16x16x32_bf16 v[140:143], a[52:55], a[220:223], v[140:143]
    ds_read_b64_tr_b16 a[16:17], v21 offset:41120
    v_mfma_f32_16x16x32_bf16 v[140:143], a[48:51], a[212:215], v[140:143]
    ds_read_b64_tr_b16 a[18:19], v21 offset:46240
    buffer_load_dwordx4 v[168:171], v16, s[24:27], s75 offen offset:0 sc1
    v_mfma_f32_16x16x32_bf16 v[144:147], a[56:59], a[208:211], v[144:147]
    ds_read_b64_tr_b16 a[20:21], v21 offset:51360
    v_mfma_f32_16x16x32_bf16 v[144:147], a[60:63], a[216:219], v[144:147]
    ds_read_b64_tr_b16 a[22:23], v21 offset:56480
    buffer_load_dwordx4 v[172:175], v16, s[24:27], s75 offen offset:2048 sc1
    v_mfma_f32_16x16x32_bf16 v[148:151], a[60:63], a[220:223], v[148:151]
    ds_read_b64_tr_b16 a[24:25], v17 offset:41152
    v_mfma_f32_16x16x32_bf16 v[148:151], a[56:59], a[212:215], v[148:151]
    ds_read_b64_tr_b16 a[26:27], v17 offset:46272
    s_waitcnt lgkmcnt(6)
    v_mfma_f32_16x16x32_bf16 v[152:155], a[0:3], a[208:211], v[152:155]
    ds_read_b64_tr_b16 a[28:29], v17 offset:51392
    v_mfma_f32_16x16x32_bf16 v[152:155], a[4:7], a[216:219], v[152:155]
    ds_read_b64_tr_b16 a[30:31], v17 offset:56512
    v_mfma_f32_16x16x32_bf16 v[156:159], a[4:7], a[220:223], v[156:159]
    ds_read_b64_tr_b16 a[32:33], v21 offset:41184
    s_add_u32 s75, s75, 8192
    v_mfma_f32_16x16x32_bf16 v[156:159], a[0:3], a[212:215], v[156:159]
    ds_read_b64_tr_b16 a[34:35], v21 offset:46304
    v_mfma_f32_16x16x32_bf16 v[64:67], a[8:11], a[208:211], v[64:67]
    ds_read_b64_tr_b16 a[36:37], v21 offset:51424
    v_mfma_f32_16x16x32_bf16 v[64:67], a[12:15], a[216:219], v[64:67]
    ds_read_b64_tr_b16 a[38:39], v21 offset:56544
    buffer_load_dwordx4 v[176:179], v16, s[24:27], s75 offen offset:0 sc1
    v_mfma_f32_16x16x32_bf16 v[68:71], a[12:15], a[220:223], v[68:71]
    ds_read_b64_tr_b16 a[40:41], v17 offset:41216
    v_mfma_f32_16x16x32_bf16 v[68:71], a[8:11], a[212:215], v[68:71]
    ds_read_b64_tr_b16 a[42:43], v17 offset:46336
    s_waitcnt lgkmcnt(6)
    v_mfma_f32_16x16x32_bf16 v[72:75], a[16:19], a[208:211], v[72:75]
    ds_read_b64_tr_b16 a[44:45], v17 offset:51456
    buffer_load_dwordx4 v[180:183], v16, s[24:27], s75 offen offset:2048 sc1
    v_mfma_f32_16x16x32_bf16 v[72:75], a[20:23], a[216:219], v[72:75]
    s_waitcnt vmcnt(26)
    s_barrier
    ds_read_b64_tr_b16 a[46:47], v17 offset:56576
    v_mfma_f32_16x16x32_bf16 v[76:79], a[20:23], a[220:223], v[76:79]
    ds_read_b64_tr_b16 a[48:49], v18 offset:0
    v_mfma_f32_16x16x32_bf16 v[76:79], a[16:19], a[212:215], v[76:79]
    ds_read_b64_tr_b16 a[50:51], v18 offset:5120
    s_add_u32 s75, s75, 8192
    v_mfma_f32_16x16x32_bf16 v[80:83], a[24:27], a[208:211], v[80:83]
    ds_read_b64_tr_b16 a[52:53], v18 offset:10240
    v_mfma_f32_16x16x32_bf16 v[80:83], a[28:31], a[216:219], v[80:83]
    ds_read_b64_tr_b16 a[54:55], v18 offset:15360
    v_mfma_f32_16x16x32_bf16 v[84:87], a[28:31], a[220:223], v[84:87]
    ds_read_b64_tr_b16 a[56:57], v19 offset:32
    buffer_load_dwordx4 v[184:187], v16, s[24:27], s75 offen offset:0 sc1
    v_mfma_f32_16x16x32_bf16 v[84:87], a[24:27], a[212:215], v[84:87]
    ds_read_b64_tr_b16 a[58:59], v19 offset:5152
    s_waitcnt lgkmcnt(6)
    v_mfma_f32_16x16x32_bf16 v[88:91], a[32:35], a[208:211], v[88:91]
    ds_read_b64_tr_b16 a[60:61], v19 offset:10272
    buffer_load_dwordx4 v[188:191], v16, s[24:27], s75 offen offset:2048 sc1
    v_mfma_f32_16x16x32_bf16 v[88:91], a[36:39], a[216:219], v[88:91]
    ds_read_b64_tr_b16 a[62:63], v19 offset:15392
    v_mfma_f32_16x16x32_bf16 v[92:95], a[36:39], a[220:223], v[92:95]
    ds_read_b64_tr_b16 a[0:1], v18 offset:64
    v_mfma_f32_16x16x32_bf16 v[92:95], a[32:35], a[212:215], v[92:95]
    ds_read_b64_tr_b16 a[2:3], v18 offset:5184
    v_mfma_f32_16x16x32_bf16 v[96:99], a[40:43], a[208:211], v[96:99]
    ds_read_b64_tr_b16 a[4:5], v18 offset:10304
    buffer_load_dwordx4 v[192:195], v25, s[24:27], s97 offen sc1
    v_mfma_f32_16x16x32_bf16 v[96:99], a[44:47], a[216:219], v[96:99]
    ds_read_b64_tr_b16 a[6:7], v18 offset:15424
    v_mfma_f32_16x16x32_bf16 v[100:103], a[44:47], a[220:223], v[100:103]
    ds_read_b64_tr_b16 a[8:9], v19 offset:96
    v_mfma_f32_16x16x32_bf16 v[100:103], a[40:43], a[212:215], v[100:103]
    ds_read_b64_tr_b16 a[10:11], v19 offset:5216
    s_waitcnt vmcnt(44)
    s_waitcnt lgkmcnt(6)
    v_mfma_f32_16x16x32_bf16 v[128:131], a[48:51], a[224:227], v[128:131]
    ds_read_b64_tr_b16 a[12:13], v19 offset:10336
    v_mfma_f32_16x16x32_bf16 v[128:131], a[52:55], a[232:235], v[128:131]
    ds_read_b64_tr_b16 a[14:15], v19 offset:15456
    buffer_load_dwordx4 v[196:199], v20, s[24:27], s97 offen sc1
    v_mfma_f32_16x16x32_bf16 v[132:135], a[52:55], a[236:239], v[132:135]
    ds_read_b64_tr_b16 a[16:17], v18 offset:128
    v_mfma_f32_16x16x32_bf16 v[132:135], a[48:51], a[228:231], v[132:135]
    ds_read_b64_tr_b16 a[18:19], v18 offset:5248
    v_mfma_f32_16x16x32_bf16 v[136:139], a[56:59], a[224:227], v[136:139]
    ds_read_b64_tr_b16 a[20:21], v18 offset:10368
    v_mfma_f32_16x16x32_bf16 v[136:139], a[60:63], a[232:235], v[136:139]
    ds_read_b64_tr_b16 a[22:23], v18 offset:15488
    v_mfma_f32_16x16x32_bf16 v[140:143], a[60:63], a[236:239], v[140:143]
    ds_read_b64_tr_b16 a[24:25], v19 offset:160
    s_add_u32 s97, s97, 73856
    v_mfma_f32_16x16x32_bf16 v[140:143], a[56:59], a[228:231], v[140:143]
    ds_read_b64_tr_b16 a[26:27], v19 offset:5280
    s_waitcnt lgkmcnt(6)
    v_mfma_f32_16x16x32_bf16 v[144:147], a[0:3], a[224:227], v[144:147]
    ds_read_b64_tr_b16 a[28:29], v19 offset:10400
    buffer_load_dwordx4 v[200:203], v25, s[24:27], s97 offen sc1
    v_mfma_f32_16x16x32_bf16 v[144:147], a[4:7], a[232:235], v[144:147]
    ds_read_b64_tr_b16 a[30:31], v19 offset:15520
    v_mfma_f32_16x16x32_bf16 v[148:151], a[4:7], a[236:239], v[148:151]
    ds_read_b64_tr_b16 a[32:33], v18 offset:192
    buffer_load_dwordx4 v[204:207], v20, s[24:27], s97 offen sc1
    v_mfma_f32_16x16x32_bf16 v[148:151], a[0:3], a[228:231], v[148:151]
    ds_read_b64_tr_b16 a[34:35], v18 offset:5312
    v_mfma_f32_16x16x32_bf16 v[152:155], a[8:11], a[224:227], v[152:155]
    ds_read_b64_tr_b16 a[36:37], v18 offset:10432
    v_mfma_f32_16x16x32_bf16 v[152:155], a[12:15], a[232:235], v[152:155]
    ds_read_b64_tr_b16 a[38:39], v18 offset:15552
    v_mfma_f32_16x16x32_bf16 v[156:159], a[12:15], a[236:239], v[156:159]
    ds_read_b64_tr_b16 a[40:41], v19 offset:224
    v_mfma_f32_16x16x32_bf16 v[156:159], a[8:11], a[228:231], v[156:159]
    ds_read_b64_tr_b16 a[42:43], v19 offset:5344
    s_waitcnt lgkmcnt(6)
    v_mfma_f32_16x16x32_bf16 v[64:67], a[16:19], a[224:227], v[64:67]
    ds_read_b64_tr_b16 a[44:45], v19 offset:10464
    s_add_u32 s98, s98, 73856
    v_mfma_f32_16x16x32_bf16 v[64:67], a[20:23], a[232:235], v[64:67]
    ds_read_b64_tr_b16 a[46:47], v19 offset:15584
    buffer_load_dwordx4 a[64:67], v25, s[20:23], s98 offen sc1
    v_mfma_f32_16x16x32_bf16 v[68:71], a[20:23], a[236:239], v[68:71]
    ds_read_b64_tr_b16 a[48:49], v18 offset:256
    buffer_load_dwordx4 a[68:71], v20, s[20:23], s98 offen sc1
    v_mfma_f32_16x16x32_bf16 v[68:71], a[16:19], a[228:231], v[68:71]
    ds_read_b64_tr_b16 a[50:51], v18 offset:5376
    s_add_u32 s98, s98, 73856
    v_mfma_f32_16x16x32_bf16 v[72:75], a[24:27], a[224:227], v[72:75]
    ds_read_b64_tr_b16 a[52:53], v18 offset:10496
    v_mov_b32 v4, 0
    v_mfma_f32_16x16x32_bf16 v[72:75], a[28:31], a[232:235], v[72:75]
    s_waitcnt vmcnt(14)
    s_barrier
    ds_read_b64_tr_b16 a[54:55], v18 offset:15616
    v_mfma_f32_16x16x32_bf16 v[76:79], a[28:31], a[236:239], v[76:79]
    ds_read_b64_tr_b16 a[56:57], v18 offset:20480
    buffer_load_dwordx4 a[72:75], v25, s[20:23], s98 offen sc1
    buffer_load_dword v5, v4, s[36:39], 0 offen sc1
    v_mfma_f32_16x16x32_bf16 v[76:79], a[24:27], a[228:231], v[76:79]
    ds_read_b64_tr_b16 a[58:59], v18 offset:25600
    s_waitcnt lgkmcnt(6)
    v_mfma_f32_16x16x32_bf16 v[80:83], a[32:35], a[224:227], v[80:83]
    ds_read_b64_tr_b16 a[60:61], v18 offset:30720
    buffer_load_dwordx4 a[76:79], v20, s[20:23], s98 offen sc1
    v_mfma_f32_16x16x32_bf16 v[80:83], a[36:39], a[232:235], v[80:83]
    ds_read_b64_tr_b16 a[62:63], v18 offset:35840
    s_add_u32 s98, s98, 73856
    v_mfma_f32_16x16x32_bf16 v[84:87], a[36:39], a[236:239], v[84:87]
    ds_read_b64_tr_b16 a[0:1], v11 offset:0
    buffer_load_dwordx4 a[80:83], v25, s[20:23], s98 offen sc1
    v_mfma_f32_16x16x32_bf16 v[84:87], a[32:35], a[228:231], v[84:87]
    ds_read_b64_tr_b16 a[2:3], v11 offset:5120
    buffer_load_dwordx4 a[84:87], v20, s[20:23], s98 offen sc1
    v_mfma_f32_16x16x32_bf16 v[88:91], a[40:43], a[224:227], v[88:91]
    ds_read_b64_tr_b16 a[4:5], v11 offset:10240
    v_mfma_f32_16x16x32_bf16 v[88:91], a[44:47], a[232:235], v[88:91]
    ds_read_b64_tr_b16 a[6:7], v11 offset:15360
    s_add_u32 s98, s98, 73856
    v_mfma_f32_16x16x32_bf16 v[92:95], a[44:47], a[236:239], v[92:95]
    ds_read_b64_tr_b16 a[8:9], v11 offset:20480
    buffer_load_dwordx4 a[88:91], v25, s[20:23], s98 offen sc1
    v_mfma_f32_16x16x32_bf16 v[92:95], a[40:43], a[228:231], v[92:95]
    ds_read_b64_tr_b16 a[10:11], v11 offset:25600
    s_waitcnt lgkmcnt(6)
    v_mfma_f32_16x16x32_bf16 v[96:99], a[48:51], a[224:227], v[96:99]
    ds_read_b64_tr_b16 a[12:13], v11 offset:30720
    buffer_load_dwordx4 a[92:95], v20, s[20:23], s98 offen sc1
    v_mfma_f32_16x16x32_bf16 v[96:99], a[52:55], a[232:235], v[96:99]
    ds_read_b64_tr_b16 a[14:15], v11 offset:35840
    s_add_u32 s98, s98, 73856
    v_mfma_f32_16x16x32_bf16 v[100:103], a[52:55], a[236:239], v[100:103]
    ds_read_b64_tr_b16 a[16:17], v19 offset:20512
    v_mfma_f32_16x16x32_bf16 v[100:103], a[48:51], a[228:231], v[100:103]
    ds_read_b64_tr_b16 a[18:19], v19 offset:25632
    buffer_load_dwordx4 a[96:99], v25, s[20:23], s98 offen sc1
    s_waitcnt vmcnt(14)
    v_mfma_f32_16x16x32_bf16 v[128:131], a[56:59], a[240:243], v[128:131]
    ds_read_b64_tr_b16 a[20:21], v19 offset:30752
    buffer_load_dwordx4 a[100:103], v20, s[20:23], s98 offen sc1
    v_mfma_f32_16x16x32_bf16 v[128:131], a[60:63], a[248:251], v[128:131]
    ds_read_b64_tr_b16 a[22:23], v19 offset:35872
    v_mfma_f32_16x16x32_bf16 v[132:135], a[60:63], a[252:255], v[132:135]
    ds_read_b64_tr_b16 a[24:25], v14 offset:32
    s_add_u32 s98, s98, 73856
    v_mfma_f32_16x16x32_bf16 v[132:135], a[56:59], a[244:247], v[132:135]
    ds_read_b64_tr_b16 a[26:27], v14 offset:5152
    s_waitcnt lgkmcnt(6)
    v_mfma_f32_16x16x32_bf16 v[128:131], a[0:3], v[160:163], v[128:131]
    ds_read_b64_tr_b16 a[28:29], v14 offset:10272
    buffer_load_dwordx4 a[104:107], v25, s[20:23], s98 offen sc1
    v_mfma_f32_16x16x32_bf16 v[128:131], a[4:7], v[168:171], v[128:131]
    ds_read_b64_tr_b16 a[30:31], v14 offset:15392
    buffer_load_dwordx4 a[108:111], v20, s[20:23], s98 offen sc1
    v_mfma_f32_16x16x32_bf16 v[132:135], a[4:7], v[172:175], v[132:135]
    ds_read_b64_tr_b16 a[32:33], v14 offset:20512
    s_add_u32 s98, s98, 73856
    v_mfma_f32_16x16x32_bf16 v[132:135], a[0:3], v[164:167], v[132:135]
    ds_read_b64_tr_b16 a[34:35], v14 offset:25632
    v_mfma_f32_16x16x32_bf16 v[128:131], a[8:11], v[176:179], v[128:131]
    ds_read_b64_tr_b16 a[36:37], v14 offset:30752
    buffer_load_dwordx4 a[112:115], v25, s[20:23], s98 offen sc1
    v_mfma_f32_16x16x32_bf16 v[128:131], a[12:15], v[184:187], v[128:131]
    ds_read_b64_tr_b16 a[38:39], v14 offset:35872
    buffer_load_dwordx4 a[116:119], v20, s[20:23], s98 offen sc1
    v_mfma_f32_16x16x32_bf16 v[132:135], a[12:15], v[188:191], v[132:135]
    ds_read_b64_tr_b16 a[40:41], v18 offset:20544
    v_mfma_f32_16x16x32_bf16 v[132:135], a[8:11], v[180:183], v[132:135]
    ds_read_b64_tr_b16 a[42:43], v18 offset:25664
    s_waitcnt lgkmcnt(6)
    v_mfma_f32_16x16x32_bf16 v[136:139], a[16:19], a[240:243], v[136:139]
    ds_read_b64_tr_b16 a[44:45], v18 offset:30784
    s_add_u32 s98, s98, 73856
    v_mfma_f32_16x16x32_bf16 v[136:139], a[20:23], a[248:251], v[136:139]
    ds_read_b64_tr_b16 a[46:47], v18 offset:35904
    buffer_load_dwordx4 a[120:123], v25, s[20:23], s98 offen sc1
    v_mfma_f32_16x16x32_bf16 v[140:143], a[20:23], a[252:255], v[140:143]
    ds_read_b64_tr_b16 a[48:49], v11 offset:64
    buffer_load_dwordx4 a[124:127], v20, s[20:23], s98 offen sc1
    v_mfma_f32_16x16x32_bf16 v[140:143], a[16:19], a[244:247], v[140:143]
    ds_read_b64_tr_b16 a[50:51], v11 offset:5184
    v_mfma_f32_16x16x32_bf16 v[136:139], a[24:27], v[160:163], v[136:139]
    ds_read_b64_tr_b16 a[52:53], v11 offset:10304
    s_add_u32 s98, s98, 73856
    v_cvt_pk_bf16_f32 v128, v128, v129
    v_mfma_f32_16x16x32_bf16 v[136:139], a[28:31], v[168:171], v[136:139]
    ds_read_b64_tr_b16 a[54:55], v11 offset:15424
    buffer_load_dwordx4 a[128:131], v25, s[20:23], s98 offen sc1
    v_cvt_pk_bf16_f32 v129, v130, v131
    v_mfma_f32_16x16x32_bf16 v[140:143], a[28:31], v[172:175], v[140:143]
    ds_read_b64_tr_b16 a[56:57], v11 offset:20544
    buffer_load_dwordx4 a[132:135], v20, s[20:23], s98 offen sc1
    v_cvt_pk_bf16_f32 v130, v132, v133
    v_mfma_f32_16x16x32_bf16 v[140:143], a[24:27], v[164:167], v[140:143]
    ds_read_b64_tr_b16 a[58:59], v11 offset:25664
    v_cvt_pk_bf16_f32 v131, v134, v135
    s_waitcnt lgkmcnt(6)
    v_mfma_f32_16x16x32_bf16 v[136:139], a[32:35], v[176:179], v[136:139]
    ds_read_b64_tr_b16 a[60:61], v11 offset:30784
    s_add_u32 s98, s98, 73856
    s_add_u32 s47, s53, 0
    v_mfma_f32_16x16x32_bf16 v[136:139], a[36:39], v[184:187], v[136:139]
    ds_read_b64_tr_b16 a[62:63], v11 offset:35904
    v_and_b32 v6, 3, v0
    v_add_u32 v24, s44, v16
    v_mfma_f32_16x16x32_bf16 v[140:143], a[36:39], v[188:191], v[140:143]
    ds_read_b64_tr_b16 a[0:1], v19 offset:20576
    buffer_load_dwordx4 a[136:139], v25, s[20:23], s98 offen sc1
    buffer_store_dwordx4 v[128:131], v16, s[24:27], s47 offen offset:0 sc1
    v_mfma_f32_16x16x32_bf16 v[140:143], a[32:35], v[180:183], v[140:143]
    ds_read_b64_tr_b16 a[2:3], v19 offset:25696
    buffer_load_dwordx4 a[140:143], v20, s[20:23], s98 offen sc1
    ds_write_b128 v24, v[128:131] offset:0
    v_mfma_f32_16x16x32_bf16 v[144:147], a[40:43], a[240:243], v[144:147]
    ds_read_b64_tr_b16 a[4:5], v19 offset:30816
    v_lshlrev_b32 v6, 3, v6
    v_bfe_u32 v9, v0, 2, 1
    v_mfma_f32_16x16x32_bf16 v[144:147], a[44:47], a[248:251], v[144:147]
    ds_read_b64_tr_b16 a[6:7], v19 offset:35936
    s_add_u32 s5, s5, 37376
    v_mfma_f32_16x16x32_bf16 v[148:151], a[44:47], a[252:255], v[148:151]
    ds_read_b64_tr_b16 a[8:9], v14 offset:96
    buffer_load_dwordx4 a[144:147], v26, s[28:31], s5 offen sc1
    buffer_load_dwordx4 a[148:151], v27, s[28:31], s5 offen sc1
    v_mfma_f32_16x16x32_bf16 v[148:151], a[40:43], a[244:247], v[148:151]
    ds_read_b64_tr_b16 a[10:11], v14 offset:5216
    s_waitcnt lgkmcnt(7)
    v_mfma_f32_16x16x32_bf16 v[144:147], a[48:51], v[160:163], v[144:147]
    ds_read_b64_tr_b16 a[12:13], v14 offset:10336
    v_add_u32 v6, v6, v9
    v_bfe_u32 v9, v0, 6, 2
    v_mfma_f32_16x16x32_bf16 v[144:147], a[52:55], v[168:171], v[144:147]
    ds_read_b64_tr_b16 a[14:15], v14 offset:15456
    s_add_u32 s5, s5, 37376
    v_cvt_pk_bf16_f32 v136, v136, v137
    v_mfma_f32_16x16x32_bf16 v[148:151], a[52:55], v[172:175], v[148:151]
    ds_read_b64_tr_b16 a[16:17], v14 offset:20576
    v_lshl_add_u32 v6, v9, 1, v6
    v_cvt_pk_bf16_f32 v137, v138, v139
    v_mfma_f32_16x16x32_bf16 v[148:151], a[48:51], v[164:167], v[148:151]
    ds_read_b64_tr_b16 a[18:19], v14 offset:25696
    buffer_load_dwordx4 a[152:155], v26, s[28:31], s5 offen sc1
    buffer_load_dwordx4 a[156:159], v27, s[28:31], s5 offen sc1
    v_mfma_f32_16x16x32_bf16 v[144:147], a[56:59], v[176:179], v[144:147]
    ds_read_b64_tr_b16 a[20:21], v14 offset:30816
    v_lshlrev_b32 v6, 11, v6
    v_cvt_pk_bf16_f32 v138, v140, v141
    v_mfma_f32_16x16x32_bf16 v[144:147], a[60:63], v[184:187], v[144:147]
    ds_read_b64_tr_b16 a[22:23], v14 offset:35936
    v_lshrrev_b32 v7, 6, v0
    v_lshlrev_b32 v7, 12, v7
    v_mfma_f32_16x16x32_bf16 v[148:151], a[60:63], v[188:191], v[148:151]
    ds_read_b64_tr_b16 a[24:25], v18 offset:20608
    s_add_u32 s5, s5, 37376
    v_cvt_pk_bf16_f32 v139, v142, v143
    v_mfma_f32_16x16x32_bf16 v[148:151], a[56:59], v[180:183], v[148:151]
    ds_read_b64_tr_b16 a[26:27], v18 offset:25728
    buffer_store_dwordx4 v[136:139], v16, s[24:27], s47 offen offset:1024 sc1
    ds_write_b128 v24, v[136:139] offset:1024
    s_waitcnt lgkmcnt(7)
    v_mfma_f32_16x16x32_bf16 v[152:155], a[0:3], a[240:243], v[152:155]
    ds_read_b64_tr_b16 a[28:29], v18 offset:30848
    buffer_load_dwordx4 a[160:163], v26, s[28:31], s5 offen sc1
    buffer_load_dwordx4 a[164:167], v27, s[28:31], s5 offen sc1
    v_mfma_f32_16x16x32_bf16 v[152:155], a[4:7], a[248:251], v[152:155]
    ds_read_b64_tr_b16 a[30:31], v18 offset:35968
    v_and_b32 v8, 15, v0
    v_mfma_f32_16x16x32_bf16 v[156:159], a[4:7], a[252:255], v[156:159]
    ds_read_b64_tr_b16 a[32:33], v11 offset:128
    v_bfe_u32 v9, v0, 4, 2
    v_mul_u32_u24 v10, 1152, v8
    v_mfma_f32_16x16x32_bf16 v[156:159], a[0:3], a[244:247], v[156:159]
    ds_read_b64_tr_b16 a[34:35], v11 offset:5248
    s_add_u32 s5, s5, 37376
    v_mfma_f32_16x16x32_bf16 v[152:155], a[8:11], v[160:163], v[152:155]
    ds_read_b64_tr_b16 a[36:37], v11 offset:10368
    buffer_load_dwordx4 a[168:171], v26, s[28:31], s5 offen sc1
    buffer_load_dwordx4 a[172:175], v27, s[28:31], s5 offen sc1
    v_mfma_f32_16x16x32_bf16 v[152:155], a[12:15], v[168:171], v[152:155]
    ds_read_b64_tr_b16 a[38:39], v11 offset:15488
    v_lshl_add_u32 v10, v9, 3, v10
    v_cvt_pk_bf16_f32 v144, v144, v145
    v_mfma_f32_16x16x32_bf16 v[156:159], a[12:15], v[172:175], v[156:159]
    ds_read_b64_tr_b16 a[40:41], v11 offset:20608
    v_lshlrev_b32 v8, 4, v8
    v_lshl_add_u32 v8, v9, 9, v8
    v_mfma_f32_16x16x32_bf16 v[156:159], a[8:11], v[164:167], v[156:159]
    ds_read_b64_tr_b16 a[42:43], v11 offset:25728
    v_cvt_pk_bf16_f32 v145, v146, v147
    s_waitcnt lgkmcnt(6)
    v_mfma_f32_16x16x32_bf16 v[152:155], a[16:19], v[176:179], v[152:155]
    ds_read_b64_tr_b16 a[44:45], v11 offset:30848
    s_add_u32 s5, s5, 37376
    v_cvt_pk_bf16_f32 v146, v148, v149
    v_mfma_f32_16x16x32_bf16 v[152:155], a[20:23], v[184:187], v[152:155]
    ds_read_b64_tr_b16 a[46:47], v11 offset:35968
    buffer_load_dwordx4 a[176:179], v26, s[28:31], s5 offen sc1
    buffer_load_dwordx4 a[180:183], v27, s[28:31], s5 offen sc1
    v_mfma_f32_16x16x32_bf16 v[156:159], a[20:23], v[188:191], v[156:159]
    ds_read_b64_tr_b16 a[48:49], v19 offset:20640
    v_and_b32 v23, 3, v0
    v_cvt_pk_bf16_f32 v147, v150, v151
    buffer_store_dwordx4 v[144:147], v16, s[24:27], s47 offen offset:2048 sc1
    v_mfma_f32_16x16x32_bf16 v[156:159], a[16:19], v[180:183], v[156:159]
    ds_read_b64_tr_b16 a[50:51], v19 offset:25760
    v_lshlrev_b32 v23, 7, v23
    v_and_b32 v9, 60, v0
    ds_write_b128 v24, v[144:147] offset:2048
    v_mfma_f32_16x16x32_bf16 v[64:67], a[24:27], a[240:243], v[64:67]
    ds_read_b64_tr_b16 a[52:53], v19 offset:30880
    s_add_u32 s5, s5, 37376
    v_add_u32 v23, v23, v9
    v_mfma_f32_16x16x32_bf16 v[64:67], a[28:31], a[248:251], v[64:67]
    ds_read_b64_tr_b16 a[54:55], v19 offset:36000
    buffer_load_dwordx4 a[184:187], v26, s[28:31], s5 offen sc1
    buffer_load_dwordx4 a[188:191], v27, s[28:31], s5 offen sc1
    v_mfma_f32_16x16x32_bf16 v[68:71], a[28:31], a[252:255], v[68:71]
    ds_read_b64_tr_b16 a[56:57], v14 offset:160
    s_waitcnt vmcnt(32)
    v_cmp_gt_u32 vcc, 40, v5
    s_cbranch_vccz L_poll15_ok
    s_mov_b32 s83, 0
L_poll15:
    buffer_load_dword v5, v4, s[36:39], 0 offen sc1
    s_add_u32 s83, s83, 1
    s_waitcnt vmcnt(0)
    v_cmp_gt_u32 vcc, 40, v5
    s_cbranch_vccz L_poll15_ok
    s_cmp_lt_u32 s83, 0x40000
    s_cbranch_scc1 L_poll15
L_poll15_ok:
    v_mfma_f32_16x16x32_bf16 v[68:71], a[24:27], a[244:247], v[68:71]
    ds_read_b64_tr_b16 a[58:59], v14 offset:5280
    s_waitcnt lgkmcnt(7)
    v_mfma_f32_16x16x32_bf16 v[64:67], a[32:35], v[160:163], v[64:67]
    ds_read_b64_tr_b16 a[60:61], v14 offset:10400
    s_add_u32 s5, s5, 37376
    v_mfma_f32_16x16x32_bf16 v[64:67], a[36:39], v[168:171], v[64:67]
    ds_read_b64_tr_b16 a[62:63], v14 offset:15520
    v_cvt_pk_bf16_f32 v152, v152, v153
    v_mfma_f32_16x16x32_bf16 v[68:71], a[36:39], v[172:175], v[68:71]
    ds_read_b64_tr_b16 a[0:1], v14 offset:20640
    buffer_load_dwordx4 a[192:195], v26, s[28:31], s5 offen sc1
    buffer_load_dwordx4 a[196:199], v27, s[28:31], s5 offen sc1
    v_mfma_f32_16x16x32_bf16 v[68:71], a[32:35], v[164:167], v[68:71]
    ds_read_b64_tr_b16 a[2:3], v14 offset:25760
    v_cvt_pk_bf16_f32 v153, v154, v155
    v_cvt_pk_bf16_f32 v154, v156, v157
    v_mfma_f32_16x16x32_bf16 v[64:67], a[40:43], v[176:179], v[64:67]
    ds_read_b64_tr_b16 a[4:5], v14 offset:30880
    s_waitcnt vmcnt(38)
    v_cvt_pk_bf16_f32 v155, v158, v159
    v_mfma_f32_16x16x32_bf16 v[64:67], a[44:47], v[184:187], v[64:67]
    ds_read_b64_tr_b16 a[6:7], v14 offset:36000
    s_add_u32 s5, s5, 37376
    buffer_store_dwordx4 v[152:155], v16, s[24:27], s47 offen offset:3072 sc1
    v_mfma_f32_16x16x32_bf16 v[68:71], a[44:47], v[188:191], v[68:71]
    ds_read_b64_tr_b16 a[8:9], v18 offset:20672
    v_mov_b32 v2, 0x3f80
    ds_write_b128 v24, v[152:155] offset:3072
    v_mfma_f32_16x16x32_bf16 v[68:71], a[40:43], v[180:183], v[68:71]
    ds_read_b64_tr_b16 a[10:11], v18 offset:25792
    s_waitcnt lgkmcnt(7)
    v_mfma_f32_16x16x32_bf16 v[72:75], a[48:51], a[240:243], v[72:75]
    ds_read_b64_tr_b16 a[12:13], v18 offset:30912
    buffer_load_dwordx4 a[200:203], v26, s[28:31], s5 offen sc1
    buffer_load_dwordx4 a[204:207], v27, s[28:31], s5 offen sc1
    v_mfma_f32_16x16x32_bf16 v[72:75], a[52:55], a[248:251], v[72:75]
    ds_read_b64_tr_b16 a[14:15], v18 offset:36032
    s_mov_b32 s65, -1
    s_mov_b32 s67, 0
    v_mfma_f32_16x16x32_bf16 v[76:79], a[52:55], a[252:255], v[76:79]
    ds_read_b64_tr_b16 a[16:17], v11 offset:192
    s_add_u32 s5, s5, 37376
    v_mfma_f32_16x16x32_bf16 v[76:79], a[48:51], a[244:247], v[76:79]
    ds_read_b64_tr_b16 a[18:19], v11 offset:5312
    buffer_load_dwordx4 a[208:211], v26, s[28:31], s5 offen sc1
    buffer_load_dwordx4 a[212:215], v27, s[28:31], s5 offen sc1
    v_mfma_f32_16x16x32_bf16 v[72:75], a[56:59], v[160:163], v[72:75]
    ds_read_b64_tr_b16 a[20:21], v11 offset:10432
    s_cmp_le_u32 s96, 0
    s_cselect_b32 s64, -1, 0
    v_mfma_f32_16x16x32_bf16 v[72:75], a[60:63], v[168:171], v[72:75]
    ds_read_b64_tr_b16 a[22:23], v11 offset:15552
    s_cmp_ge_u32 s96, 0
    s_cselect_b32 s66, -1, 0
    v_mfma_f32_16x16x32_bf16 v[76:79], a[60:63], v[172:175], v[76:79]
    ds_read_b64_tr_b16 a[24:25], v11 offset:20672
    s_add_u32 s5, s5, 37376
    v_cvt_pk_bf16_f32 v64, v64, v65
    v_mfma_f32_16x16x32_bf16 v[76:79], a[56:59], v[164:167], v[76:79]
    ds_read_b64_tr_b16 a[26:27], v11 offset:25792
    v_cvt_pk_bf16_f32 v65, v66, v67
    s_waitcnt lgkmcnt(6)
    v_mfma_f32_16x16x32_bf16 v[72:75], a[0:3], v[176:179], v[72:75]
    ds_read_b64_tr_b16 a[28:29], v11 offset:30912
    buffer_load_dwordx4 a[216:219], v26, s[28:31], s5 offen sc1
    buffer_load_dwordx4 a[220:223], v27, s[28:31], s5 offen sc1
    v_mfma_f32_16x16x32_bf16 v[72:75], a[4:7], v[184:187], v[72:75]
    ds_read_b64_tr_b16 a[30:31], v11 offset:36032
    v_cndmask_b32 v192, 0, v192, s[64:65]
    v_cvt_pk_bf16_f32 v66, v68, v69
    v_mfma_f32_16x16x32_bf16 v[76:79], a[4:7], v[188:191], v[76:79]
    ds_read_b64_tr_b16 a[32:33], v19 offset:20704
    v_cndmask_b32 v196, v2, v196, s[66:67]
    v_cvt_pk_bf16_f32 v67, v70, v71
    v_mfma_f32_16x16x32_bf16 v[76:79], a[0:3], v[180:183], v[76:79]
    ds_read_b64_tr_b16 a[34:35], v19 offset:25824
    v_cndmask_b32 v200, 0, v200, s[64:65]
    s_add_u32 s47, s53, 4096
    buffer_store_dwordx4 v[64:67], v16, s[24:27], s47 offen offset:0 sc1
    ds_write_b128 v24, v[64:67] offset:4096
    v_mfma_f32_16x16x32_bf16 v[80:83], a[8:11], a[240:243], v[80:83]
    ds_read_b64_tr_b16 a[36:37], v19 offset:30944
    v_cndmask_b32 v204, v2, v204, s[66:67]
    v_mfma_f32_16x16x32_bf16 v[80:83], a[12:15], a[248:251], v[80:83]
    ds_read_b64_tr_b16 a[38:39], v19 offset:36064
    s_cmp_le_u32 s96, 1
    s_cselect_b32 s64, -1, 0
    v_mfma_f32_16x16x32_bf16 v[84:87], a[12:15], a[252:255], v[84:87]
    ds_read_b64_tr_b16 a[40:41], v14 offset:224
    v_mfma_f32_16x16x32_bf16 v[84:87], a[8:11], a[244:247], v[84:87]
    ds_read_b64_tr_b16 a[42:43], v14 offset:5344
    s_waitcnt lgkmcnt(7)
    v_mfma_f32_16x16x32_bf16 v[80:83], a[16:19], v[160:163], v[80:83]
    ds_read_b64_tr_b16 a[44:45], v14 offset:10464
    s_cmp_ge_u32 s96, 1
    s_cselect_b32 s66, -1, 0
    v_mfma_f32_16x16x32_bf16 v[80:83], a[20:23], v[168:171], v[80:83]
    ds_read_b64_tr_b16 a[46:47], v14 offset:15584
    v_cvt_pk_bf16_f32 v72, v72, v73
    v_mfma_f32_16x16x32_bf16 v[84:87], a[20:23], v[172:175], v[84:87]
    ds_read_b64_tr_b16 a[48:49], v14 offset:20704
    v_cndmask_b32 v193, 0, v193, s[64:65]
    v_mfma_f32_16x16x32_bf16 v[84:87], a[16:19], v[164:167], v[84:87]
    ds_read_b64_tr_b16 a[50:51], v14 offset:25824
    v_cndmask_b32 v197, 0, v197, s[66:67]
    v_mfma_f32_16x16x32_bf16 v[80:83], a[24:27], v[176:179], v[80:83]
    ds_read_b64_tr_b16 a[52:53], v14 offset:30944
    v_cvt_pk_bf16_f32 v73, v74, v75
    v_cvt_pk_bf16_f32 v74, v76, v77
    v_mfma_f32_16x16x32_bf16 v[80:83], a[28:31], v[184:187], v[80:83]
    ds_read_b64_tr_b16 a[54:55], v14 offset:36064
    v_cndmask_b32 v201, 0, v201, s[64:65]
    v_cvt_pk_bf16_f32 v75, v78, v79
    v_mfma_f32_16x16x32_bf16 v[84:87], a[28:31], v[188:191], v[84:87]
    ds_read_b64_tr_b16 a[56:57], v18 offset:20736
    v_cndmask_b32 v205, 0, v205, s[66:67]
    buffer_store_dwordx4 v[72:75], v16, s[24:27], s47 offen offset:1024 sc1
    v_mfma_f32_16x16x32_bf16 v[84:87], a[24:27], v[180:183], v[84:87]
    ds_read_b64_tr_b16 a[58:59], v18 offset:25856
    ds_write_b128 v24, v[72:75] offset:5120
    s_waitcnt lgkmcnt(7)
    v_mfma_f32_16x16x32_bf16 v[88:91], a[32:35], a[240:243], v[88:91]
    ds_read_b64_tr_b16 a[60:61], v18 offset:30976
    s_cmp_le_u32 s96, 2
    s_cselect_b32 s64, -1, 0
    v_mfma_f32_16x16x32_bf16 v[88:91], a[36:39], a[248:251], v[88:91]
    ds_read_b64_tr_b16 a[62:63], v18 offset:36096
    v_mfma_f32_16x16x32_bf16 v[92:95], a[36:39], a[252:255], v[92:95]
    ds_read_b64_tr_b16 a[0:1], v11 offset:256
    s_cmp_ge_u32 s96, 2
    s_cselect_b32 s66, -1, 0
    v_mfma_f32_16x16x32_bf16 v[92:95], a[32:35], a[244:247], v[92:95]
    ds_read_b64_tr_b16 a[2:3], v11 offset:5376
    v_mfma_f32_16x16x32_bf16 v[88:91], a[40:43], v[160:163], v[88:91]
    ds_read_b64_tr_b16 a[4:5], v11 offset:10496
    v_cvt_pk_bf16_f32 v80, v80, v81
    v_mfma_f32_16x16x32_bf16 v[88:91], a[44:47], v[168:171], v[88:91]
    ds_read_b64_tr_b16 a[6:7], v11 offset:15616
    v_cndmask_b32 v194, 0, v194, s[64:65]
    v_cvt_pk_bf16_f32 v81, v82, v83
    v_mfma_f32_16x16x32_bf16 v[92:95], a[44:47], v[172:175], v[92:95]
    ds_read_b64_tr_b16 a[8:9], v11 offset:20736
    v_cndmask_b32 v198, 0, v198, s[66:67]
    v_cvt_pk_bf16_f32 v82, v84, v85
    v_mfma_f32_16x16x32_bf16 v[92:95], a[40:43], v[164:167], v[92:95]
    ds_read_b64_tr_b16 a[10:11], v11 offset:25856
    s_waitcnt lgkmcnt(6)
    v_mfma_f32_16x16x32_bf16 v[88:91], a[48:51], v[176:179], v[88:91]
    ds_read_b64_tr_b16 a[12:13], v11 offset:30976
    v_cndmask_b32 v202, 0, v202, s[64:65]
    v_mfma_f32_16x16x32_bf16 v[88:91], a[52:55], v[184:187], v[88:91]
    ds_read_b64_tr_b16 a[14:15], v11 offset:36096
    v_cndmask_b32 v206, 0, v206, s[66:67]
    v_mfma_f32_16x16x32_bf16 v[92:95], a[52:55], v[188:191], v[92:95]
    s_cmp_le_u32 s96, 3
    s_cselect_b32 s64, -1, 0
    v_mfma_f32_16x16x32_bf16 v[92:95], a[48:51], v[180:183], v[92:95]
    v_cvt_pk_bf16_f32 v83, v86, v87
    buffer_store_dwordx4 v[80:83], v16, s[24:27], s47 offen offset:2048 sc1
    ds_write_b128 v24, v[80:83] offset:6144
    v_mfma_f32_16x16x32_bf16 v[96:99], a[56:59], a[240:243], v[96:99]
    v_mfma_f32_16x16x32_bf16 v[96:99], a[60:63], a[248:251], v[96:99]
    s_cmp_ge_u32 s96, 3
    s_cselect_b32 s66, -1, 0
    v_mfma_f32_16x16x32_bf16 v[100:103], a[60:63], a[252:255], v[100:103]
    v_mfma_f32_16x16x32_bf16 v[100:103], a[56:59], a[244:247], v[100:103]
    s_waitcnt lgkmcnt(1)
    v_mfma_f32_16x16x32_bf16 v[96:99], a[0:3], v[160:163], v[96:99]
    v_cndmask_b32 v195, 0, v195, s[64:65]
    v_mfma_f32_16x16x32_bf16 v[96:99], a[4:7], v[168:171], v[96:99]
    v_cndmask_b32 v199, 0, v199, s[66:67]
    v_mfma_f32_16x16x32_bf16 v[100:103], a[4:7], v[172:175], v[100:103]
    v_cvt_pk_bf16_f32 v88, v88, v89
    v_cvt_pk_bf16_f32 v89, v90, v91
    v_mfma_f32_16x16x32_bf16 v[100:103], a[0:3], v[164:167], v[100:103]
    v_cndmask_b32 v203, 0, v203, s[64:65]
    v_mfma_f32_16x16x32_bf16 v[96:99], a[8:11], v[176:179], v[96:99]
    v_cndmask_b32 v207, 0, v207, s[66:67]
    v_mfma_f32_16x16x32_bf16 v[96:99], a[12:15], v[184:187], v[96:99]
    v_cvt_pk_bf16_f32 v90, v92, v93
    v_mfma_f32_16x16x32_bf16 v[100:103], a[12:15], v[188:191], v[100:103]
    v_cvt_pk_bf16_f32 v91, v94, v95
    buffer_store_dwordx4 v[88:91], v16, s[24:27], s47 offen offset:3072 sc1
    v_mfma_f32_16x16x32_bf16 v[100:103], a[8:11], v[180:183], v[100:103]
    ds_write_b128 v24, v[88:91] offset:7168
    s_mov_b32 s63, 0xffff0000
    s_mov_b32 s46, 0x07060302
    s_waitcnt vmcnt(27)
    s_cmp_ge_u32 s94, 8
    s_cbranch_scc1 L_nob
    s_mov_b32 exec_lo, 0
    s_cmp_lt_u32 s94, 8
    s_cselect_b32 s99, 0x3f80f149, 1.0
    v_accvgpr_write_b32 a68, s99
    s_cmp_lt_u32 s94, 7
    s_cselect_b32 s99, 0x3f80f149, 1.0
    v_accvgpr_write_b32 a76, s99
    s_cmp_lt_u32 s94, 6
    s_cselect_b32 s99, 0x3f80f149, 1.0
    v_accvgpr_write_b32 a84, s99
    s_cmp_lt_u32 s94, 5
    s_cselect_b32 s99, 0x3f80f149, 1.0
    v_accvgpr_write_b32 a92, s99
    s_cmp_lt_u32 s94, 4
    s_cselect_b32 s99, 0x3f80f149, 1.0
    v_accvgpr_write_b32 a100, s99
    s_cmp_lt_u32 s94, 3
    s_cselect_b32 s99, 0x3f80f149, 1.0
    v_accvgpr_write_b32 a108, s99
    s_cmp_lt_u32 s94, 2
    s_cselect_b32 s99, 0x3f80f149, 1.0
    v_accvgpr_write_b32 a116, s99
    s_cmp_lt_u32 s94, 1
    s_cselect_b32 s99, 0x3f80f149, 1.0
    v_accvgpr_write_b32 a124, s99
    s_mov_b32 exec_lo, -1
    s_nop 1
L_nob:
    v_mfma_f32_32x32x16_bf16 v[112:127], a[64:67], v[192:195], v[224:239]
    v_mfma_f32_32x32x16_bf16 v[112:127], a[68:71], v[196:199], v[112:127]
    v_mfma_f32_32x32x16_bf16 v[240:255], a[72:75], v[192:195], 0
    v_mfma_f32_32x32x16_bf16 v[240:255], a[76:79], v[196:199], v[240:255]
    v_cvt_pk_bf16_f32 v96, v96, v97
    v_cvt_pk_bf16_f32 v97, v98, v99
    v_cvt_pk_bf16_f32 v98, v100, v101
    v_cvt_pk_bf16_f32 v99, v102, v103
    s_add_u32 s47, s53, 8192
    buffer_store_dwordx4 v[96:99], v16, s[24:27], s47 offen offset:0 sc1
    ds_write_b128 v24, v[96:99] offset:8192
    v_mfma_f32_32x32x16_bf16 v[160:175], a[80:83], v[192:195], 0
    s_nop 1
    v_max_f32 v1, v112, v113
    v_max_f32 v2, v114, v115
    v_max_f32 v3, v116, v117
    v_max_f32 v4, v118, v119
    v_mfma_f32_32x32x16_bf16 v[160:175], a[84:87], v[196:199], v[160:175]
    v_max3_f32 v1, v120, v121, v1
    v_max3_f32 v2, v122, v123, v2
    v_max3_f32 v3, v124, v125, v3
    v_max3_f32 v4, v126, v127, v4
    v_mfma_f32_32x32x16_bf16 v[112:127], a[88:91], v[192:195], 0
    v_max3_f32 v1, v240, v241, v1
    v_max3_f32 v2, v242, v243, v2
    v_max3_f32 v3, v244, v245, v3
    v_max3_f32 v4, v246, v247, v4
    v_mfma_f32_32x32x16_bf16 v[112:127], a[92:95], v[196:199], v[112:127]
    v_max3_f32 v1, v248, v249, v1
    v_max3_f32 v2, v250, v251, v2
    v_max3_f32 v3, v252, v253, v3
    v_max3_f32 v4, v254, v255, v4
    v_mfma_f32_32x32x16_bf16 v[240:255], a[96:99], v[192:195], 0
    v_max3_f32 v1, v160, v161, v1
    v_max3_f32 v2, v162, v163, v2
    v_max3_f32 v3, v164, v165, v3
    v_max3_f32 v4, v166, v167, v4
    v_mfma_f32_32x32x16_bf16 v[240:255], a[100:103], v[196:199], v[240:255]
    v_max3_f32 v1, v168, v169, v1
    v_max3_f32 v2, v170, v171, v2
    v_max3_f32 v3, v172, v173, v3
    v_max3_f32 v4, v174, v175, v4
    v_mfma_f32_32x32x16_bf16 v[160:175], a[104:107], v[192:195], 0
    v_max3_f32 v1, v112, v113, v1
    v_max3_f32 v2, v114, v115, v2
    v_max3_f32 v3, v116, v117, v3
    v_max3_f32 v4, v118, v119, v4
    v_mfma_f32_32x32x16_bf16 v[160:175], a[108:111], v[196:199], v[160:175]
    v_max3_f32 v1, v120, v121, v1
    v_max3_f32 v2, v122, v123, v2
    v_max3_f32 v3, v124, v125, v3
    v_max3_f32 v4, v126, v127, v4
    v_mfma_f32_32x32x16_bf16 v[112:127], a[112:115], v[192:195], 0
    v_max3_f32 v1, v240, v241, v1
    v_max3_f32 v2, v242, v243, v2
    v_max3_f32 v3, v244, v245, v3
    v_max3_f32 v4, v246, v247, v4
    v_mfma_f32_32x32x16_bf16 v[112:127], a[116:119], v[196:199], v[112:127]
    v_max3_f32 v1, v248, v249, v1
    v_max3_f32 v2, v250, v251, v2
    v_max3_f32 v3, v252, v253, v3
    v_max3_f32 v4, v254, v255, v4
    v_mfma_f32_32x32x16_bf16 v[240:255], a[120:123], v[192:195], 0
    v_max3_f32 v1, v160, v161, v1
    v_max3_f32 v2, v162, v163, v2
    v_max3_f32 v3, v164, v165, v3
    v_max3_f32 v4, v166, v167, v4
    v_mfma_f32_32x32x16_bf16 v[240:255], a[124:127], v[196:199], v[240:255]
    v_max3_f32 v1, v168, v169, v1
    v_max3_f32 v2, v170, v171, v2
    v_max3_f32 v3, v172, v173, v3
    v_max3_f32 v4, v174, v175, v4
    v_mfma_f32_32x32x16_bf16 v[160:175], a[128:131], v[192:195], v[208:223]
    v_max3_f32 v1, v112, v113, v1
    v_max3_f32 v2, v114, v115, v2
    v_max3_f32 v3, v116, v117, v3
    v_max3_f32 v4, v118, v119, v4
    v_mfma_f32_32x32x16_bf16 v[160:175], a[132:135], v[196:199], v[160:175]
    v_max3_f32 v1, v120, v121, v1
    v_max3_f32 v2, v122, v123, v2
    v_max3_f32 v3, v124, v125, v3
    v_max3_f32 v4, v126, v127, v4
    v_max3_f32 v1, v240, v241, v1
    v_max3_f32 v2, v242, v243, v2
    v_max3_f32 v3, v244, v245, v3
    v_max3_f32 v4, v246, v247, v4
    v_max3_f32 v1, v248, v249, v1
    v_max3_f32 v2, v250, v251, v2
    v_max3_f32 v3, v252, v253, v3
    v_max3_f32 v4, v254, v255, v4
    s_barrier
    v_max3_f32 v1, v160, v161, v1
    v_max3_f32 v2, v162, v163, v2
    v_max3_f32 v3, v164, v165, v3
    v_max3_f32 v4, v166, v167, v4
    v_max3_f32 v1, v168, v169, v1
    v_max3_f32 v2, v170, v171, v2
    v_max3_f32 v3, v172, v173, v3
    v_max3_f32 v4, v174, v175, v4
    v_max3_f32 v1, v1, v2, v3
    v_max_f32 v1, v1, v4
    v_mov_b32 v2, v1
    s_nop 1
    v_permlane32_swap_b32 v1, v2
    v_max_f32 v1, v1, v2
    v_sub_f32 v1, 0, v1
    v_and_b32 v2, s63, v1
    v_sub_f32 v1, v1, v2
    v_and_b32 v3, s63, v1
    v_sub_f32 v1, v1, v3
    s_mov_b32 exec_lo, 0
    v_or_b32 v196, 0x3f80, v2
    v_perm_b32 v197, v1, v3, s46
    s_mov_b32 exec_lo, -1
    v_mfma_f32_32x32x16_bf16 v[128:143], a[64:67], v[192:195], v[224:239]
    v_mfma_f32_32x32x16_bf16 v[128:143], a[68:71], v[196:199], v[128:143]
    v_mfma_f32_32x32x16_bf16 v[144:159], a[72:75], v[192:195], 0
    v_mfma_f32_32x32x16_bf16 v[144:159], a[76:79], v[196:199], v[144:159]
    v_mfma_f32_32x32x16_bf16 v[112:127], a[72:75], v[200:203], v[224:239]
    v_mfma_f32_32x32x16_bf16 v[112:127], a[76:79], v[204:207], v[112:127]
    s_nop 7
    v_exp_f32 v128, v128
    v_mfma_f32_32x32x16_bf16 v[176:191], a[80:83], v[192:195], 0
    v_exp_f32 v129, v129
    v_exp_f32 v130, v130
    v_exp_f32 v131, v131
    v_cvt_pk_bf16_f32 v32, v128, v129
    v_exp_f32 v132, v132
    v_exp_f32 v133, v133
    v_mfma_f32_32x32x16_bf16 v[176:191], a[84:87], v[196:199], v[176:191]
    v_cvt_pk_bf16_f32 v33, v130, v131
    v_exp_f32 v134, v134
    v_exp_f32 v135, v135
    v_cvt_pk_bf16_f32 v34, v132, v133
    v_exp_f32 v136, v136
    v_exp_f32 v137, v137
    v_mfma_f32_32x32x16_bf16 v[240:255], a[80:83], v[200:203], 0
    v_cvt_pk_bf16_f32 v35, v134, v135
    v_exp_f32 v138, v138
    v_exp_f32 v139, v139
    v_cvt_pk_bf16_f32 v36, v136, v137
    v_exp_f32 v140, v140
    v_exp_f32 v141, v141
    v_mfma_f32_32x32x16_bf16 v[240:255], a[84:87], v[204:207], v[240:255]
    v_cvt_pk_bf16_f32 v37, v138, v139
    v_exp_f32 v142, v142
    v_exp_f32 v143, v143
    v_cvt_pk_bf16_f32 v38, v140, v141
    v_cvt_pk_bf16_f32 v39, v142, v143
    s_waitcnt vmcnt(26)
    v_exp_f32 v144, v144
    v_mfma_f32_32x32x16_bf16 v[128:143], a[88:91], v[192:195], 0
    v_exp_f32 v145, v145
    s_mul_i32 s62, s84, 6144
    s_add_u32 s62, s62, s54
    buffer_load_dwordx4 a[0:3], v16, s[24:27], s62 offen offset:0 sc1
    v_exp_f32 v146, v146
    v_exp_f32 v147, v147
    buffer_load_dwordx4 a[4:7], v16, s[24:27], s62 offen offset:1024 sc1
    v_cvt_pk_bf16_f32 v40, v144, v145
    v_exp_f32 v148, v148
    v_mfma_f32_32x32x16_bf16 v[128:143], a[92:95], v[196:199], v[128:143]
    v_exp_f32 v149, v149
    buffer_load_dwordx4 a[8:11], v16, s[24:27], s62 offen offset:2048 sc1
    v_cvt_pk_bf16_f32 v41, v146, v147
    v_exp_f32 v150, v150
    v_exp_f32 v151, v151
    s_add_u32 s62, s62, 3072
    buffer_load_dwordx4 a[12:15], v16, s[24:27], s62 offen offset:0 sc1
    v_cvt_pk_bf16_f32 v42, v148, v149
    v_mfma_f32_32x32x16_bf16 v[48:63], a[144:147], v[32:35], 0
    v_exp_f32 v152, v152
    v_max_f32 v1, v112, v113
    buffer_load_dwordx2 v[100:101], v10, s[8:11], s60 offen offset:0
    v_max_f32 v2, v114, v115
    v_max_f32 v3, v116, v117
    v_max_f32 v4, v118, v119
    buffer_load_dwordx2 v[102:103], v10, s[8:11], s61 offen offset:0
    v_max3_f32 v1, v120, v121, v1
    v_mfma_f32_32x32x16_bf16 v[48:63], a[148:151], v[36:39], v[48:63]
    v_max3_f32 v2, v122, v123, v2
    v_max3_f32 v3, v124, v125, v3
    buffer_load_dwordx2 v[104:105], v10, s[8:11], s60 offen offset:32
    v_max3_f32 v4, v126, v127, v4
    v_exp_f32 v153, v153
    v_cvt_pk_bf16_f32 v43, v150, v151
    v_mfma_f32_32x32x16_bf16 v[160:175], a[88:91], v[200:203], 0
    buffer_load_dwordx2 v[106:107], v10, s[8:11], s61 offen offset:32
    v_exp_f32 v154, v154
    v_exp_f32 v155, v155
    v_cvt_pk_bf16_f32 v44, v152, v153
    buffer_load_dwordx2 v[108:109], v10, s[8:11], s60 offen offset:64
    v_exp_f32 v156, v156
    v_exp_f32 v157, v157
    v_mfma_f32_32x32x16_bf16 v[160:175], a[92:95], v[204:207], v[160:175]
    v_cvt_pk_bf16_f32 v45, v154, v155
    buffer_load_dwordx2 v[110:111], v10, s[8:11], s61 offen offset:64
    v_exp_f32 v158, v158
    v_exp_f32 v159, v159
    v_cvt_pk_bf16_f32 v46, v156, v157
    v_cvt_pk_bf16_f32 v47, v158, v159
    s_waitcnt vmcnt(34)
    v_exp_f32 v176, v176
    v_mfma_f32_32x32x16_bf16 v[144:159], a[96:99], v[192:195], 0
    v_exp_f32 v177, v177
    buffer_load_dwordx4 a[16:19], v16, s[24:27], s62 offen offset:1024 sc1
    v_exp_f32 v178, v178
    v_exp_f32 v179, v179
    v_cvt_pk_bf16_f32 v32, v176, v177
    v_exp_f32 v180, v180
    v_mfma_f32_32x32x16_bf16 v[144:159], a[100:103], v[196:199], v[144:159]
    v_exp_f32 v181, v181
    v_cvt_pk_bf16_f32 v33, v178, v179
    v_exp_f32 v182, v182
    v_exp_f32 v183, v183
    v_cvt_pk_bf16_f32 v34, v180, v181
    v_mfma_f32_32x32x16_bf16 v[48:63], a[152:155], v[40:43], v[48:63]
    buffer_load_dwordx4 a[20:23], v16, s[24:27], s62 offen offset:2048 sc1
    v_exp_f32 v184, v184
    v_max3_f32 v1, v240, v241, v1
    v_max3_f32 v2, v242, v243, v2
    v_max3_f32 v3, v244, v245, v3
    v_max3_f32 v4, v246, v247, v4
    v_max3_f32 v1, v248, v249, v1
    v_mfma_f32_32x32x16_bf16 v[48:63], a[156:159], v[44:47], v[48:63]
    v_max3_f32 v2, v250, v251, v2
    v_max3_f32 v3, v252, v253, v3
    v_max3_f32 v4, v254, v255, v4
    v_exp_f32 v185, v185
    s_mul_i32 s62, s85, 6144
    s_add_u32 s62, s62, s54
    buffer_load_dwordx4 a[24:27], v16, s[24:27], s62 offen offset:0 sc1
    v_cvt_pk_bf16_f32 v35, v182, v183
    v_mfma_f32_32x32x16_bf16 v[112:127], a[96:99], v[200:203], 0
    v_exp_f32 v186, v186
    v_exp_f32 v187, v187
    v_cvt_pk_bf16_f32 v36, v184, v185
    v_exp_f32 v188, v188
    v_exp_f32 v189, v189
    v_mfma_f32_32x32x16_bf16 v[112:127], a[100:103], v[204:207], v[112:127]
    v_cvt_pk_bf16_f32 v37, v186, v187
    v_exp_f32 v190, v190
    v_exp_f32 v191, v191
    v_cvt_pk_bf16_f32 v38, v188, v189
    v_cvt_pk_bf16_f32 v39, v190, v191
    s_waitcnt vmcnt(34)
    v_exp_f32 v128, v128
    v_mfma_f32_32x32x16_bf16 v[176:191], a[104:107], v[192:195], 0
    v_exp_f32 v129, v129
    buffer_load_dwordx4 a[28:31], v16, s[24:27], s62 offen offset:1024 sc1
    v_exp_f32 v130, v130
    v_exp_f32 v131, v131
    v_cvt_pk_bf16_f32 v40, v128, v129
    v_exp_f32 v132, v132
    v_mfma_f32_32x32x16_bf16 v[176:191], a[108:111], v[196:199], v[176:191]
    v_exp_f32 v133, v133
    v_cvt_pk_bf16_f32 v41, v130, v131
    v_exp_f32 v134, v134
    buffer_load_dwordx4 a[32:35], v16, s[24:27], s62 offen offset:2048 sc1
    v_exp_f32 v135, v135
    v_cvt_pk_bf16_f32 v42, v132, v133
    v_mfma_f32_32x32x16_bf16 v[48:63], a[160:163], v[32:35], v[48:63]
    v_exp_f32 v136, v136
    v_max3_f32 v1, v160, v161, v1
    v_max3_f32 v2, v162, v163, v2
    v_max3_f32 v3, v164, v165, v3
    v_max3_f32 v4, v166, v167, v4
    s_add_u32 s62, s62, 3072
    buffer_load_dwordx4 a[36:39], v16, s[24:27], s62 offen offset:0 sc1
    v_max3_f32 v1, v168, v169, v1
    v_mfma_f32_32x32x16_bf16 v[48:63], a[164:167], v[36:39], v[48:63]
    v_max3_f32 v2, v170, v171, v2
    v_max3_f32 v3, v172, v173, v3
    v_max3_f32 v4, v174, v175, v4
    v_exp_f32 v137, v137
    v_cvt_pk_bf16_f32 v43, v134, v135
    v_mfma_f32_32x32x16_bf16 v[240:255], a[104:107], v[200:203], 0
    v_exp_f32 v138, v138
    buffer_load_dwordx4 a[40:43], v16, s[24:27], s62 offen offset:1024 sc1
    v_exp_f32 v139, v139
    v_cvt_pk_bf16_f32 v44, v136, v137
    v_exp_f32 v140, v140
    v_exp_f32 v141, v141
    v_mfma_f32_32x32x16_bf16 v[240:255], a[108:111], v[204:207], v[240:255]
    v_cvt_pk_bf16_f32 v45, v138, v139
    v_exp_f32 v142, v142
    v_exp_f32 v143, v143
    v_cvt_pk_bf16_f32 v46, v140, v141
    v_cvt_pk_bf16_f32 v47, v142, v143
    s_waitcnt vmcnt(36)
    v_exp_f32 v144, v144
    v_mfma_f32_32x32x16_bf16 v[128:143], a[112:115], v[192:195], 0
    v_exp_f32 v145, v145
    s_lshl_b32 s82, s3, 7
    s_add_u32 s82, s82, s6
    v_mov_b32 v29, s7
    v_lshrrev_b32 v28, 2, v16
    v_add_u32 v29, 1, v29
    s_waitcnt vmcnt(17)
    s_mov_b32 exec_hi, 0
    buffer_store_dword v29, v28, s[24:27], s82 offen offset:512 sc1
    s_mov_b32 exec_hi, -1
    v_exp_f32 v146, v146
    v_exp_f32 v147, v147
    v_cvt_pk_bf16_f32 v32, v144, v145
    v_exp_f32 v148, v148
    v_mfma_f32_32x32x16_bf16 v[128:143], a[116:119], v[196:199], v[128:143]
    v_exp_f32 v149, v149
    v_cvt_pk_bf16_f32 v33, v146, v147
    v_exp_f32 v150, v150
    buffer_load_dwordx4 a[44:47], v16, s[24:27], s62 offen offset:2048 sc1
    v_exp_f32 v151, v151
    v_cvt_pk_bf16_f32 v34, v148, v149
    v_mfma_f32_32x32x16_bf16 v[48:63], a[168:171], v[40:43], v[48:63]
    v_exp_f32 v152, v152
    v_max3_f32 v1, v112, v113, v1
    v_max3_f32 v2, v114, v115, v2
    v_max3_f32 v3, v116, v117, v3
    v_max3_f32 v4, v118, v119, v4
    s_mul_i32 s62, s86, 6144
    s_add_u32 s62, s62, s54
    buffer_load_dwordx4 a[48:51], v16, s[24:27], s62 offen offset:0 sc1
    v_max3_f32 v1, v120, v121, v1
    v_mfma_f32_32x32x16_bf16 v[48:63], a[172:175], v[44:47], v[48:63]
    v_max3_f32 v2, v122, v123, v2
    v_max3_f32 v3, v124, v125, v3
    v_max3_f32 v4, v126, v127, v4
    v_exp_f32 v153, v153
    v_cvt_pk_bf16_f32 v35, v150, v151
    v_mfma_f32_32x32x16_bf16 v[160:175], a[112:115], v[200:203], 0
    v_exp_f32 v154, v154
    buffer_load_dwordx4 a[52:55], v16, s[24:27], s62 offen offset:1024 sc1
    v_exp_f32 v155, v155
    v_cvt_pk_bf16_f32 v36, v152, v153
    v_exp_f32 v156, v156
    v_exp_f32 v157, v157
    v_mfma_f32_32x32x16_bf16 v[160:175], a[116:119], v[204:207], v[160:175]
    v_cvt_pk_bf16_f32 v37, v154, v155
    v_exp_f32 v158, v158
    v_exp_f32 v159, v159
    v_cvt_pk_bf16_f32 v38, v156, v157
    v_cvt_pk_bf16_f32 v39, v158, v159
    s_waitcnt vmcnt(38)
    v_exp_f32 v176, v176
    v_mfma_f32_32x32x16_bf16 v[144:159], a[120:123], v[192:195], 0
    v_exp_f32 v177, v177
    buffer_load_dwordx4 a[56:59], v16, s[24:27], s62 offen offset:2048 sc1
    v_exp_f32 v178, v178
    v_exp_f32 v179, v179
    v_cvt_pk_bf16_f32 v40, v176, v177
    v_exp_f32 v180, v180
    v_mfma_f32_32x32x16_bf16 v[144:159], a[124:127], v[196:199], v[144:159]
    v_exp_f32 v181, v181
    v_cvt_pk_bf16_f32 v41, v178, v179
    v_exp_f32 v182, v182
    v_exp_f32 v183, v183
    v_cvt_pk_bf16_f32 v42, v180, v181
    v_mfma_f32_32x32x16_bf16 v[48:63], a[176:179], v[32:35], v[48:63]
    s_add_u32 s62, s62, 3072
    buffer_load_dwordx4 a[60:63], v16, s[24:27], s62 offen offset:0 sc1
    v_exp_f32 v184, v184
    v_max3_f32 v1, v240, v241, v1
    v_max3_f32 v2, v242, v243, v2
    v_max3_f32 v3, v244, v245, v3
    v_max3_f32 v4, v246, v247, v4
    v_max3_f32 v1, v248, v249, v1
    v_mfma_f32_32x32x16_bf16 v[48:63], a[180:183], v[36:39], v[48:63]
    v_max3_f32 v2, v250, v251, v2
    v_max3_f32 v3, v252, v253, v3
    v_max3_f32 v4, v254, v255, v4
    v_exp_f32 v185, v185
    buffer_load_dwordx4 a[224:227], v16, s[24:27], s62 offen offset:1024 sc1
    v_cvt_pk_bf16_f32 v43, v182, v183
    v_mfma_f32_32x32x16_bf16 v[112:127], a[120:123], v[200:203], 0
    v_exp_f32 v186, v186
    v_exp_f32 v187, v187
    v_cvt_pk_bf16_f32 v44, v184, v185
    v_exp_f32 v188, v188
    v_exp_f32 v189, v189
    v_mfma_f32_32x32x16_bf16 v[112:127], a[124:127], v[204:207], v[112:127]
    v_cvt_pk_bf16_f32 v45, v186, v187
    v_exp_f32 v190, v190
    v_exp_f32 v191, v191
    v_cvt_pk_bf16_f32 v46, v188, v189
    v_cvt_pk_bf16_f32 v47, v190, v191
    s_waitcnt vmcnt(38)
    v_exp_f32 v128, v128
    v_mfma_f32_32x32x16_bf16 v[176:191], a[128:131], v[192:195], v[208:223]
    v_exp_f32 v129, v129
    buffer_load_dwordx4 a[228:231], v16, s[24:27], s62 offen offset:2048 sc1
    v_exp_f32 v130, v130
    v_exp_f32 v131, v131
    v_cvt_pk_bf16_f32 v32, v128, v129
    v_exp_f32 v132, v132
    v_mfma_f32_32x32x16_bf16 v[176:191], a[132:135], v[196:199], v[176:191]
    v_exp_f32 v133, v133
    v_cvt_pk_bf16_f32 v33, v130, v131
    v_exp_f32 v134, v134
    s_mul_i32 s62, s87, 6144
    s_add_u32 s62, s62, s54
    buffer_load_dwordx4 a[232:235], v16, s[24:27], s62 offen offset:0 sc1
    v_exp_f32 v135, v135
    v_cvt_pk_bf16_f32 v34, v132, v133
    v_mfma_f32_32x32x16_bf16 v[48:63], a[184:187], v[40:43], v[48:63]
    v_exp_f32 v136, v136
    v_max3_f32 v1, v160, v161, v1
    v_max3_f32 v2, v162, v163, v2
    v_max3_f32 v3, v164, v165, v3
    v_max3_f32 v4, v166, v167, v4
    buffer_load_dwordx4 a[236:239], v16, s[24:27], s62 offen offset:1024 sc1
    v_max3_f32 v1, v168, v169, v1
    v_mfma_f32_32x32x16_bf16 v[48:63], a[188:191], v[44:47], v[48:63]
    v_max3_f32 v2, v170, v171, v2
    v_max3_f32 v3, v172, v173, v3
    v_max3_f32 v4, v174, v175, v4
    v_exp_f32 v137, v137
    v_cvt_pk_bf16_f32 v35, v134, v135
    v_mfma_f32_32x32x16_bf16 v[240:255], a[128:131], v[200:203], 0
    v_exp_f32 v138, v138
    buffer_load_dwordx4 a[240:243], v16, s[24:27], s62 offen offset:2048 sc1
    v_exp_f32 v139, v139
    v_cvt_pk_bf16_f32 v36, v136, v137
    v_exp_f32 v140, v140
    v_exp_f32 v141, v141
    v_mfma_f32_32x32x16_bf16 v[240:255], a[132:135], v[204:207], v[240:255]
    v_cvt_pk_bf16_f32 v37, v138, v139
    v_exp_f32 v142, v142
    v_exp_f32 v143, v143
    v_cvt_pk_bf16_f32 v38, v140, v141
    v_cvt_pk_bf16_f32 v39, v142, v143
    s_waitcnt vmcnt(40)
    v_exp_f32 v144, v144
    v_mfma_f32_32x32x16_bf16 v[48:63], a[192:195], v[32:35], v[48:63]
    v_exp_f32 v145, v145
    s_add_u32 s62, s62, 3072
    buffer_load_dwordx4 a[244:247], v16, s[24:27], s62 offen offset:0 sc1
    v_exp_f32 v146, v146
    v_exp_f32 v147, v147
    v_cvt_pk_bf16_f32 v40, v144, v145
    v_exp_f32 v148, v148
    v_exp_f32 v149, v149
    v_cvt_pk_bf16_f32 v41, v146, v147
    v_exp_f32 v150, v150
    v_mfma_f32_32x32x16_bf16 v[48:63], a[196:199], v[36:39], v[48:63]
    v_exp_f32 v151, v151
    v_cvt_pk_bf16_f32 v42, v148, v149
    buffer_load_dwordx4 a[248:251], v16, s[24:27], s62 offen offset:1024 sc1
    v_exp_f32 v152, v152
    v_max3_f32 v1, v112, v113, v1
    v_max3_f32 v2, v114, v115, v2
    v_max3_f32 v3, v116, v117, v3
    v_max3_f32 v4, v118, v119, v4
    v_max3_f32 v1, v120, v121, v1
    v_mfma_f32_32x32x16_bf16 v[160:175], a[136:139], v[200:203], v[208:223]
    v_max3_f32 v2, v122, v123, v2
    v_max3_f32 v3, v124, v125, v3
    v_max3_f32 v4, v126, v127, v4
    v_exp_f32 v153, v153
    buffer_load_dwordx4 a[252:255], v16, s[24:27], s62 offen offset:2048 sc1
    v_cvt_pk_bf16_f32 v43, v150, v151
    v_exp_f32 v154, v154
    v_exp_f32 v155, v155
    v_cvt_pk_bf16_f32 v44, v152, v153
    v_mfma_f32_32x32x16_bf16 v[160:175], a[140:143], v[204:207], v[160:175]
    v_exp_f32 v156, v156
    v_exp_f32 v157, v157
    v_cvt_pk_bf16_f32 v45, v154, v155
    v_exp_f32 v158, v158
    v_exp_f32 v159, v159
    v_cvt_pk_bf16_f32 v46, v156, v157
    v_cvt_pk_bf16_f32 v47, v158, v159
    s_waitcnt vmcnt(40)
    v_exp_f32 v176, v176
    v_mfma_f32_32x32x16_bf16 v[48:63], a[200:203], v[40:43], v[48:63]
    v_exp_f32 v177, v177
    s_mul_i32 s62, s88, 6144
    s_add_u32 s62, s62, s54
    buffer_load_dwordx4 v[64:67], v16, s[24:27], s62 offen offset:0 sc1
    v_exp_f32 v178, v178
    v_exp_f32 v179, v179
    v_cvt_pk_bf16_f32 v32, v176, v177
    v_exp_f32 v180, v180
    v_exp_f32 v181, v181
    v_cvt_pk_bf16_f32 v33, v178, v179
    v_exp_f32 v182, v182
    buffer_load_dwordx4 v[68:71], v16, s[24:27], s62 offen offset:1024 sc1
    v_exp_f32 v183, v183
    v_cvt_pk_bf16_f32 v34, v180, v181
    v_exp_f32 v184, v184
    v_max3_f32 v1, v240, v241, v1
    v_max3_f32 v2, v242, v243, v2
    v_max3_f32 v3, v244, v245, v3
    v_max3_f32 v4, v246, v247, v4
    buffer_load_dwordx4 v[72:75], v16, s[24:27], s62 offen offset:2048 sc1
    v_max3_f32 v1, v248, v249, v1
    v_mfma_f32_32x32x16_bf16 v[48:63], a[204:207], v[44:47], v[48:63]
    v_max3_f32 v2, v250, v251, v2
    v_max3_f32 v3, v252, v253, v3
    v_max3_f32 v4, v254, v255, v4
    v_exp_f32 v185, v185
    v_cvt_pk_bf16_f32 v35, v182, v183
    v_exp_f32 v186, v186
    buffer_load_dword v12, v7, s[24:27], s15 offen sc1
    v_exp_f32 v187, v187
    v_cvt_pk_bf16_f32 v36, v184, v185
    v_exp_f32 v188, v188
    v_exp_f32 v189, v189
    v_cvt_pk_bf16_f32 v37, v186, v187
    v_exp_f32 v190, v190
    v_exp_f32 v191, v191
    v_cvt_pk_bf16_f32 v38, v188, v189
    v_cvt_pk_bf16_f32 v39, v190, v191
    s_waitcnt vmcnt(40)
    v_mfma_f32_32x32x16_bf16 v[48:63], a[208:211], v[32:35], v[48:63]
    v_mfma_f32_32x32x16_bf16 v[48:63], a[212:215], v[36:39], v[48:63]
    v_max3_f32 v1, v160, v161, v1
    v_max3_f32 v2, v162, v163, v2
    v_max3_f32 v3, v164, v165, v3
    v_max3_f32 v4, v166, v167, v4
    v_max3_f32 v1, v168, v169, v1
    v_max3_f32 v2, v170, v171, v2
    v_max3_f32 v3, v172, v173, v3
    v_max3_f32 v4, v174, v175, v4
    v_max3_f32 v1, v1, v2, v3
    v_max_f32 v1, v1, v4
    v_mov_b32 v2, v1
    s_nop 1
    v_permlane32_swap_b32 v1, v2
    v_max_f32 v1, v1, v2
    v_sub_f32 v1, 0, v1
    v_and_b32 v2, s63, v1
    v_sub_f32 v1, v1, v2
    v_and_b32 v3, s63, v1
    v_sub_f32 v1, v1, v3
    s_mov_b32 exec_lo, 0
    v_or_b32 v204, 0x3f80, v2
    v_perm_b32 v205, v1, v3, s46
    s_mov_b32 exec_lo, -1
    v_mfma_f32_32x32x16_bf16 v[128:143], a[72:75], v[200:203], v[224:239]
    v_mfma_f32_32x32x16_bf16 v[128:143], a[76:79], v[204:207], v[128:143]
    v_mfma_f32_32x32x16_bf16 v[144:159], a[80:83], v[200:203], 0
    v_mfma_f32_32x32x16_bf16 v[144:159], a[84:87], v[204:207], v[144:159]
    v_rcp_f32 v15, v58
    s_add_u32 s97, s94, 0
    s_mul_i32 s97, s97, 36864
    v_mul_f32 v48, v15, v48
    v_mul_f32 v49, v15, v49
    v_mul_f32 v50, v15, v50
    v_mul_f32 v51, v15, v51
    v_mul_f32 v52, v15, v52
    v_mul_f32 v53, v15, v53
    v_mul_f32 v54, v15, v54
    v_mul_f32 v55, v15, v55
    v_mul_f32 v56, v15, v56
    v_mul_f32 v57, v15, v57
    v_cvt_pk_bf16_f32 v48, v48, v49
    v_cvt_pk_bf16_f32 v49, v50, v51
    v_cvt_pk_bf16_f32 v50, v52, v53
    v_cvt_pk_bf16_f32 v51, v54, v55
    v_cvt_pk_bf16_f32 v52, v56, v57
    s_add_u32 s97, s97, 27262976
    s_lshl_b32 s99, s93, 10
    s_add_u32 s99, s99, s97
    buffer_store_dwordx4 v[48:51], v16, s[24:27], s99 offen sc1
    s_lshl_b32 s99, s93, 7
    s_add_u32 s97, s97, s99
    s_add_u32 s97, s97, 32768
    v_lshrrev_b32 v15, 2, v16
    s_mov_b32 exec_hi, 0
    buffer_store_dword v52, v15, s[24:27], s97 offen sc1
    s_mov_b32 exec_hi, -1
    v_exp_f32 v128, v128
    v_mfma_f32_32x32x16_bf16 v[176:191], a[88:91], v[200:203], 0
    v_exp_f32 v129, v129
    s_add_u32 s62, s62, 3072
    buffer_load_dwordx4 v[76:79], v16, s[24:27], s62 offen offset:0 sc1
    v_exp_f32 v130, v130
    v_exp_f32 v131, v131
    v_cvt_pk_bf16_f32 v32, v128, v129
    v_exp_f32 v132, v132
    v_exp_f32 v133, v133
    buffer_load_dwordx4 v[80:83], v16, s[24:27], s62 offen offset:1024 sc1
    v_cvt_pk_bf16_f32 v33, v130, v131
    v_exp_f32 v134, v134
    v_exp_f32 v135, v135
    v_cvt_pk_bf16_f32 v34, v132, v133
    v_exp_f32 v136, v136
    buffer_load_dwordx4 v[84:87], v16, s[24:27], s62 offen offset:2048 sc1
    v_exp_f32 v137, v137
    v_mfma_f32_32x32x16_bf16 v[176:191], a[92:95], v[204:207], v[176:191]
    v_cvt_pk_bf16_f32 v35, v134, v135
    v_exp_f32 v138, v138
    v_exp_f32 v139, v139
    v_cvt_pk_bf16_f32 v36, v136, v137
    s_mul_i32 s62, s89, 6144
    s_add_u32 s62, s62, s54
    buffer_load_dwordx4 v[88:91], v16, s[24:27], s62 offen offset:0 sc1
    v_exp_f32 v140, v140
    v_exp_f32 v141, v141
    v_cvt_pk_bf16_f32 v37, v138, v139
    v_exp_f32 v142, v142
    v_exp_f32 v143, v143
    v_cvt_pk_bf16_f32 v38, v140, v141
    v_cvt_pk_bf16_f32 v39, v142, v143
    v_exp_f32 v144, v144
    v_mfma_f32_32x32x16_bf16 v[128:143], a[96:99], v[200:203], 0
    v_exp_f32 v145, v145
    buffer_load_dwordx4 v[92:95], v16, s[24:27], s62 offen offset:1024 sc1
    v_exp_f32 v146, v146
    v_exp_f32 v147, v147
    v_cvt_pk_bf16_f32 v40, v144, v145
    buffer_load_dwordx4 v[96:99], v16, s[24:27], s62 offen offset:2048 sc1
    v_exp_f32 v148, v148
    v_exp_f32 v149, v149
    v_mfma_f32_32x32x16_bf16 v[128:143], a[100:103], v[204:207], v[128:143]
    v_cvt_pk_bf16_f32 v41, v146, v147
    v_exp_f32 v150, v150
    s_add_u32 s62, s62, 3072
    buffer_load_dwordx4 v[240:243], v16, s[24:27], s62 offen offset:0 sc1
    v_exp_f32 v151, v151
    v_cvt_pk_bf16_f32 v42, v148, v149
    v_exp_f32 v152, v152
    s_add_u32 s82, s7, 1
    s_waitcnt vmcnt(9)
    v_subrev_u32 v12, s82, v12
    v_cmp_lt_u32 vcc, 7, v12
    s_cbranch_vccz L_poll16_ok
    s_mov_b32 s83, 0
L_poll16:
    buffer_load_dword v12, v7, s[24:27], s15 offen sc1
    s_add_u32 s83, s83, 1
    s_waitcnt vmcnt(0)
    v_subrev_u32 v12, s82, v12
    v_cmp_lt_u32 vcc, 7, v12
    s_cbranch_vccz L_poll16_ok
    s_cmp_lt_u32 s83, 0x40000
    s_cbranch_scc1 L_poll16
L_poll16_ok:
    v_exp_f32 v153, v153
    v_mfma_f32_32x32x16_bf16 v[48:63], a[152:155], v[32:35], 0
    v_cvt_pk_bf16_f32 v43, v150, v151
    v_exp_f32 v154, v154
    v_exp_f32 v155, v155
    s_add_u32 m0, s56, 0
    s_nop 0
    buffer_load_dwordx4 v16, s[24:27], s59 offen offset:0 sc1 lds
    v_cvt_pk_bf16_f32 v44, v152, v153
    v_exp_f32 v156, v156
    v_exp_f32 v157, v157
    v_mfma_f32_32x32x16_bf16 v[48:63], a[156:159], v[36:39], v[48:63]
    s_add_u32 m0, s56, 0
    s_nop 0
    buffer_load_dwordx4 v16, s[24:27], s59 offen offset:1024 sc1 lds
    v_cvt_pk_bf16_f32 v45, v154, v155
    v_exp_f32 v158, v158
    v_exp_f32 v159, v159
    v_cvt_pk_bf16_f32 v46, v156, v157
    v_cvt_pk_bf16_f32 v47, v158, v159
    v_exp_f32 v176, v176
    v_mfma_f32_32x32x16_bf16 v[144:159], a[104:107], v[200:203], 0
    v_exp_f32 v177, v177
    buffer_load_dwordx4 v[244:247], v16, s[24:27], s62 offen offset:1024 sc1
    v_exp_f32 v178, v178
    v_exp_f32 v179, v179
    v_cvt_pk_bf16_f32 v32, v176, v177
    buffer_load_dwordx4 v[248:251], v16, s[24:27], s62 offen offset:2048 sc1
    v_exp_f32 v180, v180
    v_exp_f32 v181, v181
    v_mfma_f32_32x32x16_bf16 v[144:159], a[108:111], v[204:207], v[144:159]
    v_cvt_pk_bf16_f32 v33, v178, v179
    v_exp_f32 v182, v182
    s_mul_i32 s62, s90, 6144
    s_add_u32 s62, s62, s54
    buffer_load_dwordx4 v[252:255], v16, s[24:27], s62 offen offset:0 sc1
    v_exp_f32 v183, v183
    v_cvt_pk_bf16_f32 v34, v180, v181
    v_exp_f32 v184, v184
    buffer_load_dwordx4 a[144:147], v16, s[24:27], s62 offen offset:1024 sc1
    v_exp_f32 v185, v185
    v_mfma_f32_32x32x16_bf16 v[48:63], a[160:163], v[40:43], v[48:63]
    v_cvt_pk_bf16_f32 v35, v182, v183
    v_exp_f32 v186, v186
    v_exp_f32 v187, v187
    s_lshl_b32 s82, s3, 7
    s_add_u32 s82, s82, s6
    v_mov_b32 v29, s7
    v_lshrrev_b32 v28, 2, v16
    v_add_u32 v29, 1, v29
    s_waitcnt vmcnt(13)
    s_mov_b32 exec_hi, 0
    buffer_store_dword v29, v28, s[24:27], s82 offen offset:1024 sc1
    s_mov_b32 exec_hi, -1
    v_cvt_pk_bf16_f32 v36, v184, v185
    v_exp_f32 v188, v188
    v_exp_f32 v189, v189
    v_mfma_f32_32x32x16_bf16 v[48:63], a[164:167], v[44:47], v[48:63]
    s_add_u32 m0, s56, 0
    s_nop 0
    buffer_load_dwordx4 v16, s[24:27], s59 offen offset:2048 sc1 lds
    v_cvt_pk_bf16_f32 v37, v186, v187
    v_exp_f32 v190, v190
    v_exp_f32 v191, v191
    v_cvt_pk_bf16_f32 v38, v188, v189
    v_cvt_pk_bf16_f32 v39, v190, v191
    v_exp_f32 v128, v128
    v_mfma_f32_32x32x16_bf16 v[176:191], a[112:115], v[200:203], 0
    v_exp_f32 v129, v129
    buffer_load_dwordx4 a[148:151], v16, s[24:27], s62 offen offset:2048 sc1
    v_exp_f32 v130, v130
    v_exp_f32 v131, v131
    v_cvt_pk_bf16_f32 v40, v128, v129
    v_exp_f32 v132, v132
    v_exp_f32 v133, v133
    v_mfma_f32_32x32x16_bf16 v[176:191], a[116:119], v[204:207], v[176:191]
    s_add_u32 s62, s62, 3072
    buffer_load_dwordx4 a[64:67], v16, s[24:27], s62 offen offset:0 sc1
    v_cvt_pk_bf16_f32 v41, v130, v131
    v_exp_f32 v134, v134
    v_exp_f32 v135, v135
    v_cvt_pk_bf16_f32 v42, v132, v133
    v_exp_f32 v136, v136
    buffer_load_dwordx4 a[68:71], v16, s[24:27], s62 offen offset:1024 sc1
    v_exp_f32 v137, v137
    v_mfma_f32_32x32x16_bf16 v[48:63], a[168:171], v[32:35], v[48:63]
    v_cvt_pk_bf16_f32 v43, v134, v135
    v_exp_f32 v138, v138
    v_exp_f32 v139, v139
    v_cvt_pk_bf16_f32 v44, v136, v137
    s_add_u32 m0, s56, 0
    s_nop 0
    buffer_load_dwordx4 v16, s[24:27], s59 offen offset:3072 sc1 lds
    v_exp_f32 v140, v140
    v_exp_f32 v141, v141
    v_mfma_f32_32x32x16_bf16 v[48:63], a[172:175], v[36:39], v[48:63]
    v_cvt_pk_bf16_f32 v45, v138, v139
    v_exp_f32 v142, v142
    v_exp_f32 v143, v143
    v_cvt_pk_bf16_f32 v46, v140, v141
    v_cvt_pk_bf16_f32 v47, v142, v143
    v_exp_f32 v144, v144
    v_mfma_f32_32x32x16_bf16 v[128:143], a[120:123], v[200:203], 0
    v_exp_f32 v145, v145
    buffer_load_dwordx4 a[72:75], v16, s[24:27], s62 offen offset:2048 sc1
    v_exp_f32 v146, v146
    v_exp_f32 v147, v147
    v_cvt_pk_bf16_f32 v32, v144, v145
    v_exp_f32 v148, v148
    s_mul_i32 s62, s91, 6144
    s_add_u32 s62, s62, s54
    buffer_load_dwordx4 a[76:79], v16, s[24:27], s62 offen offset:0 sc1
    v_exp_f32 v149, v149
    v_mfma_f32_32x32x16_bf16 v[128:143], a[124:127], v[204:207], v[128:143]
    v_cvt_pk_bf16_f32 v33, v146, v147
    v_exp_f32 v150, v150
    v_exp_f32 v151, v151
    buffer_load_dwordx4 a[80:83], v16, s[24:27], s62 offen offset:1024 sc1
    v_cvt_pk_bf16_f32 v34, v148, v149
    v_exp_f32 v152, v152
    v_exp_f32 v153, v153
    v_mfma_f32_32x32x16_bf16 v[48:63], a[176:179], v[40:43], v[48:63]
    v_cvt_pk_bf16_f32 v35, v150, v151
    s_add_u32 m0, s56, 4096
    s_add_u32 s59, s59, 4096
    buffer_load_dwordx4 v16, s[24:27], s59 offen offset:0 sc1 lds
    v_exp_f32 v154, v154
    v_exp_f32 v155, v155
    v_cvt_pk_bf16_f32 v36, v152, v153
    v_exp_f32 v156, v156
    s_add_u32 m0, s56, 4096
    s_nop 0
    buffer_load_dwordx4 v16, s[24:27], s59 offen offset:1024 sc1 lds
    v_exp_f32 v157, v157
    v_mfma_f32_32x32x16_bf16 v[48:63], a[180:183], v[44:47], v[48:63]
    v_cvt_pk_bf16_f32 v37, v154, v155
    v_exp_f32 v158, v158
    v_exp_f32 v159, v159
    v_cvt_pk_bf16_f32 v38, v156, v157
    v_cvt_pk_bf16_f32 v39, v158, v159
    v_exp_f32 v176, v176
    v_mfma_f32_32x32x16_bf16 v[144:159], a[128:131], v[200:203], 0
    v_exp_f32 v177, v177
    buffer_load_dwordx4 a[84:87], v16, s[24:27], s62 offen offset:2048 sc1
    v_exp_f32 v178, v178
    v_exp_f32 v179, v179
    v_cvt_pk_bf16_f32 v40, v176, v177
    v_exp_f32 v180, v180
    s_add_u32 s62, s62, 3072
    buffer_load_dwordx4 a[88:91], v16, s[24:27], s62 offen offset:0 sc1
    v_exp_f32 v181, v181
    v_mfma_f32_32x32x16_bf16 v[144:159], a[132:135], v[204:207], v[144:159]
    v_cvt_pk_bf16_f32 v41, v178, v179
    v_exp_f32 v182, v182
    v_exp_f32 v183, v183
    buffer_load_dwordx4 a[92:95], v16, s[24:27], s62 offen offset:1024 sc1
    v_cvt_pk_bf16_f32 v42, v180, v181
    v_exp_f32 v184, v184
    v_exp_f32 v185, v185
    v_mfma_f32_32x32x16_bf16 v[48:63], a[184:187], v[32:35], v[48:63]
    v_cvt_pk_bf16_f32 v43, v182, v183
    buffer_load_dwordx4 a[96:99], v16, s[24:27], s62 offen offset:2048 sc1
    v_exp_f32 v186, v186
    v_exp_f32 v187, v187
    v_cvt_pk_bf16_f32 v44, v184, v185
    v_exp_f32 v188, v188
    s_add_u32 m0, s56, 4096
    s_nop 0
    buffer_load_dwordx4 v16, s[24:27], s59 offen offset:2048 sc1 lds
    v_exp_f32 v189, v189
    v_mfma_f32_32x32x16_bf16 v[48:63], a[188:191], v[36:39], v[48:63]
    v_cvt_pk_bf16_f32 v45, v186, v187
    v_exp_f32 v190, v190
    v_exp_f32 v191, v191
    v_cvt_pk_bf16_f32 v46, v188, v189
    v_cvt_pk_bf16_f32 v47, v190, v191
    v_exp_f32 v128, v128
    v_mfma_f32_32x32x16_bf16 v[176:191], a[136:139], v[200:203], v[208:223]
    v_exp_f32 v129, v129
    s_mul_i32 s62, s92, 6144
    s_add_u32 s62, s62, s54
    buffer_load_dwordx4 a[100:103], v16, s[24:27], s62 offen offset:0 sc1
    v_exp_f32 v130, v130
    v_exp_f32 v131, v131
    v_cvt_pk_bf16_f32 v32, v128, v129
    v_exp_f32 v132, v132
    v_exp_f32 v133, v133
    v_mfma_f32_32x32x16_bf16 v[176:191], a[140:143], v[204:207], v[176:191]
    buffer_load_dwordx4 a[104:107], v16, s[24:27], s62 offen offset:1024 sc1
    v_cvt_pk_bf16_f32 v33, v130, v131
    v_exp_f32 v134, v134
    v_exp_f32 v135, v135
    v_cvt_pk_bf16_f32 v34, v132, v133
    v_exp_f32 v136, v136
    buffer_load_dwordx4 a[108:111], v16, s[24:27], s62 offen offset:2048 sc1
    v_exp_f32 v137, v137
    v_mfma_f32_32x32x16_bf16 v[48:63], a[192:195], v[40:43], v[48:63]
    v_cvt_pk_bf16_f32 v35, v134, v135
    v_exp_f32 v138, v138
    v_exp_f32 v139, v139
    v_cvt_pk_bf16_f32 v36, v136, v137
    s_add_u32 m0, s56, 4096
    s_nop 0
    buffer_load_dwordx4 v16, s[24:27], s59 offen offset:3072 sc1 lds
    v_exp_f32 v140, v140
    v_exp_f32 v141, v141
    v_mfma_f32_32x32x16_bf16 v[48:63], a[196:199], v[44:47], v[48:63]
    v_cvt_pk_bf16_f32 v37, v138, v139
    v_exp_f32 v142, v142
    v_exp_f32 v143, v143
    v_cvt_pk_bf16_f32 v38, v140, v141
    v_cvt_pk_bf16_f32 v39, v142, v143
    v_exp_f32 v144, v144
    v_mfma_f32_32x32x16_bf16 v[48:63], a[200:203], v[32:35], v[48:63]
    v_exp_f32 v145, v145
    s_add_u32 s62, s62, 3072
    buffer_load_dwordx4 a[112:115], v16, s[24:27], s62 offen offset:0 sc1
    v_exp_f32 v146, v146
    v_exp_f32 v147, v147
    v_cvt_pk_bf16_f32 v40, v144, v145
    v_exp_f32 v148, v148
    buffer_load_dwordx4 a[116:119], v16, s[24:27], s62 offen offset:1024 sc1
    v_exp_f32 v149, v149
    v_cvt_pk_bf16_f32 v41, v146, v147
    v_exp_f32 v150, v150
    v_exp_f32 v151, v151
    buffer_load_dwordx4 a[120:123], v16, s[24:27], s62 offen offset:2048 sc1
    v_cvt_pk_bf16_f32 v42, v148, v149
    v_exp_f32 v152, v152
    v_exp_f32 v153, v153
    v_mfma_f32_32x32x16_bf16 v[48:63], a[204:207], v[36:39], v[48:63]
    v_cvt_pk_bf16_f32 v43, v150, v151
    s_add_u32 m0, s56, 8192
    s_add_u32 s59, s59, 4096
    buffer_load_dwordx4 v16, s[24:27], s59 offen offset:0 sc1 lds
    v_exp_f32 v154, v154
    v_exp_f32 v155, v155
    v_cvt_pk_bf16_f32 v44, v152, v153
    v_exp_f32 v156, v156
    buffer_load_dword v5, v6, s[24:27], s57 offen sc1
    v_exp_f32 v157, v157
    v_cvt_pk_bf16_f32 v45, v154, v155
    v_exp_f32 v158, v158
    v_exp_f32 v159, v159
    v_cvt_pk_bf16_f32 v46, v156, v157
    v_cvt_pk_bf16_f32 v47, v158, v159
    v_exp_f32 v176, v176
    v_mfma_f32_32x32x16_bf16 v[48:63], a[208:211], v[40:43], v[48:63]
    v_exp_f32 v177, v177
    v_exp_f32 v178, v178
    v_exp_f32 v179, v179
    v_cvt_pk_bf16_f32 v32, v176, v177
    v_exp_f32 v180, v180
    v_exp_f32 v181, v181
    v_cvt_pk_bf16_f32 v33, v178, v179
    v_exp_f32 v182, v182
    v_exp_f32 v183, v183
    v_cvt_pk_bf16_f32 v34, v180, v181
    v_exp_f32 v184, v184
    v_exp_f32 v185, v185
    v_mfma_f32_32x32x16_bf16 v[48:63], a[212:215], v[44:47], v[48:63]
    v_cvt_pk_bf16_f32 v35, v182, v183
    v_exp_f32 v186, v186
    v_exp_f32 v187, v187
    v_cvt_pk_bf16_f32 v36, v184, v185
    v_exp_f32 v188, v188
    v_exp_f32 v189, v189
    v_cvt_pk_bf16_f32 v37, v186, v187
    v_exp_f32 v190, v190
    v_exp_f32 v191, v191
    v_cvt_pk_bf16_f32 v38, v188, v189
    v_cvt_pk_bf16_f32 v39, v190, v191
    v_mfma_f32_32x32x16_bf16 v[48:63], a[216:219], v[32:35], v[48:63]
    s_nop 0
    v_mfma_f32_32x32x16_bf16 v[48:63], a[220:223], v[36:39], v[48:63]
    s_nop 11
    v_rcp_f32 v15, v58
    s_add_u32 s97, s94, 1
    s_mul_i32 s97, s97, 36864
    v_mul_f32 v48, v15, v48
    v_mul_f32 v49, v15, v49
    v_mul_f32 v50, v15, v50
    v_mul_f32 v51, v15, v51
    v_mul_f32 v52, v15, v52
    v_mul_f32 v53, v15, v53
    v_mul_f32 v54, v15, v54
    v_mul_f32 v55, v15, v55
    v_mul_f32 v56, v15, v56
    v_mul_f32 v57, v15, v57
    v_cvt_pk_bf16_f32 v48, v48, v49
    v_cvt_pk_bf16_f32 v49, v50, v51
    v_cvt_pk_bf16_f32 v50, v52, v53
    v_cvt_pk_bf16_f32 v51, v54, v55
    v_cvt_pk_bf16_f32 v52, v56, v57
    s_add_u32 s97, s97, 27262976
    s_lshl_b32 s99, s93, 10
    s_add_u32 s99, s99, s97
    buffer_store_dwordx4 v[48:51], v16, s[24:27], s99 offen sc1
    s_lshl_b32 s99, s93, 7
    s_add_u32 s97, s97, s99
    s_add_u32 s97, s97, 32768
    v_lshrrev_b32 v15, 2, v16
    s_mov_b32 exec_hi, 0
    buffer_store_dword v52, v15, s[24:27], s97 offen sc1
    s_mov_b32 exec_hi, -1
    s_mul_i32 s52, s3, 3072
    v_add_u32 v9, s52, v16
    v_add_u32 v9, 40960, v9
    s_add_u32 s82, s7, 1
    s_waitcnt vmcnt(2)
    v_subrev_u32 v5, s82, v5
    v_cmp_lt_u32 vcc, 7, v5
    s_cbranch_vccz L_poll17_ok
    s_mov_b32 s83, 0
L_poll17:
    buffer_load_dword v5, v6, s[24:27], s57 offen sc1
    s_add_u32 s83, s83, 1
    s_waitcnt vmcnt(0)
    v_subrev_u32 v5, s82, v5
    v_cmp_lt_u32 vcc, 7, v5
    s_cbranch_vccz L_poll17_ok
    s_cmp_lt_u32 s83, 0x40000
    s_cbranch_scc1 L_poll17
L_poll17_ok:
    s_add_u32 m0, s80, 0
    s_add_u32 s52, s55, 0
    buffer_load_dwordx4 v8, s[24:27], s52 offen sc1 lds
    s_add_u32 m0, s80, 2048
    s_add_u32 s52, s55, 2048
    buffer_load_dwordx4 v8, s[24:27], s52 offen sc1 lds
    s_add_u32 m0, s81, 0
    s_add_u32 s52, s55, 4096
    buffer_load_dwordx4 v8, s[24:27], s52 offen sc1 lds
    s_add_u32 m0, s81, 2048
    s_add_u32 s52, s55, 6144
    buffer_load_dwordx4 v8, s[24:27], s52 offen sc1 lds
    s_add_u32 m0, s14, 0
    s_add_u32 s52, s4, 0
    buffer_load_dword v23, s[24:27], s52 offen sc1 lds
    s_add_u32 m0, s14, 256
    s_add_u32 s52, s4, 512
    buffer_load_dword v23, s[24:27], s52 offen sc1 lds
    s_waitcnt lgkmcnt(0)
    s_waitcnt vmcnt(9)
    s_barrier
    ds_read_b128 v[176:179], v9 offset:0
    ds_read_b128 v[180:183], v9 offset:9216
    ds_read_b128 v[184:187], v9 offset:18432
    ds_read_b128 v[188:191], v9 offset:27648
    ds_read_b128 v[192:195], v9 offset:1024
    ds_read_b128 v[196:199], v9 offset:10240
    ds_read_b128 v[200:203], v9 offset:19456
    ds_read_b128 v[204:207], v9 offset:28672
    ds_read_b128 v[208:211], v9 offset:2048
    ds_read_b128 v[212:215], v9 offset:11264
    ds_read_b128 v[216:219], v9 offset:20480
    ds_read_b128 v[220:223], v9 offset:29696
    s_waitcnt lgkmcnt(0)
    v_lshlrev_b32 v128, 16, v176
    v_and_b32 v129, s63, v176
    v_lshlrev_b32 v114, 16, v180
    v_and_b32 v115, s63, v180
    v_add_f32 v128, v128, v114
    v_add_f32 v129, v129, v115
    v_lshlrev_b32 v112, 16, v184
    v_and_b32 v113, s63, v184
    v_add_f32 v128, v128, v112
    v_add_f32 v129, v129, v113
    v_lshlrev_b32 v114, 16, v188
    v_and_b32 v115, s63, v188
    v_add_f32 v128, v128, v114
    v_add_f32 v129, v129, v115
    v_lshlrev_b32 v130, 16, v177
    v_and_b32 v131, s63, v177
    v_lshlrev_b32 v114, 16, v181
    v_and_b32 v115, s63, v181
    v_add_f32 v130, v130, v114
    v_add_f32 v131, v131, v115
    v_lshlrev_b32 v112, 16, v185
    v_and_b32 v113, s63, v185
    v_add_f32 v130, v130, v112
    v_add_f32 v131, v131, v113
    v_lshlrev_b32 v114, 16, v189
    v_and_b32 v115, s63, v189
    v_add_f32 v130, v130, v114
    v_add_f32 v131, v131, v115
    v_mul_f32 v116, 0xbfb8aa3b, v128
    v_mul_f32 v117, 0xbfb8aa3b, v129
    v_mul_f32 v118, 0xbfb8aa3b, v130
    v_mul_f32 v119, 0xbfb8aa3b, v131
    v_exp_f32 v116, v116
    v_exp_f32 v117, v117
    v_exp_f32 v118, v118
    v_exp_f32 v119, v119
    v_lshlrev_b32 v132, 16, v100
    v_and_b32 v133, s63, v100
    v_lshlrev_b32 v134, 16, v101
    v_and_b32 v135, s63, v101
    v_add_f32 v116, 1.0, v116
    v_add_f32 v117, 1.0, v117
    v_add_f32 v118, 1.0, v118
    v_add_f32 v119, 1.0, v119
    v_rcp_f32 v116, v116
    v_rcp_f32 v117, v117
    v_rcp_f32 v118, v118
    v_rcp_f32 v119, v119
    v_mul_f32 v128, v128, v116
    v_mul_f32 v129, v129, v117
    v_mul_f32 v130, v130, v118
    v_mul_f32 v131, v131, v119
    s_lshl_b32 s82, s3, 7
    s_add_u32 s82, s82, s6
    v_mov_b32 v29, s7
    v_lshrrev_b32 v28, 2, v16
    v_add_u32 v29, 2, v29
    s_waitcnt vmcnt(6)
    s_mov_b32 exec_hi, 0
    buffer_store_dword v29, v28, s[24:27], s82 offen offset:1024 sc1
    s_mov_b32 exec_hi, -1
    v_lshlrev_b32 v144, 16, v192
    v_and_b32 v145, s63, v192
    v_lshlrev_b32 v114, 16, v196
    v_and_b32 v115, s63, v196
    v_add_f32 v144, v144, v114
    v_add_f32 v145, v145, v115
    v_lshlrev_b32 v112, 16, v200
    v_and_b32 v113, s63, v200
    v_add_f32 v144, v144, v112
    v_add_f32 v145, v145, v113
    v_lshlrev_b32 v114, 16, v204
    v_and_b32 v115, s63, v204
    v_add_f32 v144, v144, v114
    v_add_f32 v145, v145, v115
    v_lshlrev_b32 v146, 16, v193
    v_and_b32 v147, s63, v193
    v_lshlrev_b32 v114, 16, v197
    v_and_b32 v115, s63, v197
    v_add_f32 v146, v146, v114
    v_add_f32 v147, v147, v115
    v_lshlrev_b32 v112, 16, v201
    v_and_b32 v113, s63, v201
    v_add_f32 v146, v146, v112
    v_add_f32 v147, v147, v113
    v_lshlrev_b32 v114, 16, v205
    v_and_b32 v115, s63, v205
    v_add_f32 v146, v146, v114
    v_add_f32 v147, v147, v115
    v_mul_f32 v116, 0xbfb8aa3b, v144
    v_mul_f32 v117, 0xbfb8aa3b, v145
    v_mul_f32 v118, 0xbfb8aa3b, v146
    v_mul_f32 v119, 0xbfb8aa3b, v147
    v_exp_f32 v116, v116
    v_exp_f32 v117, v117
    v_exp_f32 v118, v118
    v_exp_f32 v119, v119
    v_lshlrev_b32 v148, 16, v104
    v_and_b32 v149, s63, v104
    v_lshlrev_b32 v150, 16, v105
    v_and_b32 v151, s63, v105
    v_add_f32 v116, 1.0, v116
    v_add_f32 v117, 1.0, v117
    v_add_f32 v118, 1.0, v118
    v_add_f32 v119, 1.0, v119
    v_rcp_f32 v116, v116
    v_rcp_f32 v117, v117
    v_rcp_f32 v118, v118
    v_rcp_f32 v119, v119
    v_mul_f32 v144, v144, v116
    v_mul_f32 v145, v145, v117
    v_mul_f32 v146, v146, v118
    v_mul_f32 v147, v147, v119
    s_waitcnt vmcnt(1)
    s_barrier
    ds_read_b128 v[224:227], v16 offset:0
    ds_read_b128 v[228:231], v16 offset:2048
    ds_read_b128 v[232:235], v16 offset:4096
    ds_read_b128 v[236:239], v16 offset:6144
    ds_read_b128 v[120:123], v16 offset:8192
    ds_read_b128 v[124:127], v16 offset:10240
    s_waitcnt lgkmcnt(5)
    v_mfma_f32_16x16x32_bf16 v[32:35], a[0:3], v[224:227], 0
    ds_read_b128 v[56:59], v16 offset:12288
    v_lshlrev_b32 v160, 16, v208
    v_and_b32 v161, s63, v208
    v_mfma_f32_16x16x32_bf16 v[40:43], a[4:7], v[224:227], 0
    v_lshlrev_b32 v114, 16, v212
    v_and_b32 v115, s63, v212
    v_mfma_f32_16x16x32_bf16 v[48:51], a[8:11], v[224:227], 0
    v_add_f32 v160, v160, v114
    v_add_f32 v161, v161, v115
    s_waitcnt lgkmcnt(5)
    v_mfma_f32_16x16x32_bf16 v[32:35], a[12:15], v[228:231], v[32:35]
    ds_read_b128 v[60:63], v16 offset:14336
    v_lshlrev_b32 v112, 16, v216
    v_and_b32 v113, s63, v216
    v_mfma_f32_16x16x32_bf16 v[40:43], a[16:19], v[228:231], v[40:43]
    v_add_f32 v160, v160, v112
    v_add_f32 v161, v161, v113
    v_mfma_f32_16x16x32_bf16 v[48:51], a[20:23], v[228:231], v[48:51]
    v_lshlrev_b32 v114, 16, v220
    v_and_b32 v115, s63, v220
    s_waitcnt lgkmcnt(5)
    v_mfma_f32_16x16x32_bf16 v[32:35], a[24:27], v[232:235], v[32:35]
    ds_read_b128 v[224:227], v16 offset:16384
    v_add_f32 v160, v160, v114
    v_add_f32 v161, v161, v115
    v_mfma_f32_16x16x32_bf16 v[40:43], a[28:31], v[232:235], v[40:43]
    v_lshlrev_b32 v162, 16, v209
    v_and_b32 v163, s63, v209
    v_mfma_f32_16x16x32_bf16 v[48:51], a[32:35], v[232:235], v[48:51]
    v_lshlrev_b32 v114, 16, v213
    v_and_b32 v115, s63, v213
    s_waitcnt lgkmcnt(5)
    v_mfma_f32_16x16x32_bf16 v[32:35], a[36:39], v[236:239], v[32:35]
    ds_read_b128 v[228:231], v16 offset:18432
    v_add_f32 v162, v162, v114
    v_add_f32 v163, v163, v115
    v_mfma_f32_16x16x32_bf16 v[40:43], a[40:43], v[236:239], v[40:43]
    v_lshlrev_b32 v112, 16, v217
    v_and_b32 v113, s63, v217
    v_mfma_f32_16x16x32_bf16 v[48:51], a[44:47], v[236:239], v[48:51]
    v_add_f32 v162, v162, v112
    v_add_f32 v163, v163, v113
    s_waitcnt lgkmcnt(5)
    v_mfma_f32_16x16x32_bf16 v[32:35], a[48:51], v[120:123], v[32:35]
    ds_read_b128 v[232:235], v16 offset:20480
    v_lshlrev_b32 v114, 16, v221
    v_and_b32 v115, s63, v221
    v_mfma_f32_16x16x32_bf16 v[40:43], a[52:55], v[120:123], v[40:43]
    v_add_f32 v162, v162, v114
    v_add_f32 v163, v163, v115
    v_mfma_f32_16x16x32_bf16 v[48:51], a[56:59], v[120:123], v[48:51]
    v_mul_f32 v116, 0xbfb8aa3b, v160
    v_mul_f32 v117, 0xbfb8aa3b, v161
    s_waitcnt lgkmcnt(5)
    v_mfma_f32_16x16x32_bf16 v[32:35], a[60:63], v[124:127], v[32:35]
    ds_read_b128 v[236:239], v16 offset:22528
    v_mul_f32 v118, 0xbfb8aa3b, v162
    v_mul_f32 v119, 0xbfb8aa3b, v163
    v_mfma_f32_16x16x32_bf16 v[40:43], a[224:227], v[124:127], v[40:43]
    v_exp_f32 v116, v116
    v_exp_f32 v117, v117
    v_mfma_f32_16x16x32_bf16 v[48:51], a[228:231], v[124:127], v[48:51]
    v_exp_f32 v118, v118
    v_exp_f32 v119, v119
    s_waitcnt lgkmcnt(5)
    v_mfma_f32_16x16x32_bf16 v[32:35], a[232:235], v[56:59], v[32:35]
    ds_read_b128 v[120:123], v16 offset:24576
    v_lshlrev_b32 v164, 16, v108
    v_and_b32 v165, s63, v108
    v_mfma_f32_16x16x32_bf16 v[40:43], a[236:239], v[56:59], v[40:43]
    v_lshlrev_b32 v166, 16, v109
    v_and_b32 v167, s63, v109
    v_mfma_f32_16x16x32_bf16 v[48:51], a[240:243], v[56:59], v[48:51]
    v_add_f32 v116, 1.0, v116
    v_add_f32 v117, 1.0, v117
    s_waitcnt lgkmcnt(5)
    v_mfma_f32_16x16x32_bf16 v[32:35], a[244:247], v[60:63], v[32:35]
    ds_read_b128 v[124:127], v16 offset:26624
    v_add_f32 v118, 1.0, v118
    v_add_f32 v119, 1.0, v119
    v_mfma_f32_16x16x32_bf16 v[40:43], a[248:251], v[60:63], v[40:43]
    v_rcp_f32 v116, v116
    v_rcp_f32 v117, v117
    v_mfma_f32_16x16x32_bf16 v[48:51], a[252:255], v[60:63], v[48:51]
    v_rcp_f32 v118, v118
    v_rcp_f32 v119, v119
    s_waitcnt lgkmcnt(5)
    v_mfma_f32_16x16x32_bf16 v[32:35], v[64:67], v[224:227], v[32:35]
    ds_read_b128 v[56:59], v16 offset:28672
    v_mul_f32 v160, v160, v116
    v_mul_f32 v161, v161, v117
    v_mfma_f32_16x16x32_bf16 v[40:43], v[68:71], v[224:227], v[40:43]
    v_mul_f32 v162, v162, v118
    v_mul_f32 v163, v163, v119
    v_mfma_f32_16x16x32_bf16 v[48:51], v[72:75], v[224:227], v[48:51]
    v_lshlrev_b32 v136, 16, v178
    v_and_b32 v137, s63, v178
    s_waitcnt lgkmcnt(5)
    v_mfma_f32_16x16x32_bf16 v[32:35], v[76:79], v[228:231], v[32:35]
    ds_read_b128 v[60:63], v16 offset:30720
    v_lshlrev_b32 v114, 16, v182
    v_and_b32 v115, s63, v182
    v_mfma_f32_16x16x32_bf16 v[40:43], v[80:83], v[228:231], v[40:43]
    v_add_f32 v136, v136, v114
    v_add_f32 v137, v137, v115
    v_mfma_f32_16x16x32_bf16 v[48:51], v[84:87], v[228:231], v[48:51]
    v_lshlrev_b32 v112, 16, v186
    v_and_b32 v113, s63, v186
    s_waitcnt lgkmcnt(5)
    v_mfma_f32_16x16x32_bf16 v[32:35], v[88:91], v[232:235], v[32:35]
    ds_read_b128 v[224:227], v16 offset:32768
    v_add_f32 v136, v136, v112
    v_add_f32 v137, v137, v113
    v_mfma_f32_16x16x32_bf16 v[40:43], v[92:95], v[232:235], v[40:43]
    v_lshlrev_b32 v114, 16, v190
    v_and_b32 v115, s63, v190
    v_mfma_f32_16x16x32_bf16 v[48:51], v[96:99], v[232:235], v[48:51]
    v_add_f32 v136, v136, v114
    v_add_f32 v137, v137, v115
    buffer_load_dword v5, v6, s[24:27], s57 offen sc1
    s_waitcnt lgkmcnt(5)
    v_mfma_f32_16x16x32_bf16 v[32:35], v[240:243], v[236:239], v[32:35]
    ds_read_b128 v[228:231], v16 offset:34816
    v_lshlrev_b32 v138, 16, v179
    v_and_b32 v139, s63, v179
    v_mfma_f32_16x16x32_bf16 v[40:43], v[244:247], v[236:239], v[40:43]
    v_lshlrev_b32 v114, 16, v183
    v_and_b32 v115, s63, v183
    v_mfma_f32_16x16x32_bf16 v[48:51], v[248:251], v[236:239], v[48:51]
    v_add_f32 v138, v138, v114
    v_add_f32 v139, v139, v115
    s_waitcnt lgkmcnt(5)
    v_mfma_f32_16x16x32_bf16 v[32:35], v[252:255], v[120:123], v[32:35]
    v_lshlrev_b32 v112, 16, v187
    v_and_b32 v113, s63, v187
    v_mfma_f32_16x16x32_bf16 v[40:43], a[144:147], v[120:123], v[40:43]
    v_add_f32 v138, v138, v112
    v_add_f32 v139, v139, v113
    v_mfma_f32_16x16x32_bf16 v[48:51], a[148:151], v[120:123], v[48:51]
    v_lshlrev_b32 v114, 16, v191
    v_and_b32 v115, s63, v191
    s_waitcnt lgkmcnt(4)
    v_mfma_f32_16x16x32_bf16 v[32:35], a[64:67], v[124:127], v[32:35]
    v_add_f32 v138, v138, v114
    v_add_f32 v139, v139, v115
    v_mfma_f32_16x16x32_bf16 v[40:43], a[68:71], v[124:127], v[40:43]
    v_mul_f32 v116, 0xbfb8aa3b, v136
    v_mul_f32 v117, 0xbfb8aa3b, v137
    v_mfma_f32_16x16x32_bf16 v[48:51], a[72:75], v[124:127], v[48:51]
    v_mul_f32 v118, 0xbfb8aa3b, v138
    v_mul_f32 v119, 0xbfb8aa3b, v139
    s_waitcnt lgkmcnt(3)
    v_mfma_f32_16x16x32_bf16 v[32:35], a[76:79], v[56:59], v[32:35]
    v_exp_f32 v116, v116
    v_exp_f32 v117, v117
    v_mfma_f32_16x16x32_bf16 v[40:43], a[80:83], v[56:59], v[40:43]
    v_exp_f32 v118, v118
    v_exp_f32 v119, v119
    v_mfma_f32_16x16x32_bf16 v[48:51], a[84:87], v[56:59], v[48:51]
    v_lshlrev_b32 v140, 16, v102
    v_and_b32 v141, s63, v102
    s_waitcnt lgkmcnt(2)
    v_mfma_f32_16x16x32_bf16 v[32:35], a[88:91], v[60:63], v[32:35]
    v_lshlrev_b32 v142, 16, v103
    v_and_b32 v143, s63, v103
    v_mfma_f32_16x16x32_bf16 v[40:43], a[92:95], v[60:63], v[40:43]
    v_add_f32 v116, 1.0, v116
    v_add_f32 v117, 1.0, v117
    v_mfma_f32_16x16x32_bf16 v[48:51], a[96:99], v[60:63], v[48:51]
    v_add_f32 v118, 1.0, v118
    v_add_f32 v119, 1.0, v119
    s_waitcnt lgkmcnt(1)
    v_mfma_f32_16x16x32_bf16 v[32:35], a[100:103], v[224:227], v[32:35]
    v_rcp_f32 v116, v116
    v_rcp_f32 v117, v117
    v_mfma_f32_16x16x32_bf16 v[40:43], a[104:107], v[224:227], v[40:43]
    v_rcp_f32 v118, v118
    v_rcp_f32 v119, v119
    v_mfma_f32_16x16x32_bf16 v[48:51], a[108:111], v[224:227], v[48:51]
    v_mul_f32 v136, v136, v116
    v_mul_f32 v137, v137, v117
    s_waitcnt lgkmcnt(0)
    v_mfma_f32_16x16x32_bf16 v[32:35], a[112:115], v[228:231], v[32:35]
    v_mul_f32 v138, v138, v118
    v_mul_f32 v139, v139, v119
    v_mfma_f32_16x16x32_bf16 v[40:43], a[116:119], v[228:231], v[40:43]
    v_mfma_f32_16x16x32_bf16 v[48:51], a[120:123], v[228:231], v[48:51]
    s_add_u32 s82, s7, 2
    s_waitcnt vmcnt(0)
    v_subrev_u32 v5, s82, v5
    v_cmp_lt_u32 vcc, 7, v5
    s_cbranch_vccz L_poll18_ok
    s_mov_b32 s83, 0
L_poll18:
    buffer_load_dword v5, v6, s[24:27], s57 offen sc1
    s_add_u32 s83, s83, 1
    s_waitcnt vmcnt(0)
    v_subrev_u32 v5, s82, v5
    v_cmp_lt_u32 vcc, 7, v5
    s_cbranch_vccz L_poll18_ok
    s_cmp_lt_u32 s83, 0x40000
    s_cbranch_scc1 L_poll18
L_poll18_ok:
    s_add_u32 m0, s80, 1024
    s_add_u32 s52, s55, 36864
    buffer_load_dwordx4 v8, s[24:27], s52 offen sc1 lds
    s_add_u32 m0, s80, 3072
    s_add_u32 s52, s55, 38912
    buffer_load_dwordx4 v8, s[24:27], s52 offen sc1 lds
    s_add_u32 m0, s81, 1024
    s_add_u32 s52, s55, 40960
    buffer_load_dwordx4 v8, s[24:27], s52 offen sc1 lds
    s_add_u32 m0, s81, 3072
    s_add_u32 s52, s55, 43008
    buffer_load_dwordx4 v8, s[24:27], s52 offen sc1 lds
    s_add_u32 m0, s14, 1024
    s_add_u32 s52, s4, 36864
    buffer_load_dword v23, s[24:27], s52 offen sc1 lds
    s_add_u32 m0, s14, 1280
    s_add_u32 s52, s4, 37376
    buffer_load_dword v23, s[24:27], s52 offen sc1 lds
    v_fma_f32 v128, v128, v32, v132
    v_fma_f32 v129, v129, v33, v133
    v_fma_f32 v130, v130, v34, v134
    v_fma_f32 v131, v131, v35, v135
    v_cvt_pk_bf16_f32 v132, v128, v129
    v_cvt_pk_bf16_f32 v133, v130, v131
    buffer_store_dwordx2 v[132:133], v10, s[40:43], s60 offen offset:0
    v_fma_f32 v144, v144, v40, v148
    v_fma_f32 v145, v145, v41, v149
    v_fma_f32 v146, v146, v42, v150
    v_fma_f32 v147, v147, v43, v151
    v_cvt_pk_bf16_f32 v148, v144, v145
    v_cvt_pk_bf16_f32 v149, v146, v147
    buffer_store_dwordx2 v[148:149], v10, s[40:43], s60 offen offset:32
    v_fma_f32 v160, v160, v48, v164
    v_fma_f32 v161, v161, v49, v165
    v_fma_f32 v162, v162, v50, v166
    v_fma_f32 v163, v163, v51, v167
    v_cvt_pk_bf16_f32 v164, v160, v161
    v_cvt_pk_bf16_f32 v165, v162, v163
    buffer_store_dwordx2 v[164:165], v10, s[40:43], s60 offen offset:64
    v_lshlrev_b32 v152, 16, v194
    v_and_b32 v153, s63, v194
    v_lshlrev_b32 v114, 16, v198
    v_and_b32 v115, s63, v198
    v_add_f32 v152, v152, v114
    v_add_f32 v153, v153, v115
    v_lshlrev_b32 v112, 16, v202
    v_and_b32 v113, s63, v202
    v_add_f32 v152, v152, v112
    v_add_f32 v153, v153, v113
    v_lshlrev_b32 v114, 16, v206
    v_and_b32 v115, s63, v206
    v_add_f32 v152, v152, v114
    v_add_f32 v153, v153, v115
    v_lshlrev_b32 v154, 16, v195
    v_and_b32 v155, s63, v195
    v_lshlrev_b32 v114, 16, v199
    v_and_b32 v115, s63, v199
    v_add_f32 v154, v154, v114
    v_add_f32 v155, v155, v115
    v_lshlrev_b32 v112, 16, v203
    v_and_b32 v113, s63, v203
    v_add_f32 v154, v154, v112
    v_add_f32 v155, v155, v113
    v_lshlrev_b32 v114, 16, v207
    v_and_b32 v115, s63, v207
    v_add_f32 v154, v154, v114
    v_add_f32 v155, v155, v115
    v_mul_f32 v116, 0xbfb8aa3b, v152
    v_mul_f32 v117, 0xbfb8aa3b, v153
    v_mul_f32 v118, 0xbfb8aa3b, v154
    v_mul_f32 v119, 0xbfb8aa3b, v155
    v_exp_f32 v116, v116
    v_exp_f32 v117, v117
    v_exp_f32 v118, v118
    v_exp_f32 v119, v119
    v_lshlrev_b32 v156, 16, v106
    v_and_b32 v157, s63, v106
    v_lshlrev_b32 v158, 16, v107
    v_and_b32 v159, s63, v107
    v_add_f32 v116, 1.0, v116
    v_add_f32 v117, 1.0, v117
    v_add_f32 v118, 1.0, v118
    v_add_f32 v119, 1.0, v119
    v_rcp_f32 v116, v116
    v_rcp_f32 v117, v117
    v_rcp_f32 v118, v118
    v_rcp_f32 v119, v119
    v_mul_f32 v152, v152, v116
    v_mul_f32 v153, v153, v117
    v_mul_f32 v154, v154, v118
    v_mul_f32 v155, v155, v119
    v_lshlrev_b32 v168, 16, v210
    v_and_b32 v169, s63, v210
    v_lshlrev_b32 v114, 16, v214
    v_and_b32 v115, s63, v214
    v_add_f32 v168, v168, v114
    v_add_f32 v169, v169, v115
    v_lshlrev_b32 v112, 16, v218
    v_and_b32 v113, s63, v218
    v_add_f32 v168, v168, v112
    v_add_f32 v169, v169, v113
    v_lshlrev_b32 v114, 16, v222
    v_and_b32 v115, s63, v222
    v_add_f32 v168, v168, v114
    v_add_f32 v169, v169, v115
    v_lshlrev_b32 v170, 16, v211
    v_and_b32 v171, s63, v211
    v_lshlrev_b32 v114, 16, v215
    v_and_b32 v115, s63, v215
    v_add_f32 v170, v170, v114
    v_add_f32 v171, v171, v115
    v_lshlrev_b32 v112, 16, v219
    v_and_b32 v113, s63, v219
    v_add_f32 v170, v170, v112
    v_add_f32 v171, v171, v113
    v_lshlrev_b32 v114, 16, v223
    v_and_b32 v115, s63, v223
    v_add_f32 v170, v170, v114
    v_add_f32 v171, v171, v115
    v_mul_f32 v116, 0xbfb8aa3b, v168
    v_mul_f32 v117, 0xbfb8aa3b, v169
    v_mul_f32 v118, 0xbfb8aa3b, v170
    v_mul_f32 v119, 0xbfb8aa3b, v171
    v_exp_f32 v116, v116
    v_exp_f32 v117, v117
    v_exp_f32 v118, v118
    v_exp_f32 v119, v119
    v_lshlrev_b32 v172, 16, v110
    v_and_b32 v173, s63, v110
    v_lshlrev_b32 v174, 16, v111
    v_and_b32 v175, s63, v111
    v_add_f32 v116, 1.0, v116
    v_add_f32 v117, 1.0, v117
    v_add_f32 v118, 1.0, v118
    v_add_f32 v119, 1.0, v119
    v_rcp_f32 v116, v116
    v_rcp_f32 v117, v117
    v_rcp_f32 v118, v118
    v_rcp_f32 v119, v119
    v_mul_f32 v168, v168, v116
    v_mul_f32 v169, v169, v117
    v_mul_f32 v170, v170, v118
    v_mul_f32 v171, v171, v119
    s_waitcnt vmcnt(3)
    s_barrier
    s_cmp_ge_u32 s3, 3
    s_cbranch_scc1 L_mk_w3
    ds_read_b128 v[224:227], v16 offset:1024
    ds_read_b128 v[228:231], v16 offset:3072
    ds_read_b128 v[232:235], v16 offset:5120
    ds_read_b128 v[236:239], v16 offset:7168
    ds_read_b128 v[120:123], v16 offset:9216
    ds_read_b128 v[124:127], v16 offset:11264
    s_waitcnt lgkmcnt(5)
    v_mfma_f32_16x16x32_bf16 v[36:39], a[0:3], v[224:227], 0
    ds_read_b128 v[56:59], v16 offset:13312
    v_mfma_f32_16x16x32_bf16 v[44:47], a[4:7], v[224:227], 0
    v_mfma_f32_16x16x32_bf16 v[52:55], a[8:11], v[224:227], 0
    s_waitcnt lgkmcnt(5)
    v_mfma_f32_16x16x32_bf16 v[36:39], a[12:15], v[228:231], v[36:39]
    ds_read_b128 v[60:63], v16 offset:15360
    v_mfma_f32_16x16x32_bf16 v[44:47], a[16:19], v[228:231], v[44:47]
    v_mfma_f32_16x16x32_bf16 v[52:55], a[20:23], v[228:231], v[52:55]
    s_waitcnt lgkmcnt(5)
    v_mfma_f32_16x16x32_bf16 v[36:39], a[24:27], v[232:235], v[36:39]
    ds_read_b128 v[224:227], v16 offset:17408
    v_mfma_f32_16x16x32_bf16 v[44:47], a[28:31], v[232:235], v[44:47]
    v_mfma_f32_16x16x32_bf16 v[52:55], a[32:35], v[232:235], v[52:55]
    s_waitcnt lgkmcnt(5)
    v_mfma_f32_16x16x32_bf16 v[36:39], a[36:39], v[236:239], v[36:39]
    ds_read_b128 v[228:231], v16 offset:19456
    v_mfma_f32_16x16x32_bf16 v[44:47], a[40:43], v[236:239], v[44:47]
    v_mfma_f32_16x16x32_bf16 v[52:55], a[44:47], v[236:239], v[52:55]
    s_waitcnt lgkmcnt(5)
    v_mfma_f32_16x16x32_bf16 v[36:39], a[48:51], v[120:123], v[36:39]
    ds_read_b128 v[232:235], v16 offset:21504
    v_mfma_f32_16x16x32_bf16 v[44:47], a[52:55], v[120:123], v[44:47]
    v_mfma_f32_16x16x32_bf16 v[52:55], a[56:59], v[120:123], v[52:55]
    s_waitcnt lgkmcnt(5)
    v_mfma_f32_16x16x32_bf16 v[36:39], a[60:63], v[124:127], v[36:39]
    ds_read_b128 v[236:239], v16 offset:23552
    v_mfma_f32_16x16x32_bf16 v[44:47], a[224:227], v[124:127], v[44:47]
    v_mfma_f32_16x16x32_bf16 v[52:55], a[228:231], v[124:127], v[52:55]
    s_waitcnt lgkmcnt(5)
    v_mfma_f32_16x16x32_bf16 v[36:39], a[232:235], v[56:59], v[36:39]
    ds_read_b128 v[120:123], v16 offset:25600
    v_mfma_f32_16x16x32_bf16 v[44:47], a[236:239], v[56:59], v[44:47]
    v_mfma_f32_16x16x32_bf16 v[52:55], a[240:243], v[56:59], v[52:55]
    s_waitcnt lgkmcnt(5)
    v_mfma_f32_16x16x32_bf16 v[36:39], a[244:247], v[60:63], v[36:39]
    ds_read_b128 v[124:127], v16 offset:27648
    v_mfma_f32_16x16x32_bf16 v[44:47], a[248:251], v[60:63], v[44:47]
    v_mfma_f32_16x16x32_bf16 v[52:55], a[252:255], v[60:63], v[52:55]
    s_waitcnt lgkmcnt(5)
    v_mfma_f32_16x16x32_bf16 v[36:39], v[64:67], v[224:227], v[36:39]
    ds_read_b128 v[56:59], v16 offset:29696
    v_mfma_f32_16x16x32_bf16 v[44:47], v[68:71], v[224:227], v[44:47]
    v_mfma_f32_16x16x32_bf16 v[52:55], v[72:75], v[224:227], v[52:55]
    s_waitcnt lgkmcnt(5)
    v_mfma_f32_16x16x32_bf16 v[36:39], v[76:79], v[228:231], v[36:39]
    ds_read_b128 v[60:63], v16 offset:31744
    v_mfma_f32_16x16x32_bf16 v[44:47], v[80:83], v[228:231], v[44:47]
    v_mfma_f32_16x16x32_bf16 v[52:55], v[84:87], v[228:231], v[52:55]
    s_waitcnt lgkmcnt(5)
    v_mfma_f32_16x16x32_bf16 v[36:39], v[88:91], v[232:235], v[36:39]
    ds_read_b128 v[224:227], v16 offset:33792
    v_mfma_f32_16x16x32_bf16 v[44:47], v[92:95], v[232:235], v[44:47]
    v_mfma_f32_16x16x32_bf16 v[52:55], v[96:99], v[232:235], v[52:55]
    s_waitcnt lgkmcnt(5)
    v_mfma_f32_16x16x32_bf16 v[36:39], v[240:243], v[236:239], v[36:39]
    ds_read_b128 v[228:231], v16 offset:35840
    v_mfma_f32_16x16x32_bf16 v[44:47], v[244:247], v[236:239], v[44:47]
    v_mfma_f32_16x16x32_bf16 v[52:55], v[248:251], v[236:239], v[52:55]
    s_waitcnt lgkmcnt(5)
    v_mfma_f32_16x16x32_bf16 v[36:39], v[252:255], v[120:123], v[36:39]
    v_mfma_f32_16x16x32_bf16 v[44:47], a[144:147], v[120:123], v[44:47]
    v_mfma_f32_16x16x32_bf16 v[52:55], a[148:151], v[120:123], v[52:55]
    s_waitcnt lgkmcnt(4)
    v_mfma_f32_16x16x32_bf16 v[36:39], a[64:67], v[124:127], v[36:39]
    v_mfma_f32_16x16x32_bf16 v[44:47], a[68:71], v[124:127], v[44:47]
    v_mfma_f32_16x16x32_bf16 v[52:55], a[72:75], v[124:127], v[52:55]
    s_waitcnt lgkmcnt(3)
    v_mfma_f32_16x16x32_bf16 v[36:39], a[76:79], v[56:59], v[36:39]
    v_mfma_f32_16x16x32_bf16 v[44:47], a[80:83], v[56:59], v[44:47]
    v_mfma_f32_16x16x32_bf16 v[52:55], a[84:87], v[56:59], v[52:55]
    s_waitcnt lgkmcnt(2)
    v_mfma_f32_16x16x32_bf16 v[36:39], a[88:91], v[60:63], v[36:39]
    v_mfma_f32_16x16x32_bf16 v[44:47], a[92:95], v[60:63], v[44:47]
    v_mfma_f32_16x16x32_bf16 v[52:55], a[96:99], v[60:63], v[52:55]
    s_waitcnt lgkmcnt(1)
    v_mfma_f32_16x16x32_bf16 v[36:39], a[100:103], v[224:227], v[36:39]
    v_mfma_f32_16x16x32_bf16 v[44:47], a[104:107], v[224:227], v[44:47]
    v_mfma_f32_16x16x32_bf16 v[52:55], a[108:111], v[224:227], v[52:55]
    s_waitcnt lgkmcnt(0)
    v_mfma_f32_16x16x32_bf16 v[36:39], a[112:115], v[228:231], v[36:39]
    v_mfma_f32_16x16x32_bf16 v[44:47], a[116:119], v[228:231], v[44:47]
    v_mfma_f32_16x16x32_bf16 v[52:55], a[120:123], v[228:231], v[52:55]
    s_nop 5
    v_fma_f32 v136, v136, v36, v140
    v_fma_f32 v137, v137, v37, v141
    v_fma_f32 v138, v138, v38, v142
    v_fma_f32 v139, v139, v39, v143
    v_cvt_pk_bf16_f32 v140, v136, v137
    v_cvt_pk_bf16_f32 v141, v138, v139
    buffer_store_dwordx2 v[140:141], v10, s[40:43], s61 offen offset:0
    v_fma_f32 v152, v152, v44, v156
    v_fma_f32 v153, v153, v45, v157
    v_fma_f32 v154, v154, v46, v158
    v_fma_f32 v155, v155, v47, v159
    v_cvt_pk_bf16_f32 v156, v152, v153
    v_cvt_pk_bf16_f32 v157, v154, v155
    buffer_store_dwordx2 v[156:157], v10, s[40:43], s61 offen offset:32
    v_fma_f32 v168, v168, v52, v172
    v_fma_f32 v169, v169, v53, v173
    v_fma_f32 v170, v170, v54, v174
    v_fma_f32 v171, v171, v55, v175
    v_cvt_pk_bf16_f32 v172, v168, v169
    v_cvt_pk_bf16_f32 v173, v170, v171
    buffer_store_dwordx2 v[172:173], v10, s[40:43], s61 offen offset:64
    s_branch L_mk_fin
L_mk_w3:
    s_cmp_lg_u32 s2, 0
    s_cbranch_scc1 L_mk_fin
    s_add_u32 s45, s45, 1
    v_mov_b32 v8, s45
    v_lshrrev_b32 v9, 2, v16
    s_mov_b32 s47, 60817408
    buffer_store_dword v8, v9, s[24:27], s47 offen sc1
L_mk_fin:
L_mk_end:
    s_endpgm
.p2align 7
.type L_masks,@object
L_masks:
    .long 0x0, 0xf149f2ca, 0xf149f2ca, 0xf149f2ca
    .long 0x0, 0x0, 0xf149f2ca, 0xf149f2ca
    .long 0x0, 0x0, 0x0, 0xf149f2ca
    .long 0x0, 0x0, 0x0, 0x0
    .long 0x0, 0x0, 0x0, 0x0
    .long 0x0, 0x0, 0x0, 0x0
    .long 0x0, 0x0, 0x0, 0x0
    .long 0x0, 0x0, 0x0, 0x0
    .long 0x0, 0x0, 0x0, 0x0
    .long 0x0, 0x0, 0x0, 0x0
    .long 0x0, 0x0, 0x0, 0x0
    .long 0x0, 0x0, 0x0, 0x0
    .long 0x0, 0x0, 0x0, 0x0
    .long 0x0, 0x0, 0x0, 0x0
    .long 0x0, 0x0, 0x0, 0x0
    .long 0x0, 0x0, 0x0, 0x0
    .long 0x0, 0x0, 0x0, 0x0
    .long 0x0, 0x0, 0x0, 0x0
    .long 0x0, 0x0, 0x0, 0x0
    .long 0x0, 0x0, 0x0, 0x0
    .long 0x0, 0x0, 0x0, 0x0
    .long 0x0, 0x0, 0x0, 0x0
    .long 0x0, 0x0, 0x0, 0x0
    .long 0x0, 0x0, 0x0, 0x0
    .long 0x0, 0x0, 0x0, 0x0
    .long 0x0, 0x0, 0x0, 0x0
    .long 0x0, 0x0, 0x0, 0x0
    .long 0x0, 0x0, 0x0, 0x0
    .long 0x0, 0x0, 0x0, 0x0
    .long 0x0, 0x0, 0x0, 0x0
    .long 0x0, 0x0, 0x0, 0x0
    .long 0x0, 0x0, 0x0, 0x0
    .long 0xf149f2ca, 0xf149f2ca, 0xf149f2ca, 0xf149f2ca
    .long 0xf149f2ca, 0xf149f2ca, 0xf149f2ca, 0xf149f2ca
    .long 0xf149f2ca, 0xf149f2ca, 0xf149f2ca, 0xf149f2ca
    .long 0xf149f2ca, 0xf149f2ca, 0xf149f2ca, 0xf149f2ca
    .long 0x0, 0xf149f2ca, 0xf149f2ca, 0xf149f2ca
    .long 0x0, 0x0, 0xf149f2ca, 0xf149f2ca
    .long 0x0, 0x0, 0x0, 0xf149f2ca
    .long 0x0, 0x0, 0x0, 0x0
    .long 0x0, 0x0, 0x0, 0x0
    .long 0x0, 0x0, 0x0, 0x0
    .long 0x0, 0x0, 0x0, 0x0
    .long 0x0, 0x0, 0x0, 0x0
    .long 0x0, 0x0, 0x0, 0x0
    .long 0x0, 0x0, 0x0, 0x0
    .long 0x0, 0x0, 0x0, 0x0
    .long 0x0, 0x0, 0x0, 0x0
    .long 0x0, 0x0, 0x0, 0x0
    .long 0x0, 0x0, 0x0, 0x0
    .long 0x0, 0x0, 0x0, 0x0
    .long 0x0, 0x0, 0x0, 0x0
    .long 0x0, 0x0, 0x0, 0x0
    .long 0x0, 0x0, 0x0, 0x0
    .long 0x0, 0x0, 0x0, 0x0
    .long 0x0, 0x0, 0x0, 0x0
    .long 0x0, 0x0, 0x0, 0x0
    .long 0x0, 0x0, 0x0, 0x0
    .long 0x0, 0x0, 0x0, 0x0
    .long 0x0, 0x0, 0x0, 0x0
    .long 0x0, 0x0, 0x0, 0x0
    .long 0x0, 0x0, 0x0, 0x0
    .long 0x0, 0x0, 0x0, 0x0
    .long 0x0, 0x0, 0x0, 0x0
    .long 0xf149f2ca, 0xf149f2ca, 0xf149f2ca, 0xf149f2ca
    .long 0xf149f2ca, 0xf149f2ca, 0xf149f2ca, 0xf149f2ca
    .long 0xf149f2ca, 0xf149f2ca, 0xf149f2ca, 0xf149f2ca
    .long 0xf149f2ca, 0xf149f2ca, 0xf149f2ca, 0xf149f2ca
    .long 0xf149f2ca, 0xf149f2ca, 0xf149f2ca, 0xf149f2ca
    .long 0xf149f2ca, 0xf149f2ca, 0xf149f2ca, 0xf149f2ca
    .long 0xf149f2ca, 0xf149f2ca, 0xf149f2ca, 0xf149f2ca
    .long 0xf149f2ca, 0xf149f2ca, 0xf149f2ca, 0xf149f2ca
    .long 0x0, 0xf149f2ca, 0xf149f2ca, 0xf149f2ca
    .long 0x0, 0x0, 0xf149f2ca, 0xf149f2ca
    .long 0x0, 0x0, 0x0, 0xf149f2ca
    .long 0x0, 0x0, 0x0, 0x0
    .long 0x0, 0x0, 0x0, 0x0
    .long 0x0, 0x0, 0x0, 0x0
    .long 0x0, 0x0, 0x0, 0x0
    .long 0x0, 0x0, 0x0, 0x0
    .long 0x0, 0x0, 0x0, 0x0
    .long 0x0, 0x0, 0x0, 0x0
    .long 0x0, 0x0, 0x0, 0x0
    .long 0x0, 0x0, 0x0, 0x0
    .long 0x0, 0x0, 0x0, 0x0
    .long 0x0, 0x0, 0x0, 0x0
    .long 0x0, 0x0, 0x0, 0x0
    .long 0x0, 0x0, 0x0, 0x0
    .long 0x0, 0x0, 0x0, 0x0
    .long 0x0, 0x0, 0x0, 0x0
    .long 0x0, 0x0, 0x0, 0x0
    .long 0x0, 0x0, 0x0, 0x0
    .long 0x0, 0x0, 0x0, 0x0
    .long 0x0, 0x0, 0x0, 0x0
    .long 0x0, 0x0, 0x0, 0x0
    .long 0x0, 0x0, 0x0, 0x0
    .long 0xf149f2ca, 0xf149f2ca, 0xf149f2ca, 0xf149f2ca
    .long 0xf149f2ca, 0xf149f2ca, 0xf149f2ca, 0xf149f2ca
    .long 0xf149f2ca, 0xf149f2ca, 0xf149f2ca, 0xf149f2ca
    .long 0xf149f2ca, 0xf149f2ca, 0xf149f2ca, 0xf149f2ca
    .long 0xf149f2ca, 0xf149f2ca, 0xf149f2ca, 0xf149f2ca
    .long 0xf149f2ca, 0xf149f2ca, 0xf149f2ca, 0xf149f2ca
    .long 0xf149f2ca, 0xf149f2ca, 0xf149f2ca, 0xf149f2ca
    .long 0xf149f2ca, 0xf149f2ca, 0xf149f2ca, 0xf149f2ca
    .long 0xf149f2ca, 0xf149f2ca, 0xf149f2ca, 0xf149f2ca
    .long 0xf149f2ca, 0xf149f2ca, 0xf149f2ca, 0xf149f2ca
    .long 0xf149f2ca, 0xf149f2ca, 0xf149f2ca, 0xf149f2ca
    .long 0xf149f2ca, 0xf149f2ca, 0xf149f2ca, 0xf149f2ca
    .long 0x0, 0xf149f2ca, 0xf149f2ca, 0xf149f2ca
    .long 0x0, 0x0, 0xf149f2ca, 0xf149f2ca
    .long 0x0, 0x0, 0x0, 0xf149f2ca
    .long 0x0, 0x0, 0x0, 0x0
    .long 0x0, 0x0, 0x0, 0x0
    .long 0x0, 0x0, 0x0, 0x0
    .long 0x0, 0x0, 0x0, 0x0
    .long 0x0, 0x0, 0x0, 0x0
    .long 0x0, 0x0, 0x0, 0x0
    .long 0x0, 0x0, 0x0, 0x0
    .long 0x0, 0x0, 0x0, 0x0
    .long 0x0, 0x0, 0x0, 0x0
    .long 0x0, 0x0, 0x0, 0x0
    .long 0x0, 0x0, 0x0, 0x0
    .long 0x0, 0x0, 0x0, 0x0
    .long 0x0, 0x0, 0x0, 0x0
    .long 0x0, 0x0, 0x0, 0x0
    .long 0x0, 0x0, 0x0, 0x0
    .long 0x0, 0x0, 0x0, 0x0
    .long 0x0, 0x0, 0x0, 0x0
    .long 0xf149f2ca, 0xf149f2ca, 0xf149f2ca, 0xf149f2ca
    .long 0xf149f2ca, 0xf149f2ca, 0xf149f2ca, 0xf149f2ca
    .long 0xf149f2ca, 0xf149f2ca, 0xf149f2ca, 0xf149f2ca
    .long 0xf149f2ca, 0xf149f2ca, 0xf149f2ca, 0xf149f2ca
    .long 0xf149f2ca, 0xf149f2ca, 0xf149f2ca, 0xf149f2ca
    .long 0xf149f2ca, 0xf149f2ca, 0xf149f2ca, 0xf149f2ca
    .long 0xf149f2ca, 0xf149f2ca, 0xf149f2ca, 0xf149f2ca
    .long 0xf149f2ca, 0xf149f2ca, 0xf149f2ca, 0xf149f2ca
    .long 0xf149f2ca, 0xf149f2ca, 0xf149f2ca, 0xf149f2ca
    .long 0xf149f2ca, 0xf149f2ca, 0xf149f2ca, 0xf149f2ca
    .long 0xf149f2ca, 0xf149f2ca, 0xf149f2ca, 0xf149f2ca
    .long 0xf149f2ca, 0xf149f2ca, 0xf149f2ca, 0xf149f2ca
    .long 0xf149f2ca, 0xf149f2ca, 0xf149f2ca, 0xf149f2ca
    .long 0xf149f2ca, 0xf149f2ca, 0xf149f2ca, 0xf149f2ca
    .long 0xf149f2ca, 0xf149f2ca, 0xf149f2ca, 0xf149f2ca
    .long 0xf149f2ca, 0xf149f2ca, 0xf149f2ca, 0xf149f2ca
    .long 0x0, 0xf149f2ca, 0xf149f2ca, 0xf149f2ca
    .long 0x0, 0x0, 0xf149f2ca, 0xf149f2ca
    .long 0x0, 0x0, 0x0, 0xf149f2ca
    .long 0x0, 0x0, 0x0, 0x0
    .long 0x0, 0x0, 0x0, 0x0
    .long 0x0, 0x0, 0x0, 0x0
    .long 0x0, 0x0, 0x0, 0x0
    .long 0x0, 0x0, 0x0, 0x0
    .long 0x0, 0x0, 0x0, 0x0
    .long 0x0, 0x0, 0x0, 0x0
    .long 0x0, 0x0, 0x0, 0x0
    .long 0x0, 0x0, 0x0, 0x0
    .long 0x0, 0x0, 0x0, 0x0
    .long 0x0, 0x0, 0x0, 0x0
    .long 0x0, 0x0, 0x0, 0x0
    .long 0x0, 0x0, 0x0, 0x0
    .long 0xf149f2ca, 0xf149f2ca, 0xf149f2ca, 0xf149f2ca
    .long 0xf149f2ca, 0xf149f2ca, 0xf149f2ca, 0xf149f2ca
    .long 0xf149f2ca, 0xf149f2ca, 0xf149f2ca, 0xf149f2ca
    .long 0xf149f2ca, 0xf149f2ca, 0xf149f2ca, 0xf149f2ca
    .long 0xf149f2ca, 0xf149f2ca, 0xf149f2ca, 0xf149f2ca
    .long 0xf149f2ca, 0xf149f2ca, 0xf149f2ca, 0xf149f2ca
    .long 0xf149f2ca, 0xf149f2ca, 0xf149f2ca, 0xf149f2ca
    .long 0xf149f2ca, 0xf149f2ca, 0xf149f2ca, 0xf149f2ca
    .long 0xf149f2ca, 0xf149f2ca, 0xf149f2ca, 0xf149f2ca
    .long 0xf149f2ca, 0xf149f2ca, 0xf149f2ca, 0xf149f2ca
    .long 0xf149f2ca, 0xf149f2ca, 0xf149f2ca, 0xf149f2ca
    .long 0xf149f2ca, 0xf149f2ca, 0xf149f2ca, 0xf149f2ca
    .long 0xf149f2ca, 0xf149f2ca, 0xf149f2ca, 0xf149f2ca
    .long 0xf149f2ca, 0xf149f2ca, 0xf149f2ca, 0xf149f2ca
    .long 0xf149f2ca, 0xf149f2ca, 0xf149f2ca, 0xf149f2ca
    .long 0xf149f2ca, 0xf149f2ca, 0xf149f2ca, 0xf149f2ca
    .long 0xf149f2ca, 0xf149f2ca, 0xf149f2ca, 0xf149f2ca
    .long 0xf149f2ca, 0xf149f2ca, 0xf149f2ca, 0xf149f2ca
    .long 0xf149f2ca, 0xf149f2ca, 0xf149f2ca, 0xf149f2ca
    .long 0xf149f2ca, 0xf149f2ca, 0xf149f2ca, 0xf149f2ca
    .long 0x0, 0xf149f2ca, 0xf149f2ca, 0xf149f2ca
    .long 0x0, 0x0, 0xf149f2ca, 0xf149f2ca
    .long 0x0, 0x0, 0x0, 0xf149f2ca
    .long 0x0, 0x0, 0x0, 0x0
    .long 0x0, 0x0, 0x0, 0x0
    .long 0x0, 0x0, 0x0, 0x0
    .long 0x0, 0x0, 0x0, 0x0
    .long 0x0, 0x0, 0x0, 0x0
    .long 0x0, 0x0, 0x0, 0x0
    .long 0x0, 0x0, 0x0, 0x0
    .long 0x0, 0x0, 0x0, 0x0
    .long 0x0, 0x0, 0x0, 0x0
    .long 0xf149f2ca, 0xf149f2ca, 0xf149f2ca, 0xf149f2ca
    .long 0xf149f2ca, 0xf149f2ca, 0xf149f2ca, 0xf149f2ca
    .long 0xf149f2ca, 0xf149f2ca, 0xf149f2ca, 0xf149f2ca
    .long 0xf149f2ca, 0xf149f2ca, 0xf149f2ca, 0xf149f2ca
    .long 0xf149f2ca, 0xf149f2ca, 0xf149f2ca, 0xf149f2ca
    .long 0xf149f2ca, 0xf149f2ca, 0xf149f2ca, 0xf149f2ca
    .long 0xf149f2ca, 0xf149f2ca, 0xf149f2ca, 0xf149f2ca
    .long 0xf149f2ca, 0xf149f2ca, 0xf149f2ca, 0xf149f2ca
    .long 0xf149f2ca, 0xf149f2ca, 0xf149f2ca, 0xf149f2ca
    .long 0xf149f2ca, 0xf149f2ca, 0xf149f2ca, 0xf149f2ca
    .long 0xf149f2ca, 0xf149f2ca, 0xf149f2ca, 0xf149f2ca
    .long 0xf149f2ca, 0xf149f2ca, 0xf149f2ca, 0xf149f2ca
    .long 0xf149f2ca, 0xf149f2ca, 0xf149f2ca, 0xf149f2ca
    .long 0xf149f2ca, 0xf149f2ca, 0xf149f2ca, 0xf149f2ca
    .long 0xf149f2ca, 0xf149f2ca, 0xf149f2ca, 0xf149f2ca
    .long 0xf149f2ca, 0xf149f2ca, 0xf149f2ca, 0xf149f2ca
    .long 0xf149f2ca, 0xf149f2ca, 0xf149f2ca, 0xf149f2ca
    .long 0xf149f2ca, 0xf149f2ca, 0xf149f2ca, 0xf149f2ca
    .long 0xf149f2ca, 0xf149f2ca, 0xf149f2ca, 0xf149f2ca
    .long 0xf149f2ca, 0xf149f2ca, 0xf149f2ca, 0xf149f2ca
    .long 0xf149f2ca, 0xf149f2ca, 0xf149f2ca, 0xf149f2ca
    .long 0xf149f2ca, 0xf149f2ca, 0xf149f2ca, 0xf149f2ca
    .long 0xf149f2ca, 0xf149f2ca, 0xf149f2ca, 0xf149f2ca
    .long 0xf149f2ca, 0xf149f2ca, 0xf149f2ca, 0xf149f2ca
    .long 0x0, 0xf149f2ca, 0xf149f2ca, 0xf149f2ca
    .long 0x0, 0x0, 0xf149f2ca, 0xf149f2ca
    .long 0x0, 0x0, 0x0, 0xf149f2ca
    .long 0x0, 0x0, 0x0, 0x0
    .long 0x0, 0x0, 0x0, 0x0
    .long 0x0, 0x0, 0x0, 0x0
    .long 0x0, 0x0, 0x0, 0x0
    .long 0x0, 0x0, 0x0, 0x0
    .long 0xf149f2ca, 0xf149f2ca, 0xf149f2ca, 0xf149f2ca
    .long 0xf149f2ca, 0xf149f2ca, 0xf149f2ca, 0xf149f2ca
    .long 0xf149f2ca, 0xf149f2ca, 0xf149f2ca, 0xf149f2ca
    .long 0xf149f2ca, 0xf149f2ca, 0xf149f2ca, 0xf149f2ca
    .long 0xf149f2ca, 0xf149f2ca, 0xf149f2ca, 0xf149f2ca
    .long 0xf149f2ca, 0xf149f2ca, 0xf149f2ca, 0xf149f2ca
    .long 0xf149f2ca, 0xf149f2ca, 0xf149f2ca, 0xf149f2ca
    .long 0xf149f2ca, 0xf149f2ca, 0xf149f2ca, 0xf149f2ca
    .long 0xf149f2ca, 0xf149f2ca, 0xf149f2ca, 0xf149f2ca
    .long 0xf149f2ca, 0xf149f2ca, 0xf149f2ca, 0xf149f2ca
    .long 0xf149f2ca, 0xf149f2ca, 0xf149f2ca, 0xf149f2ca
    .long 0xf149f2ca, 0xf149f2ca, 0xf149f2ca, 0xf149f2ca
    .long 0xf149f2ca, 0xf149f2ca, 0xf149f2ca, 0xf149f2ca
    .long 0xf149f2ca, 0xf149f2ca, 0xf149f2ca, 0xf149f2ca
    .long 0xf149f2ca, 0xf149f2ca, 0xf149f2ca, 0xf149f2ca
    .long 0xf149f2ca, 0xf149f2ca, 0xf149f2ca, 0xf149f2ca
    .long 0xf149f2ca, 0xf149f2ca, 0xf149f2ca, 0xf149f2ca
    .long 0xf149f2ca, 0xf149f2ca, 0xf149f2ca, 0xf149f2ca
    .long 0xf149f2ca, 0xf149f2ca, 0xf149f2ca, 0xf149f2ca
    .long 0xf149f2ca, 0xf149f2ca, 0xf149f2ca, 0xf149f2ca
    .long 0xf149f2ca, 0xf149f2ca, 0xf149f2ca, 0xf149f2ca
    .long 0xf149f2ca, 0xf149f2ca, 0xf149f2ca, 0xf149f2ca
    .long 0xf149f2ca, 0xf149f2ca, 0xf149f2ca, 0xf149f2ca
    .long 0xf149f2ca, 0xf149f2ca, 0xf149f2ca, 0xf149f2ca
    .long 0xf149f2ca, 0xf149f2ca, 0xf149f2ca, 0xf149f2ca
    .long 0xf149f2ca, 0xf149f2ca, 0xf149f2ca, 0xf149f2ca
    .long 0xf149f2ca, 0xf149f2ca, 0xf149f2ca, 0xf149f2ca
    .long 0xf149f2ca, 0xf149f2ca, 0xf149f2ca, 0xf149f2ca
    .long 0x0, 0xf149f2ca, 0xf149f2ca, 0xf149f2ca
    .long 0x0, 0x0, 0xf149f2ca, 0xf149f2ca
    .long 0x0, 0x0, 0x0, 0xf149f2ca
    .long 0x0, 0x0, 0x0, 0x0
    .long 0xf149f2ca, 0x0, 0x0, 0x0
    .long 0xf149f2ca, 0xf149f2ca, 0x0, 0x0
    .long 0xf149f2ca, 0xf149f2ca, 0xf149f2ca, 0x0
    .long 0xf149f2ca, 0xf149f2ca, 0xf149f2ca, 0xf149f2ca
    .long 0xf149f2ca, 0xf149f2ca, 0xf149f2ca, 0xf149f2ca
    .long 0xf149f2ca, 0xf149f2ca, 0xf149f2ca, 0xf149f2ca
    .long 0xf149f2ca, 0xf149f2ca, 0xf149f2ca, 0xf149f2ca
    .long 0xf149f2ca, 0xf149f2ca, 0xf149f2ca, 0xf149f2ca
    .long 0xf149f2ca, 0xf149f2ca, 0xf149f2ca, 0xf149f2ca
    .long 0xf149f2ca, 0xf149f2ca, 0xf149f2ca, 0xf149f2ca
    .long 0xf149f2ca, 0xf149f2ca, 0xf149f2ca, 0xf149f2ca
    .long 0xf149f2ca, 0xf149f2ca, 0xf149f2ca, 0xf149f2ca
    .long 0xf149f2ca, 0xf149f2ca, 0xf149f2ca, 0xf149f2ca
    .long 0xf149f2ca, 0xf149f2ca, 0xf149f2ca, 0xf149f2ca
    .long 0xf149f2ca, 0xf149f2ca, 0xf149f2ca, 0xf149f2ca
    .long 0xf149f2ca, 0xf149f2ca, 0xf149f2ca, 0xf149f2ca
    .long 0xf149f2ca, 0xf149f2ca, 0xf149f2ca, 0xf149f2ca
    .long 0xf149f2ca, 0xf149f2ca, 0xf149f2ca, 0xf149f2ca
    .long 0xf149f2ca, 0xf149f2ca, 0xf149f2ca, 0xf149f2ca
    .long 0xf149f2ca, 0xf149f2ca, 0xf149f2ca, 0xf149f2ca
    .long 0xf149f2ca, 0xf149f2ca, 0xf149f2ca, 0xf149f2ca
    .long 0xf149f2ca, 0xf149f2ca, 0xf149f2ca, 0xf149f2ca
    .long 0xf149f2ca, 0xf149f2ca, 0xf149f2ca, 0xf149f2ca
    .long 0xf149f2ca, 0xf149f2ca, 0xf149f2ca, 0xf149f2ca
    .long 0xf149f2ca, 0xf149f2ca, 0xf149f2ca, 0xf149f2ca
    .long 0xf149f2ca, 0xf149f2ca, 0xf149f2ca, 0xf149f2ca
    .long 0xf149f2ca, 0xf149f2ca, 0xf149f2ca, 0xf149f2ca
    .long 0xf149f2ca, 0xf149f2ca, 0xf149f2ca, 0xf149f2ca
    .long 0xf149f2ca, 0xf149f2ca, 0xf149f2ca, 0xf149f2ca
    .long 0xf149f2ca, 0xf149f2ca, 0xf149f2ca, 0xf149f2ca
    .long 0xf149f2ca, 0xf149f2ca, 0xf149f2ca, 0xf149f2ca
    .long 0xf149f2ca, 0xf149f2ca, 0xf149f2ca, 0xf149f2ca
    .long 0x0, 0x0, 0x0, 0x0
    .long 0x0, 0x0, 0x0, 0x0
    .long 0x0, 0x0, 0x0, 0x0
    .long 0x0, 0x0, 0x0, 0x0
    .long 0xf149f2ca, 0x0, 0x0, 0x0
    .long 0xf149f2ca, 0xf149f2ca, 0x0, 0x0
    .long 0xf149f2ca, 0xf149f2ca, 0xf149f2ca, 0x0
    .long 0xf149f2ca, 0xf149f2ca, 0xf149f2ca, 0xf149f2ca
    .long 0xf149f2ca, 0xf149f2ca, 0xf149f2ca, 0xf149f2ca
    .long 0xf149f2ca, 0xf149f2ca, 0xf149f2ca, 0xf149f2ca
    .long 0xf149f2ca, 0xf149f2ca, 0xf149f2ca, 0xf149f2ca
    .long 0xf149f2ca, 0xf149f2ca, 0xf149f2ca, 0xf149f2ca
    .long 0xf149f2ca, 0xf149f2ca, 0xf149f2ca, 0xf149f2ca
    .long 0xf149f2ca, 0xf149f2ca, 0xf149f2ca, 0xf149f2ca
    .long 0xf149f2ca, 0xf149f2ca, 0xf149f2ca, 0xf149f2ca
    .long 0xf149f2ca, 0xf149f2ca, 0xf149f2ca, 0xf149f2ca
    .long 0xf149f2ca, 0xf149f2ca, 0xf149f2ca, 0xf149f2ca
    .long 0xf149f2ca, 0xf149f2ca, 0xf149f2ca, 0xf149f2ca
    .long 0xf149f2ca, 0xf149f2ca, 0xf149f2ca, 0xf149f2ca
    .long 0xf149f2ca, 0xf149f2ca, 0xf149f2ca, 0xf149f2ca
    .long 0xf149f2ca, 0xf149f2ca, 0xf149f2ca, 0xf149f2ca
    .long 0xf149f2ca, 0xf149f2ca, 0xf149f2ca, 0xf149f2ca
    .long 0xf149f2ca, 0xf149f2ca, 0xf149f2ca, 0xf149f2ca
    .long 0xf149f2ca, 0xf149f2ca, 0xf149f2ca, 0xf149f2ca
    .long 0xf149f2ca, 0xf149f2ca, 0xf149f2ca, 0xf149f2ca
    .long 0xf149f2ca, 0xf149f2ca, 0xf149f2ca, 0xf149f2ca
    .long 0xf149f2ca, 0xf149f2ca, 0xf149f2ca, 0xf149f2ca
    .long 0xf149f2ca, 0xf149f2ca, 0xf149f2ca, 0xf149f2ca
    .long 0xf149f2ca, 0xf149f2ca, 0xf149f2ca, 0xf149f2ca
    .long 0xf149f2ca, 0xf149f2ca, 0xf149f2ca, 0xf149f2ca
    .long 0xf149f2ca, 0xf149f2ca, 0xf149f2ca, 0xf149f2ca
    .long 0xf149f2ca, 0xf149f2ca, 0xf149f2ca, 0xf149f2ca
    .long 0x0, 0x0, 0x0, 0x0
    .long 0x0, 0x0, 0x0, 0x0
    .long 0x0, 0x0, 0x0, 0x0
    .long 0x0, 0x0, 0x0, 0x0
    .long 0x0, 0x0, 0x0, 0x0
    .long 0x0, 0x0, 0x0, 0x0
    .long 0x0, 0x0, 0x0, 0x0
    .long 0x0, 0x0, 0x0, 0x0
    .long 0xf149f2ca, 0x0, 0x0, 0x0
    .long 0xf149f2ca, 0xf149f2ca, 0x0, 0x0
    .long 0xf149f2ca, 0xf149f2ca, 0xf149f2ca, 0x0
    .long 0xf149f2ca, 0xf149f2ca, 0xf149f2ca, 0xf149f2ca
    .long 0xf149f2ca, 0xf149f2ca, 0xf149f2ca, 0xf149f2ca
    .long 0xf149f2ca, 0xf149f2ca, 0xf149f2ca, 0xf149f2ca
    .long 0xf149f2ca, 0xf149f2ca, 0xf149f2ca, 0xf149f2ca
    .long 0xf149f2ca, 0xf149f2ca, 0xf149f2ca, 0xf149f2ca
    .long 0xf149f2ca, 0xf149f2ca, 0xf149f2ca, 0xf149f2ca
    .long 0xf149f2ca, 0xf149f2ca, 0xf149f2ca, 0xf149f2ca
    .long 0xf149f2ca, 0xf149f2ca, 0xf149f2ca, 0xf149f2ca
    .long 0xf149f2ca, 0xf149f2ca, 0xf149f2ca, 0xf149f2ca
    .long 0xf149f2ca, 0xf149f2ca, 0xf149f2ca, 0xf149f2ca
    .long 0xf149f2ca, 0xf149f2ca, 0xf149f2ca, 0xf149f2ca
    .long 0xf149f2ca, 0xf149f2ca, 0xf149f2ca, 0xf149f2ca
    .long 0xf149f2ca, 0xf149f2ca, 0xf149f2ca, 0xf149f2ca
    .long 0xf149f2ca, 0xf149f2ca, 0xf149f2ca, 0xf149f2ca
    .long 0xf149f2ca, 0xf149f2ca, 0xf149f2ca, 0xf149f2ca
    .long 0xf149f2ca, 0xf149f2ca, 0xf149f2ca, 0xf149f2ca
    .long 0xf149f2ca, 0xf149f2ca, 0xf149f2ca, 0xf149f2ca
    .long 0xf149f2ca, 0xf149f2ca, 0xf149f2ca, 0xf149f2ca
    .long 0xf149f2ca, 0xf149f2ca, 0xf149f2ca, 0xf149f2ca
    .long 0xf149f2ca, 0xf149f2ca, 0xf149f2ca, 0xf149f2ca
    .long 0xf149f2ca, 0xf149f2ca, 0xf149f2ca, 0xf149f2ca
    .long 0x0, 0x0, 0x0, 0x0
    .long 0x0, 0x0, 0x0, 0x0
    .long 0x0, 0x0, 0x0, 0x0
    .long 0x0, 0x0, 0x0, 0x0
    .long 0x0, 0x0, 0x0, 0x0
    .long 0x0, 0x0, 0x0, 0x0
    .long 0x0, 0x0, 0x0, 0x0
    .long 0x0, 0x0, 0x0, 0x0
    .long 0x0, 0x0, 0x0, 0x0
    .long 0x0, 0x0, 0x0, 0x0
    .long 0x0, 0x0, 0x0, 0x0
    .long 0x0, 0x0, 0x0, 0x0
    .long 0xf149f2ca, 0x0, 0x0, 0x0
    .long 0xf149f2ca, 0xf149f2ca, 0x0, 0x0
    .long 0xf149f2ca, 0xf149f2ca, 0xf149f2ca, 0x0
    .long 0xf149f2ca, 0xf149f2ca, 0xf149f2ca, 0xf149f2ca
    .long 0xf149f2ca, 0xf149f2ca, 0xf149f2ca, 0xf149f2ca
    .long 0xf149f2ca, 0xf149f2ca, 0xf149f2ca, 0xf149f2ca
    .long 0xf149f2ca, 0xf149f2ca, 0xf149f2ca, 0xf149f2ca
    .long 0xf149f2ca, 0xf149f2ca, 0xf149f2ca, 0xf149f2ca
    .long 0xf149f2ca, 0xf149f2ca, 0xf149f2ca, 0xf149f2ca
    .long 0xf149f2ca, 0xf149f2ca, 0xf149f2ca, 0xf149f2ca
    .long 0xf149f2ca, 0xf149f2ca, 0xf149f2ca, 0xf149f2ca
    .long 0xf149f2ca, 0xf149f2ca, 0xf149f2ca, 0xf149f2ca
    .long 0xf149f2ca, 0xf149f2ca, 0xf149f2ca, 0xf149f2ca
    .long 0xf149f2ca, 0xf149f2ca, 0xf149f2ca, 0xf149f2ca
    .long 0xf149f2ca, 0xf149f2ca, 0xf149f2ca, 0xf149f2ca
    .long 0xf149f2ca, 0xf149f2ca, 0xf149f2ca, 0xf149f2ca
    .long 0xf149f2ca, 0xf149f2ca, 0xf149f2ca, 0xf149f2ca
    .long 0xf149f2ca, 0xf149f2ca, 0xf149f2ca, 0xf149f2ca
    .long 0xf149f2ca, 0xf149f2ca, 0xf149f2ca, 0xf149f2ca
    .long 0xf149f2ca, 0xf149f2ca, 0xf149f2ca, 0xf149f2ca
    .long 0x0, 0x0, 0x0, 0x0
    .long 0x0, 0x0, 0x0, 0x0
    .long 0x0, 0x0, 0x0, 0x0
    .long 0x0, 0x0, 0x0, 0x0
    .long 0x0, 0x0, 0x0, 0x0
    .long 0x0, 0x0, 0x0, 0x0
    .long 0x0, 0x0, 0x0, 0x0
    .long 0x0, 0x0, 0x0, 0x0
    .long 0x0, 0x0, 0x0, 0x0
    .long 0x0, 0x0, 0x0, 0x0
    .long 0x0, 0x0, 0x0, 0x0
    .long 0x0, 0x0, 0x0, 0x0
    .long 0x0, 0x0, 0x0, 0x0
    .long 0x0, 0x0, 0x0, 0x0
    .long 0x0, 0x0, 0x0, 0x0
    .long 0x0, 0x0, 0x0, 0x0
    .long 0xf149f2ca, 0x0, 0x0, 0x0
    .long 0xf149f2ca, 0xf149f2ca, 0x0, 0x0
    .long 0xf149f2ca, 0xf149f2ca, 0xf149f2ca, 0x0
    .long 0xf149f2ca, 0xf149f2ca, 0xf149f2ca, 0xf149f2ca
    .long 0xf149f2ca, 0xf149f2ca, 0xf149f2ca, 0xf149f2ca
    .long 0xf149f2ca, 0xf149f2ca, 0xf149f2ca, 0xf149f2ca
    .long 0xf149f2ca, 0xf149f2ca, 0xf149f2ca, 0xf149f2ca
    .long 0xf149f2ca, 0xf149f2ca, 0xf149f2ca, 0xf149f2ca
    .long 0xf149f2ca, 0xf149f2ca, 0xf149f2ca, 0xf149f2ca
    .long 0xf149f2ca, 0xf149f2ca, 0xf149f2ca, 0xf149f2ca
    .long 0xf149f2ca, 0xf149f2ca, 0xf149f2ca, 0xf149f2ca
    .long 0xf149f2ca, 0xf149f2ca, 0xf149f2ca, 0xf149f2ca
    .long 0xf149f2ca, 0xf149f2ca, 0xf149f2ca, 0xf149f2ca
    .long 0xf149f2ca, 0xf149f2ca, 0xf149f2ca, 0xf149f2ca
    .long 0xf149f2ca, 0xf149f2ca, 0xf149f2ca, 0xf149f2ca
    .long 0xf149f2ca, 0xf149f2ca, 0xf149f2ca, 0xf149f2ca
    .long 0x0, 0x0, 0x0, 0x0
    .long 0x0, 0x0, 0x0, 0x0
    .long 0x0, 0x0, 0x0, 0x0
    .long 0x0, 0x0, 0x0, 0x0
    .long 0x0, 0x0, 0x0, 0x0
    .long 0x0, 0x0, 0x0, 0x0
    .long 0x0, 0x0, 0x0, 0x0
    .long 0x0, 0x0, 0x0, 0x0
    .long 0x0, 0x0, 0x0, 0x0
    .long 0x0, 0x0, 0x0, 0x0
    .long 0x0, 0x0, 0x0, 0x0
    .long 0x0, 0x0, 0x0, 0x0
    .long 0x0, 0x0, 0x0, 0x0
    .long 0x0, 0x0, 0x0, 0x0
    .long 0x0, 0x0, 0x0, 0x0
    .long 0x0, 0x0, 0x0, 0x0
    .long 0x0, 0x0, 0x0, 0x0
    .long 0x0, 0x0, 0x0, 0x0
    .long 0x0, 0x0, 0x0, 0x0
    .long 0x0, 0x0, 0x0, 0x0
    .long 0xf149f2ca, 0x0, 0x0, 0x0
    .long 0xf149f2ca, 0xf149f2ca, 0x0, 0x0
    .long 0xf149f2ca, 0xf149f2ca, 0xf149f2ca, 0x0
    .long 0xf149f2ca, 0xf149f2ca, 0xf149f2ca, 0xf149f2ca
    .long 0xf149f2ca, 0xf149f2ca, 0xf149f2ca, 0xf149f2ca
    .long 0xf149f2ca, 0xf149f2ca, 0xf149f2ca, 0xf149f2ca
    .long 0xf149f2ca, 0xf149f2ca, 0xf149f2ca, 0xf149f2ca
    .long 0xf149f2ca, 0xf149f2ca, 0xf149f2ca, 0xf149f2ca
    .long 0xf149f2ca, 0xf149f2ca, 0xf149f2ca, 0xf149f2ca
    .long 0xf149f2ca, 0xf149f2ca, 0xf149f2ca, 0xf149f2ca
    .long 0xf149f2ca, 0xf149f2ca, 0xf149f2ca, 0xf149f2ca
    .long 0xf149f2ca, 0xf149f2ca, 0xf149f2ca, 0xf149f2ca
    .long 0x0, 0x0, 0x0, 0x0
    .long 0x0, 0x0, 0x0, 0x0
    .long 0x0, 0x0, 0x0, 0x0
    .long 0x0, 0x0, 0x0, 0x0
    .long 0x0, 0x0, 0x0, 0x0
    .long 0x0, 0x0, 0x0, 0x0
    .long 0x0, 0x0, 0x0, 0x0
    .long 0x0, 0x0, 0x0, 0x0
    .long 0x0, 0x0, 0x0, 0x0
    .long 0x0, 0x0, 0x0, 0x0
    .long 0x0, 0x0, 0x0, 0x0
    .long 0x0, 0x0, 0x0, 0x0
    .long 0x0, 0x0, 0x0, 0x0
    .long 0x0, 0x0, 0x0, 0x0
    .long 0x0, 0x0, 0x0, 0x0
    .long 0x0, 0x0, 0x0, 0x0
    .long 0x0, 0x0, 0x0, 0x0
    .long 0x0, 0x0, 0x0, 0x0
    .long 0x0, 0x0, 0x0, 0x0
    .long 0x0, 0x0, 0x0, 0x0
    .long 0x0, 0x0, 0x0, 0x0
    .long 0x0, 0x0, 0x0, 0x0
    .long 0x0, 0x0, 0x0, 0x0
    .long 0x0, 0x0, 0x0, 0x0
    .long 0xf149f2ca, 0x0, 0x0, 0x0
    .long 0xf149f2ca, 0xf149f2ca, 0x0, 0x0
    .long 0xf149f2ca, 0xf149f2ca, 0xf149f2ca, 0x0
    .long 0xf149f2ca, 0xf149f2ca, 0xf149f2ca, 0xf149f2ca
    .long 0xf149f2ca, 0xf149f2ca, 0xf149f2ca, 0xf149f2ca
    .long 0xf149f2ca, 0xf149f2ca, 0xf149f2ca, 0xf149f2ca
    .long 0xf149f2ca, 0xf149f2ca, 0xf149f2ca, 0xf149f2ca
    .long 0xf149f2ca, 0xf149f2ca, 0xf149f2ca, 0xf149f2ca
    .long 0x0, 0x0, 0x0, 0x0
    .long 0x0, 0x0, 0x0, 0x0
    .long 0x0, 0x0, 0x0, 0x0
    .long 0x0, 0x0, 0x0, 0x0
    .long 0x0, 0x0, 0x0, 0x0
    .long 0x0, 0x0, 0x0, 0x0
    .long 0x0, 0x0, 0x0, 0x0
    .long 0x0, 0x0, 0x0, 0x0
    .long 0x0, 0x0, 0x0, 0x0
    .long 0x0, 0x0, 0x0, 0x0
    .long 0x0, 0x0, 0x0, 0x0
    .long 0x0, 0x0, 0x0, 0x0
    .long 0x0, 0x0, 0x0, 0x0
    .long 0x0, 0x0, 0x0, 0x0
    .long 0x0, 0x0, 0x0, 0x0
    .long 0x0, 0x0, 0x0, 0x0
    .long 0x0, 0x0, 0x0, 0x0
    .long 0x0, 0x0, 0x0, 0x0
    .long 0x0, 0x0, 0x0, 0x0
    .long 0x0, 0x0, 0x0, 0x0
    .long 0x0, 0x0, 0x0, 0x0
    .long 0x0, 0x0, 0x0, 0x0
    .long 0x0, 0x0, 0x0, 0x0
    .long 0x0, 0x0, 0x0, 0x0
    .long 0x0, 0x0, 0x0, 0x0
    .long 0x0, 0x0, 0x0, 0x0
    .long 0x0, 0x0, 0x0, 0x0
    .long 0x0, 0x0, 0x0, 0x0
    .long 0xf149f2ca, 0x0, 0x0, 0x0
    .long 0xf149f2ca, 0xf149f2ca, 0x0, 0x0
    .long 0xf149f2ca, 0xf149f2ca, 0xf149f2ca, 0x0
    .long 0xf149f2ca, 0xf149f2ca, 0xf149f2ca, 0xf149f2ca
.size L_masks, 8192
.section .rodata,"a"
.p2align 6
.amdhsa_kernel recurrent_scan__sliding_block__glu_gated_bilinear__prompt_kernel
  .amdhsa_next_free_vgpr 512
  .amdhsa_next_free_sgpr 102
  .amdhsa_accum_offset 256
  .amdhsa_group_segment_fixed_size 0
  .amdhsa_kernarg_size 80
  .amdhsa_user_sgpr_count 2
  .amdhsa_user_sgpr_kernarg_segment_ptr 1
  .amdhsa_system_sgpr_workgroup_id_x 1
.end_amdhsa_kernel
```
